```python
import torch

def _softmax(x, axis=-1):
    return torch.softmax(x, dim=axis)
def _gelu(x):
    return torch.nn.functional.gelu(x, approximate="tanh")
def _silu(x):
    return torch.nn.functional.silu(x)
def _sigmoid(x):
    return torch.sigmoid(x)
def _layernorm(x, axis=-1, eps=1e-5):
    m = x.mean(dim=axis, keepdim=True)
    v = x.var(dim=axis, keepdim=True, unbiased=False)
    return (x - m) / torch.sqrt(v + eps)
def _scatter_add(tgt, idx, src, axis=0):
    return tgt.clone().index_add_(axis, idx, src)
def _segment_sum(src, seg, n):
    out = torch.zeros((n,) + src.shape[1:], dtype=src.dtype)
    return out.index_add_(0, seg, src)
def _pad(x, pw):
    flat = tuple(v for pair in reversed(pw) for v in pair)
    return torch.nn.functional.pad(x, flat)

kernel_name = 'concat_heads__gqa_block_cached__mha_block_cached__near_ridge'

def setup_inputs():

    _w = (lambda a: (lambda t: t.to(torch.bfloat16) if t.is_floating_point() else t)(torch.as_tensor(a)))
    def _A_setup():
        B, Sq, D = 16, 96, 448
        Hq, Hkv, Sk, Dh = 16, 8, 1024, 256
        assert Hq % Hkv == 0, (Hq, Hkv)
        return {
            "x": _w((lambda *s: torch.randn(*s, dtype=torch.bfloat16) * 0.8)(B, Sq, D)),
            "k_cache": _w((lambda *s: torch.randn(*s, dtype=torch.bfloat16) * 0.8)(B, Hkv, Sk, Dh)),
            "v_cache": _w((lambda *s: torch.randn(*s, dtype=torch.bfloat16) * 0.05)(B, Hkv, Sk, Dh)),
            "wq": _w((lambda *s: torch.randn(*s, dtype=torch.bfloat16) * 0.8)(D, Hq * Dh) * (D ** -0.5)),
            "wo": _w((lambda *s: torch.randn(*s, dtype=torch.bfloat16) * 0.05)(Hq * Dh, D) * ((Hq * Dh) ** -0.5)),
        }
    _A_in = _A_setup()

    def _B_setup():
        B, Sq, D = 16, 96, 448
        H, Sk, Dh = 16, 1024, 256
        return {
            "x": _w((lambda *s: torch.randn(*s, dtype=torch.bfloat16) * 0.8)(B, Sq, D)),
            "k_cache": _w((lambda *s: torch.randn(*s, dtype=torch.bfloat16) * 0.8)(B, H, Sk, Dh)),
            "v_cache": _w((lambda *s: torch.randn(*s, dtype=torch.bfloat16) * 0.05)(B, H, Sk, Dh)),
            "wq": _w((lambda *s: torch.randn(*s, dtype=torch.bfloat16) * 0.8)(D, H * Dh) * (D ** -0.5)),
            "wo": _w((lambda *s: torch.randn(*s, dtype=torch.bfloat16) * 0.05)(H * Dh, D) * ((H * Dh) ** -0.5)),
        }
    _B_in = _B_setup()

    return {
        "A_x": _A_in["x"],
        "A_k_cache": _A_in["k_cache"],
        "A_v_cache": _A_in["v_cache"],
        "A_wq": _A_in["wq"],
        "A_wo": _A_in["wo"],
        "B_x": _B_in["x"],
        "B_k_cache": _B_in["k_cache"],
        "B_v_cache": _B_in["v_cache"],
        "B_wq": _B_in["wq"],
        "B_wo": _B_in["wo"],
    }

def reference(A_x, A_k_cache, A_v_cache, A_wq, A_wo, B_x, B_k_cache, B_v_cache, B_wq, B_wo):
    def _A_ref(x, k_cache, v_cache, wq, wo):
        B, Sq, D = x.shape
        Hq, Dh = 16, 256
        Hkv = k_cache.shape[1]
        rep = Hq // Hkv
        q = (lambda x, *d: x.permute(*d))((x @ wq).reshape(B, Sq, Hq, Dh), 0, 2, 1, 3)
        k = (lambda x, n, axis: torch.repeat_interleave(x, n, dim=axis))(k_cache, rep, axis=1)
        v = (lambda x, n, axis: torch.repeat_interleave(x, n, dim=axis))(v_cache, rep, axis=1)
        scores = torch.einsum("bhqd,bhkd->bhqk", q, k) * (Dh ** -0.5)
        p = _softmax(scores, axis=-1)
        o = torch.einsum("bhqk,bhkd->bhqd", p, v)
        return (lambda x, *d: x.permute(*d))(o, 0, 2, 1, 3).reshape(B, Sq, Hq * Dh) @ wo

    def _B_ref(x, k_cache, v_cache, wq, wo):
        B, Sq, D = x.shape
        H, Dh = 16, 256
        q = (lambda x, *d: x.permute(*d))((x @ wq).reshape(B, Sq, H, Dh), 0, 2, 1, 3)
        scores = torch.einsum("bhqd,bhkd->bhqk", q, k_cache) * (Dh ** -0.5)
        p = _softmax(scores, axis=-1)
        o = torch.einsum("bhqk,bhkd->bhqd", p, v_cache)
        return (lambda x, *d: x.permute(*d))(o, 0, 2, 1, 3).reshape(B, Sq, H * Dh) @ wo

    a = _A_ref(A_x, A_k_cache, A_v_cache, A_wq, A_wo)
    b = _B_ref(B_x, B_k_cache, B_v_cache, B_wq, B_wo)
    return torch.concatenate([a, b], axis=-1)
```

```asm
; @launch grid=(256,1,1) block=(256,1,1) lds=163840
.amdgcn_target "amdgcn-amd-amdhsa--gfx950"
.macro MM p0,p1,p2,p3
 v_mfma_f32_16x16x32_bf16 \p0, \p1, \p2, \p3
.endm
.macro TR p0,p1,p2
 ds_read_b64_tr_b16 \p0, \p1 offset:\p2
.endm
.macro CV p0,p1,p2
 v_cvt_pk_bf16_f32 \p0, \p1, \p2
.endm
.macro AR p0,p1
 v_accvgpr_read_b32 \p0, \p1
.endm
.macro AW p0,p1
 v_accvgpr_write_b32 \p0, \p1
.endm
.text
.globl concat_heads__gqa_block_cached__mha_block_cached__near_ridge_kernel
.p2align 8
.type concat_heads__gqa_block_cached__mha_block_cached__near_ridge_kernel,@function
concat_heads__gqa_block_cached__mha_block_cached__near_ridge_kernel:
 s_cmp_lt_u32 s2, 256
 s_cbranch_scc1 L_go
L_end0:
 s_endpgm
L_go:
 s_load_dwordx16 s[4:19], s[0:1], 0
 s_load_dwordx4 s[20:23], s[0:1], 64
 s_load_dwordx4 s[24:27], s[0:1], 80
 s_load_dwordx2 s[30:31], s[0:1], 96
 s_getpc_b64 s[98:99]
L_pc:
 s_lshr_b32 s3, s2, 4
 s_lshl_b32 s3, s3, 14
 v_lshl_add_u32 v255, v0, 7, s3
 v_min_u32 v255, L_codeend-L_pc-4, v255
 v_readfirstlane_b32 s28, v0
 s_and_b32 s3, s2, 8
 s_nop 0
 s_and_b32 s28, s28, 128
 s_or_b32 s3, s3, s28
 s_cbranch_scc1 L_nopf
 global_load_dword a250, v255, s[98:99]
L_nopf:
 v_lshrrev_b32 v2, 6, v0
 v_and_b32 v1, 63, v0
 v_readfirstlane_b32 s28, v2
 s_and_b32 s85, s2, 7
 s_lshr_b32 s86, s2, 4
 s_bfe_u32 s3, s2, 0x10003
 s_lshr_b32 s29, s28, 1
 s_and_b32 s87, s28, 1
 s_lshl_b32 s88, s87, 1
 s_cmp_eq_u32 s3, 1
 s_cselect_b32 s88, s88, s28
 v_mov_b32 v2, s88
 s_mul_i32 s89, s88, 4224
 s_add_u32 s90, s89, 16896
 s_add_u32 s91, s89, 33792
 s_add_u32 s92, s89, 50688
 s_add_u32 s93, s89, 67584
 s_add_u32 s94, s89, 84480
 s_add_u32 s95, s89, 101376
 s_add_u32 s96, s89, 118272
 s_add_u32 s97, s89, 135168
 s_mov_b32 s82, 0x3db8aa3b
 v_and_b32 v3, 15, v1
 v_lshrrev_b32 v16, 3, v1
 v_and_b32 v17, 7, v1
 v_xor_b32 v17, v17, v16
 s_mul_i32 s88, s28, 24
 v_add_u32 v16, s88, v16
 v_mul_u32_u24 v16, 896, v16
 v_lshl_add_u32 v247, v17, 4, v16
 v_add_u32 v248, 6144, v247
 v_add_u32 v249, 12288, v247
 v_lshrrev_b32 v17, 4, v1
 v_and_b32 v16, 7, v1
 v_bfe_u32 v18, v1, 3, 1
 s_mul_i32 s88, s87, 6
 v_add_u32 v18, s88, v18
 v_lshlrev_b32 v18, 10, v18
 v_lshl_add_u32 v18, v16, 7, v18
 v_xor_b32 v19, v17, v16
 v_lshl_add_u32 v253, v19, 4, v18
 v_xor_b32 v254, 64, v253
 v_lshrrev_b32 v18, 5, v1
 v_lshlrev_b32 v18, 15, v18
 v_lshl_add_u32 v18, v2, 16, v18
 v_and_b32 v19, 31, v1
 v_lshl_add_u32 v18, v19, 4, v18
 v_add_u32 v8, 512, v18
 v_add_u32 v9, 7648, v18
 v_add_u32 v10, 14784, v18
 v_add_u32 v11, 21920, v18
 v_lshlrev_b32 v250, 4, v1
 v_lshl_add_u32 v18, v2, 12, v250
 v_add_u32 v4, 512, v18
 v_add_u32 v5, 480, v18
 v_add_u32 v6, 448, v18
 v_add_u32 v7, 416, v18
 v_lshrrev_b32 v18, 3, v1
 v_lshlrev_b32 v18, 4, v18
 v_lshl_add_u32 v18, v2, 2, v18
 v_mul_u32_u24 v18, 896, v18
 v_and_b32 v19, 7, v1
 v_lshl_add_u32 v18, v19, 4, v18
 v_add_u32 v240, 512, v18
 v_add_u32 v241, 352, v18
 v_add_u32 v242, 192, v18
 v_add_u32 v243, 32, v18
 v_mul_u32_u24 v18, 1056, v3
 v_lshl_add_u32 v12, v17, 4, v18
 v_add_u32 v13, 67584, v12
 v_lshrrev_b32 v18, 2, v1
 v_mul_u32_u24 v18, 1056, v18
 v_and_b32 v19, 3, v1
 v_lshl_add_u32 v14, v19, 3, v18
 v_add_u32 v15, 67584, v14
 v_mov_b32 v251, v14
 v_mov_b32 v252, v15
 s_waitcnt lgkmcnt(0)
 s_lshl_b32 s88, s3, 1
 s_and_b32 s88, s88, s28
 s_cmp_eq_u32 s88, 2
 s_cbranch_scc1 L_typeB1
 s_cmp_eq_u32 s3, 1
 s_cbranch_scc1 L_typeB0
 s_mul_i32 s88, s86, 86016
 s_add_u32 s56, s4, s88
 s_addc_u32 s57, s5, 0
 s_mov_b32 s58, 86016
 s_mov_b32 s59, 0x20000
 s_lshl_b32 s88, s85, 10
 s_add_u32 s48, s10, s88
 s_addc_u32 s49, s11, 0
 s_sub_u32 s48, s48, 512
 s_subb_u32 s49, s49, 0
 s_sub_u32 s50, 3670528, s88
 s_mov_b32 s51, 0x20000
 s_lshl_b32 s88, s85, 10
 s_add_u32 s88, s88, 512
 s_add_u32 s52, s10, s88
 s_addc_u32 s53, s11, 0
 s_sub_u32 s52, s52, 512
 s_subb_u32 s53, s53, 0
 s_sub_u32 s54, 3670528, s88
 s_mov_b32 s55, 0x20000
 s_mul_i32 s88, s86, 7
 s_lshr_b32 s88, s88, 4
 s_lshl_b32 s76, s88, 19
 s_mov_b32 s77, s76
 s_lshr_b32 s78, s76, 12
 s_mul_i32 s79, s28, 3072
 s_add_u32 s79, s79, 101376
 s_add_u32 m0, s79, 0
 s_nop 0
 buffer_load_dwordx4 v247, s[56:59], s78 offen offset:0 lds
 buffer_load_dwordx4 v248, s[56:59], s78 offen offset:1024 lds
 buffer_load_dwordx4 v249, s[56:59], s78 offen offset:2048 lds
 s_add_u32 s78, s78, 128
 s_cmp_eq_u32 s78, 896
 s_cselect_b32 s78, 0, s78
 s_mov_b32 m0, s91
 s_nop 0
 buffer_load_dwordx4 v8, s[48:51], s76 offen offset:0 lds
 buffer_load_dwordx4 v9, s[48:51], s76 offen offset:1056 lds
 buffer_load_dwordx4 v10, s[48:51], s76 offen offset:2112 lds
 buffer_load_dwordx4 v11, s[48:51], s76 offen offset:3168 lds
 s_add_u32 s76, s76, 262144
 s_cmp_eq_u32 s76, 3670016
 s_cselect_b32 s76, 0, s76
 s_mov_b32 m0, s92
 s_nop 0
 buffer_load_dwordx4 v8, s[52:55], s77 offen offset:0 lds
 buffer_load_dwordx4 v9, s[52:55], s77 offen offset:1056 lds
 buffer_load_dwordx4 v10, s[52:55], s77 offen offset:2112 lds
 buffer_load_dwordx4 v11, s[52:55], s77 offen offset:3168 lds
 s_add_u32 s77, s77, 262144
 s_cmp_eq_u32 s77, 3670016
 s_cselect_b32 s77, 0, s77
 s_lshl_b32 s88, s86, 3
 s_add_u32 s88, s88, s85
 s_lshl_b32 s88, s88, 19
 s_add_u32 s32, s6, s88
 s_addc_u32 s33, s7, 0
 s_sub_u32 s32, s32, 512
 s_subb_u32 s33, s33, 0
 s_mov_b32 s34, 524800
 s_mov_b32 s35, 0x20000
 s_add_u32 s40, s8, s88
 s_addc_u32 s41, s9, 0
 s_sub_u32 s40, s40, 512
 s_subb_u32 s41, s41, 0
 s_mov_b32 s42, 524800
 s_mov_b32 s43, 0x20000
 s_mov_b32 s72, 0
 s_mov_b32 s73, 0
 s_mov_b32 s74, 0
 s_mov_b32 s75, 0
 s_mul_i32 s88, s85, 458752
 s_add_u32 s64, s12, s88
 s_addc_u32 s65, s13, 0
 s_sub_u32 s64, s64, 512
 s_subb_u32 s65, s65, 0
 s_mov_b32 s66, 459264
 s_mov_b32 s67, 0x20000
 s_mul_i32 s88, s85, 458752
 s_add_u32 s88, s88, 229376
 s_add_u32 s68, s12, s88
 s_addc_u32 s69, s13, 0
 s_sub_u32 s68, s68, 512
 s_subb_u32 s69, s69, 0
 s_mov_b32 s70, 229888
 s_mov_b32 s71, 0x20000
 s_lshl_b32 s88, s86, 3
 s_add_u32 s88, s88, s85
 s_mul_i32 s88, s88, 86016
 s_mul_i32 s23, s87, 43008
 s_add_u32 s88, s88, s23
 s_add_u32 s60, s30, s88
 s_addc_u32 s61, s31, 0
 s_mov_b32 s62, 43008
 s_mov_b32 s63, 0x20000
 s_mov_b32 s5, s86
 s_lshl_b32 s6, s85, 2
 s_add_u32 s6, s6, s28
 s_lshl_b32 s4, s86, 3
 s_mul_i32 s23, s86, 7
 s_lshr_b32 s23, s23, 4
 s_lshl_b32 s80, s23, 7
 s_mul_i32 s83, s23, 6144
 s_mul_i32 s88, s29, 3072
 s_add_u32 s83, s83, s88
 s_mul_i32 s88, s29, 16896
 v_add_u32 v251, s88, v251
 v_add_u32 v252, s88, v252
 v_and_b32 v16, 7, v0
 s_lshl_b32 s88, s86, 10
 s_add_u32 s88, s88, 50331648
 s_lshl_b32 s23, s85, 7
 s_add_u32 s23, s23, s88
 v_lshl_add_u32 v17, v16, 2, s23
 global_load_dword a254, v17, s[30:31] sc1
 s_lshl_b32 s23, s85, 2
 s_add_u32 s23, s23, s88
 v_lshl_add_u32 v17, v16, 7, s23
 global_load_dword a253, v17, s[30:31] sc1
 v_add_u32 v253, 101376, v253
 v_add_u32 v254, 101376, v254
 s_waitcnt vmcnt(2)
 s_barrier
 ds_read_b128 a[0:3], v253 offset:0
 ds_read_b128 a[4:7], v253 offset:2048
 ds_read_b128 a[8:11], v253 offset:4096
 ds_read_b128 a[12:15], v254 offset:0
 ds_read_b128 a[16:19], v254 offset:2048
 ds_read_b128 a[20:23], v254 offset:4096
 TR v[208:209],v251,33792
 TR v[210:211],v251,34304
 TR v[212:213],v251,33824
 TR v[214:215],v251,34336
 TR v[216:217],v251,33856
 TR v[218:219],v251,34368
 s_waitcnt lgkmcnt(4)
 TR v[220:221],v251,33888
 MM v[16:19],v[208:211],a[0:3],0
 TR v[222:223],v251,34400
 MM v[20:23],v[208:211],a[4:7],0
 TR v[224:225],v251,33920
 MM v[24:27],v[208:211],a[8:11],0
 s_waitcnt lgkmcnt(5)
 s_mov_b32 m0, s93
 TR v[226:227],v251,34432
 MM v[28:31],v[212:215],a[0:3],0
 buffer_load_dwordx4 v8, s[48:51], s76 offen offset:0 lds
 MM v[32:35],v[212:215],a[4:7],0
 TR v[228:229],v251,33952
 buffer_load_dwordx4 v9, s[48:51], s76 offen offset:1056 lds
 MM v[36:39],v[212:215],a[8:11],0
 s_waitcnt lgkmcnt(3)
 TR v[230:231],v251,34464
 buffer_load_dwordx4 v10, s[48:51], s76 offen offset:2112 lds
 MM v[40:43],v[216:219],a[0:3],0
 TR v[232:233],v251,33984
 MM v[44:47],v[216:219],a[4:7],0
 TR v[234:235],v251,34496
 MM v[48:51],v[216:219],a[8:11],0
 buffer_load_dwordx4 v11, s[48:51], s76 offen offset:3168 lds
 MM v[52:55],v[220:223],a[0:3],0
 s_add_u32 s76, s76, 262144
 s_cmp_eq_u32 s76, 3670016
 s_cselect_b32 s76, 0, s76
 TR v[236:237],v251,34016
 MM v[56:59],v[220:223],a[4:7],0
 TR v[238:239],v251,34528
 MM v[60:63],v[220:223],a[8:11],0
 s_waitcnt lgkmcnt(4)
 TR v[208:209],v251,34048
 MM v[64:67],v[224:227],a[0:3],0
 s_mov_b32 m0, s94
 TR v[210:211],v251,34560
 MM v[68:71],v[224:227],a[4:7],0
 buffer_load_dwordx4 v8, s[52:55], s77 offen offset:0 lds
 MM v[72:75],v[224:227],a[8:11],0
 TR v[212:213],v251,34080
 buffer_load_dwordx4 v9, s[52:55], s77 offen offset:1056 lds
 MM v[76:79],v[228:231],a[0:3],0
 TR v[214:215],v251,34592
 MM v[80:83],v[228:231],a[4:7],0
 TR v[216:217],v251,34112
 MM v[84:87],v[228:231],a[8:11],0
 s_waitcnt lgkmcnt(5)
 buffer_load_dwordx4 v10, s[52:55], s77 offen offset:2112 lds
 MM v[88:91],v[232:235],a[0:3],0
 TR v[218:219],v251,34624
 buffer_load_dwordx4 v11, s[52:55], s77 offen offset:3168 lds
 MM v[92:95],v[232:235],a[4:7],0
 s_add_u32 s77, s77, 262144
 s_cmp_eq_u32 s77, 3670016
 s_cselect_b32 s77, 0, s77
 TR v[220:221],v251,34144
 MM v[96:99],v[232:235],a[8:11],0
 TR v[222:223],v251,34656
 MM v[100:103],v[236:239],a[0:3],0
 s_add_u32 m0, s79, 12288
 TR v[224:225],v251,34176
 MM v[104:107],v[236:239],a[4:7],0
 buffer_load_dwordx4 v247, s[56:59], s78 offen offset:0 lds
 MM v[108:111],v[236:239],a[8:11],0
 s_waitcnt lgkmcnt(5)
 TR v[226:227],v251,34688
 buffer_load_dwordx4 v248, s[56:59], s78 offen offset:1024 lds
 MM v[112:115],v[208:211],a[0:3],0
 TR v[228:229],v251,34208
 buffer_load_dwordx4 v249, s[56:59], s78 offen offset:2048 lds
 MM v[116:119],v[208:211],a[4:7],0
 s_add_u32 s78, s78, 128
 s_cmp_eq_u32 s78, 896
 s_cselect_b32 s78, 0, s78
 TR v[230:231],v251,34720
 MM v[120:123],v[208:211],a[8:11],0
 s_add_u32 m0, s79, 24576
 TR v[232:233],v251,34240
 MM v[124:127],v[212:215],a[0:3],0
 buffer_load_dwordx4 v247, s[56:59], s78 offen offset:0 lds
 MM v[128:131],v[212:215],a[4:7],0
 TR v[234:235],v251,34752
 buffer_load_dwordx4 v248, s[56:59], s78 offen offset:1024 lds
 MM v[132:135],v[212:215],a[8:11],0
 s_waitcnt lgkmcnt(6)
 TR v[236:237],v251,34272
 MM v[136:139],v[216:219],a[0:3],0
 TR v[238:239],v251,34784
 MM v[140:143],v[216:219],a[4:7],0
 buffer_load_dwordx4 v249, s[56:59], s78 offen offset:2048 lds
 MM v[144:147],v[216:219],a[8:11],0
 s_add_u32 s78, s78, 128
 s_cmp_eq_u32 s78, 896
 s_cselect_b32 s78, 0, s78
 MM v[148:151],v[220:223],a[0:3],0
 s_mov_b32 m0, s89
 MM v[152:155],v[220:223],a[4:7],0
 buffer_load_dwordx4 v8, s[48:51], s76 offen offset:0 lds
 MM v[156:159],v[220:223],a[8:11],0
 s_waitcnt lgkmcnt(6)
 buffer_load_dwordx4 v9, s[48:51], s76 offen offset:1056 lds
 MM v[160:163],v[224:227],a[0:3],0
 buffer_load_dwordx4 v10, s[48:51], s76 offen offset:2112 lds
 MM v[164:167],v[224:227],a[4:7],0
 buffer_load_dwordx4 v11, s[48:51], s76 offen offset:3168 lds
 MM v[168:171],v[224:227],a[8:11],0
 s_waitcnt lgkmcnt(0) vmcnt(10)
 s_barrier
 s_add_u32 s76, s76, 262144
 s_cmp_eq_u32 s76, 3670016
 s_cselect_b32 s76, 0, s76
 TR v[208:209],v252,0
 MM v[172:175],v[228:231],a[0:3],0
 s_mov_b32 m0, s90
 TR v[210:211],v252,512
 MM v[176:179],v[228:231],a[4:7],0
 buffer_load_dwordx4 v8, s[52:55], s77 offen offset:0 lds
 MM v[180:183],v[228:231],a[8:11],0
 TR v[212:213],v252,32
 buffer_load_dwordx4 v9, s[52:55], s77 offen offset:1056 lds
 MM v[184:187],v[232:235],a[0:3],0
 TR v[214:215],v252,544
 buffer_load_dwordx4 v10, s[52:55], s77 offen offset:2112 lds
 MM v[188:191],v[232:235],a[4:7],0
 buffer_load_dwordx4 v11, s[52:55], s77 offen offset:3168 lds
 MM v[192:195],v[232:235],a[8:11],0
 s_add_u32 s77, s77, 262144
 s_cmp_eq_u32 s77, 3670016
 s_cselect_b32 s77, 0, s77
 TR v[216:217],v252,64
 MM v[196:199],v[236:239],a[0:3],0
 TR v[218:219],v252,576
 MM v[200:203],v[236:239],a[4:7],0
 MM v[204:207],v[236:239],a[8:11],0
 s_waitcnt lgkmcnt(4)
 TR v[220:221],v252,96
 MM v[16:19],v[208:211],a[12:15],v[16:19]
 TR v[222:223],v252,608
 MM v[20:23],v[208:211],a[16:19],v[20:23]
 TR v[224:225],v252,128
 MM v[24:27],v[208:211],a[20:23],v[24:27]
 s_waitcnt lgkmcnt(5)
 s_add_u32 m0, s79, 36864
 TR v[226:227],v252,640
 MM v[28:31],v[212:215],a[12:15],v[28:31]
 buffer_load_dwordx4 v247, s[56:59], s78 offen offset:0 lds
 MM v[32:35],v[212:215],a[16:19],v[32:35]
 TR v[228:229],v252,160
 buffer_load_dwordx4 v248, s[56:59], s78 offen offset:1024 lds
 MM v[36:39],v[212:215],a[20:23],v[36:39]
 s_waitcnt lgkmcnt(3)
 TR v[230:231],v252,672
 buffer_load_dwordx4 v249, s[56:59], s78 offen offset:2048 lds
 MM v[40:43],v[216:219],a[12:15],v[40:43]
 s_add_u32 s78, s78, 128
 s_cmp_eq_u32 s78, 896
 s_cselect_b32 s78, 0, s78
 TR v[232:233],v252,192
 MM v[44:47],v[216:219],a[16:19],v[44:47]
 s_add_u32 m0, s79, 49152
 TR v[234:235],v252,704
 MM v[48:51],v[216:219],a[20:23],v[48:51]
 buffer_load_dwordx4 v247, s[56:59], s78 offen offset:0 lds
 MM v[52:55],v[220:223],a[12:15],v[52:55]
 TR v[236:237],v252,224
 MM v[56:59],v[220:223],a[16:19],v[56:59]
 TR v[238:239],v252,736
 buffer_load_dwordx4 v248, s[56:59], s78 offen offset:1024 lds
 MM v[60:63],v[220:223],a[20:23],v[60:63]
 s_waitcnt lgkmcnt(4)
 TR v[208:209],v252,256
 MM v[64:67],v[224:227],a[12:15],v[64:67]
 TR v[210:211],v252,768
 MM v[68:71],v[224:227],a[16:19],v[68:71]
 buffer_load_dwordx4 v249, s[56:59], s78 offen offset:2048 lds
 MM v[72:75],v[224:227],a[20:23],v[72:75]
 s_add_u32 s78, s78, 128
 s_cmp_eq_u32 s78, 896
 s_cselect_b32 s78, 0, s78
 TR v[212:213],v252,288
 MM v[76:79],v[228:231],a[12:15],v[76:79]
 TR v[214:215],v252,800
 MM v[80:83],v[228:231],a[16:19],v[80:83]
 s_mov_b32 m0, s91
 TR v[216:217],v252,320
 MM v[84:87],v[228:231],a[20:23],v[84:87]
 s_waitcnt lgkmcnt(5)
 buffer_load_dwordx4 v8, s[48:51], s76 offen offset:0 lds
 MM v[88:91],v[232:235],a[12:15],v[88:91]
 TR v[218:219],v252,832
 buffer_load_dwordx4 v9, s[48:51], s76 offen offset:1056 lds
 MM v[92:95],v[232:235],a[16:19],v[92:95]
 TR v[220:221],v252,352
 MM v[96:99],v[232:235],a[20:23],v[96:99]
 TR v[222:223],v252,864
 MM v[100:103],v[236:239],a[12:15],v[100:103]
 TR v[224:225],v252,384
 MM v[104:107],v[236:239],a[16:19],v[104:107]
 buffer_load_dwordx4 v10, s[48:51], s76 offen offset:2112 lds
 MM v[108:111],v[236:239],a[20:23],v[108:111]
 s_waitcnt lgkmcnt(5)
 TR v[226:227],v252,896
 buffer_load_dwordx4 v11, s[48:51], s76 offen offset:3168 lds
 MM v[112:115],v[208:211],a[12:15],v[112:115]
 s_add_u32 s76, s76, 262144
 s_cmp_eq_u32 s76, 3670016
 s_cselect_b32 s76, 0, s76
 TR v[228:229],v252,416
 MM v[116:119],v[208:211],a[16:19],v[116:119]
 TR v[230:231],v252,928
 MM v[120:123],v[208:211],a[20:23],v[120:123]
 s_mov_b32 m0, s92
 TR v[232:233],v252,448
 MM v[124:127],v[212:215],a[12:15],v[124:127]
 buffer_load_dwordx4 v8, s[52:55], s77 offen offset:0 lds
 MM v[128:131],v[212:215],a[16:19],v[128:131]
 TR v[234:235],v252,960
 buffer_load_dwordx4 v9, s[52:55], s77 offen offset:1056 lds
 MM v[132:135],v[212:215],a[20:23],v[132:135]
 s_waitcnt lgkmcnt(6)
 TR v[236:237],v252,480
 MM v[136:139],v[216:219],a[12:15],v[136:139]
 TR v[238:239],v252,992
 MM v[140:143],v[216:219],a[16:19],v[140:143]
 buffer_load_dwordx4 v10, s[52:55], s77 offen offset:2112 lds
 MM v[144:147],v[216:219],a[20:23],v[144:147]
 MM v[148:151],v[220:223],a[12:15],v[148:151]
 buffer_load_dwordx4 v11, s[52:55], s77 offen offset:3168 lds
 MM v[152:155],v[220:223],a[16:19],v[152:155]
 s_add_u32 s77, s77, 262144
 s_cmp_eq_u32 s77, 3670016
 s_cselect_b32 s77, 0, s77
 MM v[156:159],v[220:223],a[20:23],v[156:159]
 s_waitcnt lgkmcnt(6)
 MM v[160:163],v[224:227],a[12:15],v[160:163]
 MM v[164:167],v[224:227],a[16:19],v[164:167]
 MM v[168:171],v[224:227],a[20:23],v[168:171]
 s_waitcnt lgkmcnt(0) vmcnt(14)
 s_barrier
 TR v[208:209],v251,0
 MM v[172:175],v[228:231],a[12:15],v[172:175]
 TR v[210:211],v251,512
 ds_read_b128 a[24:27], v253 offset:12288
 ds_read_b128 a[28:31], v253 offset:14336
 MM v[176:179],v[228:231],a[16:19],v[176:179]
 ds_read_b128 a[32:35], v253 offset:16384
 ds_read_b128 a[36:39], v254 offset:12288
 ds_read_b128 a[40:43], v254 offset:14336
 MM v[180:183],v[228:231],a[20:23],v[180:183]
 TR v[212:213],v251,32
 ds_read_b128 a[44:47], v254 offset:16384
 MM v[184:187],v[232:235],a[12:15],v[184:187]
 TR v[214:215],v251,544
 MM v[188:191],v[232:235],a[16:19],v[188:191]
 MM v[192:195],v[232:235],a[20:23],v[192:195]
 TR v[216:217],v251,64
 MM v[196:199],v[236:239],a[12:15],v[196:199]
 TR v[218:219],v251,576
 MM v[200:203],v[236:239],a[16:19],v[200:203]
 MM v[204:207],v[236:239],a[20:23],v[204:207]
 s_waitcnt lgkmcnt(10)
 s_waitcnt lgkmcnt(3)
 TR v[220:221],v251,96
 MM v[16:19],v[208:211],a[24:27],v[16:19]
 TR v[222:223],v251,608
 ds_read_b128 a[48:51], v253 offset:24576
 MM v[20:23],v[208:211],a[28:31],v[20:23]
 TR v[224:225],v251,128
 MM v[24:27],v[208:211],a[32:35],v[24:27]
 s_waitcnt lgkmcnt(6)
 s_mov_b32 m0, s93
 TR v[226:227],v251,640
 MM v[28:31],v[212:215],a[24:27],v[28:31]
 buffer_load_dwordx4 v8, s[48:51], s76 offen offset:0 lds
 MM v[32:35],v[212:215],a[28:31],v[32:35]
 TR v[228:229],v251,160
 buffer_load_dwordx4 v9, s[48:51], s76 offen offset:1056 lds
 MM v[36:39],v[212:215],a[32:35],v[36:39]
 s_waitcnt lgkmcnt(4)
 TR v[230:231],v251,672
 MM v[40:43],v[216:219],a[24:27],v[40:43]
 TR v[232:233],v251,192
 ds_read_b128 a[52:55], v253 offset:26624
 MM v[44:47],v[216:219],a[28:31],v[44:47]
 TR v[234:235],v251,704
 MM v[48:51],v[216:219],a[32:35],v[48:51]
 buffer_load_dwordx4 v10, s[48:51], s76 offen offset:2112 lds
 MM v[52:55],v[220:223],a[24:27],v[52:55]
 TR v[236:237],v251,224
 MM v[56:59],v[220:223],a[28:31],v[56:59]
 TR v[238:239],v251,736
 ds_read_b128 a[56:59], v253 offset:28672
 MM v[60:63],v[220:223],a[32:35],v[60:63]
 s_waitcnt lgkmcnt(6)
 TR v[208:209],v251,256
 MM v[64:67],v[224:227],a[24:27],v[64:67]
 TR v[210:211],v251,768
 MM v[68:71],v[224:227],a[28:31],v[68:71]
 buffer_load_dwordx4 v11, s[48:51], s76 offen offset:3168 lds
 MM v[72:75],v[224:227],a[32:35],v[72:75]
 s_add_u32 s76, s76, 262144
 s_cmp_eq_u32 s76, 3670016
 s_cselect_b32 s76, 0, s76
 TR v[212:213],v251,288
 MM v[76:79],v[228:231],a[24:27],v[76:79]
 TR v[214:215],v251,800
 ds_read_b128 a[60:63], v254 offset:24576
 MM v[80:83],v[228:231],a[28:31],v[80:83]
 s_mov_b32 m0, s94
 TR v[216:217],v251,320
 MM v[84:87],v[228:231],a[32:35],v[84:87]
 s_waitcnt lgkmcnt(7)
 buffer_load_dwordx4 v8, s[52:55], s77 offen offset:0 lds
 MM v[88:91],v[232:235],a[24:27],v[88:91]
 TR v[218:219],v251,832
 MM v[92:95],v[232:235],a[28:31],v[92:95]
 TR v[220:221],v251,352
 MM v[96:99],v[232:235],a[32:35],v[96:99]
 TR v[222:223],v251,864
 ds_read_b128 a[64:67], v254 offset:26624
 MM v[100:103],v[236:239],a[24:27],v[100:103]
 TR v[224:225],v251,384
 MM v[104:107],v[236:239],a[28:31],v[104:107]
 buffer_load_dwordx4 v9, s[52:55], s77 offen offset:1056 lds
 MM v[108:111],v[236:239],a[32:35],v[108:111]
 s_waitcnt lgkmcnt(7)
 TR v[226:227],v251,896
 MM v[112:115],v[208:211],a[24:27],v[112:115]
 TR v[228:229],v251,416
 ds_read_b128 a[68:71], v254 offset:28672
 MM v[116:119],v[208:211],a[28:31],v[116:119]
 TR v[230:231],v251,928
 MM v[120:123],v[208:211],a[32:35],v[120:123]
 TR v[232:233],v251,448
 MM v[124:127],v[212:215],a[24:27],v[124:127]
 buffer_load_dwordx4 v10, s[52:55], s77 offen offset:2112 lds
 MM v[128:131],v[212:215],a[28:31],v[128:131]
 TR v[234:235],v251,960
 MM v[132:135],v[212:215],a[32:35],v[132:135]
 s_waitcnt lgkmcnt(8)
 TR v[236:237],v251,480
 MM v[136:139],v[216:219],a[24:27],v[136:139]
 TR v[238:239],v251,992
 MM v[140:143],v[216:219],a[28:31],v[140:143]
 buffer_load_dwordx4 v11, s[52:55], s77 offen offset:3168 lds
 MM v[144:147],v[216:219],a[32:35],v[144:147]
 s_add_u32 s77, s77, 262144
 s_cmp_eq_u32 s77, 3670016
 s_cselect_b32 s77, 0, s77
 MM v[148:151],v[220:223],a[24:27],v[148:151]
 MM v[152:155],v[220:223],a[28:31],v[152:155]
 MM v[156:159],v[220:223],a[32:35],v[156:159]
 s_waitcnt lgkmcnt(7)
 MM v[160:163],v[224:227],a[24:27],v[160:163]
 MM v[164:167],v[224:227],a[28:31],v[164:167]
 MM v[168:171],v[224:227],a[32:35],v[168:171]
 s_waitcnt lgkmcnt(0) vmcnt(8)
 s_barrier
 TR v[208:209],v251,33792
 MM v[172:175],v[228:231],a[24:27],v[172:175]
 TR v[210:211],v251,34304
 MM v[176:179],v[228:231],a[28:31],v[176:179]
 MM v[180:183],v[228:231],a[32:35],v[180:183]
 TR v[212:213],v251,33824
 MM v[184:187],v[232:235],a[24:27],v[184:187]
 TR v[214:215],v251,34336
 MM v[188:191],v[232:235],a[28:31],v[188:191]
 MM v[192:195],v[232:235],a[32:35],v[192:195]
 TR v[216:217],v251,33856
 MM v[196:199],v[236:239],a[24:27],v[196:199]
 TR v[218:219],v251,34368
 MM v[200:203],v[236:239],a[28:31],v[200:203]
 MM v[204:207],v[236:239],a[32:35],v[204:207]
 s_waitcnt lgkmcnt(4)
 TR v[220:221],v251,33888
 ds_read_b128 a[72:75], v253 offset:36864
 MM v[16:19],v[208:211],a[36:39],v[16:19]
 TR v[222:223],v251,34400
 ds_read_b128 a[96:99], v253 offset:49152
 MM v[20:23],v[208:211],a[40:43],v[20:23]
 TR v[224:225],v251,33920
 v_mov_b32 v2, 0x3f803f80
 MM v[24:27],v[208:211],a[44:47],v[24:27]
 s_waitcnt lgkmcnt(7)
 s_mov_b32 m0, s89
 TR v[226:227],v251,34432
 MM v[28:31],v[212:215],a[36:39],v[28:31]
 buffer_load_dwordx4 v8, s[48:51], s76 offen offset:0 lds
 ds_read_b128 a[76:79], v253 offset:38912
 MM v[32:35],v[212:215],a[40:43],v[32:35]
 TR v[228:229],v251,33952
 buffer_load_dwordx4 v9, s[48:51], s76 offen offset:1056 lds
 MM v[36:39],v[212:215],a[44:47],v[36:39]
 s_waitcnt lgkmcnt(5)
 TR v[230:231],v251,34464
 ds_read_b128 a[100:103], v253 offset:51200
 MM v[40:43],v[216:219],a[36:39],v[40:43]
 TR v[232:233],v251,33984
 MM v[44:47],v[216:219],a[40:43],v[44:47]
 TR v[234:235],v251,34496
 MM v[48:51],v[216:219],a[44:47],v[48:51]
 buffer_load_dwordx4 v10, s[48:51], s76 offen offset:2112 lds
 ds_read_b128 a[80:83], v253 offset:40960
 MM v[52:55],v[220:223],a[36:39],v[52:55]
 TR v[236:237],v251,34016
 buffer_load_dwordx4 v11, s[48:51], s76 offen offset:3168 lds
 MM v[56:59],v[220:223],a[40:43],v[56:59]
 s_add_u32 s76, s76, 262144
 s_cmp_eq_u32 s76, 3670016
 s_cselect_b32 s76, 0, s76
 TR v[238:239],v251,34528
 MM v[60:63],v[220:223],a[44:47],v[60:63]
 s_waitcnt lgkmcnt(6)
 TR v[208:209],v251,34048
 ds_read_b128 a[104:107], v253 offset:53248
 MM v[64:67],v[224:227],a[36:39],v[64:67]
 s_mov_b32 m0, s90
 TR v[210:211],v251,34560
 MM v[68:71],v[224:227],a[40:43],v[68:71]
 buffer_load_dwordx4 v8, s[52:55], s77 offen offset:0 lds
 MM v[72:75],v[224:227],a[44:47],v[72:75]
 TR v[212:213],v251,34080
 ds_read_b128 a[84:87], v254 offset:36864
 MM v[76:79],v[228:231],a[36:39],v[76:79]
 TR v[214:215],v251,34592
 ds_read_b128 a[108:111], v254 offset:49152
 MM v[80:83],v[228:231],a[40:43],v[80:83]
 TR v[216:217],v251,34112
 MM v[84:87],v[228:231],a[44:47],v[84:87]
 s_waitcnt lgkmcnt(8)
 buffer_load_dwordx4 v9, s[52:55], s77 offen offset:1056 lds
 MM v[88:91],v[232:235],a[36:39],v[88:91]
 TR v[218:219],v251,34624
 buffer_load_dwordx4 v10, s[52:55], s77 offen offset:2112 lds
 MM v[92:95],v[232:235],a[40:43],v[92:95]
 TR v[220:221],v251,34144
 ds_read_b128 a[88:91], v254 offset:38912
 MM v[96:99],v[232:235],a[44:47],v[96:99]
 TR v[222:223],v251,34656
 ds_read_b128 a[112:115], v254 offset:51200
 MM v[100:103],v[236:239],a[36:39],v[100:103]
 TR v[224:225],v251,34176
 AW a204,v2
 MM v[104:107],v[236:239],a[40:43],v[104:107]
 buffer_load_dwordx4 v11, s[52:55], s77 offen offset:3168 lds
 MM v[108:111],v[236:239],a[44:47],v[108:111]
 s_waitcnt lgkmcnt(8)
 s_add_u32 s77, s77, 262144
 s_cmp_eq_u32 s77, 3670016
 s_cselect_b32 s77, 0, s77
 TR v[226:227],v251,34688
 MM v[112:115],v[208:211],a[36:39],v[112:115]
 TR v[228:229],v251,34208
 ds_read_b128 a[92:95], v254 offset:40960
 MM v[116:119],v[208:211],a[40:43],v[116:119]
 TR v[230:231],v251,34720
 ds_read_b128 a[116:119], v254 offset:53248
 MM v[120:123],v[208:211],a[44:47],v[120:123]
 s_mov_b32 m0, s95
 TR v[232:233],v251,34240
 MM v[124:127],v[212:215],a[36:39],v[124:127]
 buffer_load_dwordx4 v4, s[32:35], s72 offen offset:0 nt lds
 MM v[128:131],v[212:215],a[40:43],v[128:131]
 TR v[234:235],v251,34752
 buffer_load_dwordx4 v5, s[32:35], s72 offen offset:1056 nt lds
 MM v[132:135],v[212:215],a[44:47],v[132:135]
 s_waitcnt lgkmcnt(9)
 TR v[236:237],v251,34272
 MM v[136:139],v[216:219],a[36:39],v[136:139]
 TR v[238:239],v251,34784
 MM v[140:143],v[216:219],a[40:43],v[140:143]
 buffer_load_dwordx4 v6, s[32:35], s72 offen offset:2112 nt lds
 MM v[144:147],v[216:219],a[44:47],v[144:147]
 AW a205,v2
 MM v[148:151],v[220:223],a[36:39],v[148:151]
 buffer_load_dwordx4 v7, s[32:35], s72 offen offset:3168 nt lds
 MM v[152:155],v[220:223],a[40:43],v[152:155]
 s_add_u32 s72, s72, 16384
 MM v[156:159],v[220:223],a[44:47],v[156:159]
 s_waitcnt lgkmcnt(8)
 MM v[160:163],v[224:227],a[36:39],v[160:163]
 AW a206,v2
 MM v[164:167],v[224:227],a[40:43],v[164:167]
 MM v[168:171],v[224:227],a[44:47],v[168:171]
 s_waitcnt lgkmcnt(0) vmcnt(12)
 s_barrier
 TR v[208:209],v252,0
 MM v[172:175],v[228:231],a[36:39],v[172:175]
 TR v[210:211],v252,512
 MM v[176:179],v[228:231],a[40:43],v[176:179]
 MM v[180:183],v[228:231],a[44:47],v[180:183]
 TR v[212:213],v252,32
 AW a207,v2
 MM v[184:187],v[232:235],a[36:39],v[184:187]
 TR v[214:215],v252,544
 MM v[188:191],v[232:235],a[40:43],v[188:191]
 MM v[192:195],v[232:235],a[44:47],v[192:195]
 TR v[216:217],v252,64
 MM v[196:199],v[236:239],a[36:39],v[196:199]
 TR v[218:219],v252,576
 MM v[200:203],v[236:239],a[40:43],v[200:203]
 MM v[204:207],v[236:239],a[44:47],v[204:207]
 s_waitcnt lgkmcnt(4)
 TR v[220:221],v252,96
 MM v[16:19],v[208:211],a[48:51],v[16:19]
 TR v[222:223],v252,608
 MM v[20:23],v[208:211],a[52:55],v[20:23]
 TR v[224:225],v252,128
 MM v[24:27],v[208:211],a[56:59],v[24:27]
 s_waitcnt lgkmcnt(5)
 s_add_u32 m0, s79, 36864
 TR v[226:227],v252,640
 MM v[28:31],v[212:215],a[48:51],v[28:31]
 buffer_load_dwordx4 v247, s[56:59], s78 offen offset:0 lds
 MM v[32:35],v[212:215],a[52:55],v[32:35]
 TR v[228:229],v252,160
 buffer_load_dwordx4 v248, s[56:59], s78 offen offset:1024 lds
 MM v[36:39],v[212:215],a[56:59],v[36:39]
 s_waitcnt lgkmcnt(3)
 TR v[230:231],v252,672
 buffer_load_dwordx4 v249, s[56:59], s78 offen offset:2048 lds
 MM v[40:43],v[216:219],a[48:51],v[40:43]
 s_add_u32 s78, s78, 128
 s_cmp_eq_u32 s78, 896
 s_cselect_b32 s78, 0, s78
 TR v[232:233],v252,192
 MM v[44:47],v[216:219],a[52:55],v[44:47]
 s_add_u32 m0, s79, 49152
 TR v[234:235],v252,704
 MM v[48:51],v[216:219],a[56:59],v[48:51]
 buffer_load_dwordx4 v247, s[56:59], s78 offen offset:0 lds
 MM v[52:55],v[220:223],a[48:51],v[52:55]
 TR v[236:237],v252,224
 MM v[56:59],v[220:223],a[52:55],v[56:59]
 TR v[238:239],v252,736
 buffer_load_dwordx4 v248, s[56:59], s78 offen offset:1024 lds
 MM v[60:63],v[220:223],a[56:59],v[60:63]
 s_waitcnt lgkmcnt(4)
 TR v[208:209],v252,256
 MM v[64:67],v[224:227],a[48:51],v[64:67]
 TR v[210:211],v252,768
 MM v[68:71],v[224:227],a[52:55],v[68:71]
 buffer_load_dwordx4 v249, s[56:59], s78 offen offset:2048 lds
 MM v[72:75],v[224:227],a[56:59],v[72:75]
 s_add_u32 s78, s78, 128
 s_cmp_eq_u32 s78, 896
 s_cselect_b32 s78, 0, s78
 TR v[212:213],v252,288
 MM v[76:79],v[228:231],a[48:51],v[76:79]
 TR v[214:215],v252,800
 MM v[80:83],v[228:231],a[52:55],v[80:83]
 s_mov_b32 m0, s91
 TR v[216:217],v252,320
 MM v[84:87],v[228:231],a[56:59],v[84:87]
 s_waitcnt lgkmcnt(5)
 buffer_load_dwordx4 v8, s[48:51], s76 offen offset:0 lds
 MM v[88:91],v[232:235],a[48:51],v[88:91]
 TR v[218:219],v252,832
 buffer_load_dwordx4 v9, s[48:51], s76 offen offset:1056 lds
 MM v[92:95],v[232:235],a[52:55],v[92:95]
 TR v[220:221],v252,352
 MM v[96:99],v[232:235],a[56:59],v[96:99]
 TR v[222:223],v252,864
 MM v[100:103],v[236:239],a[48:51],v[100:103]
 TR v[224:225],v252,384
 MM v[104:107],v[236:239],a[52:55],v[104:107]
 buffer_load_dwordx4 v10, s[48:51], s76 offen offset:2112 lds
 MM v[108:111],v[236:239],a[56:59],v[108:111]
 s_waitcnt lgkmcnt(5)
 TR v[226:227],v252,896
 buffer_load_dwordx4 v11, s[48:51], s76 offen offset:3168 lds
 MM v[112:115],v[208:211],a[48:51],v[112:115]
 s_add_u32 s76, s76, 262144
 s_cmp_eq_u32 s76, 3670016
 s_cselect_b32 s76, 0, s76
 TR v[228:229],v252,416
 MM v[116:119],v[208:211],a[52:55],v[116:119]
 TR v[230:231],v252,928
 MM v[120:123],v[208:211],a[56:59],v[120:123]
 s_mov_b32 m0, s92
 TR v[232:233],v252,448
 MM v[124:127],v[212:215],a[48:51],v[124:127]
 buffer_load_dwordx4 v8, s[52:55], s77 offen offset:0 lds
 MM v[128:131],v[212:215],a[52:55],v[128:131]
 TR v[234:235],v252,960
 buffer_load_dwordx4 v9, s[52:55], s77 offen offset:1056 lds
 MM v[132:135],v[212:215],a[56:59],v[132:135]
 s_waitcnt lgkmcnt(6)
 TR v[236:237],v252,480
 MM v[136:139],v[216:219],a[48:51],v[136:139]
 TR v[238:239],v252,992
 MM v[140:143],v[216:219],a[52:55],v[140:143]
 buffer_load_dwordx4 v10, s[52:55], s77 offen offset:2112 lds
 MM v[144:147],v[216:219],a[56:59],v[144:147]
 MM v[148:151],v[220:223],a[48:51],v[148:151]
 buffer_load_dwordx4 v11, s[52:55], s77 offen offset:3168 lds
 MM v[152:155],v[220:223],a[52:55],v[152:155]
 s_add_u32 s77, s77, 262144
 s_cmp_eq_u32 s77, 3670016
 s_cselect_b32 s77, 0, s77
 MM v[156:159],v[220:223],a[56:59],v[156:159]
 s_waitcnt lgkmcnt(6)
 MM v[160:163],v[224:227],a[48:51],v[160:163]
 MM v[164:167],v[224:227],a[52:55],v[164:167]
 MM v[168:171],v[224:227],a[56:59],v[168:171]
 s_waitcnt lgkmcnt(0) vmcnt(18)
 s_barrier
 TR v[208:209],v251,0
 MM v[172:175],v[228:231],a[48:51],v[172:175]
 TR v[210:211],v251,512
 MM v[176:179],v[228:231],a[52:55],v[176:179]
 MM v[180:183],v[228:231],a[56:59],v[180:183]
 TR v[212:213],v251,32
 MM v[184:187],v[232:235],a[48:51],v[184:187]
 TR v[214:215],v251,544
 MM v[188:191],v[232:235],a[52:55],v[188:191]
 MM v[192:195],v[232:235],a[56:59],v[192:195]
 TR v[216:217],v251,64
 MM v[196:199],v[236:239],a[48:51],v[196:199]
 TR v[218:219],v251,576
 MM v[200:203],v[236:239],a[52:55],v[200:203]
 MM v[204:207],v[236:239],a[56:59],v[204:207]
 s_waitcnt lgkmcnt(4)
 TR v[220:221],v251,96
 MM v[16:19],v[208:211],a[60:63],v[16:19]
 TR v[222:223],v251,608
 MM v[20:23],v[208:211],a[64:67],v[20:23]
 TR v[224:225],v251,128
 MM v[24:27],v[208:211],a[68:71],v[24:27]
 s_waitcnt lgkmcnt(5)
 s_mov_b32 m0, s93
 TR v[226:227],v251,640
 MM v[28:31],v[212:215],a[60:63],v[28:31]
 buffer_load_dwordx4 v8, s[48:51], s76 offen offset:0 lds
 MM v[32:35],v[212:215],a[64:67],v[32:35]
 TR v[228:229],v251,160
 buffer_load_dwordx4 v9, s[48:51], s76 offen offset:1056 lds
 MM v[36:39],v[212:215],a[68:71],v[36:39]
 s_waitcnt lgkmcnt(3)
 TR v[230:231],v251,672
 MM v[40:43],v[216:219],a[60:63],v[40:43]
 TR v[232:233],v251,192
 MM v[44:47],v[216:219],a[64:67],v[44:47]
 TR v[234:235],v251,704
 MM v[48:51],v[216:219],a[68:71],v[48:51]
 buffer_load_dwordx4 v10, s[48:51], s76 offen offset:2112 lds
 MM v[52:55],v[220:223],a[60:63],v[52:55]
 TR v[236:237],v251,224
 buffer_load_dwordx4 v11, s[48:51], s76 offen offset:3168 lds
 MM v[56:59],v[220:223],a[64:67],v[56:59]
 s_add_u32 s76, s76, 262144
 s_cmp_eq_u32 s76, 3670016
 s_cselect_b32 s76, 0, s76
 TR v[238:239],v251,736
 MM v[60:63],v[220:223],a[68:71],v[60:63]
 s_waitcnt lgkmcnt(4)
 TR v[208:209],v251,256
 MM v[64:67],v[224:227],a[60:63],v[64:67]
 s_mov_b32 m0, s94
 TR v[210:211],v251,768
 MM v[68:71],v[224:227],a[64:67],v[68:71]
 buffer_load_dwordx4 v8, s[52:55], s77 offen offset:0 lds
 MM v[72:75],v[224:227],a[68:71],v[72:75]
 TR v[212:213],v251,288
 MM v[76:79],v[228:231],a[60:63],v[76:79]
 TR v[214:215],v251,800
 MM v[80:83],v[228:231],a[64:67],v[80:83]
 TR v[216:217],v251,320
 MM v[84:87],v[228:231],a[68:71],v[84:87]
 s_waitcnt lgkmcnt(5)
 buffer_load_dwordx4 v9, s[52:55], s77 offen offset:1056 lds
 MM v[88:91],v[232:235],a[60:63],v[88:91]
 TR v[218:219],v251,832
 buffer_load_dwordx4 v10, s[52:55], s77 offen offset:2112 lds
 MM v[92:95],v[232:235],a[64:67],v[92:95]
 TR v[220:221],v251,352
 MM v[96:99],v[232:235],a[68:71],v[96:99]
 TR v[222:223],v251,864
 MM v[100:103],v[236:239],a[60:63],v[100:103]
 TR v[224:225],v251,384
 MM v[104:107],v[236:239],a[64:67],v[104:107]
 buffer_load_dwordx4 v11, s[52:55], s77 offen offset:3168 lds
 MM v[108:111],v[236:239],a[68:71],v[108:111]
 s_waitcnt lgkmcnt(5)
 s_add_u32 s77, s77, 262144
 s_cmp_eq_u32 s77, 3670016
 s_cselect_b32 s77, 0, s77
 TR v[226:227],v251,896
 MM v[112:115],v[208:211],a[60:63],v[112:115]
 TR v[228:229],v251,416
 MM v[116:119],v[208:211],a[64:67],v[116:119]
 TR v[230:231],v251,928
 MM v[120:123],v[208:211],a[68:71],v[120:123]
 s_mov_b32 m0, s96
 TR v[232:233],v251,448
 MM v[124:127],v[212:215],a[60:63],v[124:127]
 buffer_load_dwordx4 v4, s[32:35], s72 offen offset:0 nt lds
 MM v[128:131],v[212:215],a[64:67],v[128:131]
 TR v[234:235],v251,960
 buffer_load_dwordx4 v5, s[32:35], s72 offen offset:1056 nt lds
 MM v[132:135],v[212:215],a[68:71],v[132:135]
 s_waitcnt lgkmcnt(6)
 TR v[236:237],v251,480
 MM v[136:139],v[216:219],a[60:63],v[136:139]
 TR v[238:239],v251,992
 MM v[140:143],v[216:219],a[64:67],v[140:143]
 buffer_load_dwordx4 v6, s[32:35], s72 offen offset:2112 nt lds
 MM v[144:147],v[216:219],a[68:71],v[144:147]
 MM v[148:151],v[220:223],a[60:63],v[148:151]
 buffer_load_dwordx4 v7, s[32:35], s72 offen offset:3168 nt lds
 MM v[152:155],v[220:223],a[64:67],v[152:155]
 s_add_u32 s72, s72, 16384
 MM v[156:159],v[220:223],a[68:71],v[156:159]
 s_waitcnt lgkmcnt(6)
 MM v[160:163],v[224:227],a[60:63],v[160:163]
 MM v[164:167],v[224:227],a[64:67],v[164:167]
 MM v[168:171],v[224:227],a[68:71],v[168:171]
 s_waitcnt lgkmcnt(0) vmcnt(12)
 s_barrier
 TR v[208:209],v251,33792
 MM v[172:175],v[228:231],a[60:63],v[172:175]
 TR v[210:211],v251,34304
 MM v[176:179],v[228:231],a[64:67],v[176:179]
 MM v[180:183],v[228:231],a[68:71],v[180:183]
 TR v[212:213],v251,33824
 MM v[184:187],v[232:235],a[60:63],v[184:187]
 TR v[214:215],v251,34336
 MM v[188:191],v[232:235],a[64:67],v[188:191]
 MM v[192:195],v[232:235],a[68:71],v[192:195]
 TR v[216:217],v251,33856
 MM v[196:199],v[236:239],a[60:63],v[196:199]
 TR v[218:219],v251,34368
 MM v[200:203],v[236:239],a[64:67],v[200:203]
 MM v[204:207],v[236:239],a[68:71],v[204:207]
 s_waitcnt lgkmcnt(4)
 TR v[220:221],v251,33888
 MM v[16:19],v[208:211],a[72:75],v[16:19]
 TR v[222:223],v251,34400
 MM v[20:23],v[208:211],a[76:79],v[20:23]
 TR v[224:225],v251,33920
 MM v[24:27],v[208:211],a[80:83],v[24:27]
 s_waitcnt lgkmcnt(5)
 s_mov_b32 m0, s89
 TR v[226:227],v251,34432
 MM v[28:31],v[212:215],a[72:75],v[28:31]
 buffer_load_dwordx4 v8, s[48:51], s76 offen offset:0 lds
 MM v[32:35],v[212:215],a[76:79],v[32:35]
 TR v[228:229],v251,33952
 buffer_load_dwordx4 v9, s[48:51], s76 offen offset:1056 lds
 MM v[36:39],v[212:215],a[80:83],v[36:39]
 s_waitcnt lgkmcnt(3)
 TR v[230:231],v251,34464
 MM v[40:43],v[216:219],a[72:75],v[40:43]
 TR v[232:233],v251,33984
 MM v[44:47],v[216:219],a[76:79],v[44:47]
 TR v[234:235],v251,34496
 MM v[48:51],v[216:219],a[80:83],v[48:51]
 buffer_load_dwordx4 v10, s[48:51], s76 offen offset:2112 lds
 MM v[52:55],v[220:223],a[72:75],v[52:55]
 TR v[236:237],v251,34016
 MM v[56:59],v[220:223],a[76:79],v[56:59]
 TR v[238:239],v251,34528
 MM v[60:63],v[220:223],a[80:83],v[60:63]
 s_waitcnt lgkmcnt(4)
 TR v[208:209],v251,34048
 MM v[64:67],v[224:227],a[72:75],v[64:67]
 TR v[210:211],v251,34560
 MM v[68:71],v[224:227],a[76:79],v[68:71]
 buffer_load_dwordx4 v11, s[48:51], s76 offen offset:3168 lds
 MM v[72:75],v[224:227],a[80:83],v[72:75]
 s_add_u32 s76, s76, 262144
 s_cmp_eq_u32 s76, 3670016
 s_cselect_b32 s76, 0, s76
 TR v[212:213],v251,34080
 MM v[76:79],v[228:231],a[72:75],v[76:79]
 TR v[214:215],v251,34592
 MM v[80:83],v[228:231],a[76:79],v[80:83]
 s_mov_b32 m0, s90
 TR v[216:217],v251,34112
 MM v[84:87],v[228:231],a[80:83],v[84:87]
 s_waitcnt lgkmcnt(5)
 buffer_load_dwordx4 v8, s[52:55], s77 offen offset:0 lds
 MM v[88:91],v[232:235],a[72:75],v[88:91]
 TR v[218:219],v251,34624
 MM v[92:95],v[232:235],a[76:79],v[92:95]
 TR v[220:221],v251,34144
 MM v[96:99],v[232:235],a[80:83],v[96:99]
 TR v[222:223],v251,34656
 MM v[100:103],v[236:239],a[72:75],v[100:103]
 TR v[224:225],v251,34176
 MM v[104:107],v[236:239],a[76:79],v[104:107]
 buffer_load_dwordx4 v9, s[52:55], s77 offen offset:1056 lds
 MM v[108:111],v[236:239],a[80:83],v[108:111]
 s_waitcnt lgkmcnt(5)
 TR v[226:227],v251,34688
 MM v[112:115],v[208:211],a[72:75],v[112:115]
 TR v[228:229],v251,34208
 MM v[116:119],v[208:211],a[76:79],v[116:119]
 TR v[230:231],v251,34720
 MM v[120:123],v[208:211],a[80:83],v[120:123]
 TR v[232:233],v251,34240
 MM v[124:127],v[212:215],a[72:75],v[124:127]
 buffer_load_dwordx4 v10, s[52:55], s77 offen offset:2112 lds
 MM v[128:131],v[212:215],a[76:79],v[128:131]
 TR v[234:235],v251,34752
 MM v[132:135],v[212:215],a[80:83],v[132:135]
 s_waitcnt lgkmcnt(6)
 TR v[236:237],v251,34272
 MM v[136:139],v[216:219],a[72:75],v[136:139]
 TR v[238:239],v251,34784
 MM v[140:143],v[216:219],a[76:79],v[140:143]
 buffer_load_dwordx4 v11, s[52:55], s77 offen offset:3168 lds
 MM v[144:147],v[216:219],a[80:83],v[144:147]
 s_add_u32 s77, s77, 262144
 s_cmp_eq_u32 s77, 3670016
 s_cselect_b32 s77, 0, s77
 MM v[148:151],v[220:223],a[72:75],v[148:151]
 MM v[152:155],v[220:223],a[76:79],v[152:155]
 MM v[156:159],v[220:223],a[80:83],v[156:159]
 s_waitcnt lgkmcnt(6)
 MM v[160:163],v[224:227],a[72:75],v[160:163]
 MM v[164:167],v[224:227],a[76:79],v[164:167]
 MM v[168:171],v[224:227],a[80:83],v[168:171]
 s_waitcnt lgkmcnt(0) vmcnt(12)
 s_barrier
 TR v[208:209],v252,0
 MM v[172:175],v[228:231],a[72:75],v[172:175]
 TR v[210:211],v252,512
 MM v[176:179],v[228:231],a[76:79],v[176:179]
 MM v[180:183],v[228:231],a[80:83],v[180:183]
 TR v[212:213],v252,32
 MM v[184:187],v[232:235],a[72:75],v[184:187]
 TR v[214:215],v252,544
 MM v[188:191],v[232:235],a[76:79],v[188:191]
 MM v[192:195],v[232:235],a[80:83],v[192:195]
 TR v[216:217],v252,64
 MM v[196:199],v[236:239],a[72:75],v[196:199]
 TR v[218:219],v252,576
 MM v[200:203],v[236:239],a[76:79],v[200:203]
 MM v[204:207],v[236:239],a[80:83],v[204:207]
 s_waitcnt lgkmcnt(4)
 TR v[220:221],v252,96
 MM v[16:19],v[208:211],a[84:87],v[16:19]
 TR v[222:223],v252,608
 MM v[20:23],v[208:211],a[88:91],v[20:23]
 TR v[224:225],v252,128
 MM v[24:27],v[208:211],a[92:95],v[24:27]
 s_waitcnt lgkmcnt(5)
 s_mov_b32 m0, s91
 TR v[226:227],v252,640
 MM v[28:31],v[212:215],a[84:87],v[28:31]
 buffer_load_dwordx4 v8, s[48:51], s76 offen offset:0 lds
 MM v[32:35],v[212:215],a[88:91],v[32:35]
 TR v[228:229],v252,160
 buffer_load_dwordx4 v9, s[48:51], s76 offen offset:1056 lds
 MM v[36:39],v[212:215],a[92:95],v[36:39]
 s_waitcnt lgkmcnt(3)
 TR v[230:231],v252,672
 MM v[40:43],v[216:219],a[84:87],v[40:43]
 TR v[232:233],v252,192
 MM v[44:47],v[216:219],a[88:91],v[44:47]
 TR v[234:235],v252,704
 MM v[48:51],v[216:219],a[92:95],v[48:51]
 buffer_load_dwordx4 v10, s[48:51], s76 offen offset:2112 lds
 MM v[52:55],v[220:223],a[84:87],v[52:55]
 TR v[236:237],v252,224
 MM v[56:59],v[220:223],a[88:91],v[56:59]
 TR v[238:239],v252,736
 MM v[60:63],v[220:223],a[92:95],v[60:63]
 s_waitcnt lgkmcnt(4)
 TR v[208:209],v252,256
 MM v[64:67],v[224:227],a[84:87],v[64:67]
 TR v[210:211],v252,768
 MM v[68:71],v[224:227],a[88:91],v[68:71]
 buffer_load_dwordx4 v11, s[48:51], s76 offen offset:3168 lds
 MM v[72:75],v[224:227],a[92:95],v[72:75]
 s_add_u32 s76, s76, 262144
 s_cmp_eq_u32 s76, 3670016
 s_cselect_b32 s76, 0, s76
 TR v[212:213],v252,288
 MM v[76:79],v[228:231],a[84:87],v[76:79]
 TR v[214:215],v252,800
 MM v[80:83],v[228:231],a[88:91],v[80:83]
 s_mov_b32 m0, s92
 TR v[216:217],v252,320
 MM v[84:87],v[228:231],a[92:95],v[84:87]
 s_waitcnt lgkmcnt(5)
 buffer_load_dwordx4 v8, s[52:55], s77 offen offset:0 lds
 MM v[88:91],v[232:235],a[84:87],v[88:91]
 TR v[218:219],v252,832
 MM v[92:95],v[232:235],a[88:91],v[92:95]
 TR v[220:221],v252,352
 MM v[96:99],v[232:235],a[92:95],v[96:99]
 TR v[222:223],v252,864
 MM v[100:103],v[236:239],a[84:87],v[100:103]
 TR v[224:225],v252,384
 MM v[104:107],v[236:239],a[88:91],v[104:107]
 buffer_load_dwordx4 v9, s[52:55], s77 offen offset:1056 lds
 MM v[108:111],v[236:239],a[92:95],v[108:111]
 s_waitcnt lgkmcnt(5)
 TR v[226:227],v252,896
 MM v[112:115],v[208:211],a[84:87],v[112:115]
 TR v[228:229],v252,416
 MM v[116:119],v[208:211],a[88:91],v[116:119]
 TR v[230:231],v252,928
 MM v[120:123],v[208:211],a[92:95],v[120:123]
 TR v[232:233],v252,448
 MM v[124:127],v[212:215],a[84:87],v[124:127]
 buffer_load_dwordx4 v10, s[52:55], s77 offen offset:2112 lds
 MM v[128:131],v[212:215],a[88:91],v[128:131]
 TR v[234:235],v252,960
 MM v[132:135],v[212:215],a[92:95],v[132:135]
 s_waitcnt lgkmcnt(6)
 TR v[236:237],v252,480
 MM v[136:139],v[216:219],a[84:87],v[136:139]
 TR v[238:239],v252,992
 MM v[140:143],v[216:219],a[88:91],v[140:143]
 buffer_load_dwordx4 v11, s[52:55], s77 offen offset:3168 lds
 MM v[144:147],v[216:219],a[92:95],v[144:147]
 s_add_u32 s77, s77, 262144
 s_cmp_eq_u32 s77, 3670016
 s_cselect_b32 s77, 0, s77
 MM v[148:151],v[220:223],a[84:87],v[148:151]
 MM v[152:155],v[220:223],a[88:91],v[152:155]
 MM v[156:159],v[220:223],a[92:95],v[156:159]
 s_waitcnt lgkmcnt(6)
 MM v[160:163],v[224:227],a[84:87],v[160:163]
 MM v[164:167],v[224:227],a[88:91],v[164:167]
 MM v[168:171],v[224:227],a[92:95],v[168:171]
 s_waitcnt lgkmcnt(0) vmcnt(8)
 s_barrier
 TR v[208:209],v251,0
 MM v[172:175],v[228:231],a[84:87],v[172:175]
 TR v[210:211],v251,512
 MM v[176:179],v[228:231],a[88:91],v[176:179]
 MM v[180:183],v[228:231],a[92:95],v[180:183]
 TR v[212:213],v251,32
 MM v[184:187],v[232:235],a[84:87],v[184:187]
 TR v[214:215],v251,544
 MM v[188:191],v[232:235],a[88:91],v[188:191]
 MM v[192:195],v[232:235],a[92:95],v[192:195]
 TR v[216:217],v251,64
 MM v[196:199],v[236:239],a[84:87],v[196:199]
 TR v[218:219],v251,576
 MM v[200:203],v[236:239],a[88:91],v[200:203]
 MM v[204:207],v[236:239],a[92:95],v[204:207]
 s_waitcnt lgkmcnt(4)
 TR v[220:221],v251,96
 MM v[16:19],v[208:211],a[96:99],v[16:19]
 TR v[222:223],v251,608
 ds_read_b128 a[120:123], v253 offset:36864
 MM v[20:23],v[208:211],a[100:103],v[20:23]
 TR v[224:225],v251,128
 ds_read_b128 a[144:147], v253 offset:49152
 MM v[24:27],v[208:211],a[104:107],v[24:27]
 s_waitcnt lgkmcnt(7)
 s_mov_b32 m0, s93
 TR v[226:227],v251,640
 MM v[28:31],v[212:215],a[96:99],v[28:31]
 buffer_load_dwordx4 v8, s[48:51], s76 offen offset:0 lds
 MM v[32:35],v[212:215],a[100:103],v[32:35]
 TR v[228:229],v251,160
 buffer_load_dwordx4 v9, s[48:51], s76 offen offset:1056 lds
 MM v[36:39],v[212:215],a[104:107],v[36:39]
 s_waitcnt lgkmcnt(5)
 TR v[230:231],v251,672
 MM v[40:43],v[216:219],a[96:99],v[40:43]
 TR v[232:233],v251,192
 ds_read_b128 a[124:127], v253 offset:38912
 MM v[44:47],v[216:219],a[100:103],v[44:47]
 TR v[234:235],v251,704
 ds_read_b128 a[148:151], v253 offset:51200
 MM v[48:51],v[216:219],a[104:107],v[48:51]
 buffer_load_dwordx4 v10, s[48:51], s76 offen offset:2112 lds
 MM v[52:55],v[220:223],a[96:99],v[52:55]
 TR v[236:237],v251,224
 MM v[56:59],v[220:223],a[100:103],v[56:59]
 TR v[238:239],v251,736
 ds_read_b128 a[128:131], v253 offset:40960
 MM v[60:63],v[220:223],a[104:107],v[60:63]
 s_waitcnt lgkmcnt(7)
 TR v[208:209],v251,256
 ds_read_b128 a[152:155], v253 offset:53248
 MM v[64:67],v[224:227],a[96:99],v[64:67]
 TR v[210:211],v251,768
 MM v[68:71],v[224:227],a[100:103],v[68:71]
 buffer_load_dwordx4 v11, s[48:51], s76 offen offset:3168 lds
 MM v[72:75],v[224:227],a[104:107],v[72:75]
 s_add_u32 s76, s76, 262144
 s_cmp_eq_u32 s76, 3670016
 s_cselect_b32 s76, 0, s76
 TR v[212:213],v251,288
 MM v[76:79],v[228:231],a[96:99],v[76:79]
 TR v[214:215],v251,800
 ds_read_b128 a[132:135], v254 offset:36864
 MM v[80:83],v[228:231],a[100:103],v[80:83]
 s_mov_b32 m0, s94
 TR v[216:217],v251,320
 MM v[84:87],v[228:231],a[104:107],v[84:87]
 s_waitcnt lgkmcnt(8)
 buffer_load_dwordx4 v8, s[52:55], s77 offen offset:0 lds
 ds_read_b128 a[156:159], v254 offset:49152
 MM v[88:91],v[232:235],a[96:99],v[88:91]
 TR v[218:219],v251,832
 MM v[92:95],v[232:235],a[100:103],v[92:95]
 TR v[220:221],v251,352
 MM v[96:99],v[232:235],a[104:107],v[96:99]
 TR v[222:223],v251,864
 ds_read_b128 a[136:139], v254 offset:38912
 MM v[100:103],v[236:239],a[96:99],v[100:103]
 TR v[224:225],v251,384
 ds_read_b128 a[160:163], v254 offset:51200
 MM v[104:107],v[236:239],a[100:103],v[104:107]
 buffer_load_dwordx4 v9, s[52:55], s77 offen offset:1056 lds
 MM v[108:111],v[236:239],a[104:107],v[108:111]
 s_waitcnt lgkmcnt(9)
 TR v[226:227],v251,896
 MM v[112:115],v[208:211],a[96:99],v[112:115]
 TR v[228:229],v251,416
 ds_read_b128 a[140:143], v254 offset:40960
 MM v[116:119],v[208:211],a[100:103],v[116:119]
 TR v[230:231],v251,928
 ds_read_b128 a[164:167], v254 offset:53248
 MM v[120:123],v[208:211],a[104:107],v[120:123]
 TR v[232:233],v251,448
 MM v[124:127],v[212:215],a[96:99],v[124:127]
 buffer_load_dwordx4 v10, s[52:55], s77 offen offset:2112 lds
 MM v[128:131],v[212:215],a[100:103],v[128:131]
 TR v[234:235],v251,960
 MM v[132:135],v[212:215],a[104:107],v[132:135]
 s_waitcnt lgkmcnt(10)
 TR v[236:237],v251,480
 MM v[136:139],v[216:219],a[96:99],v[136:139]
 TR v[238:239],v251,992
 MM v[140:143],v[216:219],a[100:103],v[140:143]
 buffer_load_dwordx4 v11, s[52:55], s77 offen offset:3168 lds
 MM v[144:147],v[216:219],a[104:107],v[144:147]
 s_add_u32 s77, s77, 262144
 s_cmp_eq_u32 s77, 3670016
 s_cselect_b32 s77, 0, s77
 MM v[148:151],v[220:223],a[96:99],v[148:151]
 MM v[152:155],v[220:223],a[100:103],v[152:155]
 MM v[156:159],v[220:223],a[104:107],v[156:159]
 s_waitcnt lgkmcnt(8)
 MM v[160:163],v[224:227],a[96:99],v[160:163]
 MM v[164:167],v[224:227],a[100:103],v[164:167]
 MM v[168:171],v[224:227],a[104:107],v[168:171]
 s_waitcnt lgkmcnt(0) vmcnt(8)
 s_barrier
 TR v[208:209],v251,33792
 MM v[172:175],v[228:231],a[96:99],v[172:175]
 TR v[210:211],v251,34304
 MM v[176:179],v[228:231],a[100:103],v[176:179]
 MM v[180:183],v[228:231],a[104:107],v[180:183]
 TR v[212:213],v251,33824
 MM v[184:187],v[232:235],a[96:99],v[184:187]
 TR v[214:215],v251,34336
 MM v[188:191],v[232:235],a[100:103],v[188:191]
 MM v[192:195],v[232:235],a[104:107],v[192:195]
 TR v[216:217],v251,33856
 MM v[196:199],v[236:239],a[96:99],v[196:199]
 TR v[218:219],v251,34368
 MM v[200:203],v[236:239],a[100:103],v[200:203]
 MM v[204:207],v[236:239],a[104:107],v[204:207]
 s_waitcnt lgkmcnt(4)
 TR v[220:221],v251,33888
 MM v[16:19],v[208:211],a[108:111],v[16:19]
 TR v[222:223],v251,34400
 MM v[20:23],v[208:211],a[112:115],v[20:23]
 TR v[224:225],v251,33920
 MM v[24:27],v[208:211],a[116:119],v[24:27]
 s_waitcnt lgkmcnt(5)
 s_mov_b32 m0, s89
 TR v[226:227],v251,34432
 MM v[28:31],v[212:215],a[108:111],v[28:31]
 buffer_load_dwordx4 v8, s[48:51], s76 offen offset:0 lds
 MM v[32:35],v[212:215],a[112:115],v[32:35]
 TR v[228:229],v251,33952
 buffer_load_dwordx4 v9, s[48:51], s76 offen offset:1056 lds
 MM v[36:39],v[212:215],a[116:119],v[36:39]
 s_waitcnt lgkmcnt(3)
 TR v[230:231],v251,34464
 MM v[40:43],v[216:219],a[108:111],v[40:43]
 TR v[232:233],v251,33984
 MM v[44:47],v[216:219],a[112:115],v[44:47]
 TR v[234:235],v251,34496
 MM v[48:51],v[216:219],a[116:119],v[48:51]
 buffer_load_dwordx4 v10, s[48:51], s76 offen offset:2112 lds
 MM v[52:55],v[220:223],a[108:111],v[52:55]
 TR v[236:237],v251,34016
 MM v[56:59],v[220:223],a[112:115],v[56:59]
 TR v[238:239],v251,34528
 MM v[60:63],v[220:223],a[116:119],v[60:63]
 s_waitcnt lgkmcnt(4)
 TR v[208:209],v251,34048
 MM v[64:67],v[224:227],a[108:111],v[64:67]
 TR v[210:211],v251,34560
 MM v[68:71],v[224:227],a[112:115],v[68:71]
 buffer_load_dwordx4 v11, s[48:51], s76 offen offset:3168 lds
 MM v[72:75],v[224:227],a[116:119],v[72:75]
 s_add_u32 s76, s76, 262144
 s_cmp_eq_u32 s76, 3670016
 s_cselect_b32 s76, 0, s76
 TR v[212:213],v251,34080
 MM v[76:79],v[228:231],a[108:111],v[76:79]
 TR v[214:215],v251,34592
 MM v[80:83],v[228:231],a[112:115],v[80:83]
 s_mov_b32 m0, s90
 TR v[216:217],v251,34112
 MM v[84:87],v[228:231],a[116:119],v[84:87]
 s_waitcnt lgkmcnt(5)
 buffer_load_dwordx4 v8, s[52:55], s77 offen offset:0 lds
 MM v[88:91],v[232:235],a[108:111],v[88:91]
 TR v[218:219],v251,34624
 MM v[92:95],v[232:235],a[112:115],v[92:95]
 TR v[220:221],v251,34144
 MM v[96:99],v[232:235],a[116:119],v[96:99]
 TR v[222:223],v251,34656
 MM v[100:103],v[236:239],a[108:111],v[100:103]
 TR v[224:225],v251,34176
 MM v[104:107],v[236:239],a[112:115],v[104:107]
 buffer_load_dwordx4 v9, s[52:55], s77 offen offset:1056 lds
 MM v[108:111],v[236:239],a[116:119],v[108:111]
 s_waitcnt lgkmcnt(5)
 TR v[226:227],v251,34688
 MM v[112:115],v[208:211],a[108:111],v[112:115]
 TR v[228:229],v251,34208
 MM v[116:119],v[208:211],a[112:115],v[116:119]
 TR v[230:231],v251,34720
 MM v[120:123],v[208:211],a[116:119],v[120:123]
 TR v[232:233],v251,34240
 MM v[124:127],v[212:215],a[108:111],v[124:127]
 buffer_load_dwordx4 v10, s[52:55], s77 offen offset:2112 lds
 MM v[128:131],v[212:215],a[112:115],v[128:131]
 TR v[234:235],v251,34752
 MM v[132:135],v[212:215],a[116:119],v[132:135]
 s_waitcnt lgkmcnt(6)
 TR v[236:237],v251,34272
 MM v[136:139],v[216:219],a[108:111],v[136:139]
 TR v[238:239],v251,34784
 MM v[140:143],v[216:219],a[112:115],v[140:143]
 buffer_load_dwordx4 v11, s[52:55], s77 offen offset:3168 lds
 MM v[144:147],v[216:219],a[116:119],v[144:147]
 s_add_u32 s77, s77, 262144
 s_cmp_eq_u32 s77, 3670016
 s_cselect_b32 s77, 0, s77
 MM v[148:151],v[220:223],a[108:111],v[148:151]
 MM v[152:155],v[220:223],a[112:115],v[152:155]
 MM v[156:159],v[220:223],a[116:119],v[156:159]
 s_waitcnt lgkmcnt(6)
 MM v[160:163],v[224:227],a[108:111],v[160:163]
 MM v[164:167],v[224:227],a[112:115],v[164:167]
 MM v[168:171],v[224:227],a[116:119],v[168:171]
 s_waitcnt lgkmcnt(0) vmcnt(8)
 s_barrier
 TR v[208:209],v252,0
 MM v[172:175],v[228:231],a[108:111],v[172:175]
 TR v[210:211],v252,512
 MM v[176:179],v[228:231],a[112:115],v[176:179]
 MM v[180:183],v[228:231],a[116:119],v[180:183]
 TR v[212:213],v252,32
 MM v[184:187],v[232:235],a[108:111],v[184:187]
 TR v[214:215],v252,544
 MM v[188:191],v[232:235],a[112:115],v[188:191]
 MM v[192:195],v[232:235],a[116:119],v[192:195]
 TR v[216:217],v252,64
 MM v[196:199],v[236:239],a[108:111],v[196:199]
 TR v[218:219],v252,576
 MM v[200:203],v[236:239],a[112:115],v[200:203]
 MM v[204:207],v[236:239],a[116:119],v[204:207]
 s_waitcnt lgkmcnt(4)
 TR v[220:221],v252,96
 MM v[16:19],v[208:211],a[120:123],v[16:19]
 TR v[222:223],v252,608
 MM v[20:23],v[208:211],a[124:127],v[20:23]
 TR v[224:225],v252,128
 MM v[24:27],v[208:211],a[128:131],v[24:27]
 s_waitcnt lgkmcnt(5)
 s_mov_b32 m0, s91
 TR v[226:227],v252,640
 MM v[28:31],v[212:215],a[120:123],v[28:31]
 buffer_load_dwordx4 v8, s[48:51], s76 offen offset:0 lds
 MM v[32:35],v[212:215],a[124:127],v[32:35]
 TR v[228:229],v252,160
 buffer_load_dwordx4 v9, s[48:51], s76 offen offset:1056 lds
 MM v[36:39],v[212:215],a[128:131],v[36:39]
 s_waitcnt lgkmcnt(3)
 TR v[230:231],v252,672
 MM v[40:43],v[216:219],a[120:123],v[40:43]
 TR v[232:233],v252,192
 MM v[44:47],v[216:219],a[124:127],v[44:47]
 TR v[234:235],v252,704
 MM v[48:51],v[216:219],a[128:131],v[48:51]
 buffer_load_dwordx4 v10, s[48:51], s76 offen offset:2112 lds
 MM v[52:55],v[220:223],a[120:123],v[52:55]
 TR v[236:237],v252,224
 MM v[56:59],v[220:223],a[124:127],v[56:59]
 TR v[238:239],v252,736
 MM v[60:63],v[220:223],a[128:131],v[60:63]
 s_waitcnt lgkmcnt(4)
 TR v[208:209],v252,256
 MM v[64:67],v[224:227],a[120:123],v[64:67]
 TR v[210:211],v252,768
 MM v[68:71],v[224:227],a[124:127],v[68:71]
 buffer_load_dwordx4 v11, s[48:51], s76 offen offset:3168 lds
 MM v[72:75],v[224:227],a[128:131],v[72:75]
 s_add_u32 s76, s76, 262144
 s_cmp_eq_u32 s76, 3670016
 s_cselect_b32 s76, 0, s76
 TR v[212:213],v252,288
 MM v[76:79],v[228:231],a[120:123],v[76:79]
 TR v[214:215],v252,800
 MM v[80:83],v[228:231],a[124:127],v[80:83]
 s_mov_b32 m0, s92
 TR v[216:217],v252,320
 MM v[84:87],v[228:231],a[128:131],v[84:87]
 s_waitcnt lgkmcnt(5)
 buffer_load_dwordx4 v8, s[52:55], s77 offen offset:0 lds
 MM v[88:91],v[232:235],a[120:123],v[88:91]
 TR v[218:219],v252,832
 MM v[92:95],v[232:235],a[124:127],v[92:95]
 TR v[220:221],v252,352
 MM v[96:99],v[232:235],a[128:131],v[96:99]
 TR v[222:223],v252,864
 MM v[100:103],v[236:239],a[120:123],v[100:103]
 TR v[224:225],v252,384
 MM v[104:107],v[236:239],a[124:127],v[104:107]
 buffer_load_dwordx4 v9, s[52:55], s77 offen offset:1056 lds
 MM v[108:111],v[236:239],a[128:131],v[108:111]
 s_waitcnt lgkmcnt(5)
 TR v[226:227],v252,896
 MM v[112:115],v[208:211],a[120:123],v[112:115]
 TR v[228:229],v252,416
 MM v[116:119],v[208:211],a[124:127],v[116:119]
 TR v[230:231],v252,928
 MM v[120:123],v[208:211],a[128:131],v[120:123]
 TR v[232:233],v252,448
 MM v[124:127],v[212:215],a[120:123],v[124:127]
 buffer_load_dwordx4 v10, s[52:55], s77 offen offset:2112 lds
 MM v[128:131],v[212:215],a[124:127],v[128:131]
 TR v[234:235],v252,960
 MM v[132:135],v[212:215],a[128:131],v[132:135]
 s_waitcnt lgkmcnt(6)
 TR v[236:237],v252,480
 MM v[136:139],v[216:219],a[120:123],v[136:139]
 TR v[238:239],v252,992
 MM v[140:143],v[216:219],a[124:127],v[140:143]
 buffer_load_dwordx4 v11, s[52:55], s77 offen offset:3168 lds
 MM v[144:147],v[216:219],a[128:131],v[144:147]
 s_add_u32 s77, s77, 262144
 s_cmp_eq_u32 s77, 3670016
 s_cselect_b32 s77, 0, s77
 MM v[148:151],v[220:223],a[120:123],v[148:151]
 MM v[152:155],v[220:223],a[124:127],v[152:155]
 MM v[156:159],v[220:223],a[128:131],v[156:159]
 s_waitcnt lgkmcnt(6)
 MM v[160:163],v[224:227],a[120:123],v[160:163]
 MM v[164:167],v[224:227],a[124:127],v[164:167]
 MM v[168:171],v[224:227],a[128:131],v[168:171]
 s_waitcnt lgkmcnt(0) vmcnt(8)
 s_barrier
 TR v[208:209],v251,0
 MM v[172:175],v[228:231],a[120:123],v[172:175]
 TR v[210:211],v251,512
 MM v[176:179],v[228:231],a[124:127],v[176:179]
 MM v[180:183],v[228:231],a[128:131],v[180:183]
 TR v[212:213],v251,32
 MM v[184:187],v[232:235],a[120:123],v[184:187]
 TR v[214:215],v251,544
 MM v[188:191],v[232:235],a[124:127],v[188:191]
 MM v[192:195],v[232:235],a[128:131],v[192:195]
 TR v[216:217],v251,64
 MM v[196:199],v[236:239],a[120:123],v[196:199]
 TR v[218:219],v251,576
 MM v[200:203],v[236:239],a[124:127],v[200:203]
 MM v[204:207],v[236:239],a[128:131],v[204:207]
 s_waitcnt lgkmcnt(4)
 TR v[220:221],v251,96
 MM v[16:19],v[208:211],a[132:135],v[16:19]
 TR v[222:223],v251,608
 MM v[20:23],v[208:211],a[136:139],v[20:23]
 TR v[224:225],v251,128
 MM v[24:27],v[208:211],a[140:143],v[24:27]
 s_waitcnt lgkmcnt(5)
 s_mov_b32 m0, s93
 TR v[226:227],v251,640
 MM v[28:31],v[212:215],a[132:135],v[28:31]
 buffer_load_dwordx4 v8, s[48:51], s76 offen offset:0 lds
 MM v[32:35],v[212:215],a[136:139],v[32:35]
 TR v[228:229],v251,160
 buffer_load_dwordx4 v9, s[48:51], s76 offen offset:1056 lds
 MM v[36:39],v[212:215],a[140:143],v[36:39]
 s_waitcnt lgkmcnt(3)
 TR v[230:231],v251,672
 MM v[40:43],v[216:219],a[132:135],v[40:43]
 TR v[232:233],v251,192
 MM v[44:47],v[216:219],a[136:139],v[44:47]
 TR v[234:235],v251,704
 MM v[48:51],v[216:219],a[140:143],v[48:51]
 buffer_load_dwordx4 v10, s[48:51], s76 offen offset:2112 lds
 MM v[52:55],v[220:223],a[132:135],v[52:55]
 TR v[236:237],v251,224
 MM v[56:59],v[220:223],a[136:139],v[56:59]
 TR v[238:239],v251,736
 MM v[60:63],v[220:223],a[140:143],v[60:63]
 s_waitcnt lgkmcnt(4)
 TR v[208:209],v251,256
 MM v[64:67],v[224:227],a[132:135],v[64:67]
 TR v[210:211],v251,768
 MM v[68:71],v[224:227],a[136:139],v[68:71]
 buffer_load_dwordx4 v11, s[48:51], s76 offen offset:3168 lds
 MM v[72:75],v[224:227],a[140:143],v[72:75]
 s_add_u32 s76, s76, 262144
 s_cmp_eq_u32 s76, 3670016
 s_cselect_b32 s76, 0, s76
 TR v[212:213],v251,288
 MM v[76:79],v[228:231],a[132:135],v[76:79]
 TR v[214:215],v251,800
 MM v[80:83],v[228:231],a[136:139],v[80:83]
 s_mov_b32 m0, s94
 TR v[216:217],v251,320
 MM v[84:87],v[228:231],a[140:143],v[84:87]
 s_waitcnt lgkmcnt(5)
 buffer_load_dwordx4 v8, s[52:55], s77 offen offset:0 lds
 MM v[88:91],v[232:235],a[132:135],v[88:91]
 TR v[218:219],v251,832
 MM v[92:95],v[232:235],a[136:139],v[92:95]
 TR v[220:221],v251,352
 MM v[96:99],v[232:235],a[140:143],v[96:99]
 TR v[222:223],v251,864
 MM v[100:103],v[236:239],a[132:135],v[100:103]
 TR v[224:225],v251,384
 MM v[104:107],v[236:239],a[136:139],v[104:107]
 buffer_load_dwordx4 v9, s[52:55], s77 offen offset:1056 lds
 MM v[108:111],v[236:239],a[140:143],v[108:111]
 s_waitcnt lgkmcnt(5)
 TR v[226:227],v251,896
 MM v[112:115],v[208:211],a[132:135],v[112:115]
 TR v[228:229],v251,416
 MM v[116:119],v[208:211],a[136:139],v[116:119]
 TR v[230:231],v251,928
 MM v[120:123],v[208:211],a[140:143],v[120:123]
 TR v[232:233],v251,448
 MM v[124:127],v[212:215],a[132:135],v[124:127]
 buffer_load_dwordx4 v10, s[52:55], s77 offen offset:2112 lds
 MM v[128:131],v[212:215],a[136:139],v[128:131]
 TR v[234:235],v251,960
 MM v[132:135],v[212:215],a[140:143],v[132:135]
 s_waitcnt lgkmcnt(6)
 TR v[236:237],v251,480
 MM v[136:139],v[216:219],a[132:135],v[136:139]
 TR v[238:239],v251,992
 MM v[140:143],v[216:219],a[136:139],v[140:143]
 buffer_load_dwordx4 v11, s[52:55], s77 offen offset:3168 lds
 MM v[144:147],v[216:219],a[140:143],v[144:147]
 s_add_u32 s77, s77, 262144
 s_cmp_eq_u32 s77, 3670016
 s_cselect_b32 s77, 0, s77
 MM v[148:151],v[220:223],a[132:135],v[148:151]
 MM v[152:155],v[220:223],a[136:139],v[152:155]
 MM v[156:159],v[220:223],a[140:143],v[156:159]
 s_waitcnt lgkmcnt(6)
 MM v[160:163],v[224:227],a[132:135],v[160:163]
 MM v[164:167],v[224:227],a[136:139],v[164:167]
 MM v[168:171],v[224:227],a[140:143],v[168:171]
 s_waitcnt lgkmcnt(0) vmcnt(8)
 s_barrier
 TR v[208:209],v251,33792
 MM v[172:175],v[228:231],a[132:135],v[172:175]
 TR v[210:211],v251,34304
 MM v[176:179],v[228:231],a[136:139],v[176:179]
 MM v[180:183],v[228:231],a[140:143],v[180:183]
 TR v[212:213],v251,33824
 MM v[184:187],v[232:235],a[132:135],v[184:187]
 TR v[214:215],v251,34336
 MM v[188:191],v[232:235],a[136:139],v[188:191]
 MM v[192:195],v[232:235],a[140:143],v[192:195]
 TR v[216:217],v251,33856
 MM v[196:199],v[236:239],a[132:135],v[196:199]
 TR v[218:219],v251,34368
 MM v[200:203],v[236:239],a[136:139],v[200:203]
 MM v[204:207],v[236:239],a[140:143],v[204:207]
 s_waitcnt lgkmcnt(4)
 TR v[220:221],v251,33888
 MM v[16:19],v[208:211],a[144:147],v[16:19]
 TR v[222:223],v251,34400
 MM v[20:23],v[208:211],a[148:151],v[20:23]
 TR v[224:225],v251,33920
 MM v[24:27],v[208:211],a[152:155],v[24:27]
 s_waitcnt lgkmcnt(5)
 s_mov_b32 m0, s89
 TR v[226:227],v251,34432
 MM v[28:31],v[212:215],a[144:147],v[28:31]
 buffer_load_dwordx4 v4, s[40:43], s74 offen offset:0 nt lds
 MM v[32:35],v[212:215],a[148:151],v[32:35]
 TR v[228:229],v251,33952
 MM v[36:39],v[212:215],a[152:155],v[36:39]
 s_waitcnt lgkmcnt(3)
 TR v[230:231],v251,34464
 MM v[40:43],v[216:219],a[144:147],v[40:43]
 TR v[232:233],v251,33984
 MM v[44:47],v[216:219],a[148:151],v[44:47]
 TR v[234:235],v251,34496
 MM v[48:51],v[216:219],a[152:155],v[48:51]
 buffer_load_dwordx4 v5, s[40:43], s74 offen offset:1056 nt lds
 MM v[52:55],v[220:223],a[144:147],v[52:55]
 TR v[236:237],v251,34016
 MM v[56:59],v[220:223],a[148:151],v[56:59]
 TR v[238:239],v251,34528
 MM v[60:63],v[220:223],a[152:155],v[60:63]
 s_waitcnt lgkmcnt(4)
 TR v[208:209],v251,34048
 MM v[64:67],v[224:227],a[144:147],v[64:67]
 TR v[210:211],v251,34560
 MM v[68:71],v[224:227],a[148:151],v[68:71]
 MM v[72:75],v[224:227],a[152:155],v[72:75]
 TR v[212:213],v251,34080
 MM v[76:79],v[228:231],a[144:147],v[76:79]
 TR v[214:215],v251,34592
 MM v[80:83],v[228:231],a[148:151],v[80:83]
 TR v[216:217],v251,34112
 MM v[84:87],v[228:231],a[152:155],v[84:87]
 s_waitcnt lgkmcnt(5)
 buffer_load_dwordx4 v6, s[40:43], s74 offen offset:2112 nt lds
 MM v[88:91],v[232:235],a[144:147],v[88:91]
 TR v[218:219],v251,34624
 MM v[92:95],v[232:235],a[148:151],v[92:95]
 TR v[220:221],v251,34144
 MM v[96:99],v[232:235],a[152:155],v[96:99]
 TR v[222:223],v251,34656
 MM v[100:103],v[236:239],a[144:147],v[100:103]
 TR v[224:225],v251,34176
 MM v[104:107],v[236:239],a[148:151],v[104:107]
 MM v[108:111],v[236:239],a[152:155],v[108:111]
 s_waitcnt lgkmcnt(5)
 TR v[226:227],v251,34688
 MM v[112:115],v[208:211],a[144:147],v[112:115]
 TR v[228:229],v251,34208
 MM v[116:119],v[208:211],a[148:151],v[116:119]
 TR v[230:231],v251,34720
 MM v[120:123],v[208:211],a[152:155],v[120:123]
 TR v[232:233],v251,34240
 MM v[124:127],v[212:215],a[144:147],v[124:127]
 buffer_load_dwordx4 v7, s[40:43], s74 offen offset:3168 nt lds
 MM v[128:131],v[212:215],a[148:151],v[128:131]
 s_add_u32 s74, s74, 16384
 TR v[234:235],v251,34752
 MM v[132:135],v[212:215],a[152:155],v[132:135]
 s_waitcnt lgkmcnt(6)
 TR v[236:237],v251,34272
 MM v[136:139],v[216:219],a[144:147],v[136:139]
 TR v[238:239],v251,34784
 MM v[140:143],v[216:219],a[148:151],v[140:143]
 MM v[144:147],v[216:219],a[152:155],v[144:147]
 MM v[148:151],v[220:223],a[144:147],v[148:151]
 MM v[152:155],v[220:223],a[148:151],v[152:155]
 MM v[156:159],v[220:223],a[152:155],v[156:159]
 s_waitcnt lgkmcnt(6)
 MM v[160:163],v[224:227],a[144:147],v[160:163]
 MM v[164:167],v[224:227],a[148:151],v[164:167]
 MM v[168:171],v[224:227],a[152:155],v[168:171]
 s_waitcnt lgkmcnt(0) vmcnt(4)
 s_barrier
 TR v[208:209],v252,0
 MM v[172:175],v[228:231],a[144:147],v[172:175]
 TR v[210:211],v252,512
 MM v[176:179],v[228:231],a[148:151],v[176:179]
 MM v[180:183],v[228:231],a[152:155],v[180:183]
 TR v[212:213],v252,32
 MM v[184:187],v[232:235],a[144:147],v[184:187]
 TR v[214:215],v252,544
 MM v[188:191],v[232:235],a[148:151],v[188:191]
 MM v[192:195],v[232:235],a[152:155],v[192:195]
 TR v[216:217],v252,64
 MM v[196:199],v[236:239],a[144:147],v[196:199]
 TR v[218:219],v252,576
 MM v[200:203],v[236:239],a[148:151],v[200:203]
 MM v[204:207],v[236:239],a[152:155],v[204:207]
 s_waitcnt lgkmcnt(4)
 TR v[220:221],v252,96
 MM v[16:19],v[208:211],a[156:159],v[16:19]
 TR v[222:223],v252,608
 MM v[20:23],v[208:211],a[160:163],v[20:23]
 TR v[224:225],v252,128
 MM v[24:27],v[208:211],a[164:167],v[24:27]
 s_waitcnt lgkmcnt(5)
 s_mov_b32 m0, s90
 TR v[226:227],v252,640
 MM v[28:31],v[212:215],a[156:159],v[28:31]
 buffer_load_dwordx4 v4, s[32:35], s72 offen offset:0 nt lds
 MM v[32:35],v[212:215],a[160:163],v[32:35]
 TR v[228:229],v252,160
 MM v[36:39],v[212:215],a[164:167],v[36:39]
 s_waitcnt lgkmcnt(3)
 TR v[230:231],v252,672
 MM v[40:43],v[216:219],a[156:159],v[40:43]
 TR v[232:233],v252,192
 MM v[44:47],v[216:219],a[160:163],v[44:47]
 TR v[234:235],v252,704
 MM v[48:51],v[216:219],a[164:167],v[48:51]
 buffer_load_dwordx4 v5, s[32:35], s72 offen offset:1056 nt lds
 CV v16,v16,v17
 CV v17,v18,v19
 CV v18,v28,v29
 CV v19,v30,v31
 MM v[52:55],v[220:223],a[156:159],v[52:55]
 TR v[236:237],v252,224
 CV v20,v20,v21
 CV v21,v22,v23
 CV v22,v32,v33
 CV v23,v34,v35
 MM v[56:59],v[220:223],a[160:163],v[56:59]
 TR v[238:239],v252,736
 CV v24,v24,v25
 CV v25,v26,v27
 CV v26,v36,v37
 MM v[60:63],v[220:223],a[164:167],v[60:63]
 s_waitcnt lgkmcnt(4)
 TR v[208:209],v252,256
 CV v27,v38,v39
 v_permlane32_swap_b32 v16, v18
 MM v[64:67],v[224:227],a[156:159],v[64:67]
 TR v[210:211],v252,768
 v_permlane32_swap_b32 v17, v19
 v_permlane32_swap_b32 v20, v22
 MM v[68:71],v[224:227],a[160:163],v[68:71]
 v_permlane32_swap_b32 v21, v23
 v_permlane32_swap_b32 v24, v26
 MM v[72:75],v[224:227],a[164:167],v[72:75]
 TR v[212:213],v252,288
 v_permlane32_swap_b32 v25, v27
 v_permlane16_swap_b32 v16, v18
 MM v[76:79],v[228:231],a[156:159],v[76:79]
 TR v[214:215],v252,800
 v_permlane16_swap_b32 v17, v19
 MM v[80:83],v[228:231],a[160:163],v[80:83]
 TR v[216:217],v252,320
 v_permlane16_swap_b32 v20, v22
 v_permlane16_swap_b32 v21, v23
 MM v[84:87],v[228:231],a[164:167],v[84:87]
 s_waitcnt lgkmcnt(5)
 buffer_load_dwordx4 v6, s[32:35], s72 offen offset:2112 nt lds
 v_permlane16_swap_b32 v24, v26
 v_permlane16_swap_b32 v25, v27
 MM v[88:91],v[232:235],a[156:159],v[88:91]
 TR v[218:219],v252,832
 CV v28,v40,v41
 CV v29,v42,v43
 CV v30,v52,v53
 CV v31,v54,v55
 MM v[92:95],v[232:235],a[160:163],v[92:95]
 TR v[220:221],v252,352
 CV v32,v44,v45
 CV v33,v46,v47
 CV v34,v56,v57
 CV v35,v58,v59
 MM v[96:99],v[232:235],a[164:167],v[96:99]
 TR v[222:223],v252,864
 CV v36,v48,v49
 CV v37,v50,v51
 CV v38,v60,v61
 MM v[100:103],v[236:239],a[156:159],v[100:103]
 TR v[224:225],v252,384
 CV v39,v62,v63
 v_permlane32_swap_b32 v28, v30
 MM v[104:107],v[236:239],a[160:163],v[104:107]
 v_permlane32_swap_b32 v29, v31
 v_permlane32_swap_b32 v32, v34
 MM v[108:111],v[236:239],a[164:167],v[108:111]
 s_waitcnt lgkmcnt(5)
 TR v[226:227],v252,896
 v_permlane32_swap_b32 v33, v35
 v_permlane32_swap_b32 v36, v38
 MM v[112:115],v[208:211],a[156:159],v[112:115]
 TR v[228:229],v252,416
 v_permlane32_swap_b32 v37, v39
 v_permlane16_swap_b32 v28, v30
 MM v[116:119],v[208:211],a[160:163],v[116:119]
 TR v[230:231],v252,928
 v_permlane16_swap_b32 v29, v31
 MM v[120:123],v[208:211],a[164:167],v[120:123]
 TR v[232:233],v252,448
 v_permlane16_swap_b32 v32, v34
 v_permlane16_swap_b32 v33, v35
 MM v[124:127],v[212:215],a[156:159],v[124:127]
 buffer_load_dwordx4 v7, s[32:35], s72 offen offset:3168 nt lds
 v_permlane16_swap_b32 v36, v38
 v_permlane16_swap_b32 v37, v39
 MM v[128:131],v[212:215],a[160:163],v[128:131]
 s_add_u32 s72, s72, 16384
 TR v[234:235],v252,960
 CV v40,v64,v65
 CV v41,v66,v67
 CV v42,v76,v77
 MM v[132:135],v[212:215],a[164:167],v[132:135]
 s_waitcnt lgkmcnt(6)
 TR v[236:237],v252,480
 CV v43,v78,v79
 CV v44,v68,v69
 CV v45,v70,v71
 MM v[136:139],v[216:219],a[156:159],v[136:139]
 TR v[238:239],v252,992
 CV v46,v80,v81
 CV v47,v82,v83
 CV v48,v72,v73
 MM v[140:143],v[216:219],a[160:163],v[140:143]
 CV v49,v74,v75
 CV v50,v84,v85
 CV v51,v86,v87
 MM v[144:147],v[216:219],a[164:167],v[144:147]
 v_permlane32_swap_b32 v40, v42
 v_permlane32_swap_b32 v41, v43
 MM v[148:151],v[220:223],a[156:159],v[148:151]
 v_permlane32_swap_b32 v44, v46
 v_permlane32_swap_b32 v45, v47
 MM v[152:155],v[220:223],a[160:163],v[152:155]
 v_permlane32_swap_b32 v48, v50
 v_permlane32_swap_b32 v49, v51
 MM v[156:159],v[220:223],a[164:167],v[156:159]
 s_waitcnt lgkmcnt(6)
 v_permlane16_swap_b32 v40, v42
 v_permlane16_swap_b32 v41, v43
 MM v[160:163],v[224:227],a[156:159],v[160:163]
 v_permlane16_swap_b32 v44, v46
 v_permlane16_swap_b32 v45, v47
 MM v[164:167],v[224:227],a[160:163],v[164:167]
 v_permlane16_swap_b32 v48, v50
 v_permlane16_swap_b32 v49, v51
 MM v[168:171],v[224:227],a[164:167],v[168:171]
 s_waitcnt lgkmcnt(0)
 s_barrier
 ds_read_b128 v[208:211], v13 offset:33792
 CV v64,v112,v113
 CV v65,v114,v115
 MM v[172:175],v[228:231],a[156:159],v[172:175]
 CV v66,v124,v125
 CV v67,v126,v127
 CV v68,v116,v117
 CV v69,v118,v119
 CV v70,v128,v129
 MM v[176:179],v[228:231],a[160:163],v[176:179]
 CV v71,v130,v131
 CV v72,v120,v121
 CV v73,v122,v123
 CV v74,v132,v133
 CV v75,v134,v135
 MM v[180:183],v[228:231],a[164:167],v[180:183]
 ds_read_b128 v[212:215], v13 offset:34304
 v_permlane32_swap_b32 v64, v66
 v_permlane32_swap_b32 v65, v67
 MM v[184:187],v[232:235],a[156:159],v[184:187]
 v_permlane32_swap_b32 v68, v70
 v_permlane32_swap_b32 v69, v71
 MM v[188:191],v[232:235],a[160:163],v[188:191]
 v_permlane32_swap_b32 v72, v74
 v_permlane32_swap_b32 v73, v75
 MM v[192:195],v[232:235],a[164:167],v[192:195]
 ds_read_b128 v[216:219], v13 offset:33856
 v_permlane16_swap_b32 v64, v66
 v_permlane16_swap_b32 v65, v67
 MM v[196:199],v[236:239],a[156:159],v[196:199]
 v_permlane16_swap_b32 v68, v70
 v_permlane16_swap_b32 v69, v71
 MM v[200:203],v[236:239],a[160:163],v[200:203]
 v_permlane16_swap_b32 v72, v74
 v_permlane16_swap_b32 v73, v75
 MM v[204:207],v[236:239],a[164:167],v[204:207]
 s_waitcnt lgkmcnt(2)
 ds_read_b128 v[220:223], v13 offset:34368
 CV v52,v88,v89
 CV v53,v90,v91
 CV v54,v100,v101
 CV v55,v102,v103
 MM v[112:115],v[208:211],v[16:19],0
 CV v56,v92,v93
 CV v57,v94,v95
 CV v58,v104,v105
 CV v59,v106,v107
 MM v[116:119],v[208:211],v[20:23],0
 ds_read_b128 v[224:227], v13 offset:33920
 CV v60,v96,v97
 CV v61,v98,v99
 CV v62,v108,v109
 MM v[120:123],v[208:211],v[24:27],0
 s_waitcnt lgkmcnt(3)
 CV v63,v110,v111
 v_permlane32_swap_b32 v52, v54
 MM v[124:127],v[212:215],v[16:19],0
 v_permlane32_swap_b32 v53, v55
 v_permlane32_swap_b32 v56, v58
 MM v[128:131],v[212:215],v[20:23],0
 ds_read_b128 v[228:231], v13 offset:34432
 v_permlane32_swap_b32 v57, v59
 v_permlane32_swap_b32 v60, v62
 MM v[132:135],v[212:215],v[24:27],0
 s_waitcnt lgkmcnt(2)
 v_permlane32_swap_b32 v61, v63
 v_permlane16_swap_b32 v52, v54
 MM v[112:115],v[216:219],v[28:31],v[112:115]
 ds_read_b128 v[232:235], v13 offset:33984
 v_permlane16_swap_b32 v53, v55
 MM v[116:119],v[216:219],v[32:35],v[116:119]
 v_permlane16_swap_b32 v56, v58
 v_permlane16_swap_b32 v57, v59
 MM v[120:123],v[216:219],v[36:39],v[120:123]
 v_permlane16_swap_b32 v60, v62
 v_permlane16_swap_b32 v61, v63
 MM v[124:127],v[220:223],v[28:31],v[124:127]
 ds_read_b128 v[236:239], v13 offset:34496
 CV v76,v136,v137
 CV v77,v138,v139
 CV v78,v148,v149
 CV v79,v150,v151
 MM v[128:131],v[220:223],v[32:35],v[128:131]
 CV v80,v140,v141
 CV v81,v142,v143
 CV v82,v152,v153
 CV v83,v154,v155
 MM v[132:135],v[220:223],v[36:39],v[132:135]
 s_waitcnt lgkmcnt(2)
 ds_read_b128 v[208:211], v13 offset:34048
 CV v84,v144,v145
 CV v85,v146,v147
 CV v86,v156,v157
 MM v[112:115],v[224:227],v[40:43],v[112:115]
 CV v87,v158,v159
 v_permlane32_swap_b32 v76, v78
 MM v[116:119],v[224:227],v[44:47],v[116:119]
 v_permlane32_swap_b32 v77, v79
 v_permlane32_swap_b32 v80, v82
 MM v[120:123],v[224:227],v[48:51],v[120:123]
 ds_read_b128 v[212:215], v13 offset:34560
 v_permlane32_swap_b32 v81, v83
 v_permlane32_swap_b32 v84, v86
 MM v[124:127],v[228:231],v[40:43],v[124:127]
 v_permlane32_swap_b32 v85, v87
 v_permlane16_swap_b32 v76, v78
 MM v[128:131],v[228:231],v[44:47],v[128:131]
 ds_read_b128 v[216:219], v13 offset:34112
 v_permlane16_swap_b32 v77, v79
 MM v[132:135],v[228:231],v[48:51],v[132:135]
 s_waitcnt lgkmcnt(3)
 v_permlane16_swap_b32 v80, v82
 v_permlane16_swap_b32 v81, v83
 MM v[112:115],v[232:235],v[52:55],v[112:115]
 v_permlane16_swap_b32 v84, v86
 v_permlane16_swap_b32 v85, v87
 MM v[116:119],v[232:235],v[56:59],v[116:119]
 ds_read_b128 v[220:223], v13 offset:34624
 CV v88,v160,v161
 CV v89,v162,v163
 CV v90,v172,v173
 CV v91,v174,v175
 MM v[120:123],v[232:235],v[60:63],v[120:123]
 CV v92,v164,v165
 CV v93,v166,v167
 CV v94,v176,v177
 CV v95,v178,v179
 MM v[124:127],v[236:239],v[52:55],v[124:127]
 ds_read_b128 v[224:227], v13 offset:34176
 CV v96,v168,v169
 CV v97,v170,v171
 CV v98,v180,v181
 MM v[128:131],v[236:239],v[56:59],v[128:131]
 CV v99,v182,v183
 v_permlane32_swap_b32 v88, v90
 MM v[132:135],v[236:239],v[60:63],v[132:135]
 s_waitcnt lgkmcnt(3)
 v_permlane32_swap_b32 v89, v91
 v_permlane32_swap_b32 v92, v94
 MM v[112:115],v[208:211],v[64:67],v[112:115]
 ds_read_b128 v[228:231], v13 offset:34688
 v_permlane32_swap_b32 v93, v95
 v_permlane32_swap_b32 v96, v98
 MM v[116:119],v[208:211],v[68:71],v[116:119]
 v_permlane32_swap_b32 v97, v99
 v_permlane16_swap_b32 v88, v90
 MM v[120:123],v[208:211],v[72:75],v[120:123]
 ds_read_b128 v[232:235], v13 offset:34240
 v_permlane16_swap_b32 v89, v91
 MM v[124:127],v[212:215],v[64:67],v[124:127]
 v_permlane16_swap_b32 v92, v94
 v_permlane16_swap_b32 v93, v95
 MM v[128:131],v[212:215],v[68:71],v[128:131]
 v_permlane16_swap_b32 v96, v98
 v_permlane16_swap_b32 v97, v99
 MM v[132:135],v[212:215],v[72:75],v[132:135]
 s_waitcnt lgkmcnt(3)
 ds_read_b128 v[236:239], v13 offset:34752
 CV v100,v184,v185
 CV v101,v186,v187
 CV v102,v196,v197
 CV v103,v198,v199
 MM v[112:115],v[216:219],v[76:79],v[112:115]
 CV v104,v188,v189
 CV v105,v190,v191
 CV v106,v200,v201
 CV v107,v202,v203
 MM v[116:119],v[216:219],v[80:83],v[116:119]
 CV v108,v192,v193
 CV v109,v194,v195
 CV v110,v204,v205
 MM v[120:123],v[216:219],v[84:87],v[120:123]
 CV v111,v206,v207
 v_permlane32_swap_b32 v100, v102
 MM v[124:127],v[220:223],v[76:79],v[124:127]
 v_permlane32_swap_b32 v101, v103
 v_permlane32_swap_b32 v104, v106
 MM v[128:131],v[220:223],v[80:83],v[128:131]
 v_permlane32_swap_b32 v105, v107
 v_permlane32_swap_b32 v108, v110
 MM v[132:135],v[220:223],v[84:87],v[132:135]
 s_waitcnt lgkmcnt(3)
 v_permlane32_swap_b32 v109, v111
 v_permlane16_swap_b32 v100, v102
 MM v[112:115],v[224:227],v[88:91],v[112:115]
 v_permlane16_swap_b32 v101, v103
 v_permlane16_swap_b32 v104, v106
 MM v[116:119],v[224:227],v[92:95],v[116:119]
 v_permlane16_swap_b32 v105, v107
 v_permlane16_swap_b32 v108, v110
 MM v[120:123],v[224:227],v[96:99],v[120:123]
 s_waitcnt lgkmcnt(0)
 s_barrier
 ds_read_b128 v[208:211], v13 offset:50688
 v_permlane16_swap_b32 v109, v111
 MM v[124:127],v[228:231],v[88:91],v[124:127]
 MM v[128:131],v[228:231],v[92:95],v[128:131]
 MM v[132:135],v[228:231],v[96:99],v[132:135]
 ds_read_b128 v[212:215], v13 offset:50752
 MM v[112:115],v[232:235],v[100:103],v[112:115]
 MM v[116:119],v[232:235],v[104:107],v[116:119]
 MM v[120:123],v[232:235],v[108:111],v[120:123]
 ds_read_b128 v[216:219], v13 offset:50816
 MM v[124:127],v[236:239],v[100:103],v[124:127]
 MM v[128:131],v[236:239],v[104:107],v[128:131]
 MM v[132:135],v[236:239],v[108:111],v[132:135]
 s_nop 1
 v_max3_f32 v196, v112, v113, v114
 s_nop 2
 v_max3_f32 v196, v196, v115, v124
 v_max3_f32 v196, v196, v125, v126
 v_max_f32 v196, v196, v127
 v_max3_f32 v197, v116, v117, v118
 v_max3_f32 v197, v197, v119, v128
 v_max3_f32 v197, v197, v129, v130
 v_max_f32 v197, v197, v131
 v_max3_f32 v198, v120, v121, v122
 v_max3_f32 v198, v198, v123, v132
 v_max3_f32 v198, v198, v133, v134
 v_max_f32 v198, v198, v135
 v_mov_b32 v200, v196
 v_mov_b32 v201, v197
 v_mov_b32 v202, v198
 v_permlane32_swap_b32 v196, v200
 v_permlane32_swap_b32 v197, v201
 v_permlane32_swap_b32 v198, v202
 v_max_f32 v196, v196, v200
 v_max_f32 v197, v197, v201
 v_max_f32 v198, v198, v202
 v_mov_b32 v200, v196
 v_mov_b32 v201, v197
 v_mov_b32 v202, v198
 v_permlane16_swap_b32 v196, v200
 v_permlane16_swap_b32 v197, v201
 v_permlane16_swap_b32 v198, v202
 v_max_f32 v196, v196, v200
 v_max_f32 v197, v197, v201
 v_max_f32 v198, v198, v202
 v_mul_f32 v184, s82, v196
 v_mul_f32 v185, s82, v197
 v_mul_f32 v186, s82, v198
 v_sub_f32 v184, 0, v184
 v_sub_f32 v185, 0, v185
 v_sub_f32 v186, 0, v186
 v_fma_f32 v112, v112, s82, v184
 v_fma_f32 v113, v113, s82, v184
 v_fma_f32 v114, v114, s82, v184
 v_fma_f32 v115, v115, s82, v184
 v_fma_f32 v116, v116, s82, v185
 v_fma_f32 v117, v117, s82, v185
 v_fma_f32 v118, v118, s82, v185
 v_fma_f32 v119, v119, s82, v185
 v_fma_f32 v120, v120, s82, v186
 v_fma_f32 v121, v121, s82, v186
 v_fma_f32 v122, v122, s82, v186
 v_fma_f32 v123, v123, s82, v186
 v_fma_f32 v124, v124, s82, v184
 v_fma_f32 v125, v125, s82, v184
 v_fma_f32 v126, v126, s82, v184
 v_fma_f32 v127, v127, s82, v184
 v_fma_f32 v128, v128, s82, v185
 v_fma_f32 v129, v129, s82, v185
 v_fma_f32 v130, v130, s82, v185
 v_fma_f32 v131, v131, s82, v185
 v_fma_f32 v132, v132, s82, v186
 v_fma_f32 v133, v133, s82, v186
 v_fma_f32 v134, v134, s82, v186
 v_fma_f32 v135, v135, s82, v186
 s_waitcnt lgkmcnt(2)
 ds_read_b128 v[220:223], v13 offset:50880
 MM v[136:139],v[208:211],v[16:19],0
 s_mov_b32 m0, s95
 v_exp_f32 v112, v112
 MM v[140:143],v[208:211],v[20:23],0
 ds_read_b128 v[224:227], v13 offset:50944
 buffer_load_dwordx4 v4, s[40:43], s74 offen offset:0 nt lds
 MM v[144:147],v[208:211],v[24:27],0
 s_waitcnt lgkmcnt(3)
 v_exp_f32 v113, v113
 MM v[136:139],v[212:215],v[28:31],v[136:139]
 v_exp_f32 v114, v114
 MM v[140:143],v[212:215],v[32:35],v[140:143]
 ds_read_b128 v[228:231], v13 offset:51008
 CV v160,v112,v113
 MM v[144:147],v[212:215],v[36:39],v[144:147]
 s_waitcnt lgkmcnt(2)
 v_exp_f32 v115, v115
 MM v[136:139],v[216:219],v[40:43],v[136:139]
 ds_read_b128 v[232:235], v13 offset:51072
 CV v161,v114,v115
 MM v[140:143],v[216:219],v[44:47],v[140:143]
 v_exp_f32 v124, v124
 MM v[144:147],v[216:219],v[48:51],v[144:147]
 v_exp_f32 v125, v125
 MM v[136:139],v[220:223],v[52:55],v[136:139]
 ds_read_b128 v[236:239], v13 offset:51136
 buffer_load_dwordx4 v5, s[40:43], s74 offen offset:1056 nt lds
 MM v[140:143],v[220:223],v[56:59],v[140:143]
 v_exp_f32 v126, v126
 MM v[144:147],v[220:223],v[60:63],v[144:147]
 s_waitcnt lgkmcnt(2)
 ds_read_b128 v[208:211], v13 offset:51200
 CV v162,v124,v125
 MM v[136:139],v[224:227],v[64:67],v[136:139]
 v_exp_f32 v127, v127
 MM v[140:143],v[224:227],v[68:71],v[140:143]
 v_exp_f32 v116, v116
 MM v[144:147],v[224:227],v[72:75],v[144:147]
 ds_read_b128 v[212:215], v13 offset:51264
 CV v163,v126,v127
 MM v[136:139],v[228:231],v[76:79],v[136:139]
 v_exp_f32 v117, v117
 MM v[140:143],v[228:231],v[80:83],v[140:143]
 ds_read_b128 v[216:219], v13 offset:51328
 CV v164,v116,v117
 MM v[144:147],v[228:231],v[84:87],v[144:147]
 s_waitcnt lgkmcnt(3)
 v_exp_f32 v118, v118
 MM v[136:139],v[232:235],v[88:91],v[136:139]
 v_exp_f32 v119, v119
 MM v[140:143],v[232:235],v[92:95],v[140:143]
 ds_read_b128 v[220:223], v13 offset:51392
 buffer_load_dwordx4 v6, s[40:43], s74 offen offset:2112 nt lds
 MM v[144:147],v[232:235],v[96:99],v[144:147]
 v_exp_f32 v128, v128
 MM v[136:139],v[236:239],v[100:103],v[136:139]
 ds_read_b128 v[224:227], v13 offset:51456
 CV v165,v118,v119
 MM v[140:143],v[236:239],v[104:107],v[140:143]
 v_exp_f32 v129, v129
 MM v[144:147],v[236:239],v[108:111],v[144:147]
 s_waitcnt lgkmcnt(3)
 v_exp_f32 v130, v130
 MM v[148:151],v[208:211],v[16:19],0
 ds_read_b128 v[228:231], v13 offset:51520
 CV v166,v128,v129
 MM v[152:155],v[208:211],v[20:23],0
 v_exp_f32 v131, v131
 MM v[156:159],v[208:211],v[24:27],0
 ds_read_b128 v[232:235], v13 offset:51584
 buffer_load_dwordx4 v7, s[40:43], s74 offen offset:3168 nt lds
 MM v[148:151],v[212:215],v[28:31],v[148:151]
 s_add_u32 s74, s74, 16384
 v_exp_f32 v120, v120
 MM v[152:155],v[212:215],v[32:35],v[152:155]
 v_exp_f32 v121, v121
 MM v[156:159],v[212:215],v[36:39],v[156:159]
 s_waitcnt lgkmcnt(3)
 ds_read_b128 v[236:239], v13 offset:51648
 CV v167,v130,v131
 MM v[148:151],v[216:219],v[40:43],v[148:151]
 v_exp_f32 v122, v122
 MM v[152:155],v[216:219],v[44:47],v[152:155]
 v_exp_f32 v123, v123
 MM v[156:159],v[216:219],v[48:51],v[156:159]
 CV v168,v120,v121
 CV v169,v122,v123
 MM v[148:151],v[220:223],v[52:55],v[148:151]
 v_exp_f32 v132, v132
 MM v[152:155],v[220:223],v[56:59],v[152:155]
 v_exp_f32 v133, v133
 MM v[156:159],v[220:223],v[60:63],v[156:159]
 s_waitcnt lgkmcnt(3)
 v_exp_f32 v134, v134
 MM v[148:151],v[224:227],v[64:67],v[148:151]
 v_exp_f32 v135, v135
 MM v[152:155],v[224:227],v[68:71],v[152:155]
 CV v170,v132,v133
 CV v171,v134,v135
 MM v[156:159],v[224:227],v[72:75],v[156:159]
 s_waitcnt lgkmcnt(0) vmcnt(8)
 s_barrier
 TR v[208:209],v14,0
 MM v[148:151],v[228:231],v[76:79],v[148:151]
 TR v[210:211],v14,512
 MM v[152:155],v[228:231],v[80:83],v[152:155]
 MM v[156:159],v[228:231],v[84:87],v[156:159]
 TR v[212:213],v14,32
 TR v[214:215],v14,544
 MM v[148:151],v[232:235],v[88:91],v[148:151]
 MM v[152:155],v[232:235],v[92:95],v[152:155]
 MM v[156:159],v[232:235],v[96:99],v[156:159]
 TR v[216:217],v14,64
 TR v[218:219],v14,576
 MM v[148:151],v[236:239],v[100:103],v[148:151]
 MM v[152:155],v[236:239],v[104:107],v[152:155]
 MM v[156:159],v[236:239],v[108:111],v[156:159]
 MM a[192:195],a[204:207],v[160:163],0
 MM a[196:199],a[204:207],v[164:167],0
 MM a[200:203],a[204:207],v[168:171],0
 s_waitcnt lgkmcnt(4)
 TR v[220:221],v14,96
 MM a[0:3],v[208:211],v[160:163],0
 TR v[222:223],v14,608
 v_fma_f32 v136, v136, s82, v184
 MM a[4:7],v[208:211],v[164:167],0
 TR v[224:225],v14,128
 v_fma_f32 v137, v137, s82, v184
 MM a[8:11],v[208:211],v[168:171],0
 s_waitcnt lgkmcnt(5)
 s_mov_b32 m0, s96
 TR v[226:227],v14,640
 MM a[12:15],v[212:215],v[160:163],0
 buffer_load_dwordx4 v4, s[32:35], s72 offen offset:0 nt lds
 v_fma_f32 v138, v138, s82, v184
 MM a[16:19],v[212:215],v[164:167],0
 TR v[228:229],v14,160
 MM a[20:23],v[212:215],v[168:171],0
 s_waitcnt lgkmcnt(3)
 TR v[230:231],v14,672
 v_fma_f32 v139, v139, s82, v184
 MM a[24:27],v[216:219],v[160:163],0
 TR v[232:233],v14,192
 v_fma_f32 v140, v140, s82, v185
 MM a[28:31],v[216:219],v[164:167],0
 TR v[234:235],v14,704
 MM a[32:35],v[216:219],v[168:171],0
 buffer_load_dwordx4 v5, s[32:35], s72 offen offset:1056 nt lds
 v_fma_f32 v141, v141, s82, v185
 MM a[36:39],v[220:223],v[160:163],0
 TR v[236:237],v14,224
 v_fma_f32 v142, v142, s82, v185
 MM a[40:43],v[220:223],v[164:167],0
 TR v[238:239],v14,736
 MM a[44:47],v[220:223],v[168:171],0
 s_waitcnt lgkmcnt(4)
 TR v[208:209],v14,256
 v_fma_f32 v143, v143, s82, v185
 MM a[48:51],v[224:227],v[160:163],0
 TR v[210:211],v14,768
 v_max3_f32 v253, v136, v137, v138
 MM a[52:55],v[224:227],v[164:167],0
 v_max3_f32 v254, v139, v140, v141
 MM a[56:59],v[224:227],v[168:171],0
 TR v[212:213],v14,288
 v_fma_f32 v144, v144, s82, v186
 MM a[60:63],v[228:231],v[160:163],0
 TR v[214:215],v14,800
 v_fma_f32 v145, v145, s82, v186
 MM a[64:67],v[228:231],v[164:167],0
 TR v[216:217],v14,320
 MM a[68:71],v[228:231],v[168:171],0
 s_waitcnt lgkmcnt(5)
 buffer_load_dwordx4 v6, s[32:35], s72 offen offset:2112 nt lds
 v_max3_f32 v253, v253, v142, v143
 MM a[72:75],v[232:235],v[160:163],0
 TR v[218:219],v14,832
 v_fma_f32 v146, v146, s82, v186
 MM a[76:79],v[232:235],v[164:167],0
 TR v[220:221],v14,352
 MM a[80:83],v[232:235],v[168:171],0
 TR v[222:223],v14,864
 v_fma_f32 v147, v147, s82, v186
 MM a[84:87],v[236:239],v[160:163],0
 TR v[224:225],v14,384
 v_max3_f32 v254, v254, v144, v145
 MM a[88:91],v[236:239],v[164:167],0
 v_fma_f32 v148, v148, s82, v184
 MM a[92:95],v[236:239],v[168:171],0
 s_waitcnt lgkmcnt(5)
 TR v[226:227],v14,896
 v_fma_f32 v149, v149, s82, v184
 MM a[96:99],v[208:211],v[160:163],0
 TR v[228:229],v14,416
 v_max3_f32 v253, v253, v146, v147
 MM a[100:103],v[208:211],v[164:167],0
 TR v[230:231],v14,928
 MM a[104:107],v[208:211],v[168:171],0
 TR v[232:233],v14,448
 v_fma_f32 v150, v150, s82, v184
 MM a[108:111],v[212:215],v[160:163],0
 buffer_load_dwordx4 v7, s[32:35], s72 offen offset:3168 nt lds
 v_fma_f32 v151, v151, s82, v184
 MM a[112:115],v[212:215],v[164:167],0
 s_add_u32 s72, s72, 16384
 TR v[234:235],v14,960
 MM a[116:119],v[212:215],v[168:171],0
 s_waitcnt lgkmcnt(6)
 TR v[236:237],v14,480
 v_max3_f32 v254, v254, v148, v149
 MM a[120:123],v[216:219],v[160:163],0
 TR v[238:239],v14,992
 v_fma_f32 v152, v152, s82, v185
 MM a[124:127],v[216:219],v[164:167],0
 v_fma_f32 v153, v153, s82, v185
 MM a[128:131],v[216:219],v[168:171],0
 v_max3_f32 v253, v253, v150, v151
 v_fma_f32 v154, v154, s82, v185
 MM a[132:135],v[220:223],v[160:163],0
 v_fma_f32 v155, v155, s82, v185
 MM a[136:139],v[220:223],v[164:167],0
 v_max3_f32 v254, v254, v152, v153
 MM a[140:143],v[220:223],v[168:171],0
 s_waitcnt lgkmcnt(6)
 v_fma_f32 v156, v156, s82, v186
 v_fma_f32 v157, v157, s82, v186
 MM a[144:147],v[224:227],v[160:163],0
 v_max3_f32 v253, v253, v154, v155
 MM a[148:151],v[224:227],v[164:167],0
 v_fma_f32 v158, v158, s82, v186
 v_fma_f32 v159, v159, s82, v186
 MM a[152:155],v[224:227],v[168:171],0
 s_waitcnt lgkmcnt(0) vmcnt(8)
 s_barrier
 ds_read_b128 v[208:211], v12 offset:16896
 MM a[156:159],v[228:231],v[160:163],0
 v_max3_f32 v254, v254, v156, v157
 MM a[160:163],v[228:231],v[164:167],0
 v_max3_f32 v253, v253, v158, v159
 MM a[164:167],v[228:231],v[168:171],0
 ds_read_b128 v[212:215], v12 offset:16960
 v_max_f32 v253, v253, v254
 MM a[168:171],v[232:235],v[160:163],0
 v_cmp_lt_f32 vcc, 0x41800000, v253
 MM a[172:175],v[232:235],v[164:167],0
 MM a[176:179],v[232:235],v[168:171],0
 ds_read_b128 v[216:219], v12 offset:17024
 MM a[180:183],v[236:239],v[160:163],0
 MM a[184:187],v[236:239],v[164:167],0
 MM a[188:191],v[236:239],v[168:171],0
 s_cbranch_vccnz LA_t0
LA_r0:
 s_waitcnt lgkmcnt(2)
 ds_read_b128 v[220:223], v12 offset:17088
 MM v[112:115],v[208:211],v[16:19],0
 s_mov_b32 m0, s89
 v_exp_f32 v136, v136
 MM v[116:119],v[208:211],v[20:23],0
 ds_read_b128 v[224:227], v12 offset:17152
 buffer_load_dwordx4 v4, s[40:43], s74 offen offset:0 nt lds
 MM v[120:123],v[208:211],v[24:27],0
 s_waitcnt lgkmcnt(3)
 v_exp_f32 v137, v137
 MM v[112:115],v[212:215],v[28:31],v[112:115]
 v_exp_f32 v138, v138
 MM v[116:119],v[212:215],v[32:35],v[116:119]
 ds_read_b128 v[228:231], v12 offset:17216
 CV v160,v136,v137
 MM v[120:123],v[212:215],v[36:39],v[120:123]
 s_waitcnt lgkmcnt(2)
 v_exp_f32 v139, v139
 MM v[112:115],v[216:219],v[40:43],v[112:115]
 ds_read_b128 v[232:235], v12 offset:17280
 CV v161,v138,v139
 MM v[116:119],v[216:219],v[44:47],v[116:119]
 v_exp_f32 v148, v148
 MM v[120:123],v[216:219],v[48:51],v[120:123]
 v_exp_f32 v149, v149
 MM v[112:115],v[220:223],v[52:55],v[112:115]
 ds_read_b128 v[236:239], v12 offset:17344
 buffer_load_dwordx4 v5, s[40:43], s74 offen offset:1056 nt lds
 MM v[116:119],v[220:223],v[56:59],v[116:119]
 v_exp_f32 v150, v150
 MM v[120:123],v[220:223],v[60:63],v[120:123]
 s_waitcnt lgkmcnt(2)
 ds_read_b128 v[208:211], v12 offset:17408
 CV v162,v148,v149
 MM v[112:115],v[224:227],v[64:67],v[112:115]
 v_exp_f32 v151, v151
 MM v[116:119],v[224:227],v[68:71],v[116:119]
 v_exp_f32 v140, v140
 MM v[120:123],v[224:227],v[72:75],v[120:123]
 ds_read_b128 v[212:215], v12 offset:17472
 CV v163,v150,v151
 MM v[112:115],v[228:231],v[76:79],v[112:115]
 v_exp_f32 v141, v141
 MM v[116:119],v[228:231],v[80:83],v[116:119]
 ds_read_b128 v[216:219], v12 offset:17536
 CV v164,v140,v141
 MM v[120:123],v[228:231],v[84:87],v[120:123]
 s_waitcnt lgkmcnt(3)
 v_exp_f32 v142, v142
 MM v[112:115],v[232:235],v[88:91],v[112:115]
 v_exp_f32 v143, v143
 MM v[116:119],v[232:235],v[92:95],v[116:119]
 ds_read_b128 v[220:223], v12 offset:17600
 buffer_load_dwordx4 v6, s[40:43], s74 offen offset:2112 nt lds
 MM v[120:123],v[232:235],v[96:99],v[120:123]
 v_exp_f32 v152, v152
 MM v[112:115],v[236:239],v[100:103],v[112:115]
 ds_read_b128 v[224:227], v12 offset:17664
 CV v165,v142,v143
 MM v[116:119],v[236:239],v[104:107],v[116:119]
 v_exp_f32 v153, v153
 MM v[120:123],v[236:239],v[108:111],v[120:123]
 s_waitcnt lgkmcnt(3)
 v_exp_f32 v154, v154
 MM v[124:127],v[208:211],v[16:19],0
 ds_read_b128 v[228:231], v12 offset:17728
 CV v166,v152,v153
 MM v[128:131],v[208:211],v[20:23],0
 v_exp_f32 v155, v155
 MM v[132:135],v[208:211],v[24:27],0
 ds_read_b128 v[232:235], v12 offset:17792
 buffer_load_dwordx4 v7, s[40:43], s74 offen offset:3168 nt lds
 MM v[124:127],v[212:215],v[28:31],v[124:127]
 s_add_u32 s74, s74, 16384
 v_exp_f32 v144, v144
 MM v[128:131],v[212:215],v[32:35],v[128:131]
 v_exp_f32 v145, v145
 MM v[132:135],v[212:215],v[36:39],v[132:135]
 s_waitcnt lgkmcnt(3)
 ds_read_b128 v[236:239], v12 offset:17856
 CV v167,v154,v155
 MM v[124:127],v[216:219],v[40:43],v[124:127]
 v_exp_f32 v146, v146
 MM v[128:131],v[216:219],v[44:47],v[128:131]
 v_exp_f32 v147, v147
 MM v[132:135],v[216:219],v[48:51],v[132:135]
 CV v168,v144,v145
 CV v169,v146,v147
 MM v[124:127],v[220:223],v[52:55],v[124:127]
 v_exp_f32 v156, v156
 MM v[128:131],v[220:223],v[56:59],v[128:131]
 v_exp_f32 v157, v157
 MM v[132:135],v[220:223],v[60:63],v[132:135]
 s_waitcnt lgkmcnt(3)
 v_exp_f32 v158, v158
 MM v[124:127],v[224:227],v[64:67],v[124:127]
 v_exp_f32 v159, v159
 MM v[128:131],v[224:227],v[68:71],v[128:131]
 CV v170,v156,v157
 CV v171,v158,v159
 MM v[132:135],v[224:227],v[72:75],v[132:135]
 s_waitcnt lgkmcnt(0) vmcnt(8)
 s_barrier
 TR v[208:209],v15,33792
 MM v[124:127],v[228:231],v[76:79],v[124:127]
 TR v[210:211],v15,34304
 MM v[128:131],v[228:231],v[80:83],v[128:131]
 MM v[132:135],v[228:231],v[84:87],v[132:135]
 TR v[212:213],v15,33824
 TR v[214:215],v15,34336
 MM v[124:127],v[232:235],v[88:91],v[124:127]
 MM v[128:131],v[232:235],v[92:95],v[128:131]
 MM v[132:135],v[232:235],v[96:99],v[132:135]
 TR v[216:217],v15,33856
 TR v[218:219],v15,34368
 MM v[124:127],v[236:239],v[100:103],v[124:127]
 MM v[128:131],v[236:239],v[104:107],v[128:131]
 MM v[132:135],v[236:239],v[108:111],v[132:135]
 MM a[192:195],a[204:207],v[160:163],a[192:195]
 MM a[196:199],a[204:207],v[164:167],a[196:199]
 MM a[200:203],a[204:207],v[168:171],a[200:203]
 s_waitcnt lgkmcnt(4)
 TR v[220:221],v15,33888
 MM a[0:3],v[208:211],v[160:163],a[0:3]
 TR v[222:223],v15,34400
 v_fma_f32 v112, v112, s82, v184
 MM a[4:7],v[208:211],v[164:167],a[4:7]
 TR v[224:225],v15,33920
 v_fma_f32 v113, v113, s82, v184
 MM a[8:11],v[208:211],v[168:171],a[8:11]
 s_waitcnt lgkmcnt(5)
 s_mov_b32 m0, s90
 TR v[226:227],v15,34432
 MM a[12:15],v[212:215],v[160:163],a[12:15]
 buffer_load_dwordx4 v4, s[32:35], s72 offen offset:0 nt lds
 v_fma_f32 v114, v114, s82, v184
 MM a[16:19],v[212:215],v[164:167],a[16:19]
 TR v[228:229],v15,33952
 MM a[20:23],v[212:215],v[168:171],a[20:23]
 s_waitcnt lgkmcnt(3)
 TR v[230:231],v15,34464
 v_fma_f32 v115, v115, s82, v184
 MM a[24:27],v[216:219],v[160:163],a[24:27]
 TR v[232:233],v15,33984
 v_fma_f32 v116, v116, s82, v185
 MM a[28:31],v[216:219],v[164:167],a[28:31]
 TR v[234:235],v15,34496
 MM a[32:35],v[216:219],v[168:171],a[32:35]
 buffer_load_dwordx4 v5, s[32:35], s72 offen offset:1056 nt lds
 v_fma_f32 v117, v117, s82, v185
 MM a[36:39],v[220:223],v[160:163],a[36:39]
 TR v[236:237],v15,34016
 v_fma_f32 v118, v118, s82, v185
 MM a[40:43],v[220:223],v[164:167],a[40:43]
 TR v[238:239],v15,34528
 MM a[44:47],v[220:223],v[168:171],a[44:47]
 s_waitcnt lgkmcnt(4)
 TR v[208:209],v15,34048
 v_fma_f32 v119, v119, s82, v185
 MM a[48:51],v[224:227],v[160:163],a[48:51]
 TR v[210:211],v15,34560
 v_max3_f32 v253, v112, v113, v114
 MM a[52:55],v[224:227],v[164:167],a[52:55]
 v_max3_f32 v254, v115, v116, v117
 MM a[56:59],v[224:227],v[168:171],a[56:59]
 TR v[212:213],v15,34080
 v_fma_f32 v120, v120, s82, v186
 MM a[60:63],v[228:231],v[160:163],a[60:63]
 TR v[214:215],v15,34592
 v_fma_f32 v121, v121, s82, v186
 MM a[64:67],v[228:231],v[164:167],a[64:67]
 TR v[216:217],v15,34112
 MM a[68:71],v[228:231],v[168:171],a[68:71]
 s_waitcnt lgkmcnt(5)
 buffer_load_dwordx4 v6, s[32:35], s72 offen offset:2112 nt lds
 v_max3_f32 v253, v253, v118, v119
 MM a[72:75],v[232:235],v[160:163],a[72:75]
 TR v[218:219],v15,34624
 v_fma_f32 v122, v122, s82, v186
 MM a[76:79],v[232:235],v[164:167],a[76:79]
 TR v[220:221],v15,34144
 MM a[80:83],v[232:235],v[168:171],a[80:83]
 TR v[222:223],v15,34656
 v_fma_f32 v123, v123, s82, v186
 MM a[84:87],v[236:239],v[160:163],a[84:87]
 TR v[224:225],v15,34176
 v_max3_f32 v254, v254, v120, v121
 MM a[88:91],v[236:239],v[164:167],a[88:91]
 v_fma_f32 v124, v124, s82, v184
 MM a[92:95],v[236:239],v[168:171],a[92:95]
 s_waitcnt lgkmcnt(5)
 TR v[226:227],v15,34688
 v_fma_f32 v125, v125, s82, v184
 MM a[96:99],v[208:211],v[160:163],a[96:99]
 TR v[228:229],v15,34208
 v_max3_f32 v253, v253, v122, v123
 MM a[100:103],v[208:211],v[164:167],a[100:103]
 TR v[230:231],v15,34720
 MM a[104:107],v[208:211],v[168:171],a[104:107]
 TR v[232:233],v15,34240
 v_fma_f32 v126, v126, s82, v184
 MM a[108:111],v[212:215],v[160:163],a[108:111]
 buffer_load_dwordx4 v7, s[32:35], s72 offen offset:3168 nt lds
 v_fma_f32 v127, v127, s82, v184
 MM a[112:115],v[212:215],v[164:167],a[112:115]
 s_add_u32 s72, s72, 16384
 TR v[234:235],v15,34752
 MM a[116:119],v[212:215],v[168:171],a[116:119]
 s_waitcnt lgkmcnt(6)
 TR v[236:237],v15,34272
 v_max3_f32 v254, v254, v124, v125
 MM a[120:123],v[216:219],v[160:163],a[120:123]
 TR v[238:239],v15,34784
 v_fma_f32 v128, v128, s82, v185
 MM a[124:127],v[216:219],v[164:167],a[124:127]
 v_fma_f32 v129, v129, s82, v185
 MM a[128:131],v[216:219],v[168:171],a[128:131]
 v_max3_f32 v253, v253, v126, v127
 v_fma_f32 v130, v130, s82, v185
 MM a[132:135],v[220:223],v[160:163],a[132:135]
 v_fma_f32 v131, v131, s82, v185
 MM a[136:139],v[220:223],v[164:167],a[136:139]
 v_max3_f32 v254, v254, v128, v129
 MM a[140:143],v[220:223],v[168:171],a[140:143]
 s_waitcnt lgkmcnt(6)
 v_fma_f32 v132, v132, s82, v186
 v_fma_f32 v133, v133, s82, v186
 MM a[144:147],v[224:227],v[160:163],a[144:147]
 v_max3_f32 v253, v253, v130, v131
 MM a[148:151],v[224:227],v[164:167],a[148:151]
 v_fma_f32 v134, v134, s82, v186
 v_fma_f32 v135, v135, s82, v186
 MM a[152:155],v[224:227],v[168:171],a[152:155]
 s_waitcnt lgkmcnt(0) vmcnt(8)
 s_barrier
 ds_read_b128 v[208:211], v13 offset:50688
 MM a[156:159],v[228:231],v[160:163],a[156:159]
 v_max3_f32 v254, v254, v132, v133
 MM a[160:163],v[228:231],v[164:167],a[160:163]
 v_max3_f32 v253, v253, v134, v135
 MM a[164:167],v[228:231],v[168:171],a[164:167]
 ds_read_b128 v[212:215], v13 offset:50752
 v_max_f32 v253, v253, v254
 MM a[168:171],v[232:235],v[160:163],a[168:171]
 v_cmp_lt_f32 vcc, 0x41800000, v253
 MM a[172:175],v[232:235],v[164:167],a[172:175]
 MM a[176:179],v[232:235],v[168:171],a[176:179]
 ds_read_b128 v[216:219], v13 offset:50816
 MM a[180:183],v[236:239],v[160:163],a[180:183]
 MM a[184:187],v[236:239],v[164:167],a[184:187]
 MM a[188:191],v[236:239],v[168:171],a[188:191]
 s_cbranch_vccnz LA_t1
LA_r1:
 s_waitcnt lgkmcnt(2)
 ds_read_b128 v[220:223], v13 offset:50880
 MM v[136:139],v[208:211],v[16:19],0
 s_mov_b32 m0, s95
 v_exp_f32 v112, v112
 MM v[140:143],v[208:211],v[20:23],0
 ds_read_b128 v[224:227], v13 offset:50944
 buffer_load_dwordx4 v4, s[40:43], s74 offen offset:0 nt lds
 MM v[144:147],v[208:211],v[24:27],0
 s_waitcnt lgkmcnt(3)
 v_exp_f32 v113, v113
 MM v[136:139],v[212:215],v[28:31],v[136:139]
 v_exp_f32 v114, v114
 MM v[140:143],v[212:215],v[32:35],v[140:143]
 ds_read_b128 v[228:231], v13 offset:51008
 CV v160,v112,v113
 MM v[144:147],v[212:215],v[36:39],v[144:147]
 s_waitcnt lgkmcnt(2)
 v_exp_f32 v115, v115
 MM v[136:139],v[216:219],v[40:43],v[136:139]
 ds_read_b128 v[232:235], v13 offset:51072
 CV v161,v114,v115
 MM v[140:143],v[216:219],v[44:47],v[140:143]
 v_exp_f32 v124, v124
 MM v[144:147],v[216:219],v[48:51],v[144:147]
 v_exp_f32 v125, v125
 MM v[136:139],v[220:223],v[52:55],v[136:139]
 ds_read_b128 v[236:239], v13 offset:51136
 buffer_load_dwordx4 v5, s[40:43], s74 offen offset:1056 nt lds
 MM v[140:143],v[220:223],v[56:59],v[140:143]
 v_exp_f32 v126, v126
 MM v[144:147],v[220:223],v[60:63],v[144:147]
 s_waitcnt lgkmcnt(2)
 ds_read_b128 v[208:211], v13 offset:51200
 CV v162,v124,v125
 MM v[136:139],v[224:227],v[64:67],v[136:139]
 v_exp_f32 v127, v127
 MM v[140:143],v[224:227],v[68:71],v[140:143]
 v_exp_f32 v116, v116
 MM v[144:147],v[224:227],v[72:75],v[144:147]
 ds_read_b128 v[212:215], v13 offset:51264
 CV v163,v126,v127
 MM v[136:139],v[228:231],v[76:79],v[136:139]
 v_exp_f32 v117, v117
 MM v[140:143],v[228:231],v[80:83],v[140:143]
 ds_read_b128 v[216:219], v13 offset:51328
 CV v164,v116,v117
 MM v[144:147],v[228:231],v[84:87],v[144:147]
 s_waitcnt lgkmcnt(3)
 v_exp_f32 v118, v118
 MM v[136:139],v[232:235],v[88:91],v[136:139]
 v_exp_f32 v119, v119
 MM v[140:143],v[232:235],v[92:95],v[140:143]
 ds_read_b128 v[220:223], v13 offset:51392
 buffer_load_dwordx4 v6, s[40:43], s74 offen offset:2112 nt lds
 MM v[144:147],v[232:235],v[96:99],v[144:147]
 v_exp_f32 v128, v128
 MM v[136:139],v[236:239],v[100:103],v[136:139]
 ds_read_b128 v[224:227], v13 offset:51456
 CV v165,v118,v119
 MM v[140:143],v[236:239],v[104:107],v[140:143]
 v_exp_f32 v129, v129
 MM v[144:147],v[236:239],v[108:111],v[144:147]
 s_waitcnt lgkmcnt(3)
 v_exp_f32 v130, v130
 MM v[148:151],v[208:211],v[16:19],0
 ds_read_b128 v[228:231], v13 offset:51520
 CV v166,v128,v129
 MM v[152:155],v[208:211],v[20:23],0
 v_exp_f32 v131, v131
 MM v[156:159],v[208:211],v[24:27],0
 ds_read_b128 v[232:235], v13 offset:51584
 buffer_load_dwordx4 v7, s[40:43], s74 offen offset:3168 nt lds
 MM v[148:151],v[212:215],v[28:31],v[148:151]
 s_add_u32 s74, s74, 16384
 v_exp_f32 v120, v120
 MM v[152:155],v[212:215],v[32:35],v[152:155]
 v_exp_f32 v121, v121
 MM v[156:159],v[212:215],v[36:39],v[156:159]
 s_waitcnt lgkmcnt(3)
 ds_read_b128 v[236:239], v13 offset:51648
 CV v167,v130,v131
 MM v[148:151],v[216:219],v[40:43],v[148:151]
 v_exp_f32 v122, v122
 MM v[152:155],v[216:219],v[44:47],v[152:155]
 v_exp_f32 v123, v123
 MM v[156:159],v[216:219],v[48:51],v[156:159]
 CV v168,v120,v121
 CV v169,v122,v123
 MM v[148:151],v[220:223],v[52:55],v[148:151]
 v_exp_f32 v132, v132
 MM v[152:155],v[220:223],v[56:59],v[152:155]
 v_exp_f32 v133, v133
 MM v[156:159],v[220:223],v[60:63],v[156:159]
 s_waitcnt lgkmcnt(3)
 v_exp_f32 v134, v134
 MM v[148:151],v[224:227],v[64:67],v[148:151]
 v_exp_f32 v135, v135
 MM v[152:155],v[224:227],v[68:71],v[152:155]
 CV v170,v132,v133
 CV v171,v134,v135
 MM v[156:159],v[224:227],v[72:75],v[156:159]
 s_waitcnt lgkmcnt(0) vmcnt(8)
 s_barrier
 TR v[208:209],v14,0
 MM v[148:151],v[228:231],v[76:79],v[148:151]
 TR v[210:211],v14,512
 MM v[152:155],v[228:231],v[80:83],v[152:155]
 MM v[156:159],v[228:231],v[84:87],v[156:159]
 TR v[212:213],v14,32
 TR v[214:215],v14,544
 MM v[148:151],v[232:235],v[88:91],v[148:151]
 MM v[152:155],v[232:235],v[92:95],v[152:155]
 MM v[156:159],v[232:235],v[96:99],v[156:159]
 TR v[216:217],v14,64
 TR v[218:219],v14,576
 MM v[148:151],v[236:239],v[100:103],v[148:151]
 MM v[152:155],v[236:239],v[104:107],v[152:155]
 MM v[156:159],v[236:239],v[108:111],v[156:159]
 MM a[192:195],a[204:207],v[160:163],a[192:195]
 MM a[196:199],a[204:207],v[164:167],a[196:199]
 MM a[200:203],a[204:207],v[168:171],a[200:203]
 s_waitcnt lgkmcnt(4)
 TR v[220:221],v14,96
 MM a[0:3],v[208:211],v[160:163],a[0:3]
 TR v[222:223],v14,608
 v_fma_f32 v136, v136, s82, v184
 MM a[4:7],v[208:211],v[164:167],a[4:7]
 TR v[224:225],v14,128
 v_fma_f32 v137, v137, s82, v184
 MM a[8:11],v[208:211],v[168:171],a[8:11]
 s_waitcnt lgkmcnt(5)
 s_mov_b32 m0, s96
 TR v[226:227],v14,640
 MM a[12:15],v[212:215],v[160:163],a[12:15]
 buffer_load_dwordx4 v4, s[32:35], s72 offen offset:0 nt lds
 v_fma_f32 v138, v138, s82, v184
 MM a[16:19],v[212:215],v[164:167],a[16:19]
 TR v[228:229],v14,160
 MM a[20:23],v[212:215],v[168:171],a[20:23]
 s_waitcnt lgkmcnt(3)
 TR v[230:231],v14,672
 v_fma_f32 v139, v139, s82, v184
 MM a[24:27],v[216:219],v[160:163],a[24:27]
 TR v[232:233],v14,192
 v_fma_f32 v140, v140, s82, v185
 MM a[28:31],v[216:219],v[164:167],a[28:31]
 TR v[234:235],v14,704
 MM a[32:35],v[216:219],v[168:171],a[32:35]
 buffer_load_dwordx4 v5, s[32:35], s72 offen offset:1056 nt lds
 v_fma_f32 v141, v141, s82, v185
 MM a[36:39],v[220:223],v[160:163],a[36:39]
 TR v[236:237],v14,224
 v_fma_f32 v142, v142, s82, v185
 MM a[40:43],v[220:223],v[164:167],a[40:43]
 TR v[238:239],v14,736
 MM a[44:47],v[220:223],v[168:171],a[44:47]
 s_waitcnt lgkmcnt(4)
 TR v[208:209],v14,256
 v_fma_f32 v143, v143, s82, v185
 MM a[48:51],v[224:227],v[160:163],a[48:51]
 TR v[210:211],v14,768
 v_max3_f32 v253, v136, v137, v138
 MM a[52:55],v[224:227],v[164:167],a[52:55]
 v_max3_f32 v254, v139, v140, v141
 MM a[56:59],v[224:227],v[168:171],a[56:59]
 TR v[212:213],v14,288
 v_fma_f32 v144, v144, s82, v186
 MM a[60:63],v[228:231],v[160:163],a[60:63]
 TR v[214:215],v14,800
 v_fma_f32 v145, v145, s82, v186
 MM a[64:67],v[228:231],v[164:167],a[64:67]
 TR v[216:217],v14,320
 MM a[68:71],v[228:231],v[168:171],a[68:71]
 s_waitcnt lgkmcnt(5)
 buffer_load_dwordx4 v6, s[32:35], s72 offen offset:2112 nt lds
 v_max3_f32 v253, v253, v142, v143
 MM a[72:75],v[232:235],v[160:163],a[72:75]
 TR v[218:219],v14,832
 v_fma_f32 v146, v146, s82, v186
 MM a[76:79],v[232:235],v[164:167],a[76:79]
 TR v[220:221],v14,352
 MM a[80:83],v[232:235],v[168:171],a[80:83]
 TR v[222:223],v14,864
 v_fma_f32 v147, v147, s82, v186
 MM a[84:87],v[236:239],v[160:163],a[84:87]
 TR v[224:225],v14,384
 v_max3_f32 v254, v254, v144, v145
 MM a[88:91],v[236:239],v[164:167],a[88:91]
 v_fma_f32 v148, v148, s82, v184
 MM a[92:95],v[236:239],v[168:171],a[92:95]
 s_waitcnt lgkmcnt(5)
 TR v[226:227],v14,896
 v_fma_f32 v149, v149, s82, v184
 MM a[96:99],v[208:211],v[160:163],a[96:99]
 TR v[228:229],v14,416
 v_max3_f32 v253, v253, v146, v147
 MM a[100:103],v[208:211],v[164:167],a[100:103]
 TR v[230:231],v14,928
 MM a[104:107],v[208:211],v[168:171],a[104:107]
 TR v[232:233],v14,448
 v_fma_f32 v150, v150, s82, v184
 MM a[108:111],v[212:215],v[160:163],a[108:111]
 buffer_load_dwordx4 v7, s[32:35], s72 offen offset:3168 nt lds
 v_fma_f32 v151, v151, s82, v184
 MM a[112:115],v[212:215],v[164:167],a[112:115]
 s_add_u32 s72, s72, 16384
 TR v[234:235],v14,960
 MM a[116:119],v[212:215],v[168:171],a[116:119]
 s_waitcnt lgkmcnt(6)
 TR v[236:237],v14,480
 v_max3_f32 v254, v254, v148, v149
 MM a[120:123],v[216:219],v[160:163],a[120:123]
 TR v[238:239],v14,992
 v_fma_f32 v152, v152, s82, v185
 MM a[124:127],v[216:219],v[164:167],a[124:127]
 v_fma_f32 v153, v153, s82, v185
 MM a[128:131],v[216:219],v[168:171],a[128:131]
 v_max3_f32 v253, v253, v150, v151
 v_fma_f32 v154, v154, s82, v185
 MM a[132:135],v[220:223],v[160:163],a[132:135]
 v_fma_f32 v155, v155, s82, v185
 MM a[136:139],v[220:223],v[164:167],a[136:139]
 v_max3_f32 v254, v254, v152, v153
 MM a[140:143],v[220:223],v[168:171],a[140:143]
 s_waitcnt lgkmcnt(6)
 v_fma_f32 v156, v156, s82, v186
 v_fma_f32 v157, v157, s82, v186
 MM a[144:147],v[224:227],v[160:163],a[144:147]
 v_max3_f32 v253, v253, v154, v155
 MM a[148:151],v[224:227],v[164:167],a[148:151]
 v_fma_f32 v158, v158, s82, v186
 v_fma_f32 v159, v159, s82, v186
 MM a[152:155],v[224:227],v[168:171],a[152:155]
 s_waitcnt lgkmcnt(0) vmcnt(8)
 s_barrier
 ds_read_b128 v[208:211], v12 offset:16896
 MM a[156:159],v[228:231],v[160:163],a[156:159]
 v_max3_f32 v254, v254, v156, v157
 MM a[160:163],v[228:231],v[164:167],a[160:163]
 v_max3_f32 v253, v253, v158, v159
 MM a[164:167],v[228:231],v[168:171],a[164:167]
 ds_read_b128 v[212:215], v12 offset:16960
 v_max_f32 v253, v253, v254
 MM a[168:171],v[232:235],v[160:163],a[168:171]
 v_cmp_lt_f32 vcc, 0x41800000, v253
 MM a[172:175],v[232:235],v[164:167],a[172:175]
 MM a[176:179],v[232:235],v[168:171],a[176:179]
 ds_read_b128 v[216:219], v12 offset:17024
 MM a[180:183],v[236:239],v[160:163],a[180:183]
 MM a[184:187],v[236:239],v[164:167],a[184:187]
 MM a[188:191],v[236:239],v[168:171],a[188:191]
 s_cbranch_vccnz LA_t2
LA_r2:
 s_waitcnt lgkmcnt(2)
 ds_read_b128 v[220:223], v12 offset:17088
 MM v[112:115],v[208:211],v[16:19],0
 s_mov_b32 m0, s89
 v_exp_f32 v136, v136
 MM v[116:119],v[208:211],v[20:23],0
 ds_read_b128 v[224:227], v12 offset:17152
 buffer_load_dwordx4 v4, s[40:43], s74 offen offset:0 nt lds
 MM v[120:123],v[208:211],v[24:27],0
 s_waitcnt lgkmcnt(3)
 v_exp_f32 v137, v137
 MM v[112:115],v[212:215],v[28:31],v[112:115]
 v_exp_f32 v138, v138
 MM v[116:119],v[212:215],v[32:35],v[116:119]
 ds_read_b128 v[228:231], v12 offset:17216
 CV v160,v136,v137
 MM v[120:123],v[212:215],v[36:39],v[120:123]
 s_waitcnt lgkmcnt(2)
 v_exp_f32 v139, v139
 MM v[112:115],v[216:219],v[40:43],v[112:115]
 ds_read_b128 v[232:235], v12 offset:17280
 CV v161,v138,v139
 MM v[116:119],v[216:219],v[44:47],v[116:119]
 v_exp_f32 v148, v148
 MM v[120:123],v[216:219],v[48:51],v[120:123]
 v_exp_f32 v149, v149
 MM v[112:115],v[220:223],v[52:55],v[112:115]
 ds_read_b128 v[236:239], v12 offset:17344
 buffer_load_dwordx4 v5, s[40:43], s74 offen offset:1056 nt lds
 MM v[116:119],v[220:223],v[56:59],v[116:119]
 v_exp_f32 v150, v150
 MM v[120:123],v[220:223],v[60:63],v[120:123]
 s_waitcnt lgkmcnt(2)
 ds_read_b128 v[208:211], v12 offset:17408
 CV v162,v148,v149
 MM v[112:115],v[224:227],v[64:67],v[112:115]
 v_exp_f32 v151, v151
 MM v[116:119],v[224:227],v[68:71],v[116:119]
 v_exp_f32 v140, v140
 MM v[120:123],v[224:227],v[72:75],v[120:123]
 ds_read_b128 v[212:215], v12 offset:17472
 CV v163,v150,v151
 MM v[112:115],v[228:231],v[76:79],v[112:115]
 v_exp_f32 v141, v141
 MM v[116:119],v[228:231],v[80:83],v[116:119]
 ds_read_b128 v[216:219], v12 offset:17536
 CV v164,v140,v141
 MM v[120:123],v[228:231],v[84:87],v[120:123]
 s_waitcnt lgkmcnt(3)
 v_exp_f32 v142, v142
 MM v[112:115],v[232:235],v[88:91],v[112:115]
 v_exp_f32 v143, v143
 MM v[116:119],v[232:235],v[92:95],v[116:119]
 ds_read_b128 v[220:223], v12 offset:17600
 buffer_load_dwordx4 v6, s[40:43], s74 offen offset:2112 nt lds
 MM v[120:123],v[232:235],v[96:99],v[120:123]
 v_exp_f32 v152, v152
 MM v[112:115],v[236:239],v[100:103],v[112:115]
 ds_read_b128 v[224:227], v12 offset:17664
 CV v165,v142,v143
 MM v[116:119],v[236:239],v[104:107],v[116:119]
 v_exp_f32 v153, v153
 MM v[120:123],v[236:239],v[108:111],v[120:123]
 s_waitcnt lgkmcnt(3)
 v_exp_f32 v154, v154
 MM v[124:127],v[208:211],v[16:19],0
 ds_read_b128 v[228:231], v12 offset:17728
 CV v166,v152,v153
 MM v[128:131],v[208:211],v[20:23],0
 v_exp_f32 v155, v155
 MM v[132:135],v[208:211],v[24:27],0
 ds_read_b128 v[232:235], v12 offset:17792
 buffer_load_dwordx4 v7, s[40:43], s74 offen offset:3168 nt lds
 MM v[124:127],v[212:215],v[28:31],v[124:127]
 s_add_u32 s74, s74, 16384
 v_exp_f32 v144, v144
 MM v[128:131],v[212:215],v[32:35],v[128:131]
 v_exp_f32 v145, v145
 MM v[132:135],v[212:215],v[36:39],v[132:135]
 s_waitcnt lgkmcnt(3)
 ds_read_b128 v[236:239], v12 offset:17856
 CV v167,v154,v155
 MM v[124:127],v[216:219],v[40:43],v[124:127]
 v_exp_f32 v146, v146
 MM v[128:131],v[216:219],v[44:47],v[128:131]
 v_exp_f32 v147, v147
 MM v[132:135],v[216:219],v[48:51],v[132:135]
 CV v168,v144,v145
 CV v169,v146,v147
 MM v[124:127],v[220:223],v[52:55],v[124:127]
 v_exp_f32 v156, v156
 MM v[128:131],v[220:223],v[56:59],v[128:131]
 v_exp_f32 v157, v157
 MM v[132:135],v[220:223],v[60:63],v[132:135]
 s_waitcnt lgkmcnt(3)
 v_exp_f32 v158, v158
 MM v[124:127],v[224:227],v[64:67],v[124:127]
 v_exp_f32 v159, v159
 MM v[128:131],v[224:227],v[68:71],v[128:131]
 CV v170,v156,v157
 CV v171,v158,v159
 MM v[132:135],v[224:227],v[72:75],v[132:135]
 s_waitcnt lgkmcnt(0) vmcnt(8)
 s_barrier
 TR v[208:209],v15,33792
 MM v[124:127],v[228:231],v[76:79],v[124:127]
 TR v[210:211],v15,34304
 MM v[128:131],v[228:231],v[80:83],v[128:131]
 MM v[132:135],v[228:231],v[84:87],v[132:135]
 TR v[212:213],v15,33824
 TR v[214:215],v15,34336
 MM v[124:127],v[232:235],v[88:91],v[124:127]
 MM v[128:131],v[232:235],v[92:95],v[128:131]
 MM v[132:135],v[232:235],v[96:99],v[132:135]
 TR v[216:217],v15,33856
 TR v[218:219],v15,34368
 MM v[124:127],v[236:239],v[100:103],v[124:127]
 MM v[128:131],v[236:239],v[104:107],v[128:131]
 MM v[132:135],v[236:239],v[108:111],v[132:135]
 MM a[192:195],a[204:207],v[160:163],a[192:195]
 MM a[196:199],a[204:207],v[164:167],a[196:199]
 MM a[200:203],a[204:207],v[168:171],a[200:203]
 s_waitcnt lgkmcnt(4)
 TR v[220:221],v15,33888
 MM a[0:3],v[208:211],v[160:163],a[0:3]
 TR v[222:223],v15,34400
 v_fma_f32 v112, v112, s82, v184
 MM a[4:7],v[208:211],v[164:167],a[4:7]
 TR v[224:225],v15,33920
 v_fma_f32 v113, v113, s82, v184
 MM a[8:11],v[208:211],v[168:171],a[8:11]
 s_waitcnt lgkmcnt(5)
 TR v[226:227],v15,34432
 MM a[12:15],v[212:215],v[160:163],a[12:15]
 v_fma_f32 v114, v114, s82, v184
 v_fma_f32 v115, v115, s82, v184
 MM a[16:19],v[212:215],v[164:167],a[16:19]
 TR v[228:229],v15,33952
 MM a[20:23],v[212:215],v[168:171],a[20:23]
 s_waitcnt lgkmcnt(3)
 TR v[230:231],v15,34464
 v_fma_f32 v116, v116, s82, v185
 MM a[24:27],v[216:219],v[160:163],a[24:27]
 TR v[232:233],v15,33984
 v_fma_f32 v117, v117, s82, v185
 MM a[28:31],v[216:219],v[164:167],a[28:31]
 TR v[234:235],v15,34496
 MM a[32:35],v[216:219],v[168:171],a[32:35]
 v_fma_f32 v118, v118, s82, v185
 v_fma_f32 v119, v119, s82, v185
 MM a[36:39],v[220:223],v[160:163],a[36:39]
 TR v[236:237],v15,34016
 MM a[40:43],v[220:223],v[164:167],a[40:43]
 TR v[238:239],v15,34528
 v_max3_f32 v253, v112, v113, v114
 MM a[44:47],v[220:223],v[168:171],a[44:47]
 s_waitcnt lgkmcnt(4)
 TR v[208:209],v15,34048
 MM a[48:51],v[224:227],v[160:163],a[48:51]
 TR v[210:211],v15,34560
 v_max3_f32 v254, v115, v116, v117
 MM a[52:55],v[224:227],v[164:167],a[52:55]
 v_fma_f32 v120, v120, s82, v186
 MM a[56:59],v[224:227],v[168:171],a[56:59]
 TR v[212:213],v15,34080
 v_fma_f32 v121, v121, s82, v186
 MM a[60:63],v[228:231],v[160:163],a[60:63]
 TR v[214:215],v15,34592
 v_max3_f32 v253, v253, v118, v119
 MM a[64:67],v[228:231],v[164:167],a[64:67]
 TR v[216:217],v15,34112
 MM a[68:71],v[228:231],v[168:171],a[68:71]
 s_waitcnt lgkmcnt(5)
 v_fma_f32 v122, v122, s82, v186
 v_fma_f32 v123, v123, s82, v186
 MM a[72:75],v[232:235],v[160:163],a[72:75]
 TR v[218:219],v15,34624
 MM a[76:79],v[232:235],v[164:167],a[76:79]
 TR v[220:221],v15,34144
 v_max3_f32 v254, v254, v120, v121
 MM a[80:83],v[232:235],v[168:171],a[80:83]
 TR v[222:223],v15,34656
 MM a[84:87],v[236:239],v[160:163],a[84:87]
 TR v[224:225],v15,34176
 v_fma_f32 v124, v124, s82, v184
 MM a[88:91],v[236:239],v[164:167],a[88:91]
 v_fma_f32 v125, v125, s82, v184
 MM a[92:95],v[236:239],v[168:171],a[92:95]
 s_waitcnt lgkmcnt(5)
 TR v[226:227],v15,34688
 v_max3_f32 v253, v253, v122, v123
 MM a[96:99],v[208:211],v[160:163],a[96:99]
 TR v[228:229],v15,34208
 v_fma_f32 v126, v126, s82, v184
 MM a[100:103],v[208:211],v[164:167],a[100:103]
 TR v[230:231],v15,34720
 MM a[104:107],v[208:211],v[168:171],a[104:107]
 TR v[232:233],v15,34240
 v_fma_f32 v127, v127, s82, v184
 MM a[108:111],v[212:215],v[160:163],a[108:111]
 v_max3_f32 v254, v254, v124, v125
 MM a[112:115],v[212:215],v[164:167],a[112:115]
 TR v[234:235],v15,34752
 v_fma_f32 v128, v128, s82, v185
 MM a[116:119],v[212:215],v[168:171],a[116:119]
 s_waitcnt lgkmcnt(6)
 TR v[236:237],v15,34272
 MM a[120:123],v[216:219],v[160:163],a[120:123]
 TR v[238:239],v15,34784
 v_fma_f32 v129, v129, s82, v185
 MM a[124:127],v[216:219],v[164:167],a[124:127]
 v_max3_f32 v253, v253, v126, v127
 MM a[128:131],v[216:219],v[168:171],a[128:131]
 v_fma_f32 v130, v130, s82, v185
 v_fma_f32 v131, v131, s82, v185
 MM a[132:135],v[220:223],v[160:163],a[132:135]
 v_max3_f32 v254, v254, v128, v129
 MM a[136:139],v[220:223],v[164:167],a[136:139]
 v_fma_f32 v132, v132, s82, v186
 MM a[140:143],v[220:223],v[168:171],a[140:143]
 s_waitcnt lgkmcnt(6)
 v_fma_f32 v133, v133, s82, v186
 MM a[144:147],v[224:227],v[160:163],a[144:147]
 v_max3_f32 v253, v253, v130, v131
 v_fma_f32 v134, v134, s82, v186
 MM a[148:151],v[224:227],v[164:167],a[148:151]
 v_fma_f32 v135, v135, s82, v186
 MM a[152:155],v[224:227],v[168:171],a[152:155]
 s_waitcnt lgkmcnt(0) vmcnt(4)
 s_barrier
 ds_read_b128 v[208:211], v13 offset:50688
 MM a[156:159],v[228:231],v[160:163],a[156:159]
 v_max3_f32 v254, v254, v132, v133
 MM a[160:163],v[228:231],v[164:167],a[160:163]
 v_max3_f32 v253, v253, v134, v135
 v_max_f32 v253, v253, v254
 MM a[164:167],v[228:231],v[168:171],a[164:167]
 ds_read_b128 v[212:215], v13 offset:50752
 MM a[168:171],v[232:235],v[160:163],a[168:171]
 v_cmp_lt_f32 vcc, 0x41800000, v253
 MM a[172:175],v[232:235],v[164:167],a[172:175]
 MM a[176:179],v[232:235],v[168:171],a[176:179]
 ds_read_b128 v[216:219], v13 offset:50816
 MM a[180:183],v[236:239],v[160:163],a[180:183]
 MM a[184:187],v[236:239],v[164:167],a[184:187]
 MM a[188:191],v[236:239],v[168:171],a[188:191]
 s_cbranch_vccnz LA_t3
LA_r3:
 s_waitcnt lgkmcnt(2)
 ds_read_b128 v[220:223], v13 offset:50880
 MM v[136:139],v[208:211],v[16:19],0
 v_exp_f32 v112, v112
 MM v[140:143],v[208:211],v[20:23],0
 ds_read_b128 v[224:227], v13 offset:50944
 MM v[144:147],v[208:211],v[24:27],0
 s_waitcnt lgkmcnt(3)
 v_exp_f32 v113, v113
 MM v[136:139],v[212:215],v[28:31],v[136:139]
 v_exp_f32 v114, v114
 MM v[140:143],v[212:215],v[32:35],v[140:143]
 ds_read_b128 v[228:231], v13 offset:51008
 CV v160,v112,v113
 MM v[144:147],v[212:215],v[36:39],v[144:147]
 s_waitcnt lgkmcnt(2)
 v_exp_f32 v115, v115
 MM v[136:139],v[216:219],v[40:43],v[136:139]
 ds_read_b128 v[232:235], v13 offset:51072
 CV v161,v114,v115
 MM v[140:143],v[216:219],v[44:47],v[140:143]
 v_exp_f32 v124, v124
 MM v[144:147],v[216:219],v[48:51],v[144:147]
 v_exp_f32 v125, v125
 MM v[136:139],v[220:223],v[52:55],v[136:139]
 ds_read_b128 v[236:239], v13 offset:51136
 CV v162,v124,v125
 MM v[140:143],v[220:223],v[56:59],v[140:143]
 v_exp_f32 v126, v126
 MM v[144:147],v[220:223],v[60:63],v[144:147]
 s_waitcnt lgkmcnt(2)
 ds_read_b128 v[208:211], v13 offset:51200
 MM v[136:139],v[224:227],v[64:67],v[136:139]
 v_exp_f32 v127, v127
 MM v[140:143],v[224:227],v[68:71],v[140:143]
 v_exp_f32 v116, v116
 MM v[144:147],v[224:227],v[72:75],v[144:147]
 ds_read_b128 v[212:215], v13 offset:51264
 CV v163,v126,v127
 MM v[136:139],v[228:231],v[76:79],v[136:139]
 v_exp_f32 v117, v117
 MM v[140:143],v[228:231],v[80:83],v[140:143]
 ds_read_b128 v[216:219], v13 offset:51328
 CV v164,v116,v117
 MM v[144:147],v[228:231],v[84:87],v[144:147]
 s_waitcnt lgkmcnt(3)
 v_exp_f32 v118, v118
 MM v[136:139],v[232:235],v[88:91],v[136:139]
 v_exp_f32 v119, v119
 MM v[140:143],v[232:235],v[92:95],v[140:143]
 ds_read_b128 v[220:223], v13 offset:51392
 CV v165,v118,v119
 MM v[144:147],v[232:235],v[96:99],v[144:147]
 v_exp_f32 v128, v128
 MM v[136:139],v[236:239],v[100:103],v[136:139]
 ds_read_b128 v[224:227], v13 offset:51456
 MM v[140:143],v[236:239],v[104:107],v[140:143]
 v_exp_f32 v129, v129
 MM v[144:147],v[236:239],v[108:111],v[144:147]
 s_waitcnt lgkmcnt(3)
 v_exp_f32 v130, v130
 MM v[148:151],v[208:211],v[16:19],0
 ds_read_b128 v[228:231], v13 offset:51520
 CV v166,v128,v129
 MM v[152:155],v[208:211],v[20:23],0
 v_exp_f32 v131, v131
 MM v[156:159],v[208:211],v[24:27],0
 ds_read_b128 v[232:235], v13 offset:51584
 CV v167,v130,v131
 MM v[148:151],v[212:215],v[28:31],v[148:151]
 v_exp_f32 v120, v120
 MM v[152:155],v[212:215],v[32:35],v[152:155]
 v_exp_f32 v121, v121
 MM v[156:159],v[212:215],v[36:39],v[156:159]
 s_waitcnt lgkmcnt(3)
 ds_read_b128 v[236:239], v13 offset:51648
 CV v168,v120,v121
 MM v[148:151],v[216:219],v[40:43],v[148:151]
 v_exp_f32 v122, v122
 MM v[152:155],v[216:219],v[44:47],v[152:155]
 v_exp_f32 v123, v123
 MM v[156:159],v[216:219],v[48:51],v[156:159]
 v_exp_f32 v132, v132
 MM v[148:151],v[220:223],v[52:55],v[148:151]
 v_exp_f32 v133, v133
 MM v[152:155],v[220:223],v[56:59],v[152:155]
 CV v169,v122,v123
 CV v170,v132,v133
 MM v[156:159],v[220:223],v[60:63],v[156:159]
 s_waitcnt lgkmcnt(3)
 v_exp_f32 v134, v134
 MM v[148:151],v[224:227],v[64:67],v[148:151]
 v_exp_f32 v135, v135
 MM v[152:155],v[224:227],v[68:71],v[152:155]
 CV v171,v134,v135
 MM v[156:159],v[224:227],v[72:75],v[156:159]
 s_waitcnt lgkmcnt(0) vmcnt(0)
 s_barrier
 TR v[208:209],v14,0
 MM v[148:151],v[228:231],v[76:79],v[148:151]
 TR v[210:211],v14,512
 MM v[152:155],v[228:231],v[80:83],v[152:155]
 MM v[156:159],v[228:231],v[84:87],v[156:159]
 TR v[212:213],v14,32
 TR v[214:215],v14,544
 MM v[148:151],v[232:235],v[88:91],v[148:151]
 MM v[152:155],v[232:235],v[92:95],v[152:155]
 MM v[156:159],v[232:235],v[96:99],v[156:159]
 s_mov_b32 m0, s90
 TR v[216:217],v14,64
 TR v[218:219],v14,576
 MM v[148:151],v[236:239],v[100:103],v[148:151]
 buffer_load_dwordx4 v4, s[32:35], s72 offen offset:0 nt lds
 MM v[152:155],v[236:239],v[104:107],v[152:155]
 buffer_load_dwordx4 v5, s[32:35], s72 offen offset:1056 nt lds
 MM v[156:159],v[236:239],v[108:111],v[156:159]
 s_mov_b32 s79, 0
LA_loop24:
 buffer_load_dwordx4 v6, s[32:35], s72 offen offset:2112 nt lds
 MM a[192:195],a[204:207],v[160:163],a[192:195]
 buffer_load_dwordx4 v7, s[32:35], s72 offen offset:3168 nt lds
 MM a[196:199],a[204:207],v[164:167],a[196:199]
 s_add_u32 s72, s72, 16384
 MM a[200:203],a[204:207],v[168:171],a[200:203]
 s_waitcnt lgkmcnt(4)
 TR v[220:221],v14,96
 MM a[0:3],v[208:211],v[160:163],a[0:3]
 TR v[222:223],v14,608
 v_fma_f32 v136, v136, s82, v184
 MM a[4:7],v[208:211],v[164:167],a[4:7]
 TR v[224:225],v14,128
 v_fma_f32 v137, v137, s82, v184
 MM a[8:11],v[208:211],v[168:171],a[8:11]
 s_waitcnt lgkmcnt(5)
 TR v[226:227],v14,640
 MM a[12:15],v[212:215],v[160:163],a[12:15]
 v_fma_f32 v138, v138, s82, v184
 v_fma_f32 v139, v139, s82, v184
 MM a[16:19],v[212:215],v[164:167],a[16:19]
 TR v[228:229],v14,160
 MM a[20:23],v[212:215],v[168:171],a[20:23]
 s_waitcnt lgkmcnt(3)
 TR v[230:231],v14,672
 v_fma_f32 v140, v140, s82, v185
 MM a[24:27],v[216:219],v[160:163],a[24:27]
 TR v[232:233],v14,192
 v_fma_f32 v141, v141, s82, v185
 MM a[28:31],v[216:219],v[164:167],a[28:31]
 TR v[234:235],v14,704
 MM a[32:35],v[216:219],v[168:171],a[32:35]
 v_fma_f32 v142, v142, s82, v185
 v_fma_f32 v143, v143, s82, v185
 MM a[36:39],v[220:223],v[160:163],a[36:39]
 TR v[236:237],v14,224
 MM a[40:43],v[220:223],v[164:167],a[40:43]
 TR v[238:239],v14,736
 v_max3_f32 v253, v136, v137, v138
 MM a[44:47],v[220:223],v[168:171],a[44:47]
 s_waitcnt lgkmcnt(4)
 TR v[208:209],v14,256
 v_max3_f32 v254, v139, v140, v141
 MM a[48:51],v[224:227],v[160:163],a[48:51]
 TR v[210:211],v14,768
 MM a[52:55],v[224:227],v[164:167],a[52:55]
 v_fma_f32 v144, v144, s82, v186
 v_fma_f32 v145, v145, s82, v186
 MM a[56:59],v[224:227],v[168:171],a[56:59]
 TR v[212:213],v14,288
 MM a[60:63],v[228:231],v[160:163],a[60:63]
 TR v[214:215],v14,800
 v_max3_f32 v253, v253, v142, v143
 MM a[64:67],v[228:231],v[164:167],a[64:67]
 TR v[216:217],v14,320
 MM a[68:71],v[228:231],v[168:171],a[68:71]
 s_waitcnt lgkmcnt(5)
 v_fma_f32 v146, v146, s82, v186
 v_fma_f32 v147, v147, s82, v186
 MM a[72:75],v[232:235],v[160:163],a[72:75]
 TR v[218:219],v14,832
 MM a[76:79],v[232:235],v[164:167],a[76:79]
 TR v[220:221],v14,352
 v_max3_f32 v254, v254, v144, v145
 MM a[80:83],v[232:235],v[168:171],a[80:83]
 TR v[222:223],v14,864
 v_fma_f32 v148, v148, s82, v184
 MM a[84:87],v[236:239],v[160:163],a[84:87]
 TR v[224:225],v14,384
 MM a[88:91],v[236:239],v[164:167],a[88:91]
 v_fma_f32 v149, v149, s82, v184
 v_max3_f32 v253, v253, v146, v147
 MM a[92:95],v[236:239],v[168:171],a[92:95]
 s_waitcnt lgkmcnt(5)
 TR v[226:227],v14,896
 MM a[96:99],v[208:211],v[160:163],a[96:99]
 TR v[228:229],v14,416
 v_fma_f32 v150, v150, s82, v184
 MM a[100:103],v[208:211],v[164:167],a[100:103]
 TR v[230:231],v14,928
 v_fma_f32 v151, v151, s82, v184
 MM a[104:107],v[208:211],v[168:171],a[104:107]
 TR v[232:233],v14,448
 MM a[108:111],v[212:215],v[160:163],a[108:111]
 v_max3_f32 v254, v254, v148, v149
 v_fma_f32 v152, v152, s82, v185
 MM a[112:115],v[212:215],v[164:167],a[112:115]
 TR v[234:235],v14,960
 MM a[116:119],v[212:215],v[168:171],a[116:119]
 s_waitcnt lgkmcnt(6)
 TR v[236:237],v14,480
 v_fma_f32 v153, v153, s82, v185
 MM a[120:123],v[216:219],v[160:163],a[120:123]
 TR v[238:239],v14,992
 v_max3_f32 v253, v253, v150, v151
 MM a[124:127],v[216:219],v[164:167],a[124:127]
 v_fma_f32 v154, v154, s82, v185
 MM a[128:131],v[216:219],v[168:171],a[128:131]
 v_fma_f32 v155, v155, s82, v185
 MM a[132:135],v[220:223],v[160:163],a[132:135]
 v_max3_f32 v254, v254, v152, v153
 MM a[136:139],v[220:223],v[164:167],a[136:139]
 v_fma_f32 v156, v156, s82, v186
 v_fma_f32 v157, v157, s82, v186
 MM a[140:143],v[220:223],v[168:171],a[140:143]
 s_waitcnt lgkmcnt(6)
 v_max3_f32 v253, v253, v154, v155
 MM a[144:147],v[224:227],v[160:163],a[144:147]
 v_fma_f32 v158, v158, s82, v186
 MM a[148:151],v[224:227],v[164:167],a[148:151]
 v_fma_f32 v159, v159, s82, v186
 v_max3_f32 v254, v254, v156, v157
 MM a[152:155],v[224:227],v[168:171],a[152:155]
 s_waitcnt lgkmcnt(0) vmcnt(0)
 s_barrier
 ds_read_b128 v[208:211], v12 offset:16896
 MM a[156:159],v[228:231],v[160:163],a[156:159]
 v_max3_f32 v253, v253, v158, v159
 MM a[160:163],v[228:231],v[164:167],a[160:163]
 s_mov_b32 m0, s95
 v_max_f32 v253, v253, v254
 MM a[164:167],v[228:231],v[168:171],a[164:167]
 ds_read_b128 v[212:215], v12 offset:16960
 buffer_load_dwordx4 v4, s[40:43], s74 offen offset:0 nt lds
 MM a[168:171],v[232:235],v[160:163],a[168:171]
 v_cmp_lt_f32 vcc, 0x41800000, v253
 MM a[172:175],v[232:235],v[164:167],a[172:175]
 MM a[176:179],v[232:235],v[168:171],a[176:179]
 ds_read_b128 v[216:219], v12 offset:17024
 buffer_load_dwordx4 v5, s[40:43], s74 offen offset:1056 nt lds
 MM a[180:183],v[236:239],v[160:163],a[180:183]
 MM a[184:187],v[236:239],v[164:167],a[184:187]
 MM a[188:191],v[236:239],v[168:171],a[188:191]
 s_cbranch_vccnz LA_t4
LA_r4:
 s_waitcnt lgkmcnt(2)
 ds_read_b128 v[220:223], v12 offset:17088
 buffer_load_dwordx4 v6, s[40:43], s74 offen offset:2112 nt lds
 MM v[112:115],v[208:211],v[16:19],0
 v_exp_f32 v136, v136
 MM v[116:119],v[208:211],v[20:23],0
 ds_read_b128 v[224:227], v12 offset:17152
 buffer_load_dwordx4 v7, s[40:43], s74 offen offset:3168 nt lds
 MM v[120:123],v[208:211],v[24:27],0
 s_waitcnt lgkmcnt(3)
 s_add_u32 s74, s74, 16384
 MM v[112:115],v[212:215],v[28:31],v[112:115]
 v_exp_f32 v137, v137
 MM v[116:119],v[212:215],v[32:35],v[116:119]
 ds_read_b128 v[228:231], v12 offset:17216
 CV v160,v136,v137
 MM v[120:123],v[212:215],v[36:39],v[120:123]
 s_waitcnt lgkmcnt(2)
 v_exp_f32 v138, v138
 MM v[112:115],v[216:219],v[40:43],v[112:115]
 ds_read_b128 v[232:235], v12 offset:17280
 MM v[116:119],v[216:219],v[44:47],v[116:119]
 v_exp_f32 v139, v139
 MM v[120:123],v[216:219],v[48:51],v[120:123]
 v_exp_f32 v148, v148
 MM v[112:115],v[220:223],v[52:55],v[112:115]
 ds_read_b128 v[236:239], v12 offset:17344
 CV v161,v138,v139
 MM v[116:119],v[220:223],v[56:59],v[116:119]
 v_exp_f32 v149, v149
 MM v[120:123],v[220:223],v[60:63],v[120:123]
 s_waitcnt lgkmcnt(2)
 ds_read_b128 v[208:211], v12 offset:17408
 CV v162,v148,v149
 MM v[112:115],v[224:227],v[64:67],v[112:115]
 v_exp_f32 v150, v150
 MM v[116:119],v[224:227],v[68:71],v[116:119]
 v_exp_f32 v151, v151
 MM v[120:123],v[224:227],v[72:75],v[120:123]
 ds_read_b128 v[212:215], v12 offset:17472
 CV v163,v150,v151
 MM v[112:115],v[228:231],v[76:79],v[112:115]
 v_exp_f32 v140, v140
 MM v[116:119],v[228:231],v[80:83],v[116:119]
 ds_read_b128 v[216:219], v12 offset:17536
 MM v[120:123],v[228:231],v[84:87],v[120:123]
 s_waitcnt lgkmcnt(3)
 v_exp_f32 v141, v141
 MM v[112:115],v[232:235],v[88:91],v[112:115]
 v_exp_f32 v142, v142
 MM v[116:119],v[232:235],v[92:95],v[116:119]
 ds_read_b128 v[220:223], v12 offset:17600
 CV v164,v140,v141
 MM v[120:123],v[232:235],v[96:99],v[120:123]
 v_exp_f32 v143, v143
 MM v[112:115],v[236:239],v[100:103],v[112:115]
 ds_read_b128 v[224:227], v12 offset:17664
 CV v165,v142,v143
 MM v[116:119],v[236:239],v[104:107],v[116:119]
 v_exp_f32 v152, v152
 MM v[120:123],v[236:239],v[108:111],v[120:123]
 s_waitcnt lgkmcnt(3)
 v_exp_f32 v153, v153
 MM v[124:127],v[208:211],v[16:19],0
 ds_read_b128 v[228:231], v12 offset:17728
 CV v166,v152,v153
 MM v[128:131],v[208:211],v[20:23],0
 v_exp_f32 v154, v154
 MM v[132:135],v[208:211],v[24:27],0
 ds_read_b128 v[232:235], v12 offset:17792
 MM v[124:127],v[212:215],v[28:31],v[124:127]
 v_exp_f32 v155, v155
 MM v[128:131],v[212:215],v[32:35],v[128:131]
 v_exp_f32 v144, v144
 MM v[132:135],v[212:215],v[36:39],v[132:135]
 s_waitcnt lgkmcnt(3)
 ds_read_b128 v[236:239], v12 offset:17856
 CV v167,v154,v155
 MM v[124:127],v[216:219],v[40:43],v[124:127]
 v_exp_f32 v145, v145
 MM v[128:131],v[216:219],v[44:47],v[128:131]
 v_exp_f32 v146, v146
 MM v[132:135],v[216:219],v[48:51],v[132:135]
 v_exp_f32 v147, v147
 MM v[124:127],v[220:223],v[52:55],v[124:127]
 CV v168,v144,v145
 CV v169,v146,v147
 MM v[128:131],v[220:223],v[56:59],v[128:131]
 v_exp_f32 v156, v156
 MM v[132:135],v[220:223],v[60:63],v[132:135]
 s_waitcnt lgkmcnt(3)
 v_exp_f32 v157, v157
 MM v[124:127],v[224:227],v[64:67],v[124:127]
 v_exp_f32 v158, v158
 MM v[128:131],v[224:227],v[68:71],v[128:131]
 v_exp_f32 v159, v159
 MM v[132:135],v[224:227],v[72:75],v[132:135]
 s_waitcnt lgkmcnt(0) vmcnt(0)
 s_barrier
 TR v[208:209],v15,33792
 MM v[124:127],v[228:231],v[76:79],v[124:127]
 TR v[210:211],v15,34304
 CV v170,v156,v157
 MM v[128:131],v[228:231],v[80:83],v[128:131]
 CV v171,v158,v159
 MM v[132:135],v[228:231],v[84:87],v[132:135]
 TR v[212:213],v15,33824
 TR v[214:215],v15,34336
 MM v[124:127],v[232:235],v[88:91],v[124:127]
 MM v[128:131],v[232:235],v[92:95],v[128:131]
 MM v[132:135],v[232:235],v[96:99],v[132:135]
 s_mov_b32 m0, s96
 TR v[216:217],v15,33856
 TR v[218:219],v15,34368
 MM v[124:127],v[236:239],v[100:103],v[124:127]
 buffer_load_dwordx4 v4, s[32:35], s72 offen offset:0 nt lds
 MM v[128:131],v[236:239],v[104:107],v[128:131]
 buffer_load_dwordx4 v5, s[32:35], s72 offen offset:1056 nt lds
 MM v[132:135],v[236:239],v[108:111],v[132:135]
 buffer_load_dwordx4 v6, s[32:35], s72 offen offset:2112 nt lds
 MM a[192:195],a[204:207],v[160:163],a[192:195]
 buffer_load_dwordx4 v7, s[32:35], s72 offen offset:3168 nt lds
 MM a[196:199],a[204:207],v[164:167],a[196:199]
 s_add_u32 s72, s72, 16384
 MM a[200:203],a[204:207],v[168:171],a[200:203]
 s_waitcnt lgkmcnt(4)
 TR v[220:221],v15,33888
 MM a[0:3],v[208:211],v[160:163],a[0:3]
 TR v[222:223],v15,34400
 v_fma_f32 v112, v112, s82, v184
 MM a[4:7],v[208:211],v[164:167],a[4:7]
 TR v[224:225],v15,33920
 v_fma_f32 v113, v113, s82, v184
 MM a[8:11],v[208:211],v[168:171],a[8:11]
 s_waitcnt lgkmcnt(5)
 TR v[226:227],v15,34432
 MM a[12:15],v[212:215],v[160:163],a[12:15]
 v_fma_f32 v114, v114, s82, v184
 v_fma_f32 v115, v115, s82, v184
 MM a[16:19],v[212:215],v[164:167],a[16:19]
 TR v[228:229],v15,33952
 MM a[20:23],v[212:215],v[168:171],a[20:23]
 s_waitcnt lgkmcnt(3)
 TR v[230:231],v15,34464
 v_fma_f32 v116, v116, s82, v185
 MM a[24:27],v[216:219],v[160:163],a[24:27]
 TR v[232:233],v15,33984
 v_fma_f32 v117, v117, s82, v185
 MM a[28:31],v[216:219],v[164:167],a[28:31]
 TR v[234:235],v15,34496
 MM a[32:35],v[216:219],v[168:171],a[32:35]
 v_fma_f32 v118, v118, s82, v185
 v_fma_f32 v119, v119, s82, v185
 MM a[36:39],v[220:223],v[160:163],a[36:39]
 TR v[236:237],v15,34016
 MM a[40:43],v[220:223],v[164:167],a[40:43]
 TR v[238:239],v15,34528
 v_max3_f32 v253, v112, v113, v114
 MM a[44:47],v[220:223],v[168:171],a[44:47]
 s_waitcnt lgkmcnt(4)
 TR v[208:209],v15,34048
 v_max3_f32 v254, v115, v116, v117
 MM a[48:51],v[224:227],v[160:163],a[48:51]
 TR v[210:211],v15,34560
 MM a[52:55],v[224:227],v[164:167],a[52:55]
 v_fma_f32 v120, v120, s82, v186
 v_fma_f32 v121, v121, s82, v186
 MM a[56:59],v[224:227],v[168:171],a[56:59]
 TR v[212:213],v15,34080
 MM a[60:63],v[228:231],v[160:163],a[60:63]
 TR v[214:215],v15,34592
 v_max3_f32 v253, v253, v118, v119
 MM a[64:67],v[228:231],v[164:167],a[64:67]
 TR v[216:217],v15,34112
 MM a[68:71],v[228:231],v[168:171],a[68:71]
 s_waitcnt lgkmcnt(5)
 v_fma_f32 v122, v122, s82, v186
 v_fma_f32 v123, v123, s82, v186
 MM a[72:75],v[232:235],v[160:163],a[72:75]
 TR v[218:219],v15,34624
 MM a[76:79],v[232:235],v[164:167],a[76:79]
 TR v[220:221],v15,34144
 v_max3_f32 v254, v254, v120, v121
 MM a[80:83],v[232:235],v[168:171],a[80:83]
 TR v[222:223],v15,34656
 v_fma_f32 v124, v124, s82, v184
 MM a[84:87],v[236:239],v[160:163],a[84:87]
 TR v[224:225],v15,34176
 MM a[88:91],v[236:239],v[164:167],a[88:91]
 v_fma_f32 v125, v125, s82, v184
 v_max3_f32 v253, v253, v122, v123
 MM a[92:95],v[236:239],v[168:171],a[92:95]
 s_waitcnt lgkmcnt(5)
 TR v[226:227],v15,34688
 MM a[96:99],v[208:211],v[160:163],a[96:99]
 TR v[228:229],v15,34208
 v_fma_f32 v126, v126, s82, v184
 MM a[100:103],v[208:211],v[164:167],a[100:103]
 TR v[230:231],v15,34720
 v_fma_f32 v127, v127, s82, v184
 MM a[104:107],v[208:211],v[168:171],a[104:107]
 TR v[232:233],v15,34240
 MM a[108:111],v[212:215],v[160:163],a[108:111]
 v_max3_f32 v254, v254, v124, v125
 v_fma_f32 v128, v128, s82, v185
 MM a[112:115],v[212:215],v[164:167],a[112:115]
 TR v[234:235],v15,34752
 MM a[116:119],v[212:215],v[168:171],a[116:119]
 s_waitcnt lgkmcnt(6)
 TR v[236:237],v15,34272
 v_fma_f32 v129, v129, s82, v185
 MM a[120:123],v[216:219],v[160:163],a[120:123]
 TR v[238:239],v15,34784
 v_max3_f32 v253, v253, v126, v127
 MM a[124:127],v[216:219],v[164:167],a[124:127]
 v_fma_f32 v130, v130, s82, v185
 MM a[128:131],v[216:219],v[168:171],a[128:131]
 v_fma_f32 v131, v131, s82, v185
 MM a[132:135],v[220:223],v[160:163],a[132:135]
 v_max3_f32 v254, v254, v128, v129
 MM a[136:139],v[220:223],v[164:167],a[136:139]
 v_fma_f32 v132, v132, s82, v186
 v_fma_f32 v133, v133, s82, v186
 MM a[140:143],v[220:223],v[168:171],a[140:143]
 s_waitcnt lgkmcnt(6)
 v_max3_f32 v253, v253, v130, v131
 MM a[144:147],v[224:227],v[160:163],a[144:147]
 v_fma_f32 v134, v134, s82, v186
 MM a[148:151],v[224:227],v[164:167],a[148:151]
 v_fma_f32 v135, v135, s82, v186
 v_max3_f32 v254, v254, v132, v133
 MM a[152:155],v[224:227],v[168:171],a[152:155]
 s_waitcnt lgkmcnt(0) vmcnt(0)
 s_barrier
 ds_read_b128 v[208:211], v13 offset:50688
 MM a[156:159],v[228:231],v[160:163],a[156:159]
 v_max3_f32 v253, v253, v134, v135
 MM a[160:163],v[228:231],v[164:167],a[160:163]
 s_mov_b32 m0, s89
 v_max_f32 v253, v253, v254
 MM a[164:167],v[228:231],v[168:171],a[164:167]
 ds_read_b128 v[212:215], v13 offset:50752
 buffer_load_dwordx4 v4, s[40:43], s74 offen offset:0 nt lds
 MM a[168:171],v[232:235],v[160:163],a[168:171]
 v_cmp_lt_f32 vcc, 0x41800000, v253
 MM a[172:175],v[232:235],v[164:167],a[172:175]
 MM a[176:179],v[232:235],v[168:171],a[176:179]
 ds_read_b128 v[216:219], v13 offset:50816
 buffer_load_dwordx4 v5, s[40:43], s74 offen offset:1056 nt lds
 MM a[180:183],v[236:239],v[160:163],a[180:183]
 MM a[184:187],v[236:239],v[164:167],a[184:187]
 MM a[188:191],v[236:239],v[168:171],a[188:191]
 s_cbranch_vccnz LA_t5
LA_r5:
 s_waitcnt lgkmcnt(2)
 ds_read_b128 v[220:223], v13 offset:50880
 buffer_load_dwordx4 v6, s[40:43], s74 offen offset:2112 nt lds
 MM v[136:139],v[208:211],v[16:19],0
 v_exp_f32 v112, v112
 MM v[140:143],v[208:211],v[20:23],0
 ds_read_b128 v[224:227], v13 offset:50944
 buffer_load_dwordx4 v7, s[40:43], s74 offen offset:3168 nt lds
 MM v[144:147],v[208:211],v[24:27],0
 s_waitcnt lgkmcnt(3)
 s_add_u32 s74, s74, 16384
 MM v[136:139],v[212:215],v[28:31],v[136:139]
 v_exp_f32 v113, v113
 MM v[140:143],v[212:215],v[32:35],v[140:143]
 ds_read_b128 v[228:231], v13 offset:51008
 CV v160,v112,v113
 MM v[144:147],v[212:215],v[36:39],v[144:147]
 s_waitcnt lgkmcnt(2)
 v_exp_f32 v114, v114
 MM v[136:139],v[216:219],v[40:43],v[136:139]
 ds_read_b128 v[232:235], v13 offset:51072
 MM v[140:143],v[216:219],v[44:47],v[140:143]
 v_exp_f32 v115, v115
 MM v[144:147],v[216:219],v[48:51],v[144:147]
 v_exp_f32 v124, v124
 MM v[136:139],v[220:223],v[52:55],v[136:139]
 ds_read_b128 v[236:239], v13 offset:51136
 CV v161,v114,v115
 MM v[140:143],v[220:223],v[56:59],v[140:143]
 v_exp_f32 v125, v125
 MM v[144:147],v[220:223],v[60:63],v[144:147]
 s_waitcnt lgkmcnt(2)
 ds_read_b128 v[208:211], v13 offset:51200
 CV v162,v124,v125
 MM v[136:139],v[224:227],v[64:67],v[136:139]
 v_exp_f32 v126, v126
 MM v[140:143],v[224:227],v[68:71],v[140:143]
 v_exp_f32 v127, v127
 MM v[144:147],v[224:227],v[72:75],v[144:147]
 ds_read_b128 v[212:215], v13 offset:51264
 CV v163,v126,v127
 MM v[136:139],v[228:231],v[76:79],v[136:139]
 v_exp_f32 v116, v116
 MM v[140:143],v[228:231],v[80:83],v[140:143]
 ds_read_b128 v[216:219], v13 offset:51328
 MM v[144:147],v[228:231],v[84:87],v[144:147]
 s_waitcnt lgkmcnt(3)
 v_exp_f32 v117, v117
 MM v[136:139],v[232:235],v[88:91],v[136:139]
 v_exp_f32 v118, v118
 MM v[140:143],v[232:235],v[92:95],v[140:143]
 ds_read_b128 v[220:223], v13 offset:51392
 CV v164,v116,v117
 MM v[144:147],v[232:235],v[96:99],v[144:147]
 v_exp_f32 v119, v119
 MM v[136:139],v[236:239],v[100:103],v[136:139]
 ds_read_b128 v[224:227], v13 offset:51456
 CV v165,v118,v119
 MM v[140:143],v[236:239],v[104:107],v[140:143]
 v_exp_f32 v128, v128
 MM v[144:147],v[236:239],v[108:111],v[144:147]
 s_waitcnt lgkmcnt(3)
 v_exp_f32 v129, v129
 MM v[148:151],v[208:211],v[16:19],0
 ds_read_b128 v[228:231], v13 offset:51520
 CV v166,v128,v129
 MM v[152:155],v[208:211],v[20:23],0
 v_exp_f32 v130, v130
 MM v[156:159],v[208:211],v[24:27],0
 ds_read_b128 v[232:235], v13 offset:51584
 MM v[148:151],v[212:215],v[28:31],v[148:151]
 v_exp_f32 v131, v131
 MM v[152:155],v[212:215],v[32:35],v[152:155]
 v_exp_f32 v120, v120
 MM v[156:159],v[212:215],v[36:39],v[156:159]
 s_waitcnt lgkmcnt(3)
 ds_read_b128 v[236:239], v13 offset:51648
 CV v167,v130,v131
 MM v[148:151],v[216:219],v[40:43],v[148:151]
 v_exp_f32 v121, v121
 MM v[152:155],v[216:219],v[44:47],v[152:155]
 v_exp_f32 v122, v122
 MM v[156:159],v[216:219],v[48:51],v[156:159]
 v_exp_f32 v123, v123
 MM v[148:151],v[220:223],v[52:55],v[148:151]
 CV v168,v120,v121
 CV v169,v122,v123
 MM v[152:155],v[220:223],v[56:59],v[152:155]
 v_exp_f32 v132, v132
 MM v[156:159],v[220:223],v[60:63],v[156:159]
 s_waitcnt lgkmcnt(3)
 v_exp_f32 v133, v133
 MM v[148:151],v[224:227],v[64:67],v[148:151]
 v_exp_f32 v134, v134
 MM v[152:155],v[224:227],v[68:71],v[152:155]
 v_exp_f32 v135, v135
 MM v[156:159],v[224:227],v[72:75],v[156:159]
 s_waitcnt lgkmcnt(0) vmcnt(0)
 s_barrier
 TR v[208:209],v14,0
 MM v[148:151],v[228:231],v[76:79],v[148:151]
 TR v[210:211],v14,512
 CV v170,v132,v133
 MM v[152:155],v[228:231],v[80:83],v[152:155]
 CV v171,v134,v135
 MM v[156:159],v[228:231],v[84:87],v[156:159]
 TR v[212:213],v14,32
 TR v[214:215],v14,544
 MM v[148:151],v[232:235],v[88:91],v[148:151]
 MM v[152:155],v[232:235],v[92:95],v[152:155]
 MM v[156:159],v[232:235],v[96:99],v[156:159]
 s_mov_b32 m0, s90
 TR v[216:217],v14,64
 TR v[218:219],v14,576
 MM v[148:151],v[236:239],v[100:103],v[148:151]
 buffer_load_dwordx4 v4, s[32:35], s72 offen offset:0 nt lds
 MM v[152:155],v[236:239],v[104:107],v[152:155]
 buffer_load_dwordx4 v5, s[32:35], s72 offen offset:1056 nt lds
 MM v[156:159],v[236:239],v[108:111],v[156:159]
 s_add_u32 s79, s79, 1
 s_cmp_lt_u32 s79, 8
 s_cbranch_scc1 LA_loop24
 buffer_load_dwordx4 v6, s[32:35], s72 offen offset:2112 nt lds
 MM a[192:195],a[204:207],v[160:163],a[192:195]
 buffer_load_dwordx4 v7, s[32:35], s72 offen offset:3168 nt lds
 MM a[196:199],a[204:207],v[164:167],a[196:199]
 s_add_u32 s72, s72, 16384
 MM a[200:203],a[204:207],v[168:171],a[200:203]
 s_waitcnt lgkmcnt(4)
 TR v[220:221],v14,96
 MM a[0:3],v[208:211],v[160:163],a[0:3]
 TR v[222:223],v14,608
 v_fma_f32 v136, v136, s82, v184
 MM a[4:7],v[208:211],v[164:167],a[4:7]
 TR v[224:225],v14,128
 v_fma_f32 v137, v137, s82, v184
 MM a[8:11],v[208:211],v[168:171],a[8:11]
 s_waitcnt lgkmcnt(5)
 TR v[226:227],v14,640
 MM a[12:15],v[212:215],v[160:163],a[12:15]
 v_fma_f32 v138, v138, s82, v184
 v_fma_f32 v139, v139, s82, v184
 MM a[16:19],v[212:215],v[164:167],a[16:19]
 TR v[228:229],v14,160
 MM a[20:23],v[212:215],v[168:171],a[20:23]
 s_waitcnt lgkmcnt(3)
 TR v[230:231],v14,672
 v_fma_f32 v140, v140, s82, v185
 MM a[24:27],v[216:219],v[160:163],a[24:27]
 TR v[232:233],v14,192
 v_fma_f32 v141, v141, s82, v185
 MM a[28:31],v[216:219],v[164:167],a[28:31]
 TR v[234:235],v14,704
 MM a[32:35],v[216:219],v[168:171],a[32:35]
 v_fma_f32 v142, v142, s82, v185
 v_fma_f32 v143, v143, s82, v185
 MM a[36:39],v[220:223],v[160:163],a[36:39]
 TR v[236:237],v14,224
 MM a[40:43],v[220:223],v[164:167],a[40:43]
 TR v[238:239],v14,736
 v_max3_f32 v253, v136, v137, v138
 MM a[44:47],v[220:223],v[168:171],a[44:47]
 s_waitcnt lgkmcnt(4)
 TR v[208:209],v14,256
 v_max3_f32 v254, v139, v140, v141
 MM a[48:51],v[224:227],v[160:163],a[48:51]
 TR v[210:211],v14,768
 MM a[52:55],v[224:227],v[164:167],a[52:55]
 v_fma_f32 v144, v144, s82, v186
 v_fma_f32 v145, v145, s82, v186
 MM a[56:59],v[224:227],v[168:171],a[56:59]
 TR v[212:213],v14,288
 MM a[60:63],v[228:231],v[160:163],a[60:63]
 TR v[214:215],v14,800
 v_max3_f32 v253, v253, v142, v143
 MM a[64:67],v[228:231],v[164:167],a[64:67]
 TR v[216:217],v14,320
 MM a[68:71],v[228:231],v[168:171],a[68:71]
 s_waitcnt lgkmcnt(5)
 v_fma_f32 v146, v146, s82, v186
 v_fma_f32 v147, v147, s82, v186
 MM a[72:75],v[232:235],v[160:163],a[72:75]
 TR v[218:219],v14,832
 MM a[76:79],v[232:235],v[164:167],a[76:79]
 TR v[220:221],v14,352
 v_max3_f32 v254, v254, v144, v145
 MM a[80:83],v[232:235],v[168:171],a[80:83]
 TR v[222:223],v14,864
 v_fma_f32 v148, v148, s82, v184
 MM a[84:87],v[236:239],v[160:163],a[84:87]
 TR v[224:225],v14,384
 MM a[88:91],v[236:239],v[164:167],a[88:91]
 v_fma_f32 v149, v149, s82, v184
 v_max3_f32 v253, v253, v146, v147
 MM a[92:95],v[236:239],v[168:171],a[92:95]
 s_waitcnt lgkmcnt(5)
 TR v[226:227],v14,896
 MM a[96:99],v[208:211],v[160:163],a[96:99]
 TR v[228:229],v14,416
 v_fma_f32 v150, v150, s82, v184
 MM a[100:103],v[208:211],v[164:167],a[100:103]
 TR v[230:231],v14,928
 v_fma_f32 v151, v151, s82, v184
 MM a[104:107],v[208:211],v[168:171],a[104:107]
 TR v[232:233],v14,448
 MM a[108:111],v[212:215],v[160:163],a[108:111]
 v_max3_f32 v254, v254, v148, v149
 v_fma_f32 v152, v152, s82, v185
 MM a[112:115],v[212:215],v[164:167],a[112:115]
 TR v[234:235],v14,960
 MM a[116:119],v[212:215],v[168:171],a[116:119]
 s_waitcnt lgkmcnt(6)
 TR v[236:237],v14,480
 v_fma_f32 v153, v153, s82, v185
 MM a[120:123],v[216:219],v[160:163],a[120:123]
 TR v[238:239],v14,992
 v_max3_f32 v253, v253, v150, v151
 MM a[124:127],v[216:219],v[164:167],a[124:127]
 v_fma_f32 v154, v154, s82, v185
 MM a[128:131],v[216:219],v[168:171],a[128:131]
 v_fma_f32 v155, v155, s82, v185
 MM a[132:135],v[220:223],v[160:163],a[132:135]
 v_max3_f32 v254, v254, v152, v153
 MM a[136:139],v[220:223],v[164:167],a[136:139]
 v_fma_f32 v156, v156, s82, v186
 v_fma_f32 v157, v157, s82, v186
 MM a[140:143],v[220:223],v[168:171],a[140:143]
 s_waitcnt lgkmcnt(6)
 v_max3_f32 v253, v253, v154, v155
 MM a[144:147],v[224:227],v[160:163],a[144:147]
 v_fma_f32 v158, v158, s82, v186
 MM a[148:151],v[224:227],v[164:167],a[148:151]
 v_fma_f32 v159, v159, s82, v186
 v_max3_f32 v254, v254, v156, v157
 MM a[152:155],v[224:227],v[168:171],a[152:155]
 s_waitcnt lgkmcnt(0) vmcnt(0)
 s_barrier
 ds_read_b128 v[208:211], v12 offset:16896
 MM a[156:159],v[228:231],v[160:163],a[156:159]
 v_max3_f32 v253, v253, v158, v159
 MM a[160:163],v[228:231],v[164:167],a[160:163]
 s_mov_b32 m0, s95
 v_max_f32 v253, v253, v254
 MM a[164:167],v[228:231],v[168:171],a[164:167]
 ds_read_b128 v[212:215], v12 offset:16960
 buffer_load_dwordx4 v4, s[40:43], s74 offen offset:0 nt lds
 MM a[168:171],v[232:235],v[160:163],a[168:171]
 v_cmp_lt_f32 vcc, 0x41800000, v253
 MM a[172:175],v[232:235],v[164:167],a[172:175]
 MM a[176:179],v[232:235],v[168:171],a[176:179]
 ds_read_b128 v[216:219], v12 offset:17024
 buffer_load_dwordx4 v5, s[40:43], s74 offen offset:1056 nt lds
 MM a[180:183],v[236:239],v[160:163],a[180:183]
 MM a[184:187],v[236:239],v[164:167],a[184:187]
 MM a[188:191],v[236:239],v[168:171],a[188:191]
 s_cbranch_vccnz LA_t20
LA_r20:
 s_waitcnt lgkmcnt(2)
 ds_read_b128 v[220:223], v12 offset:17088
 buffer_load_dwordx4 v6, s[40:43], s74 offen offset:2112 nt lds
 MM v[112:115],v[208:211],v[16:19],0
 v_exp_f32 v136, v136
 MM v[116:119],v[208:211],v[20:23],0
 ds_read_b128 v[224:227], v12 offset:17152
 buffer_load_dwordx4 v7, s[40:43], s74 offen offset:3168 nt lds
 MM v[120:123],v[208:211],v[24:27],0
 s_waitcnt lgkmcnt(3)
 s_add_u32 s74, s74, 16384
 MM v[112:115],v[212:215],v[28:31],v[112:115]
 v_exp_f32 v137, v137
 MM v[116:119],v[212:215],v[32:35],v[116:119]
 ds_read_b128 v[228:231], v12 offset:17216
 CV v160,v136,v137
 MM v[120:123],v[212:215],v[36:39],v[120:123]
 s_waitcnt lgkmcnt(2)
 v_exp_f32 v138, v138
 MM v[112:115],v[216:219],v[40:43],v[112:115]
 ds_read_b128 v[232:235], v12 offset:17280
 MM v[116:119],v[216:219],v[44:47],v[116:119]
 v_exp_f32 v139, v139
 MM v[120:123],v[216:219],v[48:51],v[120:123]
 v_exp_f32 v148, v148
 MM v[112:115],v[220:223],v[52:55],v[112:115]
 ds_read_b128 v[236:239], v12 offset:17344
 CV v161,v138,v139
 MM v[116:119],v[220:223],v[56:59],v[116:119]
 v_exp_f32 v149, v149
 MM v[120:123],v[220:223],v[60:63],v[120:123]
 s_waitcnt lgkmcnt(2)
 ds_read_b128 v[208:211], v12 offset:17408
 CV v162,v148,v149
 MM v[112:115],v[224:227],v[64:67],v[112:115]
 v_exp_f32 v150, v150
 MM v[116:119],v[224:227],v[68:71],v[116:119]
 v_exp_f32 v151, v151
 MM v[120:123],v[224:227],v[72:75],v[120:123]
 ds_read_b128 v[212:215], v12 offset:17472
 CV v163,v150,v151
 MM v[112:115],v[228:231],v[76:79],v[112:115]
 v_exp_f32 v140, v140
 MM v[116:119],v[228:231],v[80:83],v[116:119]
 ds_read_b128 v[216:219], v12 offset:17536
 MM v[120:123],v[228:231],v[84:87],v[120:123]
 s_waitcnt lgkmcnt(3)
 v_exp_f32 v141, v141
 MM v[112:115],v[232:235],v[88:91],v[112:115]
 v_exp_f32 v142, v142
 MM v[116:119],v[232:235],v[92:95],v[116:119]
 ds_read_b128 v[220:223], v12 offset:17600
 CV v164,v140,v141
 MM v[120:123],v[232:235],v[96:99],v[120:123]
 v_exp_f32 v143, v143
 MM v[112:115],v[236:239],v[100:103],v[112:115]
 ds_read_b128 v[224:227], v12 offset:17664
 CV v165,v142,v143
 MM v[116:119],v[236:239],v[104:107],v[116:119]
 v_exp_f32 v152, v152
 MM v[120:123],v[236:239],v[108:111],v[120:123]
 s_waitcnt lgkmcnt(3)
 v_exp_f32 v153, v153
 MM v[124:127],v[208:211],v[16:19],0
 ds_read_b128 v[228:231], v12 offset:17728
 CV v166,v152,v153
 MM v[128:131],v[208:211],v[20:23],0
 v_exp_f32 v154, v154
 MM v[132:135],v[208:211],v[24:27],0
 ds_read_b128 v[232:235], v12 offset:17792
 MM v[124:127],v[212:215],v[28:31],v[124:127]
 v_exp_f32 v155, v155
 MM v[128:131],v[212:215],v[32:35],v[128:131]
 v_exp_f32 v144, v144
 MM v[132:135],v[212:215],v[36:39],v[132:135]
 s_waitcnt lgkmcnt(3)
 ds_read_b128 v[236:239], v12 offset:17856
 CV v167,v154,v155
 MM v[124:127],v[216:219],v[40:43],v[124:127]
 v_exp_f32 v145, v145
 MM v[128:131],v[216:219],v[44:47],v[128:131]
 v_exp_f32 v146, v146
 MM v[132:135],v[216:219],v[48:51],v[132:135]
 v_exp_f32 v147, v147
 MM v[124:127],v[220:223],v[52:55],v[124:127]
 CV v168,v144,v145
 CV v169,v146,v147
 MM v[128:131],v[220:223],v[56:59],v[128:131]
 v_exp_f32 v156, v156
 MM v[132:135],v[220:223],v[60:63],v[132:135]
 s_waitcnt lgkmcnt(3)
 v_exp_f32 v157, v157
 MM v[124:127],v[224:227],v[64:67],v[124:127]
 v_exp_f32 v158, v158
 MM v[128:131],v[224:227],v[68:71],v[128:131]
 v_exp_f32 v159, v159
 MM v[132:135],v[224:227],v[72:75],v[132:135]
 s_waitcnt lgkmcnt(0) vmcnt(0)
 s_barrier
 TR v[208:209],v15,33792
 MM v[124:127],v[228:231],v[76:79],v[124:127]
 TR v[210:211],v15,34304
 CV v170,v156,v157
 MM v[128:131],v[228:231],v[80:83],v[128:131]
 CV v171,v158,v159
 MM v[132:135],v[228:231],v[84:87],v[132:135]
 TR v[212:213],v15,33824
 TR v[214:215],v15,34336
 MM v[124:127],v[232:235],v[88:91],v[124:127]
 MM v[128:131],v[232:235],v[92:95],v[128:131]
 MM v[132:135],v[232:235],v[96:99],v[132:135]
 s_mov_b32 m0, s96
 TR v[216:217],v15,33856
 TR v[218:219],v15,34368
 MM v[124:127],v[236:239],v[100:103],v[124:127]
 buffer_load_dwordx4 v4, s[32:35], s72 offen offset:0 nt lds
 MM v[128:131],v[236:239],v[104:107],v[128:131]
 buffer_load_dwordx4 v5, s[32:35], s72 offen offset:1056 nt lds
 MM v[132:135],v[236:239],v[108:111],v[132:135]
 buffer_load_dwordx4 v6, s[32:35], s72 offen offset:2112 nt lds
 MM a[192:195],a[204:207],v[160:163],a[192:195]
 buffer_load_dwordx4 v7, s[32:35], s72 offen offset:3168 nt lds
 MM a[196:199],a[204:207],v[164:167],a[196:199]
 s_add_u32 s72, s72, 16384
 MM a[200:203],a[204:207],v[168:171],a[200:203]
 s_waitcnt lgkmcnt(4)
 TR v[220:221],v15,33888
 MM a[0:3],v[208:211],v[160:163],a[0:3]
 TR v[222:223],v15,34400
 v_fma_f32 v112, v112, s82, v184
 MM a[4:7],v[208:211],v[164:167],a[4:7]
 TR v[224:225],v15,33920
 v_fma_f32 v113, v113, s82, v184
 MM a[8:11],v[208:211],v[168:171],a[8:11]
 s_waitcnt lgkmcnt(5)
 TR v[226:227],v15,34432
 MM a[12:15],v[212:215],v[160:163],a[12:15]
 v_fma_f32 v114, v114, s82, v184
 v_fma_f32 v115, v115, s82, v184
 MM a[16:19],v[212:215],v[164:167],a[16:19]
 TR v[228:229],v15,33952
 MM a[20:23],v[212:215],v[168:171],a[20:23]
 s_waitcnt lgkmcnt(3)
 TR v[230:231],v15,34464
 v_fma_f32 v116, v116, s82, v185
 MM a[24:27],v[216:219],v[160:163],a[24:27]
 TR v[232:233],v15,33984
 v_fma_f32 v117, v117, s82, v185
 MM a[28:31],v[216:219],v[164:167],a[28:31]
 TR v[234:235],v15,34496
 MM a[32:35],v[216:219],v[168:171],a[32:35]
 v_fma_f32 v118, v118, s82, v185
 v_fma_f32 v119, v119, s82, v185
 MM a[36:39],v[220:223],v[160:163],a[36:39]
 TR v[236:237],v15,34016
 MM a[40:43],v[220:223],v[164:167],a[40:43]
 TR v[238:239],v15,34528
 v_max3_f32 v253, v112, v113, v114
 MM a[44:47],v[220:223],v[168:171],a[44:47]
 s_waitcnt lgkmcnt(4)
 TR v[208:209],v15,34048
 v_max3_f32 v254, v115, v116, v117
 MM a[48:51],v[224:227],v[160:163],a[48:51]
 TR v[210:211],v15,34560
 MM a[52:55],v[224:227],v[164:167],a[52:55]
 v_fma_f32 v120, v120, s82, v186
 v_fma_f32 v121, v121, s82, v186
 MM a[56:59],v[224:227],v[168:171],a[56:59]
 TR v[212:213],v15,34080
 MM a[60:63],v[228:231],v[160:163],a[60:63]
 TR v[214:215],v15,34592
 v_max3_f32 v253, v253, v118, v119
 MM a[64:67],v[228:231],v[164:167],a[64:67]
 TR v[216:217],v15,34112
 v_fma_f32 v122, v122, s82, v186
 MM a[68:71],v[228:231],v[168:171],a[68:71]
 s_waitcnt lgkmcnt(5)
 v_fma_f32 v123, v123, s82, v186
 MM a[72:75],v[232:235],v[160:163],a[72:75]
 TR v[218:219],v15,34624
 v_max3_f32 v254, v254, v120, v121
 MM a[76:79],v[232:235],v[164:167],a[76:79]
 TR v[220:221],v15,34144
 MM a[80:83],v[232:235],v[168:171],a[80:83]
 TR v[222:223],v15,34656
 v_fma_f32 v124, v124, s82, v184
 MM a[84:87],v[236:239],v[160:163],a[84:87]
 TR v[224:225],v15,34176
 v_fma_f32 v125, v125, s82, v184
 MM a[88:91],v[236:239],v[164:167],a[88:91]
 v_max3_f32 v253, v253, v122, v123
 MM a[92:95],v[236:239],v[168:171],a[92:95]
 s_waitcnt lgkmcnt(5)
 TR v[226:227],v15,34688
 v_fma_f32 v126, v126, s82, v184
 MM a[96:99],v[208:211],v[160:163],a[96:99]
 TR v[228:229],v15,34208
 MM a[100:103],v[208:211],v[164:167],a[100:103]
 TR v[230:231],v15,34720
 v_fma_f32 v127, v127, s82, v184
 MM a[104:107],v[208:211],v[168:171],a[104:107]
 TR v[232:233],v15,34240
 v_max3_f32 v254, v254, v124, v125
 MM a[108:111],v[212:215],v[160:163],a[108:111]
 v_fma_f32 v128, v128, s82, v185
 MM a[112:115],v[212:215],v[164:167],a[112:115]
 TR v[234:235],v15,34752
 v_fma_f32 v129, v129, s82, v185
 MM a[116:119],v[212:215],v[168:171],a[116:119]
 s_waitcnt lgkmcnt(6)
 TR v[236:237],v15,34272
 MM a[120:123],v[216:219],v[160:163],a[120:123]
 TR v[238:239],v15,34784
 v_max3_f32 v253, v253, v126, v127
 MM a[124:127],v[216:219],v[164:167],a[124:127]
 v_fma_f32 v130, v130, s82, v185
 MM a[128:131],v[216:219],v[168:171],a[128:131]
 v_fma_f32 v131, v131, s82, v185
 v_max3_f32 v254, v254, v128, v129
 MM a[132:135],v[220:223],v[160:163],a[132:135]
 v_fma_f32 v132, v132, s82, v186
 MM a[136:139],v[220:223],v[164:167],a[136:139]
 v_fma_f32 v133, v133, s82, v186
 MM a[140:143],v[220:223],v[168:171],a[140:143]
 s_waitcnt lgkmcnt(6)
 global_load_dword a250, v255, s[98:99]
 v_max3_f32 v253, v253, v130, v131
 MM a[144:147],v[224:227],v[160:163],a[144:147]
 v_fma_f32 v134, v134, s82, v186
 MM a[148:151],v[224:227],v[164:167],a[148:151]
 v_fma_f32 v135, v135, s82, v186
 v_max3_f32 v254, v254, v132, v133
 MM a[152:155],v[224:227],v[168:171],a[152:155]
 s_waitcnt lgkmcnt(0) vmcnt(1)
 s_barrier
 ds_read_b128 v[208:211], v13 offset:50688
 MM a[156:159],v[228:231],v[160:163],a[156:159]
 v_max3_f32 v253, v253, v134, v135
 MM a[160:163],v[228:231],v[164:167],a[160:163]
 s_mov_b32 m0, s89
 v_max_f32 v253, v253, v254
 MM a[164:167],v[228:231],v[168:171],a[164:167]
 ds_read_b128 v[212:215], v13 offset:50752
 buffer_load_dwordx4 v4, s[40:43], s74 offen offset:0 nt lds
 MM a[168:171],v[232:235],v[160:163],a[168:171]
 v_cmp_lt_f32 vcc, 0x41800000, v253
 MM a[172:175],v[232:235],v[164:167],a[172:175]
 MM a[176:179],v[232:235],v[168:171],a[176:179]
 ds_read_b128 v[216:219], v13 offset:50816
 buffer_load_dwordx4 v5, s[40:43], s74 offen offset:1056 nt lds
 MM a[180:183],v[236:239],v[160:163],a[180:183]
 MM a[184:187],v[236:239],v[164:167],a[184:187]
 MM a[188:191],v[236:239],v[168:171],a[188:191]
 s_cbranch_vccnz LA_t21
LA_r21:
 s_waitcnt lgkmcnt(2)
 ds_read_b128 v[220:223], v13 offset:50880
 buffer_load_dwordx4 v6, s[40:43], s74 offen offset:2112 nt lds
 MM v[136:139],v[208:211],v[16:19],0
 v_exp_f32 v112, v112
 MM v[140:143],v[208:211],v[20:23],0
 ds_read_b128 v[224:227], v13 offset:50944
 buffer_load_dwordx4 v7, s[40:43], s74 offen offset:3168 nt lds
 MM v[144:147],v[208:211],v[24:27],0
 s_waitcnt lgkmcnt(3)
 s_add_u32 s74, s74, 16384
 MM v[136:139],v[212:215],v[28:31],v[136:139]
 v_exp_f32 v113, v113
 MM v[140:143],v[212:215],v[32:35],v[140:143]
 ds_read_b128 v[228:231], v13 offset:51008
 CV v160,v112,v113
 MM v[144:147],v[212:215],v[36:39],v[144:147]
 s_waitcnt lgkmcnt(2)
 v_exp_f32 v114, v114
 MM v[136:139],v[216:219],v[40:43],v[136:139]
 ds_read_b128 v[232:235], v13 offset:51072
 MM v[140:143],v[216:219],v[44:47],v[140:143]
 v_exp_f32 v115, v115
 MM v[144:147],v[216:219],v[48:51],v[144:147]
 v_exp_f32 v124, v124
 MM v[136:139],v[220:223],v[52:55],v[136:139]
 ds_read_b128 v[236:239], v13 offset:51136
 CV v161,v114,v115
 MM v[140:143],v[220:223],v[56:59],v[140:143]
 v_exp_f32 v125, v125
 MM v[144:147],v[220:223],v[60:63],v[144:147]
 s_waitcnt lgkmcnt(2)
 ds_read_b128 v[208:211], v13 offset:51200
 CV v162,v124,v125
 MM v[136:139],v[224:227],v[64:67],v[136:139]
 v_exp_f32 v126, v126
 MM v[140:143],v[224:227],v[68:71],v[140:143]
 v_exp_f32 v127, v127
 MM v[144:147],v[224:227],v[72:75],v[144:147]
 ds_read_b128 v[212:215], v13 offset:51264
 CV v163,v126,v127
 MM v[136:139],v[228:231],v[76:79],v[136:139]
 v_exp_f32 v116, v116
 MM v[140:143],v[228:231],v[80:83],v[140:143]
 ds_read_b128 v[216:219], v13 offset:51328
 MM v[144:147],v[228:231],v[84:87],v[144:147]
 s_waitcnt lgkmcnt(3)
 v_exp_f32 v117, v117
 MM v[136:139],v[232:235],v[88:91],v[136:139]
 v_exp_f32 v118, v118
 MM v[140:143],v[232:235],v[92:95],v[140:143]
 ds_read_b128 v[220:223], v13 offset:51392
 CV v164,v116,v117
 MM v[144:147],v[232:235],v[96:99],v[144:147]
 v_exp_f32 v119, v119
 MM v[136:139],v[236:239],v[100:103],v[136:139]
 ds_read_b128 v[224:227], v13 offset:51456
 CV v165,v118,v119
 MM v[140:143],v[236:239],v[104:107],v[140:143]
 v_exp_f32 v128, v128
 MM v[144:147],v[236:239],v[108:111],v[144:147]
 s_waitcnt lgkmcnt(3)
 v_exp_f32 v129, v129
 MM v[148:151],v[208:211],v[16:19],0
 ds_read_b128 v[228:231], v13 offset:51520
 CV v166,v128,v129
 MM v[152:155],v[208:211],v[20:23],0
 v_exp_f32 v130, v130
 MM v[156:159],v[208:211],v[24:27],0
 ds_read_b128 v[232:235], v13 offset:51584
 MM v[148:151],v[212:215],v[28:31],v[148:151]
 v_exp_f32 v131, v131
 MM v[152:155],v[212:215],v[32:35],v[152:155]
 v_exp_f32 v120, v120
 MM v[156:159],v[212:215],v[36:39],v[156:159]
 s_waitcnt lgkmcnt(3)
 ds_read_b128 v[236:239], v13 offset:51648
 CV v167,v130,v131
 MM v[148:151],v[216:219],v[40:43],v[148:151]
 v_exp_f32 v121, v121
 MM v[152:155],v[216:219],v[44:47],v[152:155]
 v_exp_f32 v122, v122
 MM v[156:159],v[216:219],v[48:51],v[156:159]
 v_exp_f32 v123, v123
 MM v[148:151],v[220:223],v[52:55],v[148:151]
 CV v168,v120,v121
 CV v169,v122,v123
 MM v[152:155],v[220:223],v[56:59],v[152:155]
 v_exp_f32 v132, v132
 MM v[156:159],v[220:223],v[60:63],v[156:159]
 s_waitcnt lgkmcnt(3)
 v_exp_f32 v133, v133
 MM v[148:151],v[224:227],v[64:67],v[148:151]
 v_exp_f32 v134, v134
 MM v[152:155],v[224:227],v[68:71],v[152:155]
 v_exp_f32 v135, v135
 MM v[156:159],v[224:227],v[72:75],v[156:159]
 s_waitcnt lgkmcnt(0) vmcnt(0)
 s_barrier
 TR v[208:209],v14,0
 MM v[148:151],v[228:231],v[76:79],v[148:151]
 TR v[210:211],v14,512
 CV v170,v132,v133
 MM v[152:155],v[228:231],v[80:83],v[152:155]
 CV v171,v134,v135
 MM v[156:159],v[228:231],v[84:87],v[156:159]
 TR v[212:213],v14,32
 TR v[214:215],v14,544
 MM v[148:151],v[232:235],v[88:91],v[148:151]
 MM v[152:155],v[232:235],v[92:95],v[152:155]
 MM v[156:159],v[232:235],v[96:99],v[156:159]
 s_mov_b32 m0, s90
 TR v[216:217],v14,64
 TR v[218:219],v14,576
 MM v[148:151],v[236:239],v[100:103],v[148:151]
 buffer_load_dwordx4 v4, s[32:35], s72 offen offset:0 nt lds
 MM v[152:155],v[236:239],v[104:107],v[152:155]
 buffer_load_dwordx4 v5, s[32:35], s72 offen offset:1056 nt lds
 MM v[156:159],v[236:239],v[108:111],v[156:159]
 buffer_load_dwordx4 v6, s[32:35], s72 offen offset:2112 nt lds
 MM a[192:195],a[204:207],v[160:163],a[192:195]
 buffer_load_dwordx4 v7, s[32:35], s72 offen offset:3168 nt lds
 MM a[196:199],a[204:207],v[164:167],a[196:199]
 s_add_u32 s72, s72, 16384
 MM a[200:203],a[204:207],v[168:171],a[200:203]
 s_waitcnt lgkmcnt(4)
 TR v[220:221],v14,96
 MM a[0:3],v[208:211],v[160:163],a[0:3]
 TR v[222:223],v14,608
 v_fma_f32 v136, v136, s82, v184
 MM a[4:7],v[208:211],v[164:167],a[4:7]
 TR v[224:225],v14,128
 v_fma_f32 v137, v137, s82, v184
 MM a[8:11],v[208:211],v[168:171],a[8:11]
 s_waitcnt lgkmcnt(5)
 TR v[226:227],v14,640
 MM a[12:15],v[212:215],v[160:163],a[12:15]
 v_fma_f32 v138, v138, s82, v184
 v_fma_f32 v139, v139, s82, v184
 MM a[16:19],v[212:215],v[164:167],a[16:19]
 TR v[228:229],v14,160
 MM a[20:23],v[212:215],v[168:171],a[20:23]
 s_waitcnt lgkmcnt(3)
 TR v[230:231],v14,672
 v_fma_f32 v140, v140, s82, v185
 MM a[24:27],v[216:219],v[160:163],a[24:27]
 TR v[232:233],v14,192
 v_fma_f32 v141, v141, s82, v185
 MM a[28:31],v[216:219],v[164:167],a[28:31]
 TR v[234:235],v14,704
 MM a[32:35],v[216:219],v[168:171],a[32:35]
 v_fma_f32 v142, v142, s82, v185
 v_fma_f32 v143, v143, s82, v185
 MM a[36:39],v[220:223],v[160:163],a[36:39]
 TR v[236:237],v14,224
 MM a[40:43],v[220:223],v[164:167],a[40:43]
 TR v[238:239],v14,736
 v_max3_f32 v253, v136, v137, v138
 MM a[44:47],v[220:223],v[168:171],a[44:47]
 s_waitcnt lgkmcnt(4)
 TR v[208:209],v14,256
 v_max3_f32 v254, v139, v140, v141
 MM a[48:51],v[224:227],v[160:163],a[48:51]
 TR v[210:211],v14,768
 MM a[52:55],v[224:227],v[164:167],a[52:55]
 v_fma_f32 v144, v144, s82, v186
 v_fma_f32 v145, v145, s82, v186
 MM a[56:59],v[224:227],v[168:171],a[56:59]
 TR v[212:213],v14,288
 MM a[60:63],v[228:231],v[160:163],a[60:63]
 TR v[214:215],v14,800
 v_max3_f32 v253, v253, v142, v143
 MM a[64:67],v[228:231],v[164:167],a[64:67]
 TR v[216:217],v14,320
 MM a[68:71],v[228:231],v[168:171],a[68:71]
 s_waitcnt lgkmcnt(5)
 v_fma_f32 v146, v146, s82, v186
 v_fma_f32 v147, v147, s82, v186
 MM a[72:75],v[232:235],v[160:163],a[72:75]
 TR v[218:219],v14,832
 MM a[76:79],v[232:235],v[164:167],a[76:79]
 TR v[220:221],v14,352
 v_max3_f32 v254, v254, v144, v145
 MM a[80:83],v[232:235],v[168:171],a[80:83]
 TR v[222:223],v14,864
 v_fma_f32 v148, v148, s82, v184
 MM a[84:87],v[236:239],v[160:163],a[84:87]
 TR v[224:225],v14,384
 MM a[88:91],v[236:239],v[164:167],a[88:91]
 v_fma_f32 v149, v149, s82, v184
 v_max3_f32 v253, v253, v146, v147
 MM a[92:95],v[236:239],v[168:171],a[92:95]
 s_waitcnt lgkmcnt(5)
 TR v[226:227],v14,896
 MM a[96:99],v[208:211],v[160:163],a[96:99]
 TR v[228:229],v14,416
 v_fma_f32 v150, v150, s82, v184
 MM a[100:103],v[208:211],v[164:167],a[100:103]
 TR v[230:231],v14,928
 v_fma_f32 v151, v151, s82, v184
 MM a[104:107],v[208:211],v[168:171],a[104:107]
 TR v[232:233],v14,448
 MM a[108:111],v[212:215],v[160:163],a[108:111]
 v_max3_f32 v254, v254, v148, v149
 v_fma_f32 v152, v152, s82, v185
 MM a[112:115],v[212:215],v[164:167],a[112:115]
 TR v[234:235],v14,960
 MM a[116:119],v[212:215],v[168:171],a[116:119]
 s_waitcnt lgkmcnt(6)
 TR v[236:237],v14,480
 v_fma_f32 v153, v153, s82, v185
 MM a[120:123],v[216:219],v[160:163],a[120:123]
 TR v[238:239],v14,992
 v_max3_f32 v253, v253, v150, v151
 MM a[124:127],v[216:219],v[164:167],a[124:127]
 v_fma_f32 v154, v154, s82, v185
 MM a[128:131],v[216:219],v[168:171],a[128:131]
 v_fma_f32 v155, v155, s82, v185
 MM a[132:135],v[220:223],v[160:163],a[132:135]
 v_max3_f32 v254, v254, v152, v153
 MM a[136:139],v[220:223],v[164:167],a[136:139]
 v_fma_f32 v156, v156, s82, v186
 v_fma_f32 v157, v157, s82, v186
 MM a[140:143],v[220:223],v[168:171],a[140:143]
 s_waitcnt lgkmcnt(6)
 v_max3_f32 v253, v253, v154, v155
 MM a[144:147],v[224:227],v[160:163],a[144:147]
 v_fma_f32 v158, v158, s82, v186
 MM a[148:151],v[224:227],v[164:167],a[148:151]
 v_fma_f32 v159, v159, s82, v186
 v_max3_f32 v254, v254, v156, v157
 MM a[152:155],v[224:227],v[168:171],a[152:155]
 s_waitcnt lgkmcnt(0) vmcnt(0)
 s_barrier
 ds_read_b128 v[208:211], v12 offset:16896
 MM a[156:159],v[228:231],v[160:163],a[156:159]
 v_max3_f32 v253, v253, v158, v159
 MM a[160:163],v[228:231],v[164:167],a[160:163]
 s_mov_b32 m0, s95
 v_max_f32 v253, v253, v254
 MM a[164:167],v[228:231],v[168:171],a[164:167]
 ds_read_b128 v[212:215], v12 offset:16960
 buffer_load_dwordx4 v4, s[40:43], s74 offen offset:0 nt lds
 MM a[168:171],v[232:235],v[160:163],a[168:171]
 v_cmp_lt_f32 vcc, 0x41800000, v253
 MM a[172:175],v[232:235],v[164:167],a[172:175]
 MM a[176:179],v[232:235],v[168:171],a[176:179]
 ds_read_b128 v[216:219], v12 offset:17024
 buffer_load_dwordx4 v5, s[40:43], s74 offen offset:1056 nt lds
 MM a[180:183],v[236:239],v[160:163],a[180:183]
 MM a[184:187],v[236:239],v[164:167],a[184:187]
 MM a[188:191],v[236:239],v[168:171],a[188:191]
 s_cbranch_vccnz LA_t22
LA_r22:
 s_waitcnt lgkmcnt(2)
 ds_read_b128 v[220:223], v12 offset:17088
 buffer_load_dwordx4 v6, s[40:43], s74 offen offset:2112 nt lds
 MM v[112:115],v[208:211],v[16:19],0
 v_exp_f32 v136, v136
 MM v[116:119],v[208:211],v[20:23],0
 ds_read_b128 v[224:227], v12 offset:17152
 buffer_load_dwordx4 v7, s[40:43], s74 offen offset:3168 nt lds
 MM v[120:123],v[208:211],v[24:27],0
 s_waitcnt lgkmcnt(3)
 s_add_u32 s74, s74, 16384
 MM v[112:115],v[212:215],v[28:31],v[112:115]
 v_exp_f32 v137, v137
 MM v[116:119],v[212:215],v[32:35],v[116:119]
 ds_read_b128 v[228:231], v12 offset:17216
 CV v160,v136,v137
 MM v[120:123],v[212:215],v[36:39],v[120:123]
 s_waitcnt lgkmcnt(2)
 v_exp_f32 v138, v138
 MM v[112:115],v[216:219],v[40:43],v[112:115]
 ds_read_b128 v[232:235], v12 offset:17280
 MM v[116:119],v[216:219],v[44:47],v[116:119]
 v_exp_f32 v139, v139
 MM v[120:123],v[216:219],v[48:51],v[120:123]
 v_exp_f32 v148, v148
 MM v[112:115],v[220:223],v[52:55],v[112:115]
 ds_read_b128 v[236:239], v12 offset:17344
 CV v161,v138,v139
 MM v[116:119],v[220:223],v[56:59],v[116:119]
 v_exp_f32 v149, v149
 MM v[120:123],v[220:223],v[60:63],v[120:123]
 s_waitcnt lgkmcnt(2)
 ds_read_b128 v[208:211], v12 offset:17408
 CV v162,v148,v149
 MM v[112:115],v[224:227],v[64:67],v[112:115]
 v_exp_f32 v150, v150
 MM v[116:119],v[224:227],v[68:71],v[116:119]
 v_exp_f32 v151, v151
 MM v[120:123],v[224:227],v[72:75],v[120:123]
 ds_read_b128 v[212:215], v12 offset:17472
 CV v163,v150,v151
 MM v[112:115],v[228:231],v[76:79],v[112:115]
 v_exp_f32 v140, v140
 MM v[116:119],v[228:231],v[80:83],v[116:119]
 ds_read_b128 v[216:219], v12 offset:17536
 MM v[120:123],v[228:231],v[84:87],v[120:123]
 s_waitcnt lgkmcnt(3)
 v_exp_f32 v141, v141
 MM v[112:115],v[232:235],v[88:91],v[112:115]
 v_exp_f32 v142, v142
 MM v[116:119],v[232:235],v[92:95],v[116:119]
 ds_read_b128 v[220:223], v12 offset:17600
 CV v164,v140,v141
 MM v[120:123],v[232:235],v[96:99],v[120:123]
 v_exp_f32 v143, v143
 MM v[112:115],v[236:239],v[100:103],v[112:115]
 ds_read_b128 v[224:227], v12 offset:17664
 CV v165,v142,v143
 MM v[116:119],v[236:239],v[104:107],v[116:119]
 v_exp_f32 v152, v152
 MM v[120:123],v[236:239],v[108:111],v[120:123]
 s_waitcnt lgkmcnt(3)
 v_exp_f32 v153, v153
 MM v[124:127],v[208:211],v[16:19],0
 ds_read_b128 v[228:231], v12 offset:17728
 CV v166,v152,v153
 MM v[128:131],v[208:211],v[20:23],0
 v_exp_f32 v154, v154
 MM v[132:135],v[208:211],v[24:27],0
 ds_read_b128 v[232:235], v12 offset:17792
 MM v[124:127],v[212:215],v[28:31],v[124:127]
 v_exp_f32 v155, v155
 MM v[128:131],v[212:215],v[32:35],v[128:131]
 v_exp_f32 v144, v144
 MM v[132:135],v[212:215],v[36:39],v[132:135]
 s_waitcnt lgkmcnt(3)
 ds_read_b128 v[236:239], v12 offset:17856
 CV v167,v154,v155
 MM v[124:127],v[216:219],v[40:43],v[124:127]
 v_exp_f32 v145, v145
 MM v[128:131],v[216:219],v[44:47],v[128:131]
 v_exp_f32 v146, v146
 MM v[132:135],v[216:219],v[48:51],v[132:135]
 v_exp_f32 v147, v147
 MM v[124:127],v[220:223],v[52:55],v[124:127]
 CV v168,v144,v145
 CV v169,v146,v147
 MM v[128:131],v[220:223],v[56:59],v[128:131]
 v_exp_f32 v156, v156
 MM v[132:135],v[220:223],v[60:63],v[132:135]
 s_waitcnt lgkmcnt(3)
 v_exp_f32 v157, v157
 MM v[124:127],v[224:227],v[64:67],v[124:127]
 v_exp_f32 v158, v158
 MM v[128:131],v[224:227],v[68:71],v[128:131]
 v_exp_f32 v159, v159
 MM v[132:135],v[224:227],v[72:75],v[132:135]
 s_waitcnt lgkmcnt(0) vmcnt(0)
 s_barrier
 TR v[208:209],v15,33792
 MM v[124:127],v[228:231],v[76:79],v[124:127]
 TR v[210:211],v15,34304
 CV v170,v156,v157
 MM v[128:131],v[228:231],v[80:83],v[128:131]
 CV v171,v158,v159
 MM v[132:135],v[228:231],v[84:87],v[132:135]
 TR v[212:213],v15,33824
 TR v[214:215],v15,34336
 MM v[124:127],v[232:235],v[88:91],v[124:127]
 MM v[128:131],v[232:235],v[92:95],v[128:131]
 MM v[132:135],v[232:235],v[96:99],v[132:135]
 s_mov_b32 m0, s96
 TR v[216:217],v15,33856
 TR v[218:219],v15,34368
 MM v[124:127],v[236:239],v[100:103],v[124:127]
 buffer_load_dwordx4 v4, s[32:35], s72 offen offset:0 nt lds
 MM v[128:131],v[236:239],v[104:107],v[128:131]
 buffer_load_dwordx4 v5, s[32:35], s72 offen offset:1056 nt lds
 MM v[132:135],v[236:239],v[108:111],v[132:135]
 buffer_load_dwordx4 v6, s[32:35], s72 offen offset:2112 nt lds
 MM a[192:195],a[204:207],v[160:163],a[192:195]
 buffer_load_dwordx4 v7, s[32:35], s72 offen offset:3168 nt lds
 MM a[196:199],a[204:207],v[164:167],a[196:199]
 s_add_u32 s72, s72, 16384
 MM a[200:203],a[204:207],v[168:171],a[200:203]
 s_waitcnt lgkmcnt(4)
 TR v[220:221],v15,33888
 MM a[0:3],v[208:211],v[160:163],a[0:3]
 TR v[222:223],v15,34400
 v_fma_f32 v112, v112, s82, v184
 MM a[4:7],v[208:211],v[164:167],a[4:7]
 TR v[224:225],v15,33920
 v_fma_f32 v113, v113, s82, v184
 MM a[8:11],v[208:211],v[168:171],a[8:11]
 s_waitcnt lgkmcnt(5)
 TR v[226:227],v15,34432
 MM a[12:15],v[212:215],v[160:163],a[12:15]
 v_fma_f32 v114, v114, s82, v184
 v_fma_f32 v115, v115, s82, v184
 MM a[16:19],v[212:215],v[164:167],a[16:19]
 TR v[228:229],v15,33952
 MM a[20:23],v[212:215],v[168:171],a[20:23]
 s_waitcnt lgkmcnt(3)
 TR v[230:231],v15,34464
 v_fma_f32 v116, v116, s82, v185
 MM a[24:27],v[216:219],v[160:163],a[24:27]
 TR v[232:233],v15,33984
 v_fma_f32 v117, v117, s82, v185
 MM a[28:31],v[216:219],v[164:167],a[28:31]
 TR v[234:235],v15,34496
 MM a[32:35],v[216:219],v[168:171],a[32:35]
 v_fma_f32 v118, v118, s82, v185
 v_fma_f32 v119, v119, s82, v185
 MM a[36:39],v[220:223],v[160:163],a[36:39]
 TR v[236:237],v15,34016
 MM a[40:43],v[220:223],v[164:167],a[40:43]
 TR v[238:239],v15,34528
 v_max3_f32 v253, v112, v113, v114
 MM a[44:47],v[220:223],v[168:171],a[44:47]
 s_waitcnt lgkmcnt(4)
 TR v[208:209],v15,34048
 v_max3_f32 v254, v115, v116, v117
 MM a[48:51],v[224:227],v[160:163],a[48:51]
 TR v[210:211],v15,34560
 MM a[52:55],v[224:227],v[164:167],a[52:55]
 v_fma_f32 v120, v120, s82, v186
 v_fma_f32 v121, v121, s82, v186
 MM a[56:59],v[224:227],v[168:171],a[56:59]
 TR v[212:213],v15,34080
 MM a[60:63],v[228:231],v[160:163],a[60:63]
 TR v[214:215],v15,34592
 v_max3_f32 v253, v253, v118, v119
 MM a[64:67],v[228:231],v[164:167],a[64:67]
 TR v[216:217],v15,34112
 MM a[68:71],v[228:231],v[168:171],a[68:71]
 s_waitcnt lgkmcnt(5)
 v_fma_f32 v122, v122, s82, v186
 v_fma_f32 v123, v123, s82, v186
 MM a[72:75],v[232:235],v[160:163],a[72:75]
 TR v[218:219],v15,34624
 MM a[76:79],v[232:235],v[164:167],a[76:79]
 TR v[220:221],v15,34144
 v_max3_f32 v254, v254, v120, v121
 MM a[80:83],v[232:235],v[168:171],a[80:83]
 TR v[222:223],v15,34656
 v_fma_f32 v124, v124, s82, v184
 MM a[84:87],v[236:239],v[160:163],a[84:87]
 TR v[224:225],v15,34176
 MM a[88:91],v[236:239],v[164:167],a[88:91]
 v_fma_f32 v125, v125, s82, v184
 v_max3_f32 v253, v253, v122, v123
 MM a[92:95],v[236:239],v[168:171],a[92:95]
 s_waitcnt lgkmcnt(5)
 TR v[226:227],v15,34688
 MM a[96:99],v[208:211],v[160:163],a[96:99]
 TR v[228:229],v15,34208
 v_fma_f32 v126, v126, s82, v184
 MM a[100:103],v[208:211],v[164:167],a[100:103]
 TR v[230:231],v15,34720
 v_fma_f32 v127, v127, s82, v184
 MM a[104:107],v[208:211],v[168:171],a[104:107]
 TR v[232:233],v15,34240
 MM a[108:111],v[212:215],v[160:163],a[108:111]
 v_max3_f32 v254, v254, v124, v125
 v_fma_f32 v128, v128, s82, v185
 MM a[112:115],v[212:215],v[164:167],a[112:115]
 TR v[234:235],v15,34752
 MM a[116:119],v[212:215],v[168:171],a[116:119]
 s_waitcnt lgkmcnt(6)
 TR v[236:237],v15,34272
 v_fma_f32 v129, v129, s82, v185
 MM a[120:123],v[216:219],v[160:163],a[120:123]
 TR v[238:239],v15,34784
 v_max3_f32 v253, v253, v126, v127
 MM a[124:127],v[216:219],v[164:167],a[124:127]
 v_fma_f32 v130, v130, s82, v185
 MM a[128:131],v[216:219],v[168:171],a[128:131]
 v_fma_f32 v131, v131, s82, v185
 MM a[132:135],v[220:223],v[160:163],a[132:135]
 v_max3_f32 v254, v254, v128, v129
 MM a[136:139],v[220:223],v[164:167],a[136:139]
 v_fma_f32 v132, v132, s82, v186
 v_fma_f32 v133, v133, s82, v186
 MM a[140:143],v[220:223],v[168:171],a[140:143]
 s_waitcnt lgkmcnt(6)
 v_max3_f32 v253, v253, v130, v131
 MM a[144:147],v[224:227],v[160:163],a[144:147]
 v_fma_f32 v134, v134, s82, v186
 MM a[148:151],v[224:227],v[164:167],a[148:151]
 v_fma_f32 v135, v135, s82, v186
 v_max3_f32 v254, v254, v132, v133
 MM a[152:155],v[224:227],v[168:171],a[152:155]
 s_waitcnt lgkmcnt(0) vmcnt(0)
 s_barrier
 ds_read_b128 v[208:211], v13 offset:50688
 MM a[156:159],v[228:231],v[160:163],a[156:159]
 v_max3_f32 v253, v253, v134, v135
 MM a[160:163],v[228:231],v[164:167],a[160:163]
 s_mov_b32 m0, s89
 v_max_f32 v253, v253, v254
 MM a[164:167],v[228:231],v[168:171],a[164:167]
 ds_read_b128 v[212:215], v13 offset:50752
 buffer_load_dwordx4 v4, s[40:43], s74 offen offset:0 nt lds
 MM a[168:171],v[232:235],v[160:163],a[168:171]
 v_cmp_lt_f32 vcc, 0x41800000, v253
 MM a[172:175],v[232:235],v[164:167],a[172:175]
 MM a[176:179],v[232:235],v[168:171],a[176:179]
 ds_read_b128 v[216:219], v13 offset:50816
 buffer_load_dwordx4 v5, s[40:43], s74 offen offset:1056 nt lds
 MM a[180:183],v[236:239],v[160:163],a[180:183]
 MM a[184:187],v[236:239],v[164:167],a[184:187]
 MM a[188:191],v[236:239],v[168:171],a[188:191]
 s_cbranch_vccnz LA_t23
LA_r23:
 s_waitcnt lgkmcnt(2)
 ds_read_b128 v[220:223], v13 offset:50880
 buffer_load_dwordx4 v6, s[40:43], s74 offen offset:2112 nt lds
 MM v[136:139],v[208:211],v[16:19],0
 v_exp_f32 v112, v112
 MM v[140:143],v[208:211],v[20:23],0
 ds_read_b128 v[224:227], v13 offset:50944
 buffer_load_dwordx4 v7, s[40:43], s74 offen offset:3168 nt lds
 MM v[144:147],v[208:211],v[24:27],0
 s_waitcnt lgkmcnt(3)
 s_add_u32 s74, s74, 16384
 MM v[136:139],v[212:215],v[28:31],v[136:139]
 v_exp_f32 v113, v113
 MM v[140:143],v[212:215],v[32:35],v[140:143]
 ds_read_b128 v[228:231], v13 offset:51008
 CV v160,v112,v113
 MM v[144:147],v[212:215],v[36:39],v[144:147]
 s_waitcnt lgkmcnt(2)
 v_exp_f32 v114, v114
 MM v[136:139],v[216:219],v[40:43],v[136:139]
 ds_read_b128 v[232:235], v13 offset:51072
 MM v[140:143],v[216:219],v[44:47],v[140:143]
 v_exp_f32 v115, v115
 MM v[144:147],v[216:219],v[48:51],v[144:147]
 v_exp_f32 v124, v124
 MM v[136:139],v[220:223],v[52:55],v[136:139]
 ds_read_b128 v[236:239], v13 offset:51136
 CV v161,v114,v115
 MM v[140:143],v[220:223],v[56:59],v[140:143]
 v_exp_f32 v125, v125
 MM v[144:147],v[220:223],v[60:63],v[144:147]
 s_waitcnt lgkmcnt(2)
 ds_read_b128 v[208:211], v13 offset:51200
 CV v162,v124,v125
 MM v[136:139],v[224:227],v[64:67],v[136:139]
 v_exp_f32 v126, v126
 MM v[140:143],v[224:227],v[68:71],v[140:143]
 v_exp_f32 v127, v127
 MM v[144:147],v[224:227],v[72:75],v[144:147]
 ds_read_b128 v[212:215], v13 offset:51264
 CV v163,v126,v127
 MM v[136:139],v[228:231],v[76:79],v[136:139]
 v_exp_f32 v116, v116
 MM v[140:143],v[228:231],v[80:83],v[140:143]
 ds_read_b128 v[216:219], v13 offset:51328
 MM v[144:147],v[228:231],v[84:87],v[144:147]
 s_waitcnt lgkmcnt(3)
 v_exp_f32 v117, v117
 MM v[136:139],v[232:235],v[88:91],v[136:139]
 v_exp_f32 v118, v118
 MM v[140:143],v[232:235],v[92:95],v[140:143]
 ds_read_b128 v[220:223], v13 offset:51392
 CV v164,v116,v117
 MM v[144:147],v[232:235],v[96:99],v[144:147]
 v_exp_f32 v119, v119
 MM v[136:139],v[236:239],v[100:103],v[136:139]
 ds_read_b128 v[224:227], v13 offset:51456
 CV v165,v118,v119
 MM v[140:143],v[236:239],v[104:107],v[140:143]
 v_exp_f32 v128, v128
 MM v[144:147],v[236:239],v[108:111],v[144:147]
 s_waitcnt lgkmcnt(3)
 v_exp_f32 v129, v129
 MM v[148:151],v[208:211],v[16:19],0
 ds_read_b128 v[228:231], v13 offset:51520
 CV v166,v128,v129
 MM v[152:155],v[208:211],v[20:23],0
 v_exp_f32 v130, v130
 MM v[156:159],v[208:211],v[24:27],0
 ds_read_b128 v[232:235], v13 offset:51584
 MM v[148:151],v[212:215],v[28:31],v[148:151]
 v_exp_f32 v131, v131
 MM v[152:155],v[212:215],v[32:35],v[152:155]
 v_exp_f32 v120, v120
 MM v[156:159],v[212:215],v[36:39],v[156:159]
 s_waitcnt lgkmcnt(3)
 ds_read_b128 v[236:239], v13 offset:51648
 CV v167,v130,v131
 MM v[148:151],v[216:219],v[40:43],v[148:151]
 v_exp_f32 v121, v121
 MM v[152:155],v[216:219],v[44:47],v[152:155]
 v_exp_f32 v122, v122
 MM v[156:159],v[216:219],v[48:51],v[156:159]
 v_exp_f32 v123, v123
 MM v[148:151],v[220:223],v[52:55],v[148:151]
 CV v168,v120,v121
 CV v169,v122,v123
 MM v[152:155],v[220:223],v[56:59],v[152:155]
 v_exp_f32 v132, v132
 MM v[156:159],v[220:223],v[60:63],v[156:159]
 s_waitcnt lgkmcnt(3)
 v_exp_f32 v133, v133
 MM v[148:151],v[224:227],v[64:67],v[148:151]
 v_exp_f32 v134, v134
 MM v[152:155],v[224:227],v[68:71],v[152:155]
 v_exp_f32 v135, v135
 MM v[156:159],v[224:227],v[72:75],v[156:159]
 s_waitcnt lgkmcnt(0) vmcnt(0)
 s_barrier
 TR v[208:209],v14,0
 MM v[148:151],v[228:231],v[76:79],v[148:151]
 TR v[210:211],v14,512
 CV v170,v132,v133
 MM v[152:155],v[228:231],v[80:83],v[152:155]
 CV v171,v134,v135
 MM v[156:159],v[228:231],v[84:87],v[156:159]
 TR v[212:213],v14,32
 TR v[214:215],v14,544
 MM v[148:151],v[232:235],v[88:91],v[148:151]
 MM v[152:155],v[232:235],v[92:95],v[152:155]
 MM v[156:159],v[232:235],v[96:99],v[156:159]
 TR v[216:217],v14,64
 TR v[218:219],v14,576
 MM v[148:151],v[236:239],v[100:103],v[148:151]
 MM v[152:155],v[236:239],v[104:107],v[152:155]
 MM v[156:159],v[236:239],v[108:111],v[156:159]
 MM a[192:195],a[204:207],v[160:163],a[192:195]
 MM a[196:199],a[204:207],v[164:167],a[196:199]
 MM a[200:203],a[204:207],v[168:171],a[200:203]
 s_waitcnt lgkmcnt(4)
 TR v[220:221],v14,96
 MM a[0:3],v[208:211],v[160:163],a[0:3]
 TR v[222:223],v14,608
 v_fma_f32 v136, v136, s82, v184
 MM a[4:7],v[208:211],v[164:167],a[4:7]
 TR v[224:225],v14,128
 v_fma_f32 v137, v137, s82, v184
 MM a[8:11],v[208:211],v[168:171],a[8:11]
 s_waitcnt lgkmcnt(5)
 s_mov_b32 m0, s90
 TR v[226:227],v14,640
 MM a[12:15],v[212:215],v[160:163],a[12:15]
 buffer_load_dwordx4 v4, s[32:35], s72 offen offset:0 nt lds
 v_fma_f32 v138, v138, s82, v184
 MM a[16:19],v[212:215],v[164:167],a[16:19]
 TR v[228:229],v14,160
 buffer_load_dwordx4 v5, s[32:35], s72 offen offset:1056 nt lds
 MM a[20:23],v[212:215],v[168:171],a[20:23]
 s_waitcnt lgkmcnt(3)
 TR v[230:231],v14,672
 v_fma_f32 v139, v139, s82, v184
 MM a[24:27],v[216:219],v[160:163],a[24:27]
 TR v[232:233],v14,192
 MM a[28:31],v[216:219],v[164:167],a[28:31]
 TR v[234:235],v14,704
 v_fma_f32 v140, v140, s82, v185
 MM a[32:35],v[216:219],v[168:171],a[32:35]
 buffer_load_dwordx4 v6, s[32:35], s72 offen offset:2112 nt lds
 v_fma_f32 v141, v141, s82, v185
 MM a[36:39],v[220:223],v[160:163],a[36:39]
 TR v[236:237],v14,224
 v_fma_f32 v142, v142, s82, v185
 MM a[40:43],v[220:223],v[164:167],a[40:43]
 TR v[238:239],v14,736
 MM a[44:47],v[220:223],v[168:171],a[44:47]
 s_waitcnt lgkmcnt(4)
 TR v[208:209],v14,256
 v_fma_f32 v143, v143, s82, v185
 MM a[48:51],v[224:227],v[160:163],a[48:51]
 TR v[210:211],v14,768
 v_max3_f32 v253, v136, v137, v138
 MM a[52:55],v[224:227],v[164:167],a[52:55]
 buffer_load_dwordx4 v7, s[32:35], s72 offen offset:3168 nt lds
 v_max3_f32 v254, v139, v140, v141
 MM a[56:59],v[224:227],v[168:171],a[56:59]
 s_add_u32 s72, s72, 16384
 TR v[212:213],v14,288
 MM a[60:63],v[228:231],v[160:163],a[60:63]
 TR v[214:215],v14,800
 v_fma_f32 v144, v144, s82, v186
 MM a[64:67],v[228:231],v[164:167],a[64:67]
 s_mov_b32 m0, s95
 TR v[216:217],v14,320
 v_fma_f32 v145, v145, s82, v186
 MM a[68:71],v[228:231],v[168:171],a[68:71]
 s_waitcnt lgkmcnt(5)
 buffer_load_dwordx4 v4, s[40:43], s74 offen offset:0 nt lds
 v_max3_f32 v253, v253, v142, v143
 MM a[72:75],v[232:235],v[160:163],a[72:75]
 TR v[218:219],v14,832
 MM a[76:79],v[232:235],v[164:167],a[76:79]
 TR v[220:221],v14,352
 v_fma_f32 v146, v146, s82, v186
 MM a[80:83],v[232:235],v[168:171],a[80:83]
 TR v[222:223],v14,864
 v_fma_f32 v147, v147, s82, v186
 MM a[84:87],v[236:239],v[160:163],a[84:87]
 TR v[224:225],v14,384
 v_max3_f32 v254, v254, v144, v145
 MM a[88:91],v[236:239],v[164:167],a[88:91]
 buffer_load_dwordx4 v5, s[40:43], s74 offen offset:1056 nt lds
 MM a[92:95],v[236:239],v[168:171],a[92:95]
 s_waitcnt lgkmcnt(5)
 TR v[226:227],v14,896
 v_fma_f32 v148, v148, s82, v184
 MM a[96:99],v[208:211],v[160:163],a[96:99]
 TR v[228:229],v14,416
 v_fma_f32 v149, v149, s82, v184
 MM a[100:103],v[208:211],v[164:167],a[100:103]
 TR v[230:231],v14,928
 v_max3_f32 v253, v253, v146, v147
 MM a[104:107],v[208:211],v[168:171],a[104:107]
 TR v[232:233],v14,448
 MM a[108:111],v[212:215],v[160:163],a[108:111]
 buffer_load_dwordx4 v6, s[40:43], s74 offen offset:2112 nt lds
 v_fma_f32 v150, v150, s82, v184
 MM a[112:115],v[212:215],v[164:167],a[112:115]
 TR v[234:235],v14,960
 v_fma_f32 v151, v151, s82, v184
 MM a[116:119],v[212:215],v[168:171],a[116:119]
 s_waitcnt lgkmcnt(6)
 TR v[236:237],v14,480
 v_max3_f32 v254, v254, v148, v149
 MM a[120:123],v[216:219],v[160:163],a[120:123]
 TR v[238:239],v14,992
 MM a[124:127],v[216:219],v[164:167],a[124:127]
 buffer_load_dwordx4 v7, s[40:43], s74 offen offset:3168 nt lds
 v_fma_f32 v152, v152, s82, v185
 MM a[128:131],v[216:219],v[168:171],a[128:131]
 s_add_u32 s74, s74, 16384
 v_fma_f32 v153, v153, s82, v185
 v_max3_f32 v253, v253, v150, v151
 MM a[132:135],v[220:223],v[160:163],a[132:135]
 v_fma_f32 v154, v154, s82, v185
 MM a[136:139],v[220:223],v[164:167],a[136:139]
 v_fma_f32 v155, v155, s82, v185
 v_max3_f32 v254, v254, v152, v153
 MM a[140:143],v[220:223],v[168:171],a[140:143]
 s_waitcnt lgkmcnt(6)
 v_fma_f32 v156, v156, s82, v186
 MM a[144:147],v[224:227],v[160:163],a[144:147]
 v_fma_f32 v157, v157, s82, v186
 v_max3_f32 v253, v253, v154, v155
 MM a[148:151],v[224:227],v[164:167],a[148:151]
 v_fma_f32 v158, v158, s82, v186
 MM a[152:155],v[224:227],v[168:171],a[152:155]
 s_waitcnt lgkmcnt(0) vmcnt(4)
 s_barrier
 ds_read_b128 v[208:211], v12 offset:16896
 MM a[156:159],v[228:231],v[160:163],a[156:159]
 v_fma_f32 v159, v159, s82, v186
 v_max3_f32 v254, v254, v156, v157
 MM a[160:163],v[228:231],v[164:167],a[160:163]
 v_max3_f32 v253, v253, v158, v159
 MM a[164:167],v[228:231],v[168:171],a[164:167]
 ds_read_b128 v[212:215], v12 offset:16960
 v_max_f32 v253, v253, v254
 MM a[168:171],v[232:235],v[160:163],a[168:171]
 v_cmp_lt_f32 vcc, 0x41800000, v253
 MM a[172:175],v[232:235],v[164:167],a[172:175]
 MM a[176:179],v[232:235],v[168:171],a[176:179]
 ds_read_b128 v[216:219], v12 offset:17024
 MM a[180:183],v[236:239],v[160:163],a[180:183]
 MM a[184:187],v[236:239],v[164:167],a[184:187]
 MM a[188:191],v[236:239],v[168:171],a[188:191]
 s_cbranch_vccnz LA_t24
LA_r24:
 s_waitcnt lgkmcnt(2)
 ds_read_b128 v[220:223], v12 offset:17088
 MM v[112:115],v[208:211],v[16:19],0
 s_mov_b32 m0, s96
 v_exp_f32 v136, v136
 MM v[116:119],v[208:211],v[20:23],0
 ds_read_b128 v[224:227], v12 offset:17152
 buffer_load_dwordx4 v4, s[32:35], s72 offen offset:0 nt lds
 MM v[120:123],v[208:211],v[24:27],0
 s_waitcnt lgkmcnt(3)
 v_exp_f32 v137, v137
 MM v[112:115],v[212:215],v[28:31],v[112:115]
 v_exp_f32 v138, v138
 MM v[116:119],v[212:215],v[32:35],v[116:119]
 ds_read_b128 v[228:231], v12 offset:17216
 buffer_load_dwordx4 v5, s[32:35], s72 offen offset:1056 nt lds
 MM v[120:123],v[212:215],v[36:39],v[120:123]
 s_waitcnt lgkmcnt(2)
 v_exp_f32 v139, v139
 MM v[112:115],v[216:219],v[40:43],v[112:115]
 ds_read_b128 v[232:235], v12 offset:17280
 CV v160,v136,v137
 MM v[116:119],v[216:219],v[44:47],v[116:119]
 v_exp_f32 v148, v148
 MM v[120:123],v[216:219],v[48:51],v[120:123]
 v_exp_f32 v149, v149
 MM v[112:115],v[220:223],v[52:55],v[112:115]
 ds_read_b128 v[236:239], v12 offset:17344
 buffer_load_dwordx4 v6, s[32:35], s72 offen offset:2112 nt lds
 MM v[116:119],v[220:223],v[56:59],v[116:119]
 CV v161,v138,v139
 CV v162,v148,v149
 MM v[120:123],v[220:223],v[60:63],v[120:123]
 s_waitcnt lgkmcnt(2)
 ds_read_b128 v[208:211], v12 offset:17408
 MM v[112:115],v[224:227],v[64:67],v[112:115]
 v_exp_f32 v150, v150
 MM v[116:119],v[224:227],v[68:71],v[116:119]
 v_exp_f32 v151, v151
 MM v[120:123],v[224:227],v[72:75],v[120:123]
 ds_read_b128 v[212:215], v12 offset:17472
 buffer_load_dwordx4 v7, s[32:35], s72 offen offset:3168 nt lds
 MM v[112:115],v[228:231],v[76:79],v[112:115]
 s_add_u32 s72, s72, 16384
 v_exp_f32 v140, v140
 MM v[116:119],v[228:231],v[80:83],v[116:119]
 ds_read_b128 v[216:219], v12 offset:17536
 CV v163,v150,v151
 MM v[120:123],v[228:231],v[84:87],v[120:123]
 s_waitcnt lgkmcnt(3)
 v_exp_f32 v141, v141
 MM v[112:115],v[232:235],v[88:91],v[112:115]
 s_mov_b32 m0, s89
 v_exp_f32 v142, v142
 MM v[116:119],v[232:235],v[92:95],v[116:119]
 ds_read_b128 v[220:223], v12 offset:17600
 buffer_load_dwordx4 v4, s[40:43], s74 offen offset:0 nt lds
 MM v[120:123],v[232:235],v[96:99],v[120:123]
 v_exp_f32 v143, v143
 MM v[112:115],v[236:239],v[100:103],v[112:115]
 ds_read_b128 v[224:227], v12 offset:17664
 buffer_load_dwordx4 v5, s[40:43], s74 offen offset:1056 nt lds
 MM v[116:119],v[236:239],v[104:107],v[116:119]
 CV v164,v140,v141
 CV v165,v142,v143
 MM v[120:123],v[236:239],v[108:111],v[120:123]
 s_waitcnt lgkmcnt(3)
 v_exp_f32 v152, v152
 MM v[124:127],v[208:211],v[16:19],0
 ds_read_b128 v[228:231], v12 offset:17728
 MM v[128:131],v[208:211],v[20:23],0
 v_exp_f32 v153, v153
 MM v[132:135],v[208:211],v[24:27],0
 ds_read_b128 v[232:235], v12 offset:17792
 buffer_load_dwordx4 v6, s[40:43], s74 offen offset:2112 nt lds
 MM v[124:127],v[212:215],v[28:31],v[124:127]
 v_exp_f32 v154, v154
 MM v[128:131],v[212:215],v[32:35],v[128:131]
 v_exp_f32 v155, v155
 MM v[132:135],v[212:215],v[36:39],v[132:135]
 s_waitcnt lgkmcnt(3)
 ds_read_b128 v[236:239], v12 offset:17856
 buffer_load_dwordx4 v7, s[40:43], s74 offen offset:3168 nt lds
 MM v[124:127],v[216:219],v[40:43],v[124:127]
 s_add_u32 s74, s74, 16384
 CV v166,v152,v153
 CV v167,v154,v155
 MM v[128:131],v[216:219],v[44:47],v[128:131]
 v_exp_f32 v144, v144
 MM v[132:135],v[216:219],v[48:51],v[132:135]
 v_exp_f32 v145, v145
 MM v[124:127],v[220:223],v[52:55],v[124:127]
 v_exp_f32 v146, v146
 MM v[128:131],v[220:223],v[56:59],v[128:131]
 v_exp_f32 v147, v147
 MM v[132:135],v[220:223],v[60:63],v[132:135]
 s_waitcnt lgkmcnt(3)
 CV v168,v144,v145
 CV v169,v146,v147
 MM v[124:127],v[224:227],v[64:67],v[124:127]
 v_exp_f32 v156, v156
 MM v[128:131],v[224:227],v[68:71],v[128:131]
 v_exp_f32 v157, v157
 MM v[132:135],v[224:227],v[72:75],v[132:135]
 s_waitcnt lgkmcnt(0) vmcnt(8)
 s_barrier
 TR v[208:209],v15,33792
 MM v[124:127],v[228:231],v[76:79],v[124:127]
 TR v[210:211],v15,34304
 CV v170,v156,v157
 MM v[128:131],v[228:231],v[80:83],v[128:131]
 v_exp_f32 v158, v158
 MM v[132:135],v[228:231],v[84:87],v[132:135]
 TR v[212:213],v15,33824
 TR v[214:215],v15,34336
 MM v[124:127],v[232:235],v[88:91],v[124:127]
 v_exp_f32 v159, v159
 MM v[128:131],v[232:235],v[92:95],v[128:131]
 CV v171,v158,v159
 MM v[132:135],v[232:235],v[96:99],v[132:135]
 TR v[216:217],v15,33856
 TR v[218:219],v15,34368
 MM v[124:127],v[236:239],v[100:103],v[124:127]
 MM v[128:131],v[236:239],v[104:107],v[128:131]
 MM v[132:135],v[236:239],v[108:111],v[132:135]
 s_mov_b32 s79, 0
LA_loop66:
 MM a[192:195],a[204:207],v[160:163],a[192:195]
 MM a[196:199],a[204:207],v[164:167],a[196:199]
 MM a[200:203],a[204:207],v[168:171],a[200:203]
 s_waitcnt lgkmcnt(4)
 TR v[220:221],v15,33888
 MM a[0:3],v[208:211],v[160:163],a[0:3]
 TR v[222:223],v15,34400
 v_fma_f32 v112, v112, s82, v184
 MM a[4:7],v[208:211],v[164:167],a[4:7]
 TR v[224:225],v15,33920
 v_fma_f32 v113, v113, s82, v184
 MM a[8:11],v[208:211],v[168:171],a[8:11]
 s_waitcnt lgkmcnt(5)
 s_mov_b32 m0, s90
 TR v[226:227],v15,34432
 MM a[12:15],v[212:215],v[160:163],a[12:15]
 buffer_load_dwordx4 v4, s[32:35], s72 offen offset:0 nt lds
 v_fma_f32 v114, v114, s82, v184
 MM a[16:19],v[212:215],v[164:167],a[16:19]
 TR v[228:229],v15,33952
 MM a[20:23],v[212:215],v[168:171],a[20:23]
 s_waitcnt lgkmcnt(3)
 TR v[230:231],v15,34464
 v_fma_f32 v115, v115, s82, v184
 MM a[24:27],v[216:219],v[160:163],a[24:27]
 TR v[232:233],v15,33984
 v_fma_f32 v116, v116, s82, v185
 MM a[28:31],v[216:219],v[164:167],a[28:31]
 TR v[234:235],v15,34496
 MM a[32:35],v[216:219],v[168:171],a[32:35]
 buffer_load_dwordx4 v5, s[32:35], s72 offen offset:1056 nt lds
 v_fma_f32 v117, v117, s82, v185
 MM a[36:39],v[220:223],v[160:163],a[36:39]
 TR v[236:237],v15,34016
 v_fma_f32 v118, v118, s82, v185
 MM a[40:43],v[220:223],v[164:167],a[40:43]
 TR v[238:239],v15,34528
 MM a[44:47],v[220:223],v[168:171],a[44:47]
 s_waitcnt lgkmcnt(4)
 TR v[208:209],v15,34048
 v_fma_f32 v119, v119, s82, v185
 MM a[48:51],v[224:227],v[160:163],a[48:51]
 TR v[210:211],v15,34560
 v_max3_f32 v253, v112, v113, v114
 MM a[52:55],v[224:227],v[164:167],a[52:55]
 v_max3_f32 v254, v115, v116, v117
 MM a[56:59],v[224:227],v[168:171],a[56:59]
 TR v[212:213],v15,34080
 v_fma_f32 v120, v120, s82, v186
 MM a[60:63],v[228:231],v[160:163],a[60:63]
 TR v[214:215],v15,34592
 v_fma_f32 v121, v121, s82, v186
 MM a[64:67],v[228:231],v[164:167],a[64:67]
 TR v[216:217],v15,34112
 MM a[68:71],v[228:231],v[168:171],a[68:71]
 s_waitcnt lgkmcnt(5)
 buffer_load_dwordx4 v6, s[32:35], s72 offen offset:2112 nt lds
 v_max3_f32 v253, v253, v118, v119
 MM a[72:75],v[232:235],v[160:163],a[72:75]
 TR v[218:219],v15,34624
 v_fma_f32 v122, v122, s82, v186
 MM a[76:79],v[232:235],v[164:167],a[76:79]
 TR v[220:221],v15,34144
 MM a[80:83],v[232:235],v[168:171],a[80:83]
 TR v[222:223],v15,34656
 v_fma_f32 v123, v123, s82, v186
 MM a[84:87],v[236:239],v[160:163],a[84:87]
 TR v[224:225],v15,34176
 v_max3_f32 v254, v254, v120, v121
 MM a[88:91],v[236:239],v[164:167],a[88:91]
 v_fma_f32 v124, v124, s82, v184
 MM a[92:95],v[236:239],v[168:171],a[92:95]
 s_waitcnt lgkmcnt(5)
 TR v[226:227],v15,34688
 v_fma_f32 v125, v125, s82, v184
 MM a[96:99],v[208:211],v[160:163],a[96:99]
 TR v[228:229],v15,34208
 v_max3_f32 v253, v253, v122, v123
 MM a[100:103],v[208:211],v[164:167],a[100:103]
 TR v[230:231],v15,34720
 MM a[104:107],v[208:211],v[168:171],a[104:107]
 TR v[232:233],v15,34240
 v_fma_f32 v126, v126, s82, v184
 MM a[108:111],v[212:215],v[160:163],a[108:111]
 buffer_load_dwordx4 v7, s[32:35], s72 offen offset:3168 nt lds
 v_fma_f32 v127, v127, s82, v184
 MM a[112:115],v[212:215],v[164:167],a[112:115]
 s_add_u32 s72, s72, 16384
 TR v[234:235],v15,34752
 MM a[116:119],v[212:215],v[168:171],a[116:119]
 s_waitcnt lgkmcnt(6)
 TR v[236:237],v15,34272
 v_max3_f32 v254, v254, v124, v125
 MM a[120:123],v[216:219],v[160:163],a[120:123]
 TR v[238:239],v15,34784
 v_fma_f32 v128, v128, s82, v185
 MM a[124:127],v[216:219],v[164:167],a[124:127]
 v_fma_f32 v129, v129, s82, v185
 MM a[128:131],v[216:219],v[168:171],a[128:131]
 v_max3_f32 v253, v253, v126, v127
 v_fma_f32 v130, v130, s82, v185
 MM a[132:135],v[220:223],v[160:163],a[132:135]
 v_fma_f32 v131, v131, s82, v185
 MM a[136:139],v[220:223],v[164:167],a[136:139]
 v_max3_f32 v254, v254, v128, v129
 MM a[140:143],v[220:223],v[168:171],a[140:143]
 s_waitcnt lgkmcnt(6)
 v_fma_f32 v132, v132, s82, v186
 v_fma_f32 v133, v133, s82, v186
 MM a[144:147],v[224:227],v[160:163],a[144:147]
 v_max3_f32 v253, v253, v130, v131
 MM a[148:151],v[224:227],v[164:167],a[148:151]
 v_fma_f32 v134, v134, s82, v186
 v_fma_f32 v135, v135, s82, v186
 MM a[152:155],v[224:227],v[168:171],a[152:155]
 s_waitcnt lgkmcnt(0) vmcnt(8)
 s_barrier
 ds_read_b128 v[208:211], v13 offset:50688
 MM a[156:159],v[228:231],v[160:163],a[156:159]
 v_max3_f32 v254, v254, v132, v133
 MM a[160:163],v[228:231],v[164:167],a[160:163]
 v_max3_f32 v253, v253, v134, v135
 MM a[164:167],v[228:231],v[168:171],a[164:167]
 ds_read_b128 v[212:215], v13 offset:50752
 v_max_f32 v253, v253, v254
 MM a[168:171],v[232:235],v[160:163],a[168:171]
 v_cmp_lt_f32 vcc, 0x41800000, v253
 MM a[172:175],v[232:235],v[164:167],a[172:175]
 MM a[176:179],v[232:235],v[168:171],a[176:179]
 ds_read_b128 v[216:219], v13 offset:50816
 MM a[180:183],v[236:239],v[160:163],a[180:183]
 MM a[184:187],v[236:239],v[164:167],a[184:187]
 MM a[188:191],v[236:239],v[168:171],a[188:191]
 s_cbranch_vccnz LA_t25
LA_r25:
 s_waitcnt lgkmcnt(2)
 ds_read_b128 v[220:223], v13 offset:50880
 MM v[136:139],v[208:211],v[16:19],0
 s_mov_b32 m0, s95
 v_exp_f32 v112, v112
 MM v[140:143],v[208:211],v[20:23],0
 ds_read_b128 v[224:227], v13 offset:50944
 buffer_load_dwordx4 v4, s[40:43], s74 offen offset:0 nt lds
 MM v[144:147],v[208:211],v[24:27],0
 s_waitcnt lgkmcnt(3)
 v_exp_f32 v113, v113
 MM v[136:139],v[212:215],v[28:31],v[136:139]
 v_exp_f32 v114, v114
 MM v[140:143],v[212:215],v[32:35],v[140:143]
 ds_read_b128 v[228:231], v13 offset:51008
 CV v160,v112,v113
 MM v[144:147],v[212:215],v[36:39],v[144:147]
 s_waitcnt lgkmcnt(2)
 v_exp_f32 v115, v115
 MM v[136:139],v[216:219],v[40:43],v[136:139]
 ds_read_b128 v[232:235], v13 offset:51072
 CV v161,v114,v115
 MM v[140:143],v[216:219],v[44:47],v[140:143]
 v_exp_f32 v124, v124
 MM v[144:147],v[216:219],v[48:51],v[144:147]
 v_exp_f32 v125, v125
 MM v[136:139],v[220:223],v[52:55],v[136:139]
 ds_read_b128 v[236:239], v13 offset:51136
 buffer_load_dwordx4 v5, s[40:43], s74 offen offset:1056 nt lds
 MM v[140:143],v[220:223],v[56:59],v[140:143]
 v_exp_f32 v126, v126
 MM v[144:147],v[220:223],v[60:63],v[144:147]
 s_waitcnt lgkmcnt(2)
 ds_read_b128 v[208:211], v13 offset:51200
 CV v162,v124,v125
 MM v[136:139],v[224:227],v[64:67],v[136:139]
 v_exp_f32 v127, v127
 MM v[140:143],v[224:227],v[68:71],v[140:143]
 v_exp_f32 v116, v116
 MM v[144:147],v[224:227],v[72:75],v[144:147]
 ds_read_b128 v[212:215], v13 offset:51264
 CV v163,v126,v127
 MM v[136:139],v[228:231],v[76:79],v[136:139]
 v_exp_f32 v117, v117
 MM v[140:143],v[228:231],v[80:83],v[140:143]
 ds_read_b128 v[216:219], v13 offset:51328
 CV v164,v116,v117
 MM v[144:147],v[228:231],v[84:87],v[144:147]
 s_waitcnt lgkmcnt(3)
 v_exp_f32 v118, v118
 MM v[136:139],v[232:235],v[88:91],v[136:139]
 v_exp_f32 v119, v119
 MM v[140:143],v[232:235],v[92:95],v[140:143]
 ds_read_b128 v[220:223], v13 offset:51392
 buffer_load_dwordx4 v6, s[40:43], s74 offen offset:2112 nt lds
 MM v[144:147],v[232:235],v[96:99],v[144:147]
 v_exp_f32 v128, v128
 MM v[136:139],v[236:239],v[100:103],v[136:139]
 ds_read_b128 v[224:227], v13 offset:51456
 CV v165,v118,v119
 MM v[140:143],v[236:239],v[104:107],v[140:143]
 v_exp_f32 v129, v129
 MM v[144:147],v[236:239],v[108:111],v[144:147]
 s_waitcnt lgkmcnt(3)
 v_exp_f32 v130, v130
 MM v[148:151],v[208:211],v[16:19],0
 ds_read_b128 v[228:231], v13 offset:51520
 CV v166,v128,v129
 MM v[152:155],v[208:211],v[20:23],0
 v_exp_f32 v131, v131
 MM v[156:159],v[208:211],v[24:27],0
 ds_read_b128 v[232:235], v13 offset:51584
 buffer_load_dwordx4 v7, s[40:43], s74 offen offset:3168 nt lds
 MM v[148:151],v[212:215],v[28:31],v[148:151]
 s_add_u32 s74, s74, 16384
 v_exp_f32 v120, v120
 MM v[152:155],v[212:215],v[32:35],v[152:155]
 v_exp_f32 v121, v121
 MM v[156:159],v[212:215],v[36:39],v[156:159]
 s_waitcnt lgkmcnt(3)
 ds_read_b128 v[236:239], v13 offset:51648
 CV v167,v130,v131
 MM v[148:151],v[216:219],v[40:43],v[148:151]
 v_exp_f32 v122, v122
 MM v[152:155],v[216:219],v[44:47],v[152:155]
 v_exp_f32 v123, v123
 MM v[156:159],v[216:219],v[48:51],v[156:159]
 CV v168,v120,v121
 CV v169,v122,v123
 MM v[148:151],v[220:223],v[52:55],v[148:151]
 v_exp_f32 v132, v132
 MM v[152:155],v[220:223],v[56:59],v[152:155]
 v_exp_f32 v133, v133
 MM v[156:159],v[220:223],v[60:63],v[156:159]
 s_waitcnt lgkmcnt(3)
 v_exp_f32 v134, v134
 MM v[148:151],v[224:227],v[64:67],v[148:151]
 v_exp_f32 v135, v135
 MM v[152:155],v[224:227],v[68:71],v[152:155]
 CV v170,v132,v133
 CV v171,v134,v135
 MM v[156:159],v[224:227],v[72:75],v[156:159]
 s_waitcnt lgkmcnt(0) vmcnt(8)
 s_barrier
 TR v[208:209],v14,0
 MM v[148:151],v[228:231],v[76:79],v[148:151]
 TR v[210:211],v14,512
 MM v[152:155],v[228:231],v[80:83],v[152:155]
 MM v[156:159],v[228:231],v[84:87],v[156:159]
 TR v[212:213],v14,32
 TR v[214:215],v14,544
 MM v[148:151],v[232:235],v[88:91],v[148:151]
 MM v[152:155],v[232:235],v[92:95],v[152:155]
 MM v[156:159],v[232:235],v[96:99],v[156:159]
 TR v[216:217],v14,64
 TR v[218:219],v14,576
 MM v[148:151],v[236:239],v[100:103],v[148:151]
 MM v[152:155],v[236:239],v[104:107],v[152:155]
 MM v[156:159],v[236:239],v[108:111],v[156:159]
 MM a[192:195],a[204:207],v[160:163],a[192:195]
 MM a[196:199],a[204:207],v[164:167],a[196:199]
 MM a[200:203],a[204:207],v[168:171],a[200:203]
 s_waitcnt lgkmcnt(4)
 TR v[220:221],v14,96
 MM a[0:3],v[208:211],v[160:163],a[0:3]
 TR v[222:223],v14,608
 v_fma_f32 v136, v136, s82, v184
 MM a[4:7],v[208:211],v[164:167],a[4:7]
 TR v[224:225],v14,128
 v_fma_f32 v137, v137, s82, v184
 MM a[8:11],v[208:211],v[168:171],a[8:11]
 s_waitcnt lgkmcnt(5)
 s_mov_b32 m0, s96
 TR v[226:227],v14,640
 MM a[12:15],v[212:215],v[160:163],a[12:15]
 buffer_load_dwordx4 v4, s[32:35], s72 offen offset:0 nt lds
 v_fma_f32 v138, v138, s82, v184
 MM a[16:19],v[212:215],v[164:167],a[16:19]
 TR v[228:229],v14,160
 MM a[20:23],v[212:215],v[168:171],a[20:23]
 s_waitcnt lgkmcnt(3)
 TR v[230:231],v14,672
 v_fma_f32 v139, v139, s82, v184
 MM a[24:27],v[216:219],v[160:163],a[24:27]
 TR v[232:233],v14,192
 v_fma_f32 v140, v140, s82, v185
 MM a[28:31],v[216:219],v[164:167],a[28:31]
 TR v[234:235],v14,704
 MM a[32:35],v[216:219],v[168:171],a[32:35]
 buffer_load_dwordx4 v5, s[32:35], s72 offen offset:1056 nt lds
 v_fma_f32 v141, v141, s82, v185
 MM a[36:39],v[220:223],v[160:163],a[36:39]
 TR v[236:237],v14,224
 v_fma_f32 v142, v142, s82, v185
 MM a[40:43],v[220:223],v[164:167],a[40:43]
 TR v[238:239],v14,736
 MM a[44:47],v[220:223],v[168:171],a[44:47]
 s_waitcnt lgkmcnt(4)
 TR v[208:209],v14,256
 v_fma_f32 v143, v143, s82, v185
 MM a[48:51],v[224:227],v[160:163],a[48:51]
 TR v[210:211],v14,768
 v_max3_f32 v253, v136, v137, v138
 MM a[52:55],v[224:227],v[164:167],a[52:55]
 v_max3_f32 v254, v139, v140, v141
 MM a[56:59],v[224:227],v[168:171],a[56:59]
 TR v[212:213],v14,288
 v_fma_f32 v144, v144, s82, v186
 MM a[60:63],v[228:231],v[160:163],a[60:63]
 TR v[214:215],v14,800
 v_fma_f32 v145, v145, s82, v186
 MM a[64:67],v[228:231],v[164:167],a[64:67]
 TR v[216:217],v14,320
 MM a[68:71],v[228:231],v[168:171],a[68:71]
 s_waitcnt lgkmcnt(5)
 buffer_load_dwordx4 v6, s[32:35], s72 offen offset:2112 nt lds
 v_max3_f32 v253, v253, v142, v143
 MM a[72:75],v[232:235],v[160:163],a[72:75]
 TR v[218:219],v14,832
 v_fma_f32 v146, v146, s82, v186
 MM a[76:79],v[232:235],v[164:167],a[76:79]
 TR v[220:221],v14,352
 MM a[80:83],v[232:235],v[168:171],a[80:83]
 TR v[222:223],v14,864
 v_fma_f32 v147, v147, s82, v186
 MM a[84:87],v[236:239],v[160:163],a[84:87]
 TR v[224:225],v14,384
 v_max3_f32 v254, v254, v144, v145
 MM a[88:91],v[236:239],v[164:167],a[88:91]
 v_fma_f32 v148, v148, s82, v184
 MM a[92:95],v[236:239],v[168:171],a[92:95]
 s_waitcnt lgkmcnt(5)
 TR v[226:227],v14,896
 v_fma_f32 v149, v149, s82, v184
 MM a[96:99],v[208:211],v[160:163],a[96:99]
 TR v[228:229],v14,416
 v_max3_f32 v253, v253, v146, v147
 MM a[100:103],v[208:211],v[164:167],a[100:103]
 TR v[230:231],v14,928
 MM a[104:107],v[208:211],v[168:171],a[104:107]
 TR v[232:233],v14,448
 v_fma_f32 v150, v150, s82, v184
 MM a[108:111],v[212:215],v[160:163],a[108:111]
 buffer_load_dwordx4 v7, s[32:35], s72 offen offset:3168 nt lds
 v_fma_f32 v151, v151, s82, v184
 MM a[112:115],v[212:215],v[164:167],a[112:115]
 s_add_u32 s72, s72, 16384
 TR v[234:235],v14,960
 MM a[116:119],v[212:215],v[168:171],a[116:119]
 s_waitcnt lgkmcnt(6)
 TR v[236:237],v14,480
 v_max3_f32 v254, v254, v148, v149
 MM a[120:123],v[216:219],v[160:163],a[120:123]
 TR v[238:239],v14,992
 v_fma_f32 v152, v152, s82, v185
 MM a[124:127],v[216:219],v[164:167],a[124:127]
 v_fma_f32 v153, v153, s82, v185
 MM a[128:131],v[216:219],v[168:171],a[128:131]
 v_max3_f32 v253, v253, v150, v151
 v_fma_f32 v154, v154, s82, v185
 MM a[132:135],v[220:223],v[160:163],a[132:135]
 v_fma_f32 v155, v155, s82, v185
 MM a[136:139],v[220:223],v[164:167],a[136:139]
 v_max3_f32 v254, v254, v152, v153
 MM a[140:143],v[220:223],v[168:171],a[140:143]
 s_waitcnt lgkmcnt(6)
 v_fma_f32 v156, v156, s82, v186
 v_fma_f32 v157, v157, s82, v186
 MM a[144:147],v[224:227],v[160:163],a[144:147]
 v_max3_f32 v253, v253, v154, v155
 MM a[148:151],v[224:227],v[164:167],a[148:151]
 v_fma_f32 v158, v158, s82, v186
 v_fma_f32 v159, v159, s82, v186
 MM a[152:155],v[224:227],v[168:171],a[152:155]
 s_waitcnt lgkmcnt(0) vmcnt(8)
 s_barrier
 ds_read_b128 v[208:211], v12 offset:16896
 MM a[156:159],v[228:231],v[160:163],a[156:159]
 v_max3_f32 v254, v254, v156, v157
 MM a[160:163],v[228:231],v[164:167],a[160:163]
 v_max3_f32 v253, v253, v158, v159
 MM a[164:167],v[228:231],v[168:171],a[164:167]
 ds_read_b128 v[212:215], v12 offset:16960
 v_max_f32 v253, v253, v254
 MM a[168:171],v[232:235],v[160:163],a[168:171]
 v_cmp_lt_f32 vcc, 0x41800000, v253
 MM a[172:175],v[232:235],v[164:167],a[172:175]
 MM a[176:179],v[232:235],v[168:171],a[176:179]
 ds_read_b128 v[216:219], v12 offset:17024
 MM a[180:183],v[236:239],v[160:163],a[180:183]
 MM a[184:187],v[236:239],v[164:167],a[184:187]
 MM a[188:191],v[236:239],v[168:171],a[188:191]
 s_cbranch_vccnz LA_t26
LA_r26:
 s_waitcnt lgkmcnt(2)
 ds_read_b128 v[220:223], v12 offset:17088
 MM v[112:115],v[208:211],v[16:19],0
 s_mov_b32 m0, s89
 v_exp_f32 v136, v136
 MM v[116:119],v[208:211],v[20:23],0
 ds_read_b128 v[224:227], v12 offset:17152
 buffer_load_dwordx4 v4, s[40:43], s74 offen offset:0 nt lds
 MM v[120:123],v[208:211],v[24:27],0
 s_waitcnt lgkmcnt(3)
 v_exp_f32 v137, v137
 MM v[112:115],v[212:215],v[28:31],v[112:115]
 v_exp_f32 v138, v138
 MM v[116:119],v[212:215],v[32:35],v[116:119]
 ds_read_b128 v[228:231], v12 offset:17216
 CV v160,v136,v137
 MM v[120:123],v[212:215],v[36:39],v[120:123]
 s_waitcnt lgkmcnt(2)
 v_exp_f32 v139, v139
 MM v[112:115],v[216:219],v[40:43],v[112:115]
 ds_read_b128 v[232:235], v12 offset:17280
 CV v161,v138,v139
 MM v[116:119],v[216:219],v[44:47],v[116:119]
 v_exp_f32 v148, v148
 MM v[120:123],v[216:219],v[48:51],v[120:123]
 v_exp_f32 v149, v149
 MM v[112:115],v[220:223],v[52:55],v[112:115]
 ds_read_b128 v[236:239], v12 offset:17344
 buffer_load_dwordx4 v5, s[40:43], s74 offen offset:1056 nt lds
 MM v[116:119],v[220:223],v[56:59],v[116:119]
 v_exp_f32 v150, v150
 MM v[120:123],v[220:223],v[60:63],v[120:123]
 s_waitcnt lgkmcnt(2)
 ds_read_b128 v[208:211], v12 offset:17408
 CV v162,v148,v149
 MM v[112:115],v[224:227],v[64:67],v[112:115]
 v_exp_f32 v151, v151
 MM v[116:119],v[224:227],v[68:71],v[116:119]
 v_exp_f32 v140, v140
 MM v[120:123],v[224:227],v[72:75],v[120:123]
 ds_read_b128 v[212:215], v12 offset:17472
 CV v163,v150,v151
 MM v[112:115],v[228:231],v[76:79],v[112:115]
 v_exp_f32 v141, v141
 MM v[116:119],v[228:231],v[80:83],v[116:119]
 ds_read_b128 v[216:219], v12 offset:17536
 CV v164,v140,v141
 MM v[120:123],v[228:231],v[84:87],v[120:123]
 s_waitcnt lgkmcnt(3)
 v_exp_f32 v142, v142
 MM v[112:115],v[232:235],v[88:91],v[112:115]
 v_exp_f32 v143, v143
 MM v[116:119],v[232:235],v[92:95],v[116:119]
 ds_read_b128 v[220:223], v12 offset:17600
 buffer_load_dwordx4 v6, s[40:43], s74 offen offset:2112 nt lds
 MM v[120:123],v[232:235],v[96:99],v[120:123]
 v_exp_f32 v152, v152
 MM v[112:115],v[236:239],v[100:103],v[112:115]
 ds_read_b128 v[224:227], v12 offset:17664
 CV v165,v142,v143
 MM v[116:119],v[236:239],v[104:107],v[116:119]
 v_exp_f32 v153, v153
 MM v[120:123],v[236:239],v[108:111],v[120:123]
 s_waitcnt lgkmcnt(3)
 v_exp_f32 v154, v154
 MM v[124:127],v[208:211],v[16:19],0
 ds_read_b128 v[228:231], v12 offset:17728
 CV v166,v152,v153
 MM v[128:131],v[208:211],v[20:23],0
 v_exp_f32 v155, v155
 MM v[132:135],v[208:211],v[24:27],0
 ds_read_b128 v[232:235], v12 offset:17792
 buffer_load_dwordx4 v7, s[40:43], s74 offen offset:3168 nt lds
 MM v[124:127],v[212:215],v[28:31],v[124:127]
 s_add_u32 s74, s74, 16384
 v_exp_f32 v144, v144
 MM v[128:131],v[212:215],v[32:35],v[128:131]
 v_exp_f32 v145, v145
 MM v[132:135],v[212:215],v[36:39],v[132:135]
 s_waitcnt lgkmcnt(3)
 ds_read_b128 v[236:239], v12 offset:17856
 CV v167,v154,v155
 MM v[124:127],v[216:219],v[40:43],v[124:127]
 v_exp_f32 v146, v146
 MM v[128:131],v[216:219],v[44:47],v[128:131]
 v_exp_f32 v147, v147
 MM v[132:135],v[216:219],v[48:51],v[132:135]
 CV v168,v144,v145
 CV v169,v146,v147
 MM v[124:127],v[220:223],v[52:55],v[124:127]
 v_exp_f32 v156, v156
 MM v[128:131],v[220:223],v[56:59],v[128:131]
 v_exp_f32 v157, v157
 MM v[132:135],v[220:223],v[60:63],v[132:135]
 s_waitcnt lgkmcnt(3)
 v_exp_f32 v158, v158
 MM v[124:127],v[224:227],v[64:67],v[124:127]
 v_exp_f32 v159, v159
 MM v[128:131],v[224:227],v[68:71],v[128:131]
 CV v170,v156,v157
 CV v171,v158,v159
 MM v[132:135],v[224:227],v[72:75],v[132:135]
 s_waitcnt lgkmcnt(0) vmcnt(8)
 s_barrier
 TR v[208:209],v15,33792
 MM v[124:127],v[228:231],v[76:79],v[124:127]
 TR v[210:211],v15,34304
 MM v[128:131],v[228:231],v[80:83],v[128:131]
 MM v[132:135],v[228:231],v[84:87],v[132:135]
 TR v[212:213],v15,33824
 TR v[214:215],v15,34336
 MM v[124:127],v[232:235],v[88:91],v[124:127]
 MM v[128:131],v[232:235],v[92:95],v[128:131]
 MM v[132:135],v[232:235],v[96:99],v[132:135]
 TR v[216:217],v15,33856
 TR v[218:219],v15,34368
 MM v[124:127],v[236:239],v[100:103],v[124:127]
 MM v[128:131],v[236:239],v[104:107],v[128:131]
 MM v[132:135],v[236:239],v[108:111],v[132:135]
 s_add_u32 s79, s79, 1
 s_cmp_lt_u32 s79, 2
 s_cbranch_scc1 LA_loop66
 MM a[192:195],a[204:207],v[160:163],a[192:195]
 MM a[196:199],a[204:207],v[164:167],a[196:199]
 MM a[200:203],a[204:207],v[168:171],a[200:203]
 s_waitcnt lgkmcnt(4)
 TR v[220:221],v15,33888
 MM a[0:3],v[208:211],v[160:163],a[0:3]
 TR v[222:223],v15,34400
 v_fma_f32 v112, v112, s82, v184
 MM a[4:7],v[208:211],v[164:167],a[4:7]
 TR v[224:225],v15,33920
 v_fma_f32 v113, v113, s82, v184
 MM a[8:11],v[208:211],v[168:171],a[8:11]
 s_waitcnt lgkmcnt(5)
 s_mov_b32 m0, s90
 TR v[226:227],v15,34432
 MM a[12:15],v[212:215],v[160:163],a[12:15]
 buffer_load_dwordx4 v4, s[40:43], s74 offen offset:0 nt lds
 v_fma_f32 v114, v114, s82, v184
 MM a[16:19],v[212:215],v[164:167],a[16:19]
 TR v[228:229],v15,33952
 MM a[20:23],v[212:215],v[168:171],a[20:23]
 s_waitcnt lgkmcnt(3)
 TR v[230:231],v15,34464
 v_fma_f32 v115, v115, s82, v184
 MM a[24:27],v[216:219],v[160:163],a[24:27]
 TR v[232:233],v15,33984
 v_fma_f32 v116, v116, s82, v185
 MM a[28:31],v[216:219],v[164:167],a[28:31]
 TR v[234:235],v15,34496
 MM a[32:35],v[216:219],v[168:171],a[32:35]
 buffer_load_dwordx4 v5, s[40:43], s74 offen offset:1056 nt lds
 v_fma_f32 v117, v117, s82, v185
 MM a[36:39],v[220:223],v[160:163],a[36:39]
 TR v[236:237],v15,34016
 v_fma_f32 v118, v118, s82, v185
 MM a[40:43],v[220:223],v[164:167],a[40:43]
 TR v[238:239],v15,34528
 MM a[44:47],v[220:223],v[168:171],a[44:47]
 s_waitcnt lgkmcnt(4)
 TR v[208:209],v15,34048
 v_fma_f32 v119, v119, s82, v185
 MM a[48:51],v[224:227],v[160:163],a[48:51]
 TR v[210:211],v15,34560
 v_max3_f32 v253, v112, v113, v114
 MM a[52:55],v[224:227],v[164:167],a[52:55]
 v_max3_f32 v254, v115, v116, v117
 MM a[56:59],v[224:227],v[168:171],a[56:59]
 TR v[212:213],v15,34080
 v_fma_f32 v120, v120, s82, v186
 MM a[60:63],v[228:231],v[160:163],a[60:63]
 TR v[214:215],v15,34592
 v_fma_f32 v121, v121, s82, v186
 MM a[64:67],v[228:231],v[164:167],a[64:67]
 TR v[216:217],v15,34112
 MM a[68:71],v[228:231],v[168:171],a[68:71]
 s_waitcnt lgkmcnt(5)
 buffer_load_dwordx4 v6, s[40:43], s74 offen offset:2112 nt lds
 v_max3_f32 v253, v253, v118, v119
 MM a[72:75],v[232:235],v[160:163],a[72:75]
 TR v[218:219],v15,34624
 v_fma_f32 v122, v122, s82, v186
 MM a[76:79],v[232:235],v[164:167],a[76:79]
 TR v[220:221],v15,34144
 MM a[80:83],v[232:235],v[168:171],a[80:83]
 TR v[222:223],v15,34656
 v_fma_f32 v123, v123, s82, v186
 MM a[84:87],v[236:239],v[160:163],a[84:87]
 TR v[224:225],v15,34176
 v_max3_f32 v254, v254, v120, v121
 MM a[88:91],v[236:239],v[164:167],a[88:91]
 v_fma_f32 v124, v124, s82, v184
 MM a[92:95],v[236:239],v[168:171],a[92:95]
 s_waitcnt lgkmcnt(5)
 TR v[226:227],v15,34688
 v_fma_f32 v125, v125, s82, v184
 MM a[96:99],v[208:211],v[160:163],a[96:99]
 TR v[228:229],v15,34208
 v_max3_f32 v253, v253, v122, v123
 MM a[100:103],v[208:211],v[164:167],a[100:103]
 TR v[230:231],v15,34720
 MM a[104:107],v[208:211],v[168:171],a[104:107]
 TR v[232:233],v15,34240
 v_fma_f32 v126, v126, s82, v184
 MM a[108:111],v[212:215],v[160:163],a[108:111]
 buffer_load_dwordx4 v7, s[40:43], s74 offen offset:3168 nt lds
 v_fma_f32 v127, v127, s82, v184
 MM a[112:115],v[212:215],v[164:167],a[112:115]
 s_add_u32 s74, s74, 16384
 TR v[234:235],v15,34752
 MM a[116:119],v[212:215],v[168:171],a[116:119]
 s_waitcnt lgkmcnt(6)
 TR v[236:237],v15,34272
 v_max3_f32 v254, v254, v124, v125
 MM a[120:123],v[216:219],v[160:163],a[120:123]
 TR v[238:239],v15,34784
 v_fma_f32 v128, v128, s82, v185
 MM a[124:127],v[216:219],v[164:167],a[124:127]
 v_fma_f32 v129, v129, s82, v185
 MM a[128:131],v[216:219],v[168:171],a[128:131]
 v_max3_f32 v253, v253, v126, v127
 v_fma_f32 v130, v130, s82, v185
 MM a[132:135],v[220:223],v[160:163],a[132:135]
 v_fma_f32 v131, v131, s82, v185
 MM a[136:139],v[220:223],v[164:167],a[136:139]
 v_max3_f32 v254, v254, v128, v129
 MM a[140:143],v[220:223],v[168:171],a[140:143]
 s_waitcnt lgkmcnt(6)
 v_fma_f32 v132, v132, s82, v186
 v_fma_f32 v133, v133, s82, v186
 MM a[144:147],v[224:227],v[160:163],a[144:147]
 v_max3_f32 v253, v253, v130, v131
 MM a[148:151],v[224:227],v[164:167],a[148:151]
 v_fma_f32 v134, v134, s82, v186
 v_fma_f32 v135, v135, s82, v186
 MM a[152:155],v[224:227],v[168:171],a[152:155]
 s_waitcnt lgkmcnt(0) vmcnt(8)
 s_barrier
 ds_read_b128 v[208:211], v13 offset:50688
 MM a[156:159],v[228:231],v[160:163],a[156:159]
 v_max3_f32 v254, v254, v132, v133
 MM a[160:163],v[228:231],v[164:167],a[160:163]
 v_max3_f32 v253, v253, v134, v135
 MM a[164:167],v[228:231],v[168:171],a[164:167]
 ds_read_b128 v[212:215], v13 offset:50752
 v_max_f32 v253, v253, v254
 MM a[168:171],v[232:235],v[160:163],a[168:171]
 v_cmp_lt_f32 vcc, 0x41800000, v253
 MM a[172:175],v[232:235],v[164:167],a[172:175]
 MM a[176:179],v[232:235],v[168:171],a[176:179]
 ds_read_b128 v[216:219], v13 offset:50816
 MM a[180:183],v[236:239],v[160:163],a[180:183]
 MM a[184:187],v[236:239],v[164:167],a[184:187]
 MM a[188:191],v[236:239],v[168:171],a[188:191]
 s_cbranch_vccnz LA_t29
LA_r29:
 s_waitcnt lgkmcnt(2)
 ds_read_b128 v[220:223], v13 offset:50880
 MM v[136:139],v[208:211],v[16:19],0
 s_mov_b32 m0, s91
 v_exp_f32 v112, v112
 MM v[140:143],v[208:211],v[20:23],0
 ds_read_b128 v[224:227], v13 offset:50944
 buffer_load_dwordx4 v240, s[64:67], s80 offen offset:0 lds
 MM v[144:147],v[208:211],v[24:27],0
 s_waitcnt lgkmcnt(3)
 v_exp_f32 v113, v113
 MM v[136:139],v[212:215],v[28:31],v[136:139]
 v_exp_f32 v114, v114
 MM v[140:143],v[212:215],v[32:35],v[140:143]
 ds_read_b128 v[228:231], v13 offset:51008
 buffer_load_dwordx4 v241, s[64:67], s80 offen offset:1056 lds
 MM v[144:147],v[212:215],v[36:39],v[144:147]
 s_waitcnt lgkmcnt(2)
 v_exp_f32 v115, v115
 MM v[136:139],v[216:219],v[40:43],v[136:139]
 ds_read_b128 v[232:235], v13 offset:51072
 CV v160,v112,v113
 MM v[140:143],v[216:219],v[44:47],v[140:143]
 v_exp_f32 v124, v124
 MM v[144:147],v[216:219],v[48:51],v[144:147]
 v_exp_f32 v125, v125
 MM v[136:139],v[220:223],v[52:55],v[136:139]
 ds_read_b128 v[236:239], v13 offset:51136
 buffer_load_dwordx4 v242, s[64:67], s80 offen offset:2112 lds
 MM v[140:143],v[220:223],v[56:59],v[140:143]
 CV v161,v114,v115
 CV v162,v124,v125
 MM v[144:147],v[220:223],v[60:63],v[144:147]
 s_waitcnt lgkmcnt(2)
 ds_read_b128 v[208:211], v13 offset:51200
 MM v[136:139],v[224:227],v[64:67],v[136:139]
 v_exp_f32 v126, v126
 MM v[140:143],v[224:227],v[68:71],v[140:143]
 v_exp_f32 v127, v127
 MM v[144:147],v[224:227],v[72:75],v[144:147]
 ds_read_b128 v[212:215], v13 offset:51264
 buffer_load_dwordx4 v243, s[64:67], s80 offen offset:3168 lds
 MM v[136:139],v[228:231],v[76:79],v[136:139]
 v_exp_f32 v116, v116
 MM v[140:143],v[228:231],v[80:83],v[140:143]
 ds_read_b128 v[216:219], v13 offset:51328
 CV v163,v126,v127
 MM v[144:147],v[228:231],v[84:87],v[144:147]
 s_waitcnt lgkmcnt(3)
 v_exp_f32 v117, v117
 MM v[136:139],v[232:235],v[88:91],v[136:139]
 s_mov_b32 m0, s92
 v_exp_f32 v118, v118
 MM v[140:143],v[232:235],v[92:95],v[140:143]
 ds_read_b128 v[220:223], v13 offset:51392
 buffer_load_dwordx4 v240, s[68:71], s80 offen offset:0 lds
 MM v[144:147],v[232:235],v[96:99],v[144:147]
 v_exp_f32 v119, v119
 MM v[136:139],v[236:239],v[100:103],v[136:139]
 ds_read_b128 v[224:227], v13 offset:51456
 buffer_load_dwordx4 v241, s[68:71], s80 offen offset:1056 lds
 MM v[140:143],v[236:239],v[104:107],v[140:143]
 CV v164,v116,v117
 CV v165,v118,v119
 MM v[144:147],v[236:239],v[108:111],v[144:147]
 s_waitcnt lgkmcnt(3)
 v_exp_f32 v128, v128
 MM v[148:151],v[208:211],v[16:19],0
 ds_read_b128 v[228:231], v13 offset:51520
 MM v[152:155],v[208:211],v[20:23],0
 v_exp_f32 v129, v129
 MM v[156:159],v[208:211],v[24:27],0
 ds_read_b128 v[232:235], v13 offset:51584
 buffer_load_dwordx4 v242, s[68:71], s80 offen offset:2112 lds
 MM v[148:151],v[212:215],v[28:31],v[148:151]
 v_exp_f32 v130, v130
 MM v[152:155],v[212:215],v[32:35],v[152:155]
 v_exp_f32 v131, v131
 MM v[156:159],v[212:215],v[36:39],v[156:159]
 s_waitcnt lgkmcnt(3)
 ds_read_b128 v[236:239], v13 offset:51648
 buffer_load_dwordx4 v243, s[68:71], s80 offen offset:3168 lds
 MM v[148:151],v[216:219],v[40:43],v[148:151]
 s_add_u32 s81, s80, 114688
 CV v166,v128,v129
 CV v167,v130,v131
 MM v[152:155],v[216:219],v[44:47],v[152:155]
 v_exp_f32 v120, v120
 MM v[156:159],v[216:219],v[48:51],v[156:159]
 v_exp_f32 v121, v121
 MM v[148:151],v[220:223],v[52:55],v[148:151]
 v_exp_f32 v122, v122
 MM v[152:155],v[220:223],v[56:59],v[152:155]
 v_exp_f32 v123, v123
 MM v[156:159],v[220:223],v[60:63],v[156:159]
 s_waitcnt lgkmcnt(3)
 CV v168,v120,v121
 CV v169,v122,v123
 MM v[148:151],v[224:227],v[64:67],v[148:151]
 v_exp_f32 v132, v132
 MM v[152:155],v[224:227],v[68:71],v[152:155]
 v_exp_f32 v133, v133
 MM v[156:159],v[224:227],v[72:75],v[156:159]
 s_waitcnt lgkmcnt(0) vmcnt(12)
 s_barrier
 TR v[208:209],v14,0
 MM v[148:151],v[228:231],v[76:79],v[148:151]
 TR v[210:211],v14,512
 CV v170,v132,v133
 MM v[152:155],v[228:231],v[80:83],v[152:155]
 v_exp_f32 v134, v134
 MM v[156:159],v[228:231],v[84:87],v[156:159]
 TR v[212:213],v14,32
 TR v[214:215],v14,544
 MM v[148:151],v[232:235],v[88:91],v[148:151]
 v_exp_f32 v135, v135
 MM v[152:155],v[232:235],v[92:95],v[152:155]
 CV v171,v134,v135
 MM v[156:159],v[232:235],v[96:99],v[156:159]
 TR v[216:217],v14,64
 TR v[218:219],v14,576
 MM v[148:151],v[236:239],v[100:103],v[148:151]
 MM v[152:155],v[236:239],v[104:107],v[152:155]
 MM v[156:159],v[236:239],v[108:111],v[156:159]
 MM a[192:195],a[204:207],v[160:163],a[192:195]
 MM a[196:199],a[204:207],v[164:167],a[196:199]
 s_lshl_b32 s88, s29, 6
 v_add_u32 v8, s88, v251
 v_subrev_u32 v10, s88, v251
 MM a[200:203],a[204:207],v[168:171],a[200:203]
 s_waitcnt lgkmcnt(4)
 TR v[220:221],v14,96
 v_add_u32 v9, s88, v252
 MM a[0:3],v[208:211],v[160:163],a[0:3]
 TR v[222:223],v14,608
 v_fma_f32 v136, v136, s82, v184
 MM a[4:7],v[208:211],v[164:167],a[4:7]
 TR v[224:225],v14,128
 v_fma_f32 v137, v137, s82, v184
 MM a[8:11],v[208:211],v[168:171],a[8:11]
 s_waitcnt lgkmcnt(5)
 s_mov_b32 m0, s93
 TR v[226:227],v14,640
 MM a[12:15],v[212:215],v[160:163],a[12:15]
 buffer_load_dwordx4 v240, s[64:67], s81 offen offset:0 lds
 v_fma_f32 v138, v138, s82, v184
 MM a[16:19],v[212:215],v[164:167],a[16:19]
 TR v[228:229],v14,160
 buffer_load_dwordx4 v241, s[64:67], s81 offen offset:1056 lds
 MM a[20:23],v[212:215],v[168:171],a[20:23]
 s_waitcnt lgkmcnt(3)
 TR v[230:231],v14,672
 v_fma_f32 v139, v139, s82, v184
 MM a[24:27],v[216:219],v[160:163],a[24:27]
 TR v[232:233],v14,192
 v_fma_f32 v140, v140, s82, v185
 MM a[28:31],v[216:219],v[164:167],a[28:31]
 TR v[234:235],v14,704
 MM a[32:35],v[216:219],v[168:171],a[32:35]
 buffer_load_dwordx4 v242, s[64:67], s81 offen offset:2112 lds
 v_fma_f32 v141, v141, s82, v185
 MM a[36:39],v[220:223],v[160:163],a[36:39]
 TR v[236:237],v14,224
 v_fma_f32 v142, v142, s82, v185
 MM a[40:43],v[220:223],v[164:167],a[40:43]
 TR v[238:239],v14,736
 v_fma_f32 v143, v143, s82, v185
 MM a[44:47],v[220:223],v[168:171],a[44:47]
 s_waitcnt lgkmcnt(4)
 TR v[208:209],v14,256
 v_max3_f32 v253, v136, v137, v138
 MM a[48:51],v[224:227],v[160:163],a[48:51]
 TR v[210:211],v14,768
 v_max3_f32 v254, v139, v140, v141
 MM a[52:55],v[224:227],v[164:167],a[52:55]
 buffer_load_dwordx4 v243, s[64:67], s81 offen offset:3168 lds
 v_subrev_u32 v11, s88, v252
 MM a[56:59],v[224:227],v[168:171],a[56:59]
 s_mul_i32 s23, s28, 6144
 TR v[212:213],v14,288
 v_fma_f32 v144, v144, s82, v186
 MM a[60:63],v[228:231],v[160:163],a[60:63]
 s_add_u32 s23, s23, 135168
 TR v[214:215],v14,800
 v_fma_f32 v145, v145, s82, v186
 MM a[64:67],v[228:231],v[164:167],a[64:67]
 s_mov_b32 m0, s94
 TR v[216:217],v14,320
 v_max3_f32 v253, v253, v142, v143
 MM a[68:71],v[228:231],v[168:171],a[68:71]
 s_waitcnt lgkmcnt(5)
 buffer_load_dwordx4 v240, s[68:71], s81 offen offset:0 lds
 v_fma_f32 v146, v146, s82, v186
 MM a[72:75],v[232:235],v[160:163],a[72:75]
 TR v[218:219],v14,832
 v_add_u32 v247, s23, v250
 MM a[76:79],v[232:235],v[164:167],a[76:79]
 s_xor_b32 s3, s28, 2
 TR v[220:221],v14,352
 v_fma_f32 v147, v147, s82, v186
 MM a[80:83],v[232:235],v[168:171],a[80:83]
 s_mul_i32 s3, s3, 6144
 TR v[222:223],v14,864
 v_max3_f32 v254, v254, v144, v145
 MM a[84:87],v[236:239],v[160:163],a[84:87]
 s_add_u32 s3, s3, 135168
 TR v[224:225],v14,384
 v_fma_f32 v148, v148, s82, v184
 MM a[88:91],v[236:239],v[164:167],a[88:91]
 buffer_load_dwordx4 v241, s[68:71], s81 offen offset:1056 lds
 v_fma_f32 v149, v149, s82, v184
 MM a[92:95],v[236:239],v[168:171],a[92:95]
 s_waitcnt lgkmcnt(5)
 TR v[226:227],v14,896
 v_max3_f32 v253, v253, v146, v147
 MM a[96:99],v[208:211],v[160:163],a[96:99]
 TR v[228:229],v14,416
 MM a[100:103],v[208:211],v[164:167],a[100:103]
 TR v[230:231],v14,928
 v_fma_f32 v150, v150, s82, v184
 MM a[104:107],v[208:211],v[168:171],a[104:107]
 TR v[232:233],v14,448
 v_fma_f32 v151, v151, s82, v184
 MM a[108:111],v[212:215],v[160:163],a[108:111]
 buffer_load_dwordx4 v242, s[68:71], s81 offen offset:2112 lds
 v_max3_f32 v254, v254, v148, v149
 MM a[112:115],v[212:215],v[164:167],a[112:115]
 TR v[234:235],v14,960
 v_fma_f32 v152, v152, s82, v185
 MM a[116:119],v[212:215],v[168:171],a[116:119]
 s_waitcnt lgkmcnt(6)
 TR v[236:237],v14,480
 v_fma_f32 v153, v153, s82, v185
 MM a[120:123],v[216:219],v[160:163],a[120:123]
 TR v[238:239],v14,992
 v_add_u32 v248, s3, v250
 MM a[124:127],v[216:219],v[164:167],a[124:127]
 buffer_load_dwordx4 v243, s[68:71], s81 offen offset:3168 lds
 v_max3_f32 v253, v253, v150, v151
 MM a[128:131],v[216:219],v[168:171],a[128:131]
 s_add_u32 s80, s80, 128
 s_cmp_eq_u32 s80, 896
 s_cselect_b32 s80, 0, s80
 MM a[132:135],v[220:223],v[160:163],a[132:135]
 v_fma_f32 v154, v154, s82, v185
 v_fma_f32 v155, v155, s82, v185
 MM a[136:139],v[220:223],v[164:167],a[136:139]
 v_max3_f32 v254, v254, v152, v153
 MM a[140:143],v[220:223],v[168:171],a[140:143]
 s_waitcnt lgkmcnt(6)
 v_fma_f32 v156, v156, s82, v186
 v_fma_f32 v157, v157, s82, v186
 MM a[144:147],v[224:227],v[160:163],a[144:147]
 v_max3_f32 v253, v253, v154, v155
 v_fma_f32 v158, v158, s82, v186
 MM a[148:151],v[224:227],v[164:167],a[148:151]
 v_fma_f32 v159, v159, s82, v186
 MM a[152:155],v[224:227],v[168:171],a[152:155]
 s_waitcnt lgkmcnt(0) vmcnt(16)
 s_barrier
 TR v[208:209],v14,16896
 MM a[156:159],v[228:231],v[160:163],a[156:159]
 TR v[210:211],v14,17408
 v_max3_f32 v254, v254, v156, v157
 MM a[160:163],v[228:231],v[164:167],a[160:163]
 v_max3_f32 v253, v253, v158, v159
 v_max_f32 v253, v253, v254
 MM a[164:167],v[228:231],v[168:171],a[164:167]
 TR v[212:213],v14,16928
 v_cmp_lt_f32 vcc, 0x41800000, v253
 MM a[168:171],v[232:235],v[160:163],a[168:171]
 TR v[214:215],v14,17440
 MM a[172:175],v[232:235],v[164:167],a[172:175]
 MM a[176:179],v[232:235],v[168:171],a[176:179]
 TR v[216:217],v14,16960
 MM a[180:183],v[236:239],v[160:163],a[180:183]
 TR v[218:219],v14,17472
 MM a[184:187],v[236:239],v[164:167],a[184:187]
 MM a[188:191],v[236:239],v[168:171],a[188:191]
 s_cbranch_vccnz LA_t30
LA_r30:
 v_exp_f32 v136, v136
 v_exp_f32 v137, v137
 v_exp_f32 v138, v138
 v_exp_f32 v139, v139
 v_exp_f32 v148, v148
 CV v160,v136,v137
 CV v161,v138,v139
 v_exp_f32 v149, v149
 v_exp_f32 v150, v150
 v_exp_f32 v151, v151
 v_exp_f32 v140, v140
 CV v162,v148,v149
 CV v163,v150,v151
 v_exp_f32 v141, v141
 v_exp_f32 v142, v142
 v_exp_f32 v143, v143
 v_exp_f32 v152, v152
 CV v164,v140,v141
 CV v165,v142,v143
 v_exp_f32 v153, v153
 v_exp_f32 v154, v154
 v_exp_f32 v155, v155
 v_exp_f32 v144, v144
 CV v166,v152,v153
 CV v167,v154,v155
 v_exp_f32 v145, v145
 v_exp_f32 v146, v146
 v_exp_f32 v147, v147
 v_exp_f32 v156, v156
 CV v168,v144,v145
 CV v169,v146,v147
 v_exp_f32 v157, v157
 v_exp_f32 v158, v158
 v_exp_f32 v159, v159
 CV v170,v156,v157
 CV v171,v158,v159
 MM a[192:195],a[204:207],v[160:163],a[192:195]
 MM a[196:199],a[204:207],v[164:167],a[196:199]
 MM a[200:203],a[204:207],v[168:171],a[200:203]
 s_waitcnt lgkmcnt(4)
 TR v[220:221],v14,16992
 MM a[0:3],v[208:211],v[160:163],a[0:3]
 TR v[222:223],v14,17504
 MM a[4:7],v[208:211],v[164:167],a[4:7]
 TR v[224:225],v14,17024
 MM a[8:11],v[208:211],v[168:171],a[8:11]
 s_waitcnt lgkmcnt(5)
 s_mov_b32 m0, s95
 TR v[226:227],v14,17536
 AR v244,a192
 MM a[12:15],v[212:215],v[160:163],a[12:15]
 buffer_load_dwordx4 v240, s[64:67], s80 offen offset:0 lds
 AR v245,a196
 AR v246,a200
 MM a[16:19],v[212:215],v[164:167],a[16:19]
 TR v[228:229],v14,17056
 buffer_load_dwordx4 v241, s[64:67], s80 offen offset:1056 lds
 MM a[20:23],v[212:215],v[168:171],a[20:23]
 s_waitcnt lgkmcnt(3)
 TR v[230:231],v14,17568
 v_rcp_f32 v244, v244
 MM a[24:27],v[216:219],v[160:163],a[24:27]
 TR v[232:233],v14,17088
 v_rcp_f32 v245, v245
 MM a[28:31],v[216:219],v[164:167],a[28:31]
 TR v[234:235],v14,17600
 v_rcp_f32 v246, v246
 MM a[32:35],v[216:219],v[168:171],a[32:35]
 buffer_load_dwordx4 v242, s[64:67], s80 offen offset:2112 lds
 AR v196,a0
 AR v197,a1
 AR v198,a2
 MM a[36:39],v[220:223],v[160:163],a[36:39]
 TR v[236:237],v14,17120
 AR v199,a3
 AR v200,a12
 MM a[40:43],v[220:223],v[164:167],a[40:43]
 TR v[238:239],v14,17632
 AR v201,a13
 AR v202,a14
 AR v203,a15
 MM a[44:47],v[220:223],v[168:171],a[44:47]
 s_waitcnt lgkmcnt(4)
 TR v[208:209],v14,17152
 CV v16,v196,v197
 CV v17,v198,v199
 MM a[48:51],v[224:227],v[160:163],a[48:51]
 TR v[210:211],v14,17664
 CV v18,v200,v201
 CV v19,v202,v203
 AR v196,a4
 MM a[52:55],v[224:227],v[164:167],a[52:55]
 buffer_load_dwordx4 v243, s[64:67], s80 offen offset:3168 lds
 AR v197,a5
 AR v198,a6
 MM a[56:59],v[224:227],v[168:171],a[56:59]
 TR v[212:213],v14,17184
 AR v199,a7
 AR v200,a16
 MM a[60:63],v[228:231],v[160:163],a[60:63]
 TR v[214:215],v14,17696
 AR v201,a17
 AR v202,a18
 AR v203,a19
 MM a[64:67],v[228:231],v[164:167],a[64:67]
 s_mov_b32 m0, s96
 TR v[216:217],v14,17216
 CV v20,v196,v197
 CV v21,v198,v199
 MM a[68:71],v[228:231],v[168:171],a[68:71]
 s_waitcnt lgkmcnt(5)
 buffer_load_dwordx4 v240, s[68:71], s80 offen offset:0 lds
 CV v22,v200,v201
 CV v23,v202,v203
 AR v196,a8
 MM a[72:75],v[232:235],v[160:163],a[72:75]
 TR v[218:219],v14,17728
 AR v197,a9
 AR v198,a10
 MM a[76:79],v[232:235],v[164:167],a[76:79]
 TR v[220:221],v14,17248
 AR v199,a11
 AR v200,a20
 MM a[80:83],v[232:235],v[168:171],a[80:83]
 TR v[222:223],v14,17760
 AR v201,a21
 AR v202,a22
 AR v203,a23
 MM a[84:87],v[236:239],v[160:163],a[84:87]
 TR v[224:225],v14,17280
 CV v24,v196,v197
 CV v25,v198,v199
 MM a[88:91],v[236:239],v[164:167],a[88:91]
 buffer_load_dwordx4 v241, s[68:71], s80 offen offset:1056 lds
 CV v26,v200,v201
 CV v27,v202,v203
 MM a[92:95],v[236:239],v[168:171],a[92:95]
 s_waitcnt lgkmcnt(5)
 TR v[226:227],v14,17792
 AR v196,a24
 AR v197,a25
 MM a[96:99],v[208:211],v[160:163],a[96:99]
 TR v[228:229],v14,17312
 AR v198,a26
 AR v199,a27
 MM a[100:103],v[208:211],v[164:167],a[100:103]
 TR v[230:231],v14,17824
 AR v200,a36
 AR v201,a37
 MM a[104:107],v[208:211],v[168:171],a[104:107]
 TR v[232:233],v14,17344
 AR v202,a38
 AR v203,a39
 MM a[108:111],v[212:215],v[160:163],a[108:111]
 buffer_load_dwordx4 v242, s[68:71], s80 offen offset:2112 lds
 CV v28,v196,v197
 CV v29,v198,v199
 MM a[112:115],v[212:215],v[164:167],a[112:115]
 TR v[234:235],v14,17856
 CV v30,v200,v201
 CV v31,v202,v203
 MM a[116:119],v[212:215],v[168:171],a[116:119]
 s_waitcnt lgkmcnt(6)
 TR v[236:237],v14,17376
 AR v196,a28
 AR v197,a29
 MM a[120:123],v[216:219],v[160:163],a[120:123]
 TR v[238:239],v14,17888
 AR v198,a30
 AR v199,a31
 MM a[124:127],v[216:219],v[164:167],a[124:127]
 buffer_load_dwordx4 v243, s[68:71], s80 offen offset:3168 lds
 AR v200,a40
 AR v201,a41
 MM a[128:131],v[216:219],v[168:171],a[128:131]
 s_add_u32 s81, s80, 114688
 AR v202,a42
 AR v203,a43
 CV v32,v196,v197
 MM a[132:135],v[220:223],v[160:163],a[132:135]
 CV v33,v198,v199
 CV v34,v200,v201
 CV v35,v202,v203
 MM a[136:139],v[220:223],v[164:167],a[136:139]
 AR v196,a32
 AR v197,a33
 AR v198,a34
 MM a[140:143],v[220:223],v[168:171],a[140:143]
 s_waitcnt lgkmcnt(6)
 AR v199,a35
 AR v200,a44
 AR v201,a45
 MM a[144:147],v[224:227],v[160:163],a[144:147]
 AR v202,a46
 AR v203,a47
 CV v36,v196,v197
 MM a[148:151],v[224:227],v[164:167],a[148:151]
 CV v37,v198,v199
 CV v38,v200,v201
 CV v39,v202,v203
 MM a[152:155],v[224:227],v[168:171],a[152:155]
 s_waitcnt lgkmcnt(0) vmcnt(16)
 s_barrier
 TR v[208:209],v8,33792
 AR v196,a48
 MM a[156:159],v[228:231],v[160:163],a[156:159]
 TR v[210:211],v8,33920
 AR v197,a49
 AR v198,a50
 AR v199,a51
 MM a[160:163],v[228:231],v[164:167],a[160:163]
 AR v200,a60
 AR v201,a61
 AR v202,a62
 MM a[164:167],v[228:231],v[168:171],a[164:167]
 TR v[212:213],v8,33824
 AR v203,a63
 CV v40,v196,v197
 CV v41,v198,v199
 MM a[168:171],v[232:235],v[160:163],a[168:171]
 TR v[214:215],v8,33952
 CV v42,v200,v201
 CV v43,v202,v203
 MM a[172:175],v[232:235],v[164:167],a[172:175]
 AR v196,a52
 AR v197,a53
 AR v198,a54
 MM a[176:179],v[232:235],v[168:171],a[176:179]
 TR v[216:217],v10,33856
 AR v199,a55
 AR v200,a64
 AR v201,a65
 MM a[180:183],v[236:239],v[160:163],a[180:183]
 TR v[218:219],v10,33984
 AR v202,a66
 AR v203,a67
 MM a[184:187],v[236:239],v[164:167],a[184:187]
 CV v44,v196,v197
 CV v45,v198,v199
 CV v46,v200,v201
 MM a[188:191],v[236:239],v[168:171],a[188:191]
 s_waitcnt lgkmcnt(4)
 TR v[220:221],v10,33888
 CV v47,v202,v203
 AR v196,a56
 AR v197,a57
 MM v[112:115],v[208:211],v[16:19],0
 TR v[222:223],v10,34016
 AR v198,a58
 AR v199,a59
 MM v[116:119],v[208:211],v[20:23],0
 TR v[224:225],v8,34048
 AR v200,a68
 AR v201,a69
 AR v202,a70
 MM v[120:123],v[208:211],v[24:27],0
 s_waitcnt lgkmcnt(5)
 s_mov_b32 m0, s89
 TR v[226:227],v8,34176
 AR v203,a71
 MM v[124:127],v[212:215],v[16:19],0
 buffer_load_dwordx4 v240, s[64:67], s81 offen offset:0 lds
 CV v48,v196,v197
 CV v49,v198,v199
 CV v50,v200,v201
 MM v[128:131],v[212:215],v[20:23],0
 TR v[228:229],v8,34080
 buffer_load_dwordx4 v241, s[64:67], s81 offen offset:1056 lds
 CV v51,v202,v203
 MM v[132:135],v[212:215],v[24:27],0
 s_waitcnt lgkmcnt(3)
 TR v[230:231],v8,34208
 AR v196,a72
 AR v197,a73
 AR v198,a74
 MM v[136:139],v[216:219],v[16:19],0
 TR v[232:233],v10,34112
 AR v199,a75
 AR v200,a84
 MM v[140:143],v[216:219],v[20:23],0
 TR v[234:235],v10,34240
 AR v201,a85
 AR v202,a86
 AR v203,a87
 MM v[144:147],v[216:219],v[24:27],0
 buffer_load_dwordx4 v242, s[64:67], s81 offen offset:2112 lds
 CV v52,v196,v197
 CV v53,v198,v199
 MM v[148:151],v[220:223],v[16:19],0
 TR v[236:237],v10,34144
 CV v54,v200,v201
 CV v55,v202,v203
 AR v196,a76
 MM v[152:155],v[220:223],v[20:23],0
 TR v[238:239],v10,34272
 AR v197,a77
 AR v198,a78
 MM v[156:159],v[220:223],v[24:27],0
 s_waitcnt lgkmcnt(4)
 TR v[208:209],v8,34304
 AR v199,a79
 AR v200,a88
 MM v[112:115],v[224:227],v[28:31],v[112:115]
 TR v[210:211],v8,34432
 AR v201,a89
 AR v202,a90
 AR v203,a91
 MM v[116:119],v[224:227],v[32:35],v[116:119]
 buffer_load_dwordx4 v243, s[64:67], s81 offen offset:3168 lds
 CV v56,v196,v197
 CV v57,v198,v199
 MM v[120:123],v[224:227],v[36:39],v[120:123]
 TR v[212:213],v8,34336
 CV v58,v200,v201
 CV v59,v202,v203
 AR v196,a80
 MM v[124:127],v[228:231],v[28:31],v[124:127]
 TR v[214:215],v8,34464
 AR v197,a81
 AR v198,a82
 MM v[128:131],v[228:231],v[32:35],v[128:131]
 s_mov_b32 m0, s90
 TR v[216:217],v10,34368
 AR v199,a83
 AR v200,a92
 MM v[132:135],v[228:231],v[36:39],v[132:135]
 s_waitcnt lgkmcnt(5)
 buffer_load_dwordx4 v240, s[68:71], s81 offen offset:0 lds
 AR v201,a93
 AR v202,a94
 AR v203,a95
 MM v[136:139],v[232:235],v[28:31],v[136:139]
 TR v[218:219],v10,34496
 CV v60,v196,v197
 CV v61,v198,v199
 MM v[140:143],v[232:235],v[32:35],v[140:143]
 TR v[220:221],v10,34400
 CV v62,v200,v201
 CV v63,v202,v203
 MM v[144:147],v[232:235],v[36:39],v[144:147]
 TR v[222:223],v10,34528
 AR v196,a96
 AR v197,a97
 AR v198,a98
 MM v[148:151],v[236:239],v[28:31],v[148:151]
 TR v[224:225],v8,34560
 AR v199,a99
 AR v200,a108
 MM v[152:155],v[236:239],v[32:35],v[152:155]
 buffer_load_dwordx4 v241, s[68:71], s81 offen offset:1056 lds
 AR v201,a109
 AR v202,a110
 AR v203,a111
 MM v[156:159],v[236:239],v[36:39],v[156:159]
 s_waitcnt lgkmcnt(5)
 TR v[226:227],v8,34688
 CV v64,v196,v197
 CV v65,v198,v199
 MM v[112:115],v[208:211],v[40:43],v[112:115]
 TR v[228:229],v8,34592
 CV v66,v200,v201
 CV v67,v202,v203
 MM v[116:119],v[208:211],v[44:47],v[116:119]
 TR v[230:231],v8,34720
 AR v196,a100
 AR v197,a101
 AR v198,a102
 MM v[120:123],v[208:211],v[48:51],v[120:123]
 TR v[232:233],v10,34624
 AR v199,a103
 AR v200,a112
 MM v[124:127],v[212:215],v[40:43],v[124:127]
 buffer_load_dwordx4 v242, s[68:71], s81 offen offset:2112 lds
 AR v201,a113
 AR v202,a114
 MM v[128:131],v[212:215],v[44:47],v[128:131]
 TR v[234:235],v10,34752
 AR v203,a115
 CV v68,v196,v197
 CV v69,v198,v199
 MM v[132:135],v[212:215],v[48:51],v[132:135]
 s_waitcnt lgkmcnt(6)
 TR v[236:237],v10,34656
 CV v70,v200,v201
 CV v71,v202,v203
 MM v[136:139],v[216:219],v[40:43],v[136:139]
 TR v[238:239],v10,34784
 AR v196,a104
 AR v197,a105
 MM v[140:143],v[216:219],v[44:47],v[140:143]
 buffer_load_dwordx4 v243, s[68:71], s81 offen offset:3168 lds
 AR v198,a106
 AR v199,a107
 AR v200,a116
 MM v[144:147],v[216:219],v[48:51],v[144:147]
 s_add_u32 s80, s80, 128
 s_cmp_eq_u32 s80, 896
 s_cselect_b32 s80, 0, s80
 AR v201,a117
 MM v[148:151],v[220:223],v[40:43],v[148:151]
 AR v202,a118
 AR v203,a119
 CV v72,v196,v197
 MM v[152:155],v[220:223],v[44:47],v[152:155]
 CV v73,v198,v199
 CV v74,v200,v201
 CV v75,v202,v203
 MM v[156:159],v[220:223],v[48:51],v[156:159]
 s_waitcnt lgkmcnt(6)
 AR v196,a120
 AR v197,a121
 AR v198,a122
 MM v[112:115],v[224:227],v[52:55],v[112:115]
 AR v199,a123
 AR v200,a132
 AR v201,a133
 MM v[116:119],v[224:227],v[56:59],v[116:119]
 AR v202,a134
 AR v203,a135
 CV v76,v196,v197
 MM v[120:123],v[224:227],v[60:63],v[120:123]
 s_waitcnt lgkmcnt(0) vmcnt(16)
 s_barrier
 TR v[208:209],v9,0
 CV v77,v198,v199
 MM v[124:127],v[228:231],v[52:55],v[124:127]
 TR v[210:211],v9,128
 CV v78,v200,v201
 CV v79,v202,v203
 MM v[128:131],v[228:231],v[56:59],v[128:131]
 AR v196,a124
 AR v197,a125
 AR v198,a126
 MM v[132:135],v[228:231],v[60:63],v[132:135]
 TR v[212:213],v9,32
 AR v199,a127
 AR v200,a136
 MM v[136:139],v[232:235],v[52:55],v[136:139]
 TR v[214:215],v9,160
 AR v201,a137
 AR v202,a138
 AR v203,a139
 MM v[140:143],v[232:235],v[56:59],v[140:143]
 CV v80,v196,v197
 CV v81,v198,v199
 CV v82,v200,v201
 MM v[144:147],v[232:235],v[60:63],v[144:147]
 TR v[216:217],v11,64
 CV v83,v202,v203
 AR v196,a128
 MM v[148:151],v[236:239],v[52:55],v[148:151]
 TR v[218:219],v11,192
 AR v197,a129
 AR v198,a130
 MM v[152:155],v[236:239],v[56:59],v[152:155]
 AR v199,a131
 AR v200,a140
 AR v201,a141
 MM v[156:159],v[236:239],v[60:63],v[156:159]
 s_waitcnt lgkmcnt(4)
 TR v[220:221],v11,96
 AR v202,a142
 AR v203,a143
 MM v[112:115],v[208:211],v[64:67],v[112:115]
 TR v[222:223],v11,224
 CV v84,v196,v197
 CV v85,v198,v199
 MM v[116:119],v[208:211],v[68:71],v[116:119]
 TR v[224:225],v9,256
 CV v86,v200,v201
 CV v87,v202,v203
 MM v[120:123],v[208:211],v[72:75],v[120:123]
 s_waitcnt lgkmcnt(5)
 s_mov_b32 m0, s91
 TR v[226:227],v9,384
 AR v196,a144
 AR v197,a145
 MM v[124:127],v[212:215],v[64:67],v[124:127]
 buffer_load_dwordx4 v240, s[64:67], s80 offen offset:0 lds
 AR v198,a146
 AR v199,a147
 AR v200,a156
 MM v[128:131],v[212:215],v[68:71],v[128:131]
 TR v[228:229],v9,288
 buffer_load_dwordx4 v241, s[64:67], s80 offen offset:1056 lds
 AR v201,a157
 MM v[132:135],v[212:215],v[72:75],v[132:135]
 s_waitcnt lgkmcnt(3)
 TR v[230:231],v9,416
 AR v202,a158
 AR v203,a159
 CV v88,v196,v197
 MM v[136:139],v[216:219],v[64:67],v[136:139]
 TR v[232:233],v11,320
 CV v89,v198,v199
 CV v90,v200,v201
 MM v[140:143],v[216:219],v[68:71],v[140:143]
 TR v[234:235],v11,448
 CV v91,v202,v203
 AR v196,a148
 AR v197,a149
 MM v[144:147],v[216:219],v[72:75],v[144:147]
 buffer_load_dwordx4 v242, s[64:67], s80 offen offset:2112 lds
 AR v198,a150
 AR v199,a151
 MM v[148:151],v[220:223],v[64:67],v[148:151]
 TR v[236:237],v11,352
 AR v200,a160
 AR v201,a161
 AR v202,a162
 MM v[152:155],v[220:223],v[68:71],v[152:155]
 TR v[238:239],v11,480
 AR v203,a163
 CV v92,v196,v197
 MM v[156:159],v[220:223],v[72:75],v[156:159]
 s_waitcnt lgkmcnt(4)
 TR v[208:209],v9,512
 CV v93,v198,v199
 CV v94,v200,v201
 CV v95,v202,v203
 MM v[112:115],v[224:227],v[76:79],v[112:115]
 TR v[210:211],v9,640
 AR v196,a152
 AR v197,a153
 MM v[116:119],v[224:227],v[80:83],v[116:119]
 buffer_load_dwordx4 v243, s[64:67], s80 offen offset:3168 lds
 AR v198,a154
 AR v199,a155
 AR v200,a164
 MM v[120:123],v[224:227],v[84:87],v[120:123]
 TR v[212:213],v9,544
 AR v201,a165
 AR v202,a166
 MM v[124:127],v[228:231],v[76:79],v[124:127]
 TR v[214:215],v9,672
 AR v203,a167
 CV v96,v196,v197
 CV v97,v198,v199
 MM v[128:131],v[228:231],v[80:83],v[128:131]
 s_mov_b32 m0, s92
 TR v[216:217],v11,576
 CV v98,v200,v201
 CV v99,v202,v203
 MM v[132:135],v[228:231],v[84:87],v[132:135]
 s_waitcnt lgkmcnt(5)
 buffer_load_dwordx4 v240, s[68:71], s80 offen offset:0 lds
 AR v196,a168
 AR v197,a169
 AR v198,a170
 MM v[136:139],v[232:235],v[76:79],v[136:139]
 TR v[218:219],v11,704
 AR v199,a171
 AR v200,a180
 MM v[140:143],v[232:235],v[80:83],v[140:143]
 TR v[220:221],v11,608
 AR v201,a181
 AR v202,a182
 AR v203,a183
 MM v[144:147],v[232:235],v[84:87],v[144:147]
 TR v[222:223],v11,736
 CV v100,v196,v197
 CV v101,v198,v199
 MM v[148:151],v[236:239],v[76:79],v[148:151]
 TR v[224:225],v9,768
 CV v102,v200,v201
 CV v103,v202,v203
 AR v196,a172
 MM v[152:155],v[236:239],v[80:83],v[152:155]
 buffer_load_dwordx4 v241, s[68:71], s80 offen offset:1056 lds
 AR v197,a173
 AR v198,a174
 MM v[156:159],v[236:239],v[84:87],v[156:159]
 s_waitcnt lgkmcnt(5)
 TR v[226:227],v9,896
 AR v199,a175
 AR v200,a184
 MM v[112:115],v[208:211],v[88:91],v[112:115]
 TR v[228:229],v9,800
 AR v201,a185
 AR v202,a186
 AR v203,a187
 MM v[116:119],v[208:211],v[92:95],v[116:119]
 TR v[230:231],v9,928
 CV v104,v196,v197
 CV v105,v198,v199
 MM v[120:123],v[208:211],v[96:99],v[120:123]
 TR v[232:233],v11,832
 CV v106,v200,v201
 CV v107,v202,v203
 AR v196,a176
 MM v[124:127],v[212:215],v[88:91],v[124:127]
 buffer_load_dwordx4 v242, s[68:71], s80 offen offset:2112 lds
 AR v197,a177
 AR v198,a178
 MM v[128:131],v[212:215],v[92:95],v[128:131]
 TR v[234:235],v11,960
 AR v199,a179
 AR v200,a188
 MM v[132:135],v[212:215],v[96:99],v[132:135]
 s_waitcnt lgkmcnt(6)
 TR v[236:237],v11,864
 AR v201,a189
 AR v202,a190
 AR v203,a191
 MM v[136:139],v[216:219],v[88:91],v[136:139]
 TR v[238:239],v11,992
 CV v108,v196,v197
 CV v109,v198,v199
 MM v[140:143],v[216:219],v[92:95],v[140:143]
 buffer_load_dwordx4 v243, s[68:71], s80 offen offset:3168 lds
 CV v110,v200,v201
 CV v111,v202,v203
 MM v[144:147],v[216:219],v[96:99],v[144:147]
 s_add_u32 s81, s80, 114688
 MM v[148:151],v[220:223],v[88:91],v[148:151]
 MM v[152:155],v[220:223],v[92:95],v[152:155]
 MM v[156:159],v[220:223],v[96:99],v[156:159]
 s_waitcnt lgkmcnt(6)
 MM v[112:115],v[224:227],v[100:103],v[112:115]
 MM v[116:119],v[224:227],v[104:107],v[116:119]
 MM v[120:123],v[224:227],v[108:111],v[120:123]
 s_waitcnt lgkmcnt(0) vmcnt(16)
 s_barrier
 TR v[208:209],v9,33792
 MM v[124:127],v[228:231],v[100:103],v[124:127]
 TR v[210:211],v9,33920
 MM v[128:131],v[228:231],v[104:107],v[128:131]
 MM v[132:135],v[228:231],v[108:111],v[132:135]
 TR v[212:213],v9,33824
 MM v[136:139],v[232:235],v[100:103],v[136:139]
 TR v[214:215],v9,33952
 MM v[140:143],v[232:235],v[104:107],v[140:143]
 MM v[144:147],v[232:235],v[108:111],v[144:147]
 TR v[216:217],v11,33856
 MM v[148:151],v[236:239],v[100:103],v[148:151]
 TR v[218:219],v11,33984
 MM v[152:155],v[236:239],v[104:107],v[152:155]
 MM v[156:159],v[236:239],v[108:111],v[156:159]
 s_mov_b32 s79, 0
LA_loop80:
 s_waitcnt lgkmcnt(4)
 TR v[220:221],v11,33888
 MM v[160:163],v[208:211],v[16:19],0
 TR v[222:223],v11,34016
 MM v[164:167],v[208:211],v[20:23],0
 TR v[224:225],v9,34048
 MM v[168:171],v[208:211],v[24:27],0
 s_waitcnt lgkmcnt(5)
 s_mov_b32 m0, s93
 TR v[226:227],v9,34176
 MM v[172:175],v[212:215],v[16:19],0
 buffer_load_dwordx4 v240, s[64:67], s81 offen offset:0 lds
 v_mul_f32 v136, v136, v244
 MM v[176:179],v[212:215],v[20:23],0
 TR v[228:229],v9,34080
 buffer_load_dwordx4 v241, s[64:67], s81 offen offset:1056 lds
 MM v[180:183],v[212:215],v[24:27],0
 s_waitcnt lgkmcnt(3)
 TR v[230:231],v9,34208
 v_mul_f32 v137, v137, v244
 MM v[184:187],v[216:219],v[16:19],0
 TR v[232:233],v11,34112
 v_mul_f32 v138, v138, v244
 MM v[188:191],v[216:219],v[20:23],0
 TR v[234:235],v11,34240
 v_mul_f32 v139, v139, v244
 MM v[192:195],v[216:219],v[24:27],0
 buffer_load_dwordx4 v242, s[64:67], s81 offen offset:2112 lds
 ds_write_b128 v247, v[136:139] offset:0
 MM v[196:199],v[220:223],v[16:19],0
 TR v[236:237],v11,34144
 v_mul_f32 v140, v140, v245
 MM v[200:203],v[220:223],v[20:23],0
 TR v[238:239],v11,34272
 v_mul_f32 v141, v141, v245
 MM v[204:207],v[220:223],v[24:27],0
 s_waitcnt lgkmcnt(5)
 TR v[208:209],v9,34304
 v_mul_f32 v142, v142, v245
 MM v[160:163],v[224:227],v[28:31],v[160:163]
 TR v[210:211],v9,34432
 v_mul_f32 v143, v143, v245
 MM v[164:167],v[224:227],v[32:35],v[164:167]
 buffer_load_dwordx4 v243, s[64:67], s81 offen offset:3168 lds
 ds_write_b128 v247, v[140:143] offset:1024
 MM v[168:171],v[224:227],v[36:39],v[168:171]
 TR v[212:213],v9,34336
 v_mul_f32 v144, v144, v246
 MM v[172:175],v[228:231],v[28:31],v[172:175]
 TR v[214:215],v9,34464
 v_mul_f32 v145, v145, v246
 MM v[176:179],v[228:231],v[32:35],v[176:179]
 s_mov_b32 m0, s94
 TR v[216:217],v11,34368
 v_mul_f32 v146, v146, v246
 MM v[180:183],v[228:231],v[36:39],v[180:183]
 s_waitcnt lgkmcnt(6)
 buffer_load_dwordx4 v240, s[68:71], s81 offen offset:0 lds
 v_mul_f32 v147, v147, v246
 MM v[184:187],v[232:235],v[28:31],v[184:187]
 TR v[218:219],v11,34496
 ds_write_b128 v247, v[144:147] offset:2048
 MM v[188:191],v[232:235],v[32:35],v[188:191]
 TR v[220:221],v11,34400
 v_mul_f32 v148, v148, v244
 MM v[192:195],v[232:235],v[36:39],v[192:195]
 TR v[222:223],v11,34528
 MM v[196:199],v[236:239],v[28:31],v[196:199]
 TR v[224:225],v9,34560
 v_mul_f32 v149, v149, v244
 MM v[200:203],v[236:239],v[32:35],v[200:203]
 buffer_load_dwordx4 v241, s[68:71], s81 offen offset:1056 lds
 v_mul_f32 v150, v150, v244
 MM v[204:207],v[236:239],v[36:39],v[204:207]
 s_waitcnt lgkmcnt(6)
 TR v[226:227],v9,34688
 v_mul_f32 v151, v151, v244
 MM v[160:163],v[208:211],v[40:43],v[160:163]
 TR v[228:229],v9,34592
 ds_write_b128 v247, v[148:151] offset:3072
 MM v[164:167],v[208:211],v[44:47],v[164:167]
 TR v[230:231],v9,34720
 v_mul_f32 v152, v152, v245
 MM v[168:171],v[208:211],v[48:51],v[168:171]
 TR v[232:233],v11,34624
 v_mul_f32 v153, v153, v245
 MM v[172:175],v[212:215],v[40:43],v[172:175]
 buffer_load_dwordx4 v242, s[68:71], s81 offen offset:2112 lds
 v_mul_f32 v154, v154, v245
 MM v[176:179],v[212:215],v[44:47],v[176:179]
 TR v[234:235],v11,34752
 v_mul_f32 v155, v155, v245
 MM v[180:183],v[212:215],v[48:51],v[180:183]
 s_waitcnt lgkmcnt(7)
 TR v[236:237],v11,34656
 ds_write_b128 v247, v[152:155] offset:4096
 MM v[184:187],v[216:219],v[40:43],v[184:187]
 TR v[238:239],v11,34784
 v_mul_f32 v156, v156, v246
 MM v[188:191],v[216:219],v[44:47],v[188:191]
 buffer_load_dwordx4 v243, s[68:71], s81 offen offset:3168 lds
 v_mul_f32 v157, v157, v246
 MM v[192:195],v[216:219],v[48:51],v[192:195]
 s_add_u32 s80, s80, 128
 s_cmp_eq_u32 s80, 896
 s_cselect_b32 s80, 0, s80
 MM v[196:199],v[220:223],v[40:43],v[196:199]
 v_mul_f32 v158, v158, v246
 v_mul_f32 v159, v159, v246
 MM v[200:203],v[220:223],v[44:47],v[200:203]
 ds_write_b128 v247, v[156:159] offset:5120
 MM v[204:207],v[220:223],v[48:51],v[204:207]
 s_waitcnt lgkmcnt(9)
 MM v[160:163],v[224:227],v[52:55],v[160:163]
 MM v[164:167],v[224:227],v[56:59],v[164:167]
 MM v[168:171],v[224:227],v[60:63],v[168:171]
 s_waitcnt lgkmcnt(0) vmcnt(16)
 s_barrier
 TR v[208:209],v8,0
 MM v[172:175],v[228:231],v[52:55],v[172:175]
 TR v[210:211],v8,128
 MM v[176:179],v[228:231],v[56:59],v[176:179]
 MM v[180:183],v[228:231],v[60:63],v[180:183]
 TR v[212:213],v8,32
 MM v[184:187],v[232:235],v[52:55],v[184:187]
 TR v[214:215],v8,160
 MM v[188:191],v[232:235],v[56:59],v[188:191]
 MM v[192:195],v[232:235],v[60:63],v[192:195]
 TR v[216:217],v10,64
 MM v[196:199],v[236:239],v[52:55],v[196:199]
 TR v[218:219],v10,192
 MM v[200:203],v[236:239],v[56:59],v[200:203]
 MM v[204:207],v[236:239],v[60:63],v[204:207]
 s_waitcnt lgkmcnt(4)
 TR v[220:221],v10,96
 ds_read_b128 v[136:139], v248 offset:0
 MM v[160:163],v[208:211],v[64:67],v[160:163]
 TR v[222:223],v10,224
 ds_read_b128 v[148:151], v248 offset:3072
 MM v[164:167],v[208:211],v[68:71],v[164:167]
 TR v[224:225],v8,256
 ds_read_b128 v[140:143], v248 offset:1024
 MM v[168:171],v[208:211],v[72:75],v[168:171]
 s_waitcnt lgkmcnt(8)
 s_mov_b32 m0, s95
 TR v[226:227],v8,384
 MM v[172:175],v[212:215],v[64:67],v[172:175]
 buffer_load_dwordx4 v240, s[64:67], s80 offen offset:0 lds
 ds_read_b128 v[152:155], v248 offset:4096
 MM v[176:179],v[212:215],v[68:71],v[176:179]
 TR v[228:229],v8,288
 buffer_load_dwordx4 v241, s[64:67], s80 offen offset:1056 lds
 MM v[180:183],v[212:215],v[72:75],v[180:183]
 s_waitcnt lgkmcnt(6)
 TR v[230:231],v8,416
 ds_read_b128 v[144:147], v248 offset:2048
 MM v[184:187],v[216:219],v[64:67],v[184:187]
 TR v[232:233],v10,320
 ds_read_b128 v[156:159], v248 offset:5120
 MM v[188:191],v[216:219],v[68:71],v[188:191]
 TR v[234:235],v10,448
 MM v[192:195],v[216:219],v[72:75],v[192:195]
 buffer_load_dwordx4 v242, s[64:67], s80 offen offset:2112 lds
 MM v[196:199],v[220:223],v[64:67],v[196:199]
 TR v[236:237],v10,352
 MM v[200:203],v[220:223],v[68:71],v[200:203]
 TR v[238:239],v10,480
 MM v[204:207],v[220:223],v[72:75],v[204:207]
 s_waitcnt lgkmcnt(6)
 TR v[208:209],v8,512
 v_fma_f32 v112, v112, v244, v136
 MM v[160:163],v[224:227],v[76:79],v[160:163]
 TR v[210:211],v8,640
 v_fma_f32 v113, v113, v244, v137
 v_fma_f32 v114, v114, v244, v138
 MM v[164:167],v[224:227],v[80:83],v[164:167]
 buffer_load_dwordx4 v243, s[64:67], s80 offen offset:3168 lds
 v_fma_f32 v115, v115, v244, v139
 MM v[168:171],v[224:227],v[84:87],v[168:171]
 TR v[212:213],v8,544
 v_fma_f32 v124, v124, v244, v148
 MM v[172:175],v[228:231],v[76:79],v[172:175]
 TR v[214:215],v8,672
 v_fma_f32 v125, v125, v244, v149
 v_fma_f32 v126, v126, v244, v150
 MM v[176:179],v[228:231],v[80:83],v[176:179]
 s_mov_b32 m0, s96
 TR v[216:217],v10,576
 v_fma_f32 v127, v127, v244, v151
 MM v[180:183],v[228:231],v[84:87],v[180:183]
 s_waitcnt lgkmcnt(5)
 buffer_load_dwordx4 v240, s[68:71], s80 offen offset:0 lds
 CV v112,v112,v113
 MM v[184:187],v[232:235],v[76:79],v[184:187]
 TR v[218:219],v10,704
 CV v113,v114,v115
 MM v[188:191],v[232:235],v[80:83],v[188:191]
 TR v[220:221],v10,608
 CV v114,v124,v125
 MM v[192:195],v[232:235],v[84:87],v[192:195]
 TR v[222:223],v10,736
 CV v115,v126,v127
 MM v[196:199],v[236:239],v[76:79],v[196:199]
 TR v[224:225],v8,768
 v_fma_f32 v116, v116, v245, v140
 v_fma_f32 v117, v117, v245, v141
 MM v[200:203],v[236:239],v[80:83],v[200:203]
 buffer_load_dwordx4 v241, s[68:71], s80 offen offset:1056 lds
 v_fma_f32 v118, v118, v245, v142
 MM v[204:207],v[236:239],v[84:87],v[204:207]
 s_waitcnt lgkmcnt(5)
 TR v[226:227],v8,896
 v_fma_f32 v119, v119, v245, v143
 MM v[160:163],v[208:211],v[88:91],v[160:163]
 TR v[228:229],v8,800
 v_fma_f32 v128, v128, v245, v152
 MM v[164:167],v[208:211],v[92:95],v[164:167]
 TR v[230:231],v8,928
 v_fma_f32 v129, v129, v245, v153
 MM v[168:171],v[208:211],v[96:99],v[168:171]
 TR v[232:233],v10,832
 v_fma_f32 v130, v130, v245, v154
 v_fma_f32 v131, v131, v245, v155
 MM v[172:175],v[212:215],v[88:91],v[172:175]
 buffer_load_dwordx4 v242, s[68:71], s80 offen offset:2112 lds
 CV v116,v116,v117
 MM v[176:179],v[212:215],v[92:95],v[176:179]
 TR v[234:235],v10,960
 CV v117,v118,v119
 MM v[180:183],v[212:215],v[96:99],v[180:183]
 s_waitcnt lgkmcnt(6)
 TR v[236:237],v10,864
 CV v118,v128,v129
 MM v[184:187],v[216:219],v[88:91],v[184:187]
 TR v[238:239],v10,992
 CV v119,v130,v131
 MM v[188:191],v[216:219],v[92:95],v[188:191]
 buffer_load_dwordx4 v243, s[68:71], s80 offen offset:3168 lds
 v_fma_f32 v120, v120, v246, v144
 v_fma_f32 v121, v121, v246, v145
 MM v[192:195],v[216:219],v[96:99],v[192:195]
 s_add_u32 s81, s80, 114688
 v_fma_f32 v122, v122, v246, v146
 MM v[196:199],v[220:223],v[88:91],v[196:199]
 v_fma_f32 v123, v123, v246, v147
 v_fma_f32 v132, v132, v246, v156
 MM v[200:203],v[220:223],v[92:95],v[200:203]
 v_fma_f32 v133, v133, v246, v157
 v_fma_f32 v134, v134, v246, v158
 MM v[204:207],v[220:223],v[96:99],v[204:207]
 s_waitcnt lgkmcnt(6)
 v_fma_f32 v135, v135, v246, v159
 CV v120,v120,v121
 MM v[160:163],v[224:227],v[100:103],v[160:163]
 CV v121,v122,v123
 CV v122,v132,v133
 MM v[164:167],v[224:227],v[104:107],v[164:167]
 CV v123,v134,v135
 MM v[168:171],v[224:227],v[108:111],v[168:171]
 s_waitcnt lgkmcnt(0) vmcnt(16)
 s_barrier
 TR v[208:209],v8,33792
 MM v[172:175],v[228:231],v[100:103],v[172:175]
 TR v[210:211],v8,33920
 buffer_store_dwordx4 v[112:115], v250, s[60:63], s83 offen offset:0 sc1
 MM v[176:179],v[228:231],v[104:107],v[176:179]
 buffer_store_dwordx4 v[116:119], v250, s[60:63], s83 offen offset:1024 sc1
 MM v[180:183],v[228:231],v[108:111],v[180:183]
 TR v[212:213],v8,33824
 buffer_store_dwordx4 v[120:123], v250, s[60:63], s83 offen offset:2048 sc1
 MM v[184:187],v[232:235],v[100:103],v[184:187]
 TR v[214:215],v8,33952
 MM v[188:191],v[232:235],v[104:107],v[188:191]
 MM v[192:195],v[232:235],v[108:111],v[192:195]
 TR v[216:217],v10,33856
 MM v[196:199],v[236:239],v[100:103],v[196:199]
 TR v[218:219],v10,33984
 MM v[200:203],v[236:239],v[104:107],v[200:203]
 s_add_u32 s83, s83, 6144
 s_cmp_ge_u32 s83, 43008
 s_cselect_b32 s3, 43008, 0
 s_sub_u32 s83, s83, s3
 MM v[204:207],v[236:239],v[108:111],v[204:207]
 s_waitcnt lgkmcnt(4)
 TR v[220:221],v10,33888
 MM v[112:115],v[208:211],v[16:19],0
 TR v[222:223],v10,34016
 MM v[116:119],v[208:211],v[20:23],0
 TR v[224:225],v8,34048
 MM v[120:123],v[208:211],v[24:27],0
 s_waitcnt lgkmcnt(5)
 s_mov_b32 m0, s89
 TR v[226:227],v8,34176
 MM v[124:127],v[212:215],v[16:19],0
 buffer_load_dwordx4 v240, s[64:67], s81 offen offset:0 lds
 v_mul_f32 v184, v184, v244
 MM v[128:131],v[212:215],v[20:23],0
 TR v[228:229],v8,34080
 buffer_load_dwordx4 v241, s[64:67], s81 offen offset:1056 lds
 MM v[132:135],v[212:215],v[24:27],0
 s_waitcnt lgkmcnt(3)
 TR v[230:231],v8,34208
 v_mul_f32 v185, v185, v244
 MM v[136:139],v[216:219],v[16:19],0
 TR v[232:233],v10,34112
 v_mul_f32 v186, v186, v244
 MM v[140:143],v[216:219],v[20:23],0
 TR v[234:235],v10,34240
 v_mul_f32 v187, v187, v244
 MM v[144:147],v[216:219],v[24:27],0
 buffer_load_dwordx4 v242, s[64:67], s81 offen offset:2112 lds
 ds_write_b128 v247, v[184:187] offset:0
 MM v[148:151],v[220:223],v[16:19],0
 TR v[236:237],v10,34144
 v_mul_f32 v188, v188, v245
 MM v[152:155],v[220:223],v[20:23],0
 TR v[238:239],v10,34272
 v_mul_f32 v189, v189, v245
 MM v[156:159],v[220:223],v[24:27],0
 s_waitcnt lgkmcnt(5)
 TR v[208:209],v8,34304
 v_mul_f32 v190, v190, v245
 MM v[112:115],v[224:227],v[28:31],v[112:115]
 TR v[210:211],v8,34432
 v_mul_f32 v191, v191, v245
 MM v[116:119],v[224:227],v[32:35],v[116:119]
 buffer_load_dwordx4 v243, s[64:67], s81 offen offset:3168 lds
 ds_write_b128 v247, v[188:191] offset:1024
 MM v[120:123],v[224:227],v[36:39],v[120:123]
 TR v[212:213],v8,34336
 v_mul_f32 v192, v192, v246
 MM v[124:127],v[228:231],v[28:31],v[124:127]
 TR v[214:215],v8,34464
 v_mul_f32 v193, v193, v246
 MM v[128:131],v[228:231],v[32:35],v[128:131]
 s_mov_b32 m0, s90
 TR v[216:217],v10,34368
 v_mul_f32 v194, v194, v246
 MM v[132:135],v[228:231],v[36:39],v[132:135]
 s_waitcnt lgkmcnt(6)
 buffer_load_dwordx4 v240, s[68:71], s81 offen offset:0 lds
 v_mul_f32 v195, v195, v246
 MM v[136:139],v[232:235],v[28:31],v[136:139]
 TR v[218:219],v10,34496
 ds_write_b128 v247, v[192:195] offset:2048
 MM v[140:143],v[232:235],v[32:35],v[140:143]
 TR v[220:221],v10,34400
 v_mul_f32 v196, v196, v244
 MM v[144:147],v[232:235],v[36:39],v[144:147]
 TR v[222:223],v10,34528
 MM v[148:151],v[236:239],v[28:31],v[148:151]
 TR v[224:225],v8,34560
 v_mul_f32 v197, v197, v244
 MM v[152:155],v[236:239],v[32:35],v[152:155]
 buffer_load_dwordx4 v241, s[68:71], s81 offen offset:1056 lds
 v_mul_f32 v198, v198, v244
 MM v[156:159],v[236:239],v[36:39],v[156:159]
 s_waitcnt lgkmcnt(6)
 TR v[226:227],v8,34688
 v_mul_f32 v199, v199, v244
 MM v[112:115],v[208:211],v[40:43],v[112:115]
 TR v[228:229],v8,34592
 ds_write_b128 v247, v[196:199] offset:3072
 MM v[116:119],v[208:211],v[44:47],v[116:119]
 TR v[230:231],v8,34720
 v_mul_f32 v200, v200, v245
 MM v[120:123],v[208:211],v[48:51],v[120:123]
 TR v[232:233],v10,34624
 v_mul_f32 v201, v201, v245
 MM v[124:127],v[212:215],v[40:43],v[124:127]
 buffer_load_dwordx4 v242, s[68:71], s81 offen offset:2112 lds
 v_mul_f32 v202, v202, v245
 MM v[128:131],v[212:215],v[44:47],v[128:131]
 TR v[234:235],v10,34752
 v_mul_f32 v203, v203, v245
 MM v[132:135],v[212:215],v[48:51],v[132:135]
 s_waitcnt lgkmcnt(7)
 TR v[236:237],v10,34656
 ds_write_b128 v247, v[200:203] offset:4096
 MM v[136:139],v[216:219],v[40:43],v[136:139]
 TR v[238:239],v10,34784
 v_mul_f32 v204, v204, v246
 MM v[140:143],v[216:219],v[44:47],v[140:143]
 buffer_load_dwordx4 v243, s[68:71], s81 offen offset:3168 lds
 v_mul_f32 v205, v205, v246
 MM v[144:147],v[216:219],v[48:51],v[144:147]
 s_add_u32 s80, s80, 128
 s_cmp_eq_u32 s80, 896
 s_cselect_b32 s80, 0, s80
 MM v[148:151],v[220:223],v[40:43],v[148:151]
 v_mul_f32 v206, v206, v246
 v_mul_f32 v207, v207, v246
 MM v[152:155],v[220:223],v[44:47],v[152:155]
 ds_write_b128 v247, v[204:207] offset:5120
 MM v[156:159],v[220:223],v[48:51],v[156:159]
 s_waitcnt lgkmcnt(9)
 MM v[112:115],v[224:227],v[52:55],v[112:115]
 MM v[116:119],v[224:227],v[56:59],v[116:119]
 MM v[120:123],v[224:227],v[60:63],v[120:123]
 s_waitcnt lgkmcnt(0) vmcnt(16)
 s_barrier
 TR v[208:209],v9,0
 MM v[124:127],v[228:231],v[52:55],v[124:127]
 TR v[210:211],v9,128
 MM v[128:131],v[228:231],v[56:59],v[128:131]
 MM v[132:135],v[228:231],v[60:63],v[132:135]
 TR v[212:213],v9,32
 MM v[136:139],v[232:235],v[52:55],v[136:139]
 TR v[214:215],v9,160
 MM v[140:143],v[232:235],v[56:59],v[140:143]
 MM v[144:147],v[232:235],v[60:63],v[144:147]
 TR v[216:217],v11,64
 MM v[148:151],v[236:239],v[52:55],v[148:151]
 TR v[218:219],v11,192
 MM v[152:155],v[236:239],v[56:59],v[152:155]
 MM v[156:159],v[236:239],v[60:63],v[156:159]
 s_waitcnt lgkmcnt(4)
 TR v[220:221],v11,96
 ds_read_b128 v[184:187], v248 offset:0
 MM v[112:115],v[208:211],v[64:67],v[112:115]
 TR v[222:223],v11,224
 ds_read_b128 v[196:199], v248 offset:3072
 MM v[116:119],v[208:211],v[68:71],v[116:119]
 TR v[224:225],v9,256
 ds_read_b128 v[188:191], v248 offset:1024
 MM v[120:123],v[208:211],v[72:75],v[120:123]
 s_waitcnt lgkmcnt(8)
 s_mov_b32 m0, s91
 TR v[226:227],v9,384
 MM v[124:127],v[212:215],v[64:67],v[124:127]
 buffer_load_dwordx4 v240, s[64:67], s80 offen offset:0 lds
 ds_read_b128 v[200:203], v248 offset:4096
 MM v[128:131],v[212:215],v[68:71],v[128:131]
 TR v[228:229],v9,288
 buffer_load_dwordx4 v241, s[64:67], s80 offen offset:1056 lds
 MM v[132:135],v[212:215],v[72:75],v[132:135]
 s_waitcnt lgkmcnt(6)
 TR v[230:231],v9,416
 ds_read_b128 v[192:195], v248 offset:2048
 MM v[136:139],v[216:219],v[64:67],v[136:139]
 TR v[232:233],v11,320
 ds_read_b128 v[204:207], v248 offset:5120
 MM v[140:143],v[216:219],v[68:71],v[140:143]
 TR v[234:235],v11,448
 MM v[144:147],v[216:219],v[72:75],v[144:147]
 buffer_load_dwordx4 v242, s[64:67], s80 offen offset:2112 lds
 MM v[148:151],v[220:223],v[64:67],v[148:151]
 TR v[236:237],v11,352
 MM v[152:155],v[220:223],v[68:71],v[152:155]
 TR v[238:239],v11,480
 MM v[156:159],v[220:223],v[72:75],v[156:159]
 s_waitcnt lgkmcnt(6)
 TR v[208:209],v9,512
 v_fma_f32 v160, v160, v244, v184
 MM v[112:115],v[224:227],v[76:79],v[112:115]
 TR v[210:211],v9,640
 v_fma_f32 v161, v161, v244, v185
 v_fma_f32 v162, v162, v244, v186
 MM v[116:119],v[224:227],v[80:83],v[116:119]
 buffer_load_dwordx4 v243, s[64:67], s80 offen offset:3168 lds
 v_fma_f32 v163, v163, v244, v187
 MM v[120:123],v[224:227],v[84:87],v[120:123]
 TR v[212:213],v9,544
 v_fma_f32 v172, v172, v244, v196
 MM v[124:127],v[228:231],v[76:79],v[124:127]
 TR v[214:215],v9,672
 v_fma_f32 v173, v173, v244, v197
 v_fma_f32 v174, v174, v244, v198
 MM v[128:131],v[228:231],v[80:83],v[128:131]
 s_mov_b32 m0, s92
 TR v[216:217],v11,576
 v_fma_f32 v175, v175, v244, v199
 MM v[132:135],v[228:231],v[84:87],v[132:135]
 s_waitcnt lgkmcnt(5)
 buffer_load_dwordx4 v240, s[68:71], s80 offen offset:0 lds
 CV v160,v160,v161
 MM v[136:139],v[232:235],v[76:79],v[136:139]
 TR v[218:219],v11,704
 CV v161,v162,v163
 MM v[140:143],v[232:235],v[80:83],v[140:143]
 TR v[220:221],v11,608
 CV v162,v172,v173
 MM v[144:147],v[232:235],v[84:87],v[144:147]
 TR v[222:223],v11,736
 CV v163,v174,v175
 MM v[148:151],v[236:239],v[76:79],v[148:151]
 TR v[224:225],v9,768
 v_fma_f32 v164, v164, v245, v188
 v_fma_f32 v165, v165, v245, v189
 MM v[152:155],v[236:239],v[80:83],v[152:155]
 buffer_load_dwordx4 v241, s[68:71], s80 offen offset:1056 lds
 v_fma_f32 v166, v166, v245, v190
 MM v[156:159],v[236:239],v[84:87],v[156:159]
 s_waitcnt lgkmcnt(5)
 TR v[226:227],v9,896
 v_fma_f32 v167, v167, v245, v191
 MM v[112:115],v[208:211],v[88:91],v[112:115]
 TR v[228:229],v9,800
 v_fma_f32 v176, v176, v245, v200
 MM v[116:119],v[208:211],v[92:95],v[116:119]
 TR v[230:231],v9,928
 v_fma_f32 v177, v177, v245, v201
 MM v[120:123],v[208:211],v[96:99],v[120:123]
 TR v[232:233],v11,832
 v_fma_f32 v178, v178, v245, v202
 v_fma_f32 v179, v179, v245, v203
 MM v[124:127],v[212:215],v[88:91],v[124:127]
 buffer_load_dwordx4 v242, s[68:71], s80 offen offset:2112 lds
 CV v164,v164,v165
 MM v[128:131],v[212:215],v[92:95],v[128:131]
 TR v[234:235],v11,960
 CV v165,v166,v167
 MM v[132:135],v[212:215],v[96:99],v[132:135]
 s_waitcnt lgkmcnt(6)
 TR v[236:237],v11,864
 CV v166,v176,v177
 MM v[136:139],v[216:219],v[88:91],v[136:139]
 TR v[238:239],v11,992
 CV v167,v178,v179
 MM v[140:143],v[216:219],v[92:95],v[140:143]
 buffer_load_dwordx4 v243, s[68:71], s80 offen offset:3168 lds
 v_fma_f32 v168, v168, v246, v192
 v_fma_f32 v169, v169, v246, v193
 MM v[144:147],v[216:219],v[96:99],v[144:147]
 s_add_u32 s81, s80, 114688
 v_fma_f32 v170, v170, v246, v194
 MM v[148:151],v[220:223],v[88:91],v[148:151]
 v_fma_f32 v171, v171, v246, v195
 v_fma_f32 v180, v180, v246, v204
 MM v[152:155],v[220:223],v[92:95],v[152:155]
 v_fma_f32 v181, v181, v246, v205
 v_fma_f32 v182, v182, v246, v206
 MM v[156:159],v[220:223],v[96:99],v[156:159]
 s_waitcnt lgkmcnt(6)
 v_fma_f32 v183, v183, v246, v207
 CV v168,v168,v169
 MM v[112:115],v[224:227],v[100:103],v[112:115]
 CV v169,v170,v171
 CV v170,v180,v181
 MM v[116:119],v[224:227],v[104:107],v[116:119]
 CV v171,v182,v183
 MM v[120:123],v[224:227],v[108:111],v[120:123]
 s_waitcnt lgkmcnt(0) vmcnt(16)
 s_barrier
 TR v[208:209],v9,33792
 MM v[124:127],v[228:231],v[100:103],v[124:127]
 TR v[210:211],v9,33920
 buffer_store_dwordx4 v[160:163], v250, s[60:63], s83 offen offset:0 sc1
 MM v[128:131],v[228:231],v[104:107],v[128:131]
 buffer_store_dwordx4 v[164:167], v250, s[60:63], s83 offen offset:1024 sc1
 MM v[132:135],v[228:231],v[108:111],v[132:135]
 TR v[212:213],v9,33824
 buffer_store_dwordx4 v[168:171], v250, s[60:63], s83 offen offset:2048 sc1
 MM v[136:139],v[232:235],v[100:103],v[136:139]
 TR v[214:215],v9,33952
 MM v[140:143],v[232:235],v[104:107],v[140:143]
 MM v[144:147],v[232:235],v[108:111],v[144:147]
 TR v[216:217],v11,33856
 MM v[148:151],v[236:239],v[100:103],v[148:151]
 TR v[218:219],v11,33984
 MM v[152:155],v[236:239],v[104:107],v[152:155]
 s_add_u32 s83, s83, 6144
 s_cmp_ge_u32 s83, 43008
 s_cselect_b32 s3, 43008, 0
 s_sub_u32 s83, s83, s3
 MM v[156:159],v[236:239],v[108:111],v[156:159]
 s_add_u32 s79, s79, 1
 s_cmp_lt_u32 s79, 2
 s_cbranch_scc1 LA_loop80
 s_waitcnt lgkmcnt(4)
 TR v[220:221],v11,33888
 MM v[160:163],v[208:211],v[16:19],0
 TR v[222:223],v11,34016
 MM v[164:167],v[208:211],v[20:23],0
 TR v[224:225],v9,34048
 MM v[168:171],v[208:211],v[24:27],0
 s_waitcnt lgkmcnt(5)
 s_mov_b32 m0, s93
 TR v[226:227],v9,34176
 MM v[172:175],v[212:215],v[16:19],0
 buffer_load_dwordx4 v240, s[64:67], s81 offen offset:0 lds
 v_mul_f32 v136, v136, v244
 MM v[176:179],v[212:215],v[20:23],0
 TR v[228:229],v9,34080
 buffer_load_dwordx4 v241, s[64:67], s81 offen offset:1056 lds
 MM v[180:183],v[212:215],v[24:27],0
 s_waitcnt lgkmcnt(3)
 TR v[230:231],v9,34208
 buffer_load_dwordx4 v242, s[64:67], s81 offen offset:2112 lds
 MM v[184:187],v[216:219],v[16:19],0
 TR v[232:233],v11,34112
 v_mul_f32 v137, v137, v244
 MM v[188:191],v[216:219],v[20:23],0
 TR v[234:235],v11,34240
 v_mul_f32 v138, v138, v244
 MM v[192:195],v[216:219],v[24:27],0
 buffer_load_dwordx4 v243, s[64:67], s81 offen offset:3168 lds
 v_mul_f32 v139, v139, v244
 MM v[196:199],v[220:223],v[16:19],0
 s_mov_b32 m0, s94
 TR v[236:237],v11,34144
 ds_write_b128 v247, v[136:139] offset:0
 MM v[200:203],v[220:223],v[20:23],0
 TR v[238:239],v11,34272
 buffer_load_dwordx4 v240, s[68:71], s81 offen offset:0 lds
 MM v[204:207],v[220:223],v[24:27],0
 s_waitcnt lgkmcnt(5)
 TR v[208:209],v9,34304
 v_mul_f32 v140, v140, v245
 MM v[160:163],v[224:227],v[28:31],v[160:163]
 TR v[210:211],v9,34432
 v_mul_f32 v141, v141, v245
 MM v[164:167],v[224:227],v[32:35],v[164:167]
 buffer_load_dwordx4 v241, s[68:71], s81 offen offset:1056 lds
 v_mul_f32 v142, v142, v245
 MM v[168:171],v[224:227],v[36:39],v[168:171]
 TR v[212:213],v9,34336
 buffer_load_dwordx4 v242, s[68:71], s81 offen offset:2112 lds
 MM v[172:175],v[228:231],v[28:31],v[172:175]
 TR v[214:215],v9,34464
 v_mul_f32 v143, v143, v245
 MM v[176:179],v[228:231],v[32:35],v[176:179]
 TR v[216:217],v11,34368
 ds_write_b128 v247, v[140:143] offset:1024
 MM v[180:183],v[228:231],v[36:39],v[180:183]
 s_waitcnt lgkmcnt(6)
 buffer_load_dwordx4 v243, s[68:71], s81 offen offset:3168 lds
 MM v[184:187],v[232:235],v[28:31],v[184:187]
 s_add_u32 s80, s80, 128
 s_cmp_eq_u32 s80, 896
 s_cselect_b32 s80, 0, s80
 TR v[218:219],v11,34496
 MM v[188:191],v[232:235],v[32:35],v[188:191]
 TR v[220:221],v11,34400
 v_mul_f32 v144, v144, v246
 MM v[192:195],v[232:235],v[36:39],v[192:195]
 TR v[222:223],v11,34528
 v_mul_f32 v145, v145, v246
 MM v[196:199],v[236:239],v[28:31],v[196:199]
 TR v[224:225],v9,34560
 v_mul_f32 v146, v146, v246
 MM v[200:203],v[236:239],v[32:35],v[200:203]
 v_mul_f32 v147, v147, v246
 ds_write_b128 v247, v[144:147] offset:2048
 MM v[204:207],v[236:239],v[36:39],v[204:207]
 s_waitcnt lgkmcnt(7)
 TR v[226:227],v9,34688
 v_mul_f32 v148, v148, v244
 MM v[160:163],v[208:211],v[40:43],v[160:163]
 TR v[228:229],v9,34592
 v_mul_f32 v149, v149, v244
 MM v[164:167],v[208:211],v[44:47],v[164:167]
 TR v[230:231],v9,34720
 v_mul_f32 v150, v150, v244
 MM v[168:171],v[208:211],v[48:51],v[168:171]
 TR v[232:233],v11,34624
 v_mul_f32 v151, v151, v244
 MM v[172:175],v[212:215],v[40:43],v[172:175]
 ds_write_b128 v247, v[148:151] offset:3072
 MM v[176:179],v[212:215],v[44:47],v[176:179]
 TR v[234:235],v11,34752
 v_mul_f32 v152, v152, v245
 MM v[180:183],v[212:215],v[48:51],v[180:183]
 s_waitcnt lgkmcnt(8)
 TR v[236:237],v11,34656
 v_mul_f32 v153, v153, v245
 MM v[184:187],v[216:219],v[40:43],v[184:187]
 TR v[238:239],v11,34784
 v_mul_f32 v154, v154, v245
 MM v[188:191],v[216:219],v[44:47],v[188:191]
 v_mul_f32 v155, v155, v245
 ds_write_b128 v247, v[152:155] offset:4096
 MM v[192:195],v[216:219],v[48:51],v[192:195]
 v_mul_f32 v156, v156, v246
 v_mul_f32 v157, v157, v246
 MM v[196:199],v[220:223],v[40:43],v[196:199]
 v_mul_f32 v158, v158, v246
 v_mul_f32 v159, v159, v246
 MM v[200:203],v[220:223],v[44:47],v[200:203]
 ds_write_b128 v247, v[156:159] offset:5120
 MM v[204:207],v[220:223],v[48:51],v[204:207]
 s_waitcnt lgkmcnt(9)
 MM v[160:163],v[224:227],v[52:55],v[160:163]
 MM v[164:167],v[224:227],v[56:59],v[164:167]
 MM v[168:171],v[224:227],v[60:63],v[168:171]
 s_waitcnt lgkmcnt(0) vmcnt(16)
 s_barrier
 TR v[208:209],v8,0
 MM v[172:175],v[228:231],v[52:55],v[172:175]
 TR v[210:211],v8,128
 MM v[176:179],v[228:231],v[56:59],v[176:179]
 MM v[180:183],v[228:231],v[60:63],v[180:183]
 TR v[212:213],v8,32
 MM v[184:187],v[232:235],v[52:55],v[184:187]
 TR v[214:215],v8,160
 MM v[188:191],v[232:235],v[56:59],v[188:191]
 MM v[192:195],v[232:235],v[60:63],v[192:195]
 TR v[216:217],v10,64
 MM v[196:199],v[236:239],v[52:55],v[196:199]
 TR v[218:219],v10,192
 MM v[200:203],v[236:239],v[56:59],v[200:203]
 MM v[204:207],v[236:239],v[60:63],v[204:207]
 s_waitcnt lgkmcnt(4)
 TR v[220:221],v10,96
 ds_read_b128 v[136:139], v248 offset:0
 MM v[160:163],v[208:211],v[64:67],v[160:163]
 TR v[222:223],v10,224
 ds_read_b128 v[148:151], v248 offset:3072
 MM v[164:167],v[208:211],v[68:71],v[164:167]
 TR v[224:225],v8,256
 ds_read_b128 v[140:143], v248 offset:1024
 MM v[168:171],v[208:211],v[72:75],v[168:171]
 s_waitcnt lgkmcnt(8)
 TR v[226:227],v8,384
 ds_read_b128 v[152:155], v248 offset:4096
 MM v[172:175],v[212:215],v[64:67],v[172:175]
 ds_read_b128 v[144:147], v248 offset:2048
 ds_read_b128 v[156:159], v248 offset:5120
 MM v[176:179],v[212:215],v[68:71],v[176:179]
 TR v[228:229],v8,288
 MM v[180:183],v[212:215],v[72:75],v[180:183]
 s_waitcnt lgkmcnt(8)
 TR v[230:231],v8,416
 MM v[184:187],v[216:219],v[64:67],v[184:187]
 TR v[232:233],v10,320
 MM v[188:191],v[216:219],v[68:71],v[188:191]
 TR v[234:235],v10,448
 MM v[192:195],v[216:219],v[72:75],v[192:195]
 MM v[196:199],v[220:223],v[64:67],v[196:199]
 TR v[236:237],v10,352
 MM v[200:203],v[220:223],v[68:71],v[200:203]
 TR v[238:239],v10,480
 MM v[204:207],v[220:223],v[72:75],v[204:207]
 s_waitcnt lgkmcnt(4)
 TR v[208:209],v8,512
 MM v[160:163],v[224:227],v[76:79],v[160:163]
 TR v[210:211],v8,640
 v_fma_f32 v112, v112, v244, v136
 MM v[164:167],v[224:227],v[80:83],v[164:167]
 v_fma_f32 v113, v113, v244, v137
 v_fma_f32 v114, v114, v244, v138
 MM v[168:171],v[224:227],v[84:87],v[168:171]
 TR v[212:213],v8,544
 v_fma_f32 v115, v115, v244, v139
 MM v[172:175],v[228:231],v[76:79],v[172:175]
 TR v[214:215],v8,672
 v_fma_f32 v124, v124, v244, v148
 MM v[176:179],v[228:231],v[80:83],v[176:179]
 TR v[216:217],v10,576
 v_fma_f32 v125, v125, v244, v149
 MM v[180:183],v[228:231],v[84:87],v[180:183]
 s_waitcnt lgkmcnt(5)
 v_fma_f32 v126, v126, v244, v150
 v_fma_f32 v127, v127, v244, v151
 MM v[184:187],v[232:235],v[76:79],v[184:187]
 TR v[218:219],v10,704
 CV v112,v112,v113
 MM v[188:191],v[232:235],v[80:83],v[188:191]
 TR v[220:221],v10,608
 CV v113,v114,v115
 MM v[192:195],v[232:235],v[84:87],v[192:195]
 TR v[222:223],v10,736
 CV v114,v124,v125
 MM v[196:199],v[236:239],v[76:79],v[196:199]
 TR v[224:225],v8,768
 CV v115,v126,v127
 MM v[200:203],v[236:239],v[80:83],v[200:203]
 v_fma_f32 v116, v116, v245, v140
 v_fma_f32 v117, v117, v245, v141
 MM v[204:207],v[236:239],v[84:87],v[204:207]
 s_waitcnt lgkmcnt(5)
 TR v[226:227],v8,896
 v_fma_f32 v118, v118, v245, v142
 MM v[160:163],v[208:211],v[88:91],v[160:163]
 TR v[228:229],v8,800
 v_fma_f32 v119, v119, v245, v143
 MM v[164:167],v[208:211],v[92:95],v[164:167]
 TR v[230:231],v8,928
 v_fma_f32 v128, v128, v245, v152
 MM v[168:171],v[208:211],v[96:99],v[168:171]
 TR v[232:233],v10,832
 v_fma_f32 v129, v129, v245, v153
 MM v[172:175],v[212:215],v[88:91],v[172:175]
 v_fma_f32 v130, v130, v245, v154
 v_fma_f32 v131, v131, v245, v155
 MM v[176:179],v[212:215],v[92:95],v[176:179]
 TR v[234:235],v10,960
 CV v116,v116,v117
 MM v[180:183],v[212:215],v[96:99],v[180:183]
 s_waitcnt lgkmcnt(6)
 TR v[236:237],v10,864
 CV v117,v118,v119
 MM v[184:187],v[216:219],v[88:91],v[184:187]
 TR v[238:239],v10,992
 CV v118,v128,v129
 MM v[188:191],v[216:219],v[92:95],v[188:191]
 CV v119,v130,v131
 MM v[192:195],v[216:219],v[96:99],v[192:195]
 v_fma_f32 v120, v120, v246, v144
 v_fma_f32 v121, v121, v246, v145
 MM v[196:199],v[220:223],v[88:91],v[196:199]
 v_fma_f32 v122, v122, v246, v146
 v_fma_f32 v123, v123, v246, v147
 MM v[200:203],v[220:223],v[92:95],v[200:203]
 v_fma_f32 v132, v132, v246, v156
 v_fma_f32 v133, v133, v246, v157
 MM v[204:207],v[220:223],v[96:99],v[204:207]
 s_waitcnt lgkmcnt(6)
 v_fma_f32 v134, v134, v246, v158
 v_fma_f32 v135, v135, v246, v159
 MM v[160:163],v[224:227],v[100:103],v[160:163]
 CV v120,v120,v121
 CV v121,v122,v123
 MM v[164:167],v[224:227],v[104:107],v[164:167]
 CV v122,v132,v133
 CV v123,v134,v135
 MM v[168:171],v[224:227],v[108:111],v[168:171]
 s_waitcnt lgkmcnt(0) vmcnt(8)
 s_barrier
 TR v[208:209],v8,33792
 MM v[172:175],v[228:231],v[100:103],v[172:175]
 TR v[210:211],v8,33920
 buffer_store_dwordx4 v[112:115], v250, s[60:63], s83 offen offset:0 sc1
 MM v[176:179],v[228:231],v[104:107],v[176:179]
 buffer_store_dwordx4 v[116:119], v250, s[60:63], s83 offen offset:1024 sc1
 MM v[180:183],v[228:231],v[108:111],v[180:183]
 TR v[212:213],v8,33824
 buffer_store_dwordx4 v[120:123], v250, s[60:63], s83 offen offset:2048 sc1
 MM v[184:187],v[232:235],v[100:103],v[184:187]
 TR v[214:215],v8,33952
 MM v[188:191],v[232:235],v[104:107],v[188:191]
 MM v[192:195],v[232:235],v[108:111],v[192:195]
 TR v[216:217],v10,33856
 MM v[196:199],v[236:239],v[100:103],v[196:199]
 TR v[218:219],v10,33984
 MM v[200:203],v[236:239],v[104:107],v[200:203]
 s_add_u32 s83, s83, 6144
 s_cmp_ge_u32 s83, 43008
 s_cselect_b32 s3, 43008, 0
 s_sub_u32 s83, s83, s3
 MM v[204:207],v[236:239],v[108:111],v[204:207]
 s_waitcnt lgkmcnt(4)
 TR v[220:221],v10,33888
 MM v[112:115],v[208:211],v[16:19],0
 TR v[222:223],v10,34016
 MM v[116:119],v[208:211],v[20:23],0
 TR v[224:225],v8,34048
 MM v[120:123],v[208:211],v[24:27],0
 s_waitcnt lgkmcnt(5)
 TR v[226:227],v8,34176
 v_mul_f32 v184, v184, v244
 MM v[124:127],v[212:215],v[16:19],0
 v_mul_f32 v185, v185, v244
 v_mul_f32 v186, v186, v244
 MM v[128:131],v[212:215],v[20:23],0
 TR v[228:229],v8,34080
 MM v[132:135],v[212:215],v[24:27],0
 s_waitcnt lgkmcnt(3)
 TR v[230:231],v8,34208
 v_mul_f32 v187, v187, v244
 MM v[136:139],v[216:219],v[16:19],0
 TR v[232:233],v10,34112
 ds_write_b128 v247, v[184:187] offset:0
 MM v[140:143],v[216:219],v[20:23],0
 TR v[234:235],v10,34240
 MM v[144:147],v[216:219],v[24:27],0
 v_mul_f32 v188, v188, v245
 v_mul_f32 v189, v189, v245
 MM v[148:151],v[220:223],v[16:19],0
 TR v[236:237],v10,34144
 MM v[152:155],v[220:223],v[20:23],0
 TR v[238:239],v10,34272
 v_mul_f32 v190, v190, v245
 MM v[156:159],v[220:223],v[24:27],0
 s_waitcnt lgkmcnt(5)
 TR v[208:209],v8,34304
 v_mul_f32 v191, v191, v245
 MM v[112:115],v[224:227],v[28:31],v[112:115]
 TR v[210:211],v8,34432
 ds_write_b128 v247, v[188:191] offset:1024
 MM v[116:119],v[224:227],v[32:35],v[116:119]
 v_mul_f32 v192, v192, v246
 MM v[120:123],v[224:227],v[36:39],v[120:123]
 TR v[212:213],v8,34336
 v_mul_f32 v193, v193, v246
 MM v[124:127],v[228:231],v[28:31],v[124:127]
 TR v[214:215],v8,34464
 MM v[128:131],v[228:231],v[32:35],v[128:131]
 TR v[216:217],v10,34368
 v_mul_f32 v194, v194, v246
 MM v[132:135],v[228:231],v[36:39],v[132:135]
 s_waitcnt lgkmcnt(6)
 v_mul_f32 v195, v195, v246
 MM v[136:139],v[232:235],v[28:31],v[136:139]
 TR v[218:219],v10,34496
 ds_write_b128 v247, v[192:195] offset:2048
 MM v[140:143],v[232:235],v[32:35],v[140:143]
 TR v[220:221],v10,34400
 v_mul_f32 v196, v196, v244
 MM v[144:147],v[232:235],v[36:39],v[144:147]
 TR v[222:223],v10,34528
 v_mul_f32 v197, v197, v244
 MM v[148:151],v[236:239],v[28:31],v[148:151]
 TR v[224:225],v8,34560
 MM v[152:155],v[236:239],v[32:35],v[152:155]
 v_mul_f32 v198, v198, v244
 v_mul_f32 v199, v199, v244
 MM v[156:159],v[236:239],v[36:39],v[156:159]
 s_waitcnt lgkmcnt(6)
 TR v[226:227],v8,34688
 MM v[112:115],v[208:211],v[40:43],v[112:115]
 TR v[228:229],v8,34592
 ds_write_b128 v247, v[196:199] offset:3072
 MM v[116:119],v[208:211],v[44:47],v[116:119]
 TR v[230:231],v8,34720
 v_mul_f32 v200, v200, v245
 MM v[120:123],v[208:211],v[48:51],v[120:123]
 TR v[232:233],v10,34624
 MM v[124:127],v[212:215],v[40:43],v[124:127]
 v_mul_f32 v201, v201, v245
 v_mul_f32 v202, v202, v245
 MM v[128:131],v[212:215],v[44:47],v[128:131]
 TR v[234:235],v10,34752
 v_mul_f32 v203, v203, v245
 MM v[132:135],v[212:215],v[48:51],v[132:135]
 s_waitcnt lgkmcnt(7)
 TR v[236:237],v10,34656
 MM v[136:139],v[216:219],v[40:43],v[136:139]
 TR v[238:239],v10,34784
 ds_write_b128 v247, v[200:203] offset:4096
 MM v[140:143],v[216:219],v[44:47],v[140:143]
 v_mul_f32 v204, v204, v246
 MM v[144:147],v[216:219],v[48:51],v[144:147]
 v_mul_f32 v205, v205, v246
 v_mul_f32 v206, v206, v246
 MM v[148:151],v[220:223],v[40:43],v[148:151]
 v_mul_f32 v207, v207, v246
 MM v[152:155],v[220:223],v[44:47],v[152:155]
 ds_write_b128 v247, v[204:207] offset:5120
 MM v[156:159],v[220:223],v[48:51],v[156:159]
 s_waitcnt lgkmcnt(9)
 MM v[112:115],v[224:227],v[52:55],v[112:115]
 MM v[116:119],v[224:227],v[56:59],v[116:119]
 MM v[120:123],v[224:227],v[60:63],v[120:123]
 s_waitcnt lgkmcnt(0) vmcnt(0)
 s_barrier
 TR v[208:209],v9,0
 MM v[124:127],v[228:231],v[52:55],v[124:127]
 TR v[210:211],v9,128
 MM v[128:131],v[228:231],v[56:59],v[128:131]
 MM v[132:135],v[228:231],v[60:63],v[132:135]
 TR v[212:213],v9,32
 MM v[136:139],v[232:235],v[52:55],v[136:139]
 TR v[214:215],v9,160
 MM v[140:143],v[232:235],v[56:59],v[140:143]
 MM v[144:147],v[232:235],v[60:63],v[144:147]
 TR v[216:217],v11,64
 MM v[148:151],v[236:239],v[52:55],v[148:151]
 TR v[218:219],v11,192
 MM v[152:155],v[236:239],v[56:59],v[152:155]
 MM v[156:159],v[236:239],v[60:63],v[156:159]
 s_waitcnt lgkmcnt(4)
 TR v[220:221],v11,96
 ds_read_b128 v[184:187], v248 offset:0
 MM v[112:115],v[208:211],v[64:67],v[112:115]
 TR v[222:223],v11,224
 ds_read_b128 v[196:199], v248 offset:3072
 MM v[116:119],v[208:211],v[68:71],v[116:119]
 TR v[224:225],v9,256
 ds_read_b128 v[188:191], v248 offset:1024
 MM v[120:123],v[208:211],v[72:75],v[120:123]
 s_waitcnt lgkmcnt(8)
 TR v[226:227],v9,384
 ds_read_b128 v[200:203], v248 offset:4096
 MM v[124:127],v[212:215],v[64:67],v[124:127]
 ds_read_b128 v[192:195], v248 offset:2048
 ds_read_b128 v[204:207], v248 offset:5120
 MM v[128:131],v[212:215],v[68:71],v[128:131]
 TR v[228:229],v9,288
 MM v[132:135],v[212:215],v[72:75],v[132:135]
 s_waitcnt lgkmcnt(8)
 TR v[230:231],v9,416
 MM v[136:139],v[216:219],v[64:67],v[136:139]
 TR v[232:233],v11,320
 MM v[140:143],v[216:219],v[68:71],v[140:143]
 TR v[234:235],v11,448
 MM v[144:147],v[216:219],v[72:75],v[144:147]
 MM v[148:151],v[220:223],v[64:67],v[148:151]
 TR v[236:237],v11,352
 MM v[152:155],v[220:223],v[68:71],v[152:155]
 TR v[238:239],v11,480
 MM v[156:159],v[220:223],v[72:75],v[156:159]
 s_waitcnt lgkmcnt(4)
 TR v[208:209],v9,512
 MM v[112:115],v[224:227],v[76:79],v[112:115]
 TR v[210:211],v9,640
 v_fma_f32 v160, v160, v244, v184
 v_fma_f32 v161, v161, v244, v185
 MM v[116:119],v[224:227],v[80:83],v[116:119]
 v_fma_f32 v162, v162, v244, v186
 v_fma_f32 v163, v163, v244, v187
 MM v[120:123],v[224:227],v[84:87],v[120:123]
 TR v[212:213],v9,544
 v_fma_f32 v172, v172, v244, v196
 MM v[124:127],v[228:231],v[76:79],v[124:127]
 TR v[214:215],v9,672
 v_fma_f32 v173, v173, v244, v197
 MM v[128:131],v[228:231],v[80:83],v[128:131]
 TR v[216:217],v11,576
 v_fma_f32 v174, v174, v244, v198
 MM v[132:135],v[228:231],v[84:87],v[132:135]
 s_waitcnt lgkmcnt(5)
 v_fma_f32 v175, v175, v244, v199
 MM v[136:139],v[232:235],v[76:79],v[136:139]
 TR v[218:219],v11,704
 CV v160,v160,v161
 MM v[140:143],v[232:235],v[80:83],v[140:143]
 TR v[220:221],v11,608
 CV v161,v162,v163
 MM v[144:147],v[232:235],v[84:87],v[144:147]
 TR v[222:223],v11,736
 CV v162,v172,v173
 MM v[148:151],v[236:239],v[76:79],v[148:151]
 TR v[224:225],v9,768
 CV v163,v174,v175
 MM v[152:155],v[236:239],v[80:83],v[152:155]
 buffer_store_dwordx4 v[160:163], v250, s[60:63], s83 offen offset:0 sc1
 MM v[156:159],v[236:239],v[84:87],v[156:159]
 s_waitcnt lgkmcnt(5)
 TR v[226:227],v9,896
 v_fma_f32 v164, v164, v245, v188
 MM v[112:115],v[208:211],v[88:91],v[112:115]
 TR v[228:229],v9,800
 v_fma_f32 v165, v165, v245, v189
 MM v[116:119],v[208:211],v[92:95],v[116:119]
 TR v[230:231],v9,928
 v_fma_f32 v166, v166, v245, v190
 MM v[120:123],v[208:211],v[96:99],v[120:123]
 TR v[232:233],v11,832
 v_fma_f32 v167, v167, v245, v191
 MM v[124:127],v[212:215],v[88:91],v[124:127]
 v_fma_f32 v176, v176, v245, v200
 MM v[128:131],v[212:215],v[92:95],v[128:131]
 TR v[234:235],v11,960
 v_fma_f32 v177, v177, v245, v201
 MM v[132:135],v[212:215],v[96:99],v[132:135]
 s_waitcnt lgkmcnt(6)
 TR v[236:237],v11,864
 v_fma_f32 v178, v178, v245, v202
 MM v[136:139],v[216:219],v[88:91],v[136:139]
 TR v[238:239],v11,992
 v_fma_f32 v179, v179, v245, v203
 MM v[140:143],v[216:219],v[92:95],v[140:143]
 CV v164,v164,v165
 CV v165,v166,v167
 MM v[144:147],v[216:219],v[96:99],v[144:147]
 CV v166,v176,v177
 MM v[148:151],v[220:223],v[88:91],v[148:151]
 CV v167,v178,v179
 buffer_store_dwordx4 v[164:167], v250, s[60:63], s83 offen offset:1024 sc1
 MM v[152:155],v[220:223],v[92:95],v[152:155]
 v_fma_f32 v168, v168, v246, v192
 MM v[156:159],v[220:223],v[96:99],v[156:159]
 s_waitcnt lgkmcnt(6)
 v_fma_f32 v169, v169, v246, v193
 v_fma_f32 v170, v170, v246, v194
 MM v[112:115],v[224:227],v[100:103],v[112:115]
 v_fma_f32 v171, v171, v246, v195
 MM v[116:119],v[224:227],v[104:107],v[116:119]
 v_fma_f32 v180, v180, v246, v204
 v_fma_f32 v181, v181, v246, v205
 MM v[120:123],v[224:227],v[108:111],v[120:123]
 s_waitcnt lgkmcnt(0)
 s_barrier
 v_fma_f32 v182, v182, v246, v206
 MM v[124:127],v[228:231],v[100:103],v[124:127]
 v_fma_f32 v183, v183, v246, v207
 MM v[128:131],v[228:231],v[104:107],v[128:131]
 CV v168,v168,v169
 CV v169,v170,v171
 MM v[132:135],v[228:231],v[108:111],v[132:135]
 CV v170,v180,v181
 MM v[136:139],v[232:235],v[100:103],v[136:139]
 CV v171,v182,v183
 buffer_store_dwordx4 v[168:171], v250, s[60:63], s83 offen offset:2048 sc1
 MM v[140:143],v[232:235],v[104:107],v[140:143]
 MM v[144:147],v[232:235],v[108:111],v[144:147]
 s_add_u32 s83, s83, 6144
 s_cmp_ge_u32 s83, 43008
 s_cselect_b32 s3, 43008, 0
 s_sub_u32 s83, s83, s3
 MM v[148:151],v[236:239],v[100:103],v[148:151]
 MM v[152:155],v[236:239],v[104:107],v[152:155]
 MM v[156:159],v[236:239],v[108:111],v[156:159]
 v_mul_f32 v136, v136, v244
 v_mul_f32 v137, v137, v244
 v_mul_f32 v138, v138, v244
 v_mul_f32 v139, v139, v244
 ds_write_b128 v247, v[136:139] offset:0
 v_mul_f32 v140, v140, v245
 v_mul_f32 v141, v141, v245
 v_mul_f32 v142, v142, v245
 v_mul_f32 v143, v143, v245
 ds_write_b128 v247, v[140:143] offset:1024
 v_mul_f32 v144, v144, v246
 v_mul_f32 v145, v145, v246
 v_mul_f32 v146, v146, v246
 v_mul_f32 v147, v147, v246
 ds_write_b128 v247, v[144:147] offset:2048
 v_mul_f32 v148, v148, v244
 v_mul_f32 v149, v149, v244
 v_mul_f32 v150, v150, v244
 v_mul_f32 v151, v151, v244
 ds_write_b128 v247, v[148:151] offset:3072
 v_mul_f32 v152, v152, v245
 v_mul_f32 v153, v153, v245
 v_mul_f32 v154, v154, v245
 v_mul_f32 v155, v155, v245
 ds_write_b128 v247, v[152:155] offset:4096
 v_mul_f32 v156, v156, v246
 v_mul_f32 v157, v157, v246
 v_mul_f32 v158, v158, v246
 v_mul_f32 v159, v159, v246
 ds_write_b128 v247, v[156:159] offset:5120
 s_waitcnt lgkmcnt(0)
 s_barrier
 ds_read_b128 v[136:139], v248 offset:0
 ds_read_b128 v[148:151], v248 offset:3072
 ds_read_b128 v[140:143], v248 offset:1024
 ds_read_b128 v[152:155], v248 offset:4096
 ds_read_b128 v[144:147], v248 offset:2048
 ds_read_b128 v[156:159], v248 offset:5120
 s_waitcnt lgkmcnt(4)
 v_fma_f32 v112, v112, v244, v136
 v_fma_f32 v113, v113, v244, v137
 v_fma_f32 v114, v114, v244, v138
 v_fma_f32 v115, v115, v244, v139
 v_fma_f32 v124, v124, v244, v148
 v_fma_f32 v125, v125, v244, v149
 v_fma_f32 v126, v126, v244, v150
 v_fma_f32 v127, v127, v244, v151
 CV v112,v112,v113
 CV v113,v114,v115
 CV v114,v124,v125
 CV v115,v126,v127
 buffer_store_dwordx4 v[112:115], v250, s[60:63], s83 offen offset:0 sc1
 s_waitcnt lgkmcnt(2)
 v_fma_f32 v116, v116, v245, v140
 v_fma_f32 v117, v117, v245, v141
 v_fma_f32 v118, v118, v245, v142
 v_fma_f32 v119, v119, v245, v143
 v_fma_f32 v128, v128, v245, v152
 v_fma_f32 v129, v129, v245, v153
 v_fma_f32 v130, v130, v245, v154
 v_fma_f32 v131, v131, v245, v155
 CV v116,v116,v117
 CV v117,v118,v119
 CV v118,v128,v129
 CV v119,v130,v131
 buffer_store_dwordx4 v[116:119], v250, s[60:63], s83 offen offset:1024 sc1
 s_waitcnt lgkmcnt(0)
 v_fma_f32 v120, v120, v246, v144
 v_fma_f32 v121, v121, v246, v145
 v_fma_f32 v122, v122, v246, v146
 v_fma_f32 v123, v123, v246, v147
 v_fma_f32 v132, v132, v246, v156
 v_fma_f32 v133, v133, v246, v157
 v_fma_f32 v134, v134, v246, v158
 v_fma_f32 v135, v135, v246, v159
 CV v120,v120,v121
 CV v121,v122,v123
 CV v122,v132,v133
 CV v123,v134,v135
 buffer_store_dwordx4 v[120:123], v250, s[60:63], s83 offen offset:2048 sc1
 s_add_u32 s83, s83, 6144
 s_cmp_ge_u32 s83, 43008
 s_cselect_b32 s3, 43008, 0
 s_sub_u32 s83, s83, s3
 v_and_b32 v1, 63, v0
 v_and_b32 v5, 7, v1
 s_lshr_b32 s47, s6, 2
 s_lshl_b32 s88, s5, 10
 s_add_u32 s88, s88, 50331648
 s_lshl_b32 s87, s47, 7
 s_add_u32 s87, s87, s88
 v_lshl_add_u32 v2, v5, 2, s87
 global_load_dword v3, v2, s[30:31] sc1
 s_lshl_b32 s87, s47, 2
 s_add_u32 s87, s87, s88
 v_lshl_add_u32 v10, v5, 7, s87
 AR v11,a253
 AR v12,a254
 v_add_u32 v11, 1, v11
 s_lshl_b32 s40, 1, s47
 v_mov_b32 v13, s4
 v_mov_b32 v14, s40
 v_and_b32 v4, 15, v1
 v_lshrrev_b32 v5, 4, v1
 v_and_b32 v6, 1, v4
 v_lshlrev_b32 v6, 4, v6
 v_mov_b32 v7, 0x3f80
 v_lshlrev_b32 v6, v6, v7
 v_bfe_u32 v7, v4, 2, 1
 v_lshlrev_b32 v7, 1, v7
 v_lshrrev_b32 v8, 3, v4
 v_bfe_u32 v9, v4, 1, 1
 v_lshl_add_u32 v8, v8, 1, v9
 v_sub_u32 v9, v5, v7
 v_lshl_add_u32 v9, v9, 2, v8
 v_cmp_eq_u32 vcc, 0, v9
 s_nop 1
 v_cndmask_b32 v208, 0, v6, vcc
 v_cmp_eq_u32 vcc, 1, v9
 s_nop 1
 v_cndmask_b32 v209, 0, v6, vcc
 v_cmp_eq_u32 vcc, 2, v9
 s_nop 1
 v_cndmask_b32 v210, 0, v6, vcc
 v_cmp_eq_u32 vcc, 3, v9
 s_nop 1
 v_cndmask_b32 v211, 0, v6, vcc
 v_cmp_eq_u32 vcc, 4, v9
 s_nop 1
 v_cndmask_b32 v212, 0, v6, vcc
 v_cmp_eq_u32 vcc, 5, v9
 s_nop 1
 v_cndmask_b32 v213, 0, v6, vcc
 v_cmp_eq_u32 vcc, 6, v9
 s_nop 1
 v_cndmask_b32 v214, 0, v6, vcc
 v_cmp_eq_u32 vcc, 7, v9
 s_nop 1
 v_cndmask_b32 v215, 0, v6, vcc
 v_mul_u32_u24 v4, 1792, v4
 v_lshl_add_u32 v4, v5, 4, v4
 v_mov_b32 v216, 0
 v_mov_b32 v217, 0
 v_mov_b32 v218, 0
 v_mov_b32 v219, 0
 v_mov_b32 v220, 0
 v_mov_b32 v221, 0
 v_mov_b32 v222, 0
 v_mov_b32 v223, 0
 v_mov_b32 v224, 0
 v_mov_b32 v225, 0
 v_mov_b32 v226, 0
 v_mov_b32 v227, 0
 v_mov_b32 v228, 0
 v_mov_b32 v229, 0
 v_mov_b32 v230, 0
 v_mov_b32 v231, 0
 v_mov_b32 v232, 0
 v_mov_b32 v233, 0
 v_mov_b32 v234, 0
 v_mov_b32 v235, 0
 v_mov_b32 v236, 0
 v_mov_b32 v237, 0
 v_mov_b32 v238, 0
 v_mov_b32 v239, 0
 s_mov_b32 s36, s24
 s_mov_b32 s37, s25
 s_mov_b32 s38, 2752512
 s_mov_b32 s39, 0x20000
 s_mul_i32 s84, s5, 688128
 s_add_u32 s84, s84, 0
 s_add_u32 s32, s30, s84
 s_addc_u32 s33, s31, 0
 s_mov_b32 s35, 0x20000
 s_mov_b32 s34, 688128
 s_mul_i32 s84, s5, 172032
 s_add_u32 s85, s6, 0
 s_cmp_ge_u32 s85, 42
 s_cselect_b32 s86, 42, 0
 s_cselect_b32 s87, 86016, 0
 s_sub_u32 s85, s85, s86
 s_mul_i32 s86, s85, 43
 s_lshr_b32 s86, s86, 7
 s_mul_i32 s88, s86, 3
 s_sub_u32 s85, s85, s88
 s_mul_i32 s85, s85, 28672
 s_lshl_b32 s86, s86, 6
 s_add_u32 s85, s85, s86
 s_add_u32 s85, s85, s87
 s_add_u32 s44, s85, s84
 s_add_u32 s85, s6, 32
 s_cmp_ge_u32 s85, 42
 s_cselect_b32 s86, 42, 0
 s_cselect_b32 s87, 86016, 0
 s_sub_u32 s85, s85, s86
 s_mul_i32 s86, s85, 43
 s_lshr_b32 s86, s86, 7
 s_mul_i32 s88, s86, 3
 s_sub_u32 s85, s85, s88
 s_mul_i32 s85, s85, 28672
 s_lshl_b32 s86, s86, 6
 s_add_u32 s85, s85, s86
 s_add_u32 s85, s85, s87
 s_add_u32 s45, s85, s84
 s_add_u32 s85, s6, 64
 s_cmp_ge_u32 s85, 42
 s_cselect_b32 s86, 42, 0
 s_cselect_b32 s87, 86016, 0
 s_sub_u32 s85, s85, s86
 s_mul_i32 s86, s85, 43
 s_lshr_b32 s86, s86, 7
 s_mul_i32 s88, s86, 3
 s_sub_u32 s85, s85, s88
 s_mul_i32 s85, s85, 28672
 s_lshl_b32 s86, s86, 6
 s_add_u32 s85, s85, s86
 s_add_u32 s85, s85, s87
 s_add_u32 s46, s85, s84
 s_lshl_b32 s42, s6, 10
 v_add_u32 v15, 32768, v250
 v_add_u32 v9, 65536, v250
 s_waitcnt vmcnt(0)
 s_barrier
 s_cmp_lg_u32 s28, 0
 s_cbranch_scc1 LA_sig
 s_mov_b64 exec, 0xff
 global_store_dword v10, v11, s[30:31] sc1
 s_mov_b64 exec, 1
 global_atomic_or v13, v14, s[26:27]
 s_mov_b64 exec, -1
LA_sig:
 s_mov_b32 s43, 0
 s_mov_b32 s23, 0
 s_mov_b32 s48, s40
LA_round:
 v_cmp_ne_u32 vcc, v3, v12
 s_nop 1
 s_and_b32 s85, vcc_lo, 0xff
 s_or_b32 s48, s48, s85
 s_andn2_b32 s41, s48, s43
 s_cmp_eq_u32 s41, 0
 s_cbranch_scc1 LA_next
 s_bitcmp1_b32 s41, 0
 s_cbranch_scc0 LA_l0
 s_add_u32 s84, s42, 0
 buffer_load_dwordx4 v[16:19], v250, s[32:35], s84 offen sc1
 buffer_load_dwordx4 v[20:23], v15, s[32:35], s84 offen sc1
 s_cmp_ge_u32 s6, 20
 s_cbranch_scc1 LA_l0
 buffer_load_dwordx4 v[24:27], v9, s[32:35], s84 offen sc1
LA_l0:
 s_bitcmp1_b32 s41, 1
 s_cbranch_scc0 LA_l1
 s_add_u32 s84, s42, 86016
 buffer_load_dwordx4 v[28:31], v250, s[32:35], s84 offen sc1
 buffer_load_dwordx4 v[32:35], v15, s[32:35], s84 offen sc1
 s_cmp_ge_u32 s6, 20
 s_cbranch_scc1 LA_l1
 buffer_load_dwordx4 v[36:39], v9, s[32:35], s84 offen sc1
LA_l1:
 s_bitcmp1_b32 s41, 2
 s_cbranch_scc0 LA_l2
 s_add_u32 s84, s42, 172032
 buffer_load_dwordx4 v[40:43], v250, s[32:35], s84 offen sc1
 buffer_load_dwordx4 v[44:47], v15, s[32:35], s84 offen sc1
 s_cmp_ge_u32 s6, 20
 s_cbranch_scc1 LA_l2
 buffer_load_dwordx4 v[48:51], v9, s[32:35], s84 offen sc1
LA_l2:
 s_bitcmp1_b32 s41, 3
 s_cbranch_scc0 LA_l3
 s_add_u32 s84, s42, 258048
 buffer_load_dwordx4 v[52:55], v250, s[32:35], s84 offen sc1
 buffer_load_dwordx4 v[56:59], v15, s[32:35], s84 offen sc1
 s_cmp_ge_u32 s6, 20
 s_cbranch_scc1 LA_l3
 buffer_load_dwordx4 v[60:63], v9, s[32:35], s84 offen sc1
LA_l3:
 s_bitcmp1_b32 s41, 4
 s_cbranch_scc0 LA_l4
 s_add_u32 s84, s42, 344064
 buffer_load_dwordx4 v[64:67], v250, s[32:35], s84 offen sc1
 buffer_load_dwordx4 v[68:71], v15, s[32:35], s84 offen sc1
 s_cmp_ge_u32 s6, 20
 s_cbranch_scc1 LA_l4
 buffer_load_dwordx4 v[72:75], v9, s[32:35], s84 offen sc1
LA_l4:
 s_bitcmp1_b32 s41, 5
 s_cbranch_scc0 LA_l5
 s_add_u32 s84, s42, 430080
 buffer_load_dwordx4 v[76:79], v250, s[32:35], s84 offen sc1
 buffer_load_dwordx4 v[80:83], v15, s[32:35], s84 offen sc1
 s_cmp_ge_u32 s6, 20
 s_cbranch_scc1 LA_l5
 buffer_load_dwordx4 v[84:87], v9, s[32:35], s84 offen sc1
LA_l5:
 s_bitcmp1_b32 s41, 6
 s_cbranch_scc0 LA_l6
 s_add_u32 s84, s42, 516096
 buffer_load_dwordx4 v[88:91], v250, s[32:35], s84 offen sc1
 buffer_load_dwordx4 v[92:95], v15, s[32:35], s84 offen sc1
 s_cmp_ge_u32 s6, 20
 s_cbranch_scc1 LA_l6
 buffer_load_dwordx4 v[96:99], v9, s[32:35], s84 offen sc1
LA_l6:
 s_bitcmp1_b32 s41, 7
 s_cbranch_scc0 LA_l7
 s_add_u32 s84, s42, 602112
 buffer_load_dwordx4 v[100:103], v250, s[32:35], s84 offen sc1
 buffer_load_dwordx4 v[104:107], v15, s[32:35], s84 offen sc1
 s_cmp_ge_u32 s6, 20
 s_cbranch_scc1 LA_l7
 buffer_load_dwordx4 v[108:111], v9, s[32:35], s84 offen sc1
LA_l7:
 s_or_b32 s43, s43, s41
 s_cmp_eq_u32 s43, 0xff
 s_cbranch_scc1 LA_nopoll
 global_load_dword v3, v2, s[30:31] sc1
LA_nopoll:
 s_waitcnt vmcnt(0)
 s_bitcmp1_b32 s41, 0
 s_cbranch_scc0 LA_m0
 MM v[216:219],v[208:211],v[16:19],v[216:219]
 MM v[220:223],v[212:215],v[16:19],v[220:223]
 MM v[224:227],v[208:211],v[20:23],v[224:227]
 MM v[228:231],v[212:215],v[20:23],v[228:231]
 MM v[232:235],v[208:211],v[24:27],v[232:235]
 MM v[236:239],v[212:215],v[24:27],v[236:239]
LA_m0:
 s_bitcmp1_b32 s41, 1
 s_cbranch_scc0 LA_m1
 MM v[216:219],v[208:211],v[28:31],v[216:219]
 MM v[220:223],v[212:215],v[28:31],v[220:223]
 MM v[224:227],v[208:211],v[32:35],v[224:227]
 MM v[228:231],v[212:215],v[32:35],v[228:231]
 MM v[232:235],v[208:211],v[36:39],v[232:235]
 MM v[236:239],v[212:215],v[36:39],v[236:239]
LA_m1:
 s_bitcmp1_b32 s41, 2
 s_cbranch_scc0 LA_m2
 MM v[216:219],v[208:211],v[40:43],v[216:219]
 MM v[220:223],v[212:215],v[40:43],v[220:223]
 MM v[224:227],v[208:211],v[44:47],v[224:227]
 MM v[228:231],v[212:215],v[44:47],v[228:231]
 MM v[232:235],v[208:211],v[48:51],v[232:235]
 MM v[236:239],v[212:215],v[48:51],v[236:239]
LA_m2:
 s_bitcmp1_b32 s41, 3
 s_cbranch_scc0 LA_m3
 MM v[216:219],v[208:211],v[52:55],v[216:219]
 MM v[220:223],v[212:215],v[52:55],v[220:223]
 MM v[224:227],v[208:211],v[56:59],v[224:227]
 MM v[228:231],v[212:215],v[56:59],v[228:231]
 MM v[232:235],v[208:211],v[60:63],v[232:235]
 MM v[236:239],v[212:215],v[60:63],v[236:239]
LA_m3:
 s_bitcmp1_b32 s41, 4
 s_cbranch_scc0 LA_m4
 MM v[216:219],v[208:211],v[64:67],v[216:219]
 MM v[220:223],v[212:215],v[64:67],v[220:223]
 MM v[224:227],v[208:211],v[68:71],v[224:227]
 MM v[228:231],v[212:215],v[68:71],v[228:231]
 MM v[232:235],v[208:211],v[72:75],v[232:235]
 MM v[236:239],v[212:215],v[72:75],v[236:239]
LA_m4:
 s_bitcmp1_b32 s41, 5
 s_cbranch_scc0 LA_m5
 MM v[216:219],v[208:211],v[76:79],v[216:219]
 MM v[220:223],v[212:215],v[76:79],v[220:223]
 MM v[224:227],v[208:211],v[80:83],v[224:227]
 MM v[228:231],v[212:215],v[80:83],v[228:231]
 MM v[232:235],v[208:211],v[84:87],v[232:235]
 MM v[236:239],v[212:215],v[84:87],v[236:239]
LA_m5:
 s_bitcmp1_b32 s41, 6
 s_cbranch_scc0 LA_m6
 MM v[216:219],v[208:211],v[88:91],v[216:219]
 MM v[220:223],v[212:215],v[88:91],v[220:223]
 MM v[224:227],v[208:211],v[92:95],v[224:227]
 MM v[228:231],v[212:215],v[92:95],v[228:231]
 MM v[232:235],v[208:211],v[96:99],v[232:235]
 MM v[236:239],v[212:215],v[96:99],v[236:239]
LA_m6:
 s_bitcmp1_b32 s41, 7
 s_cbranch_scc0 LA_m7
 MM v[216:219],v[208:211],v[100:103],v[216:219]
 MM v[220:223],v[212:215],v[100:103],v[220:223]
 MM v[224:227],v[208:211],v[104:107],v[224:227]
 MM v[228:231],v[212:215],v[104:107],v[228:231]
 MM v[232:235],v[208:211],v[108:111],v[232:235]
 MM v[236:239],v[212:215],v[108:111],v[236:239]
LA_m7:
 s_cmp_eq_u32 s43, 0xff
 s_cbranch_scc1 LA_fin
 s_branch LA_round
LA_next:
 s_add_u32 s23, s23, 1
 s_cmp_ge_u32 s23, 100000
 s_cbranch_scc1 LA_fin
 s_sleep 2
 s_and_b32 s85, s23, 63
 s_cmp_lg_u32 s85, 0
 s_cbranch_scc1 LA_again
 global_load_dword v7, v13, s[26:27] sc1
 s_waitcnt vmcnt(0)
 v_readfirstlane_b32 s85, v7
 s_nop 1
 s_and_b32 s85, s85, 0xff
 s_or_b32 s48, s48, s85
LA_again:
 global_load_dword v3, v2, s[30:31] sc1
 s_waitcnt vmcnt(0)
 s_branch LA_round
LA_fin:
 s_nop 7
 CV v112,v216,v217
 CV v113,v218,v219
 CV v114,v220,v221
 CV v115,v222,v223
 buffer_store_dwordx4 v[112:115], v4, s[36:39], s44 offen offset:0
 CV v116,v224,v225
 CV v117,v226,v227
 CV v118,v228,v229
 CV v119,v230,v231
 buffer_store_dwordx4 v[116:119], v4, s[36:39], s45 offen offset:0
 s_cmp_ge_u32 s6, 20
 s_cbranch_scc1 LA_done
 CV v120,v232,v233
 CV v121,v234,v235
 CV v122,v236,v237
 CV v123,v238,v239
 buffer_store_dwordx4 v[120:123], v4, s[36:39], s46 offen offset:0
LA_done:
 s_endpgm
LA_t0:
 s_call_b64 s[86:87], L_rare1
 s_branch LA_r0
LA_t1:
 s_call_b64 s[86:87], L_rare0
 s_branch LA_r1
LA_t2:
 s_call_b64 s[86:87], L_rare1
 s_branch LA_r2
LA_t3:
 s_call_b64 s[86:87], L_rare0
 s_branch LA_r3
LA_t4:
 s_call_b64 s[86:87], L_rare1
 s_branch LA_r4
LA_t5:
 s_call_b64 s[86:87], L_rare0
 s_branch LA_r5
LA_t20:
 s_call_b64 s[86:87], L_rare1
 s_branch LA_r20
LA_t21:
 s_call_b64 s[86:87], L_rare0
 s_branch LA_r21
LA_t22:
 s_call_b64 s[86:87], L_rare1
 s_branch LA_r22
LA_t23:
 s_call_b64 s[86:87], L_rare0
 s_branch LA_r23
LA_t24:
 s_call_b64 s[86:87], L_rare1
 s_branch LA_r24
LA_t25:
 s_call_b64 s[86:87], L_rare0
 s_branch LA_r25
LA_t26:
 s_call_b64 s[86:87], L_rare1
 s_branch LA_r26
LA_t29:
 s_call_b64 s[86:87], L_rare0
 s_branch LA_r29
LA_t30:
 s_call_b64 s[86:87], L_rare1
 s_branch LA_r30
L_rare0:
 s_nop 7
 s_nop 1
 v_max3_f32 v196, v112, v113, v114
 v_max3_f32 v196, v196, v115, v124
 v_max3_f32 v196, v196, v125, v126
 v_max_f32 v196, v196, v127
 v_max3_f32 v197, v116, v117, v118
 v_max3_f32 v197, v197, v119, v128
 v_max3_f32 v197, v197, v129, v130
 v_max_f32 v197, v197, v131
 v_max3_f32 v198, v120, v121, v122
 v_max3_f32 v198, v198, v123, v132
 v_max3_f32 v198, v198, v133, v134
 v_max_f32 v198, v198, v135
 v_mov_b32 v200, v196
 v_mov_b32 v201, v197
 v_mov_b32 v202, v198
 v_permlane32_swap_b32 v196, v200
 v_permlane32_swap_b32 v197, v201
 v_permlane32_swap_b32 v198, v202
 v_max_f32 v196, v196, v200
 v_max_f32 v197, v197, v201
 v_max_f32 v198, v198, v202
 v_mov_b32 v200, v196
 v_mov_b32 v201, v197
 v_mov_b32 v202, v198
 v_permlane16_swap_b32 v196, v200
 v_permlane16_swap_b32 v197, v201
 v_permlane16_swap_b32 v198, v202
 v_max_f32 v196, v196, v200
 v_max_f32 v197, v197, v201
 v_max_f32 v198, v198, v202
 v_max_f32 v196, 0, v196
 v_max_f32 v197, 0, v197
 v_max_f32 v198, 0, v198
 v_exp_f32 v200, -v196
 v_exp_f32 v201, -v197
 v_exp_f32 v202, -v198
 v_sub_f32 v184, v184, v196
 v_sub_f32 v112, v112, v196
 v_sub_f32 v113, v113, v196
 v_sub_f32 v114, v114, v196
 v_sub_f32 v115, v115, v196
 v_sub_f32 v124, v124, v196
 v_sub_f32 v125, v125, v196
 v_sub_f32 v126, v126, v196
 v_sub_f32 v127, v127, v196
 v_sub_f32 v185, v185, v197
 v_sub_f32 v116, v116, v197
 v_sub_f32 v117, v117, v197
 v_sub_f32 v118, v118, v197
 v_sub_f32 v119, v119, v197
 v_sub_f32 v128, v128, v197
 v_sub_f32 v129, v129, v197
 v_sub_f32 v130, v130, v197
 v_sub_f32 v131, v131, v197
 v_sub_f32 v186, v186, v198
 v_sub_f32 v120, v120, v198
 v_sub_f32 v121, v121, v198
 v_sub_f32 v122, v122, v198
 v_sub_f32 v123, v123, v198
 v_sub_f32 v132, v132, v198
 v_sub_f32 v133, v133, v198
 v_sub_f32 v134, v134, v198
 v_sub_f32 v135, v135, v198
 AR v204,a0
 AR v205,a1
 AR v206,a2
 AR v207,a3
 v_mul_f32 v204, v204, v200
 v_mul_f32 v205, v205, v200
 v_mul_f32 v206, v206, v200
 v_mul_f32 v207, v207, v200
 AW a0,v204
 AW a1,v205
 AW a2,v206
 AW a3,v207
 AR v204,a12
 AR v205,a13
 AR v206,a14
 AR v207,a15
 v_mul_f32 v204, v204, v200
 v_mul_f32 v205, v205, v200
 v_mul_f32 v206, v206, v200
 v_mul_f32 v207, v207, v200
 AW a12,v204
 AW a13,v205
 AW a14,v206
 AW a15,v207
 AR v204,a24
 AR v205,a25
 AR v206,a26
 AR v207,a27
 v_mul_f32 v204, v204, v200
 v_mul_f32 v205, v205, v200
 v_mul_f32 v206, v206, v200
 v_mul_f32 v207, v207, v200
 AW a24,v204
 AW a25,v205
 AW a26,v206
 AW a27,v207
 AR v204,a36
 AR v205,a37
 AR v206,a38
 AR v207,a39
 v_mul_f32 v204, v204, v200
 v_mul_f32 v205, v205, v200
 v_mul_f32 v206, v206, v200
 v_mul_f32 v207, v207, v200
 AW a36,v204
 AW a37,v205
 AW a38,v206
 AW a39,v207
 AR v204,a48
 AR v205,a49
 AR v206,a50
 AR v207,a51
 v_mul_f32 v204, v204, v200
 v_mul_f32 v205, v205, v200
 v_mul_f32 v206, v206, v200
 v_mul_f32 v207, v207, v200
 AW a48,v204
 AW a49,v205
 AW a50,v206
 AW a51,v207
 AR v204,a60
 AR v205,a61
 AR v206,a62
 AR v207,a63
 v_mul_f32 v204, v204, v200
 v_mul_f32 v205, v205, v200
 v_mul_f32 v206, v206, v200
 v_mul_f32 v207, v207, v200
 AW a60,v204
 AW a61,v205
 AW a62,v206
 AW a63,v207
 AR v204,a72
 AR v205,a73
 AR v206,a74
 AR v207,a75
 v_mul_f32 v204, v204, v200
 v_mul_f32 v205, v205, v200
 v_mul_f32 v206, v206, v200
 v_mul_f32 v207, v207, v200
 AW a72,v204
 AW a73,v205
 AW a74,v206
 AW a75,v207
 AR v204,a84
 AR v205,a85
 AR v206,a86
 AR v207,a87
 v_mul_f32 v204, v204, v200
 v_mul_f32 v205, v205, v200
 v_mul_f32 v206, v206, v200
 v_mul_f32 v207, v207, v200
 AW a84,v204
 AW a85,v205
 AW a86,v206
 AW a87,v207
 AR v204,a96
 AR v205,a97
 AR v206,a98
 AR v207,a99
 v_mul_f32 v204, v204, v200
 v_mul_f32 v205, v205, v200
 v_mul_f32 v206, v206, v200
 v_mul_f32 v207, v207, v200
 AW a96,v204
 AW a97,v205
 AW a98,v206
 AW a99,v207
 AR v204,a108
 AR v205,a109
 AR v206,a110
 AR v207,a111
 v_mul_f32 v204, v204, v200
 v_mul_f32 v205, v205, v200
 v_mul_f32 v206, v206, v200
 v_mul_f32 v207, v207, v200
 AW a108,v204
 AW a109,v205
 AW a110,v206
 AW a111,v207
 AR v204,a120
 AR v205,a121
 AR v206,a122
 AR v207,a123
 v_mul_f32 v204, v204, v200
 v_mul_f32 v205, v205, v200
 v_mul_f32 v206, v206, v200
 v_mul_f32 v207, v207, v200
 AW a120,v204
 AW a121,v205
 AW a122,v206
 AW a123,v207
 AR v204,a132
 AR v205,a133
 AR v206,a134
 AR v207,a135
 v_mul_f32 v204, v204, v200
 v_mul_f32 v205, v205, v200
 v_mul_f32 v206, v206, v200
 v_mul_f32 v207, v207, v200
 AW a132,v204
 AW a133,v205
 AW a134,v206
 AW a135,v207
 AR v204,a144
 AR v205,a145
 AR v206,a146
 AR v207,a147
 v_mul_f32 v204, v204, v200
 v_mul_f32 v205, v205, v200
 v_mul_f32 v206, v206, v200
 v_mul_f32 v207, v207, v200
 AW a144,v204
 AW a145,v205
 AW a146,v206
 AW a147,v207
 AR v204,a156
 AR v205,a157
 AR v206,a158
 AR v207,a159
 v_mul_f32 v204, v204, v200
 v_mul_f32 v205, v205, v200
 v_mul_f32 v206, v206, v200
 v_mul_f32 v207, v207, v200
 AW a156,v204
 AW a157,v205
 AW a158,v206
 AW a159,v207
 AR v204,a168
 AR v205,a169
 AR v206,a170
 AR v207,a171
 v_mul_f32 v204, v204, v200
 v_mul_f32 v205, v205, v200
 v_mul_f32 v206, v206, v200
 v_mul_f32 v207, v207, v200
 AW a168,v204
 AW a169,v205
 AW a170,v206
 AW a171,v207
 AR v204,a180
 AR v205,a181
 AR v206,a182
 AR v207,a183
 v_mul_f32 v204, v204, v200
 v_mul_f32 v205, v205, v200
 v_mul_f32 v206, v206, v200
 v_mul_f32 v207, v207, v200
 AW a180,v204
 AW a181,v205
 AW a182,v206
 AW a183,v207
 AR v204,a192
 AR v205,a193
 AR v206,a194
 AR v207,a195
 v_mul_f32 v204, v204, v200
 v_mul_f32 v205, v205, v200
 v_mul_f32 v206, v206, v200
 v_mul_f32 v207, v207, v200
 AW a192,v204
 AW a193,v205
 AW a194,v206
 AW a195,v207
 AR v204,a4
 AR v205,a5
 AR v206,a6
 AR v207,a7
 v_mul_f32 v204, v204, v201
 v_mul_f32 v205, v205, v201
 v_mul_f32 v206, v206, v201
 v_mul_f32 v207, v207, v201
 AW a4,v204
 AW a5,v205
 AW a6,v206
 AW a7,v207
 AR v204,a16
 AR v205,a17
 AR v206,a18
 AR v207,a19
 v_mul_f32 v204, v204, v201
 v_mul_f32 v205, v205, v201
 v_mul_f32 v206, v206, v201
 v_mul_f32 v207, v207, v201
 AW a16,v204
 AW a17,v205
 AW a18,v206
 AW a19,v207
 AR v204,a28
 AR v205,a29
 AR v206,a30
 AR v207,a31
 v_mul_f32 v204, v204, v201
 v_mul_f32 v205, v205, v201
 v_mul_f32 v206, v206, v201
 v_mul_f32 v207, v207, v201
 AW a28,v204
 AW a29,v205
 AW a30,v206
 AW a31,v207
 AR v204,a40
 AR v205,a41
 AR v206,a42
 AR v207,a43
 v_mul_f32 v204, v204, v201
 v_mul_f32 v205, v205, v201
 v_mul_f32 v206, v206, v201
 v_mul_f32 v207, v207, v201
 AW a40,v204
 AW a41,v205
 AW a42,v206
 AW a43,v207
 AR v204,a52
 AR v205,a53
 AR v206,a54
 AR v207,a55
 v_mul_f32 v204, v204, v201
 v_mul_f32 v205, v205, v201
 v_mul_f32 v206, v206, v201
 v_mul_f32 v207, v207, v201
 AW a52,v204
 AW a53,v205
 AW a54,v206
 AW a55,v207
 AR v204,a64
 AR v205,a65
 AR v206,a66
 AR v207,a67
 v_mul_f32 v204, v204, v201
 v_mul_f32 v205, v205, v201
 v_mul_f32 v206, v206, v201
 v_mul_f32 v207, v207, v201
 AW a64,v204
 AW a65,v205
 AW a66,v206
 AW a67,v207
 AR v204,a76
 AR v205,a77
 AR v206,a78
 AR v207,a79
 v_mul_f32 v204, v204, v201
 v_mul_f32 v205, v205, v201
 v_mul_f32 v206, v206, v201
 v_mul_f32 v207, v207, v201
 AW a76,v204
 AW a77,v205
 AW a78,v206
 AW a79,v207
 AR v204,a88
 AR v205,a89
 AR v206,a90
 AR v207,a91
 v_mul_f32 v204, v204, v201
 v_mul_f32 v205, v205, v201
 v_mul_f32 v206, v206, v201
 v_mul_f32 v207, v207, v201
 AW a88,v204
 AW a89,v205
 AW a90,v206
 AW a91,v207
 AR v204,a100
 AR v205,a101
 AR v206,a102
 AR v207,a103
 v_mul_f32 v204, v204, v201
 v_mul_f32 v205, v205, v201
 v_mul_f32 v206, v206, v201
 v_mul_f32 v207, v207, v201
 AW a100,v204
 AW a101,v205
 AW a102,v206
 AW a103,v207
 AR v204,a112
 AR v205,a113
 AR v206,a114
 AR v207,a115
 v_mul_f32 v204, v204, v201
 v_mul_f32 v205, v205, v201
 v_mul_f32 v206, v206, v201
 v_mul_f32 v207, v207, v201
 AW a112,v204
 AW a113,v205
 AW a114,v206
 AW a115,v207
 AR v204,a124
 AR v205,a125
 AR v206,a126
 AR v207,a127
 v_mul_f32 v204, v204, v201
 v_mul_f32 v205, v205, v201
 v_mul_f32 v206, v206, v201
 v_mul_f32 v207, v207, v201
 AW a124,v204
 AW a125,v205
 AW a126,v206
 AW a127,v207
 AR v204,a136
 AR v205,a137
 AR v206,a138
 AR v207,a139
 v_mul_f32 v204, v204, v201
 v_mul_f32 v205, v205, v201
 v_mul_f32 v206, v206, v201
 v_mul_f32 v207, v207, v201
 AW a136,v204
 AW a137,v205
 AW a138,v206
 AW a139,v207
 AR v204,a148
 AR v205,a149
 AR v206,a150
 AR v207,a151
 v_mul_f32 v204, v204, v201
 v_mul_f32 v205, v205, v201
 v_mul_f32 v206, v206, v201
 v_mul_f32 v207, v207, v201
 AW a148,v204
 AW a149,v205
 AW a150,v206
 AW a151,v207
 AR v204,a160
 AR v205,a161
 AR v206,a162
 AR v207,a163
 v_mul_f32 v204, v204, v201
 v_mul_f32 v205, v205, v201
 v_mul_f32 v206, v206, v201
 v_mul_f32 v207, v207, v201
 AW a160,v204
 AW a161,v205
 AW a162,v206
 AW a163,v207
 AR v204,a172
 AR v205,a173
 AR v206,a174
 AR v207,a175
 v_mul_f32 v204, v204, v201
 v_mul_f32 v205, v205, v201
 v_mul_f32 v206, v206, v201
 v_mul_f32 v207, v207, v201
 AW a172,v204
 AW a173,v205
 AW a174,v206
 AW a175,v207
 AR v204,a184
 AR v205,a185
 AR v206,a186
 AR v207,a187
 v_mul_f32 v204, v204, v201
 v_mul_f32 v205, v205, v201
 v_mul_f32 v206, v206, v201
 v_mul_f32 v207, v207, v201
 AW a184,v204
 AW a185,v205
 AW a186,v206
 AW a187,v207
 AR v204,a196
 AR v205,a197
 AR v206,a198
 AR v207,a199
 v_mul_f32 v204, v204, v201
 v_mul_f32 v205, v205, v201
 v_mul_f32 v206, v206, v201
 v_mul_f32 v207, v207, v201
 AW a196,v204
 AW a197,v205
 AW a198,v206
 AW a199,v207
 AR v204,a8
 AR v205,a9
 AR v206,a10
 AR v207,a11
 v_mul_f32 v204, v204, v202
 v_mul_f32 v205, v205, v202
 v_mul_f32 v206, v206, v202
 v_mul_f32 v207, v207, v202
 AW a8,v204
 AW a9,v205
 AW a10,v206
 AW a11,v207
 AR v204,a20
 AR v205,a21
 AR v206,a22
 AR v207,a23
 v_mul_f32 v204, v204, v202
 v_mul_f32 v205, v205, v202
 v_mul_f32 v206, v206, v202
 v_mul_f32 v207, v207, v202
 AW a20,v204
 AW a21,v205
 AW a22,v206
 AW a23,v207
 AR v204,a32
 AR v205,a33
 AR v206,a34
 AR v207,a35
 v_mul_f32 v204, v204, v202
 v_mul_f32 v205, v205, v202
 v_mul_f32 v206, v206, v202
 v_mul_f32 v207, v207, v202
 AW a32,v204
 AW a33,v205
 AW a34,v206
 AW a35,v207
 AR v204,a44
 AR v205,a45
 AR v206,a46
 AR v207,a47
 v_mul_f32 v204, v204, v202
 v_mul_f32 v205, v205, v202
 v_mul_f32 v206, v206, v202
 v_mul_f32 v207, v207, v202
 AW a44,v204
 AW a45,v205
 AW a46,v206
 AW a47,v207
 AR v204,a56
 AR v205,a57
 AR v206,a58
 AR v207,a59
 v_mul_f32 v204, v204, v202
 v_mul_f32 v205, v205, v202
 v_mul_f32 v206, v206, v202
 v_mul_f32 v207, v207, v202
 AW a56,v204
 AW a57,v205
 AW a58,v206
 AW a59,v207
 AR v204,a68
 AR v205,a69
 AR v206,a70
 AR v207,a71
 v_mul_f32 v204, v204, v202
 v_mul_f32 v205, v205, v202
 v_mul_f32 v206, v206, v202
 v_mul_f32 v207, v207, v202
 AW a68,v204
 AW a69,v205
 AW a70,v206
 AW a71,v207
 AR v204,a80
 AR v205,a81
 AR v206,a82
 AR v207,a83
 v_mul_f32 v204, v204, v202
 v_mul_f32 v205, v205, v202
 v_mul_f32 v206, v206, v202
 v_mul_f32 v207, v207, v202
 AW a80,v204
 AW a81,v205
 AW a82,v206
 AW a83,v207
 AR v204,a92
 AR v205,a93
 AR v206,a94
 AR v207,a95
 v_mul_f32 v204, v204, v202
 v_mul_f32 v205, v205, v202
 v_mul_f32 v206, v206, v202
 v_mul_f32 v207, v207, v202
 AW a92,v204
 AW a93,v205
 AW a94,v206
 AW a95,v207
 AR v204,a104
 AR v205,a105
 AR v206,a106
 AR v207,a107
 v_mul_f32 v204, v204, v202
 v_mul_f32 v205, v205, v202
 v_mul_f32 v206, v206, v202
 v_mul_f32 v207, v207, v202
 AW a104,v204
 AW a105,v205
 AW a106,v206
 AW a107,v207
 AR v204,a116
 AR v205,a117
 AR v206,a118
 AR v207,a119
 v_mul_f32 v204, v204, v202
 v_mul_f32 v205, v205, v202
 v_mul_f32 v206, v206, v202
 v_mul_f32 v207, v207, v202
 AW a116,v204
 AW a117,v205
 AW a118,v206
 AW a119,v207
 AR v204,a128
 AR v205,a129
 AR v206,a130
 AR v207,a131
 v_mul_f32 v204, v204, v202
 v_mul_f32 v205, v205, v202
 v_mul_f32 v206, v206, v202
 v_mul_f32 v207, v207, v202
 AW a128,v204
 AW a129,v205
 AW a130,v206
 AW a131,v207
 AR v204,a140
 AR v205,a141
 AR v206,a142
 AR v207,a143
 v_mul_f32 v204, v204, v202
 v_mul_f32 v205, v205, v202
 v_mul_f32 v206, v206, v202
 v_mul_f32 v207, v207, v202
 AW a140,v204
 AW a141,v205
 AW a142,v206
 AW a143,v207
 AR v204,a152
 AR v205,a153
 AR v206,a154
 AR v207,a155
 v_mul_f32 v204, v204, v202
 v_mul_f32 v205, v205, v202
 v_mul_f32 v206, v206, v202
 v_mul_f32 v207, v207, v202
 AW a152,v204
 AW a153,v205
 AW a154,v206
 AW a155,v207
 AR v204,a164
 AR v205,a165
 AR v206,a166
 AR v207,a167
 v_mul_f32 v204, v204, v202
 v_mul_f32 v205, v205, v202
 v_mul_f32 v206, v206, v202
 v_mul_f32 v207, v207, v202
 AW a164,v204
 AW a165,v205
 AW a166,v206
 AW a167,v207
 AR v204,a176
 AR v205,a177
 AR v206,a178
 AR v207,a179
 v_mul_f32 v204, v204, v202
 v_mul_f32 v205, v205, v202
 v_mul_f32 v206, v206, v202
 v_mul_f32 v207, v207, v202
 AW a176,v204
 AW a177,v205
 AW a178,v206
 AW a179,v207
 AR v204,a188
 AR v205,a189
 AR v206,a190
 AR v207,a191
 v_mul_f32 v204, v204, v202
 v_mul_f32 v205, v205, v202
 v_mul_f32 v206, v206, v202
 v_mul_f32 v207, v207, v202
 AW a188,v204
 AW a189,v205
 AW a190,v206
 AW a191,v207
 AR v204,a200
 AR v205,a201
 AR v206,a202
 AR v207,a203
 v_mul_f32 v204, v204, v202
 v_mul_f32 v205, v205, v202
 v_mul_f32 v206, v206, v202
 v_mul_f32 v207, v207, v202
 AW a200,v204
 AW a201,v205
 AW a202,v206
 AW a203,v207
 s_nop 1
 s_setpc_b64 s[86:87]
L_rare1:
 s_nop 7
 s_nop 1
 v_max3_f32 v196, v136, v137, v138
 v_max3_f32 v196, v196, v139, v148
 v_max3_f32 v196, v196, v149, v150
 v_max_f32 v196, v196, v151
 v_max3_f32 v197, v140, v141, v142
 v_max3_f32 v197, v197, v143, v152
 v_max3_f32 v197, v197, v153, v154
 v_max_f32 v197, v197, v155
 v_max3_f32 v198, v144, v145, v146
 v_max3_f32 v198, v198, v147, v156
 v_max3_f32 v198, v198, v157, v158
 v_max_f32 v198, v198, v159
 v_mov_b32 v200, v196
 v_mov_b32 v201, v197
 v_mov_b32 v202, v198
 v_permlane32_swap_b32 v196, v200
 v_permlane32_swap_b32 v197, v201
 v_permlane32_swap_b32 v198, v202
 v_max_f32 v196, v196, v200
 v_max_f32 v197, v197, v201
 v_max_f32 v198, v198, v202
 v_mov_b32 v200, v196
 v_mov_b32 v201, v197
 v_mov_b32 v202, v198
 v_permlane16_swap_b32 v196, v200
 v_permlane16_swap_b32 v197, v201
 v_permlane16_swap_b32 v198, v202
 v_max_f32 v196, v196, v200
 v_max_f32 v197, v197, v201
 v_max_f32 v198, v198, v202
 v_max_f32 v196, 0, v196
 v_max_f32 v197, 0, v197
 v_max_f32 v198, 0, v198
 v_exp_f32 v200, -v196
 v_exp_f32 v201, -v197
 v_exp_f32 v202, -v198
 v_sub_f32 v184, v184, v196
 v_sub_f32 v136, v136, v196
 v_sub_f32 v137, v137, v196
 v_sub_f32 v138, v138, v196
 v_sub_f32 v139, v139, v196
 v_sub_f32 v148, v148, v196
 v_sub_f32 v149, v149, v196
 v_sub_f32 v150, v150, v196
 v_sub_f32 v151, v151, v196
 v_sub_f32 v185, v185, v197
 v_sub_f32 v140, v140, v197
 v_sub_f32 v141, v141, v197
 v_sub_f32 v142, v142, v197
 v_sub_f32 v143, v143, v197
 v_sub_f32 v152, v152, v197
 v_sub_f32 v153, v153, v197
 v_sub_f32 v154, v154, v197
 v_sub_f32 v155, v155, v197
 v_sub_f32 v186, v186, v198
 v_sub_f32 v144, v144, v198
 v_sub_f32 v145, v145, v198
 v_sub_f32 v146, v146, v198
 v_sub_f32 v147, v147, v198
 v_sub_f32 v156, v156, v198
 v_sub_f32 v157, v157, v198
 v_sub_f32 v158, v158, v198
 v_sub_f32 v159, v159, v198
 AR v204,a0
 AR v205,a1
 AR v206,a2
 AR v207,a3
 v_mul_f32 v204, v204, v200
 v_mul_f32 v205, v205, v200
 v_mul_f32 v206, v206, v200
 v_mul_f32 v207, v207, v200
 AW a0,v204
 AW a1,v205
 AW a2,v206
 AW a3,v207
 AR v204,a12
 AR v205,a13
 AR v206,a14
 AR v207,a15
 v_mul_f32 v204, v204, v200
 v_mul_f32 v205, v205, v200
 v_mul_f32 v206, v206, v200
 v_mul_f32 v207, v207, v200
 AW a12,v204
 AW a13,v205
 AW a14,v206
 AW a15,v207
 AR v204,a24
 AR v205,a25
 AR v206,a26
 AR v207,a27
 v_mul_f32 v204, v204, v200
 v_mul_f32 v205, v205, v200
 v_mul_f32 v206, v206, v200
 v_mul_f32 v207, v207, v200
 AW a24,v204
 AW a25,v205
 AW a26,v206
 AW a27,v207
 AR v204,a36
 AR v205,a37
 AR v206,a38
 AR v207,a39
 v_mul_f32 v204, v204, v200
 v_mul_f32 v205, v205, v200
 v_mul_f32 v206, v206, v200
 v_mul_f32 v207, v207, v200
 AW a36,v204
 AW a37,v205
 AW a38,v206
 AW a39,v207
 AR v204,a48
 AR v205,a49
 AR v206,a50
 AR v207,a51
 v_mul_f32 v204, v204, v200
 v_mul_f32 v205, v205, v200
 v_mul_f32 v206, v206, v200
 v_mul_f32 v207, v207, v200
 AW a48,v204
 AW a49,v205
 AW a50,v206
 AW a51,v207
 AR v204,a60
 AR v205,a61
 AR v206,a62
 AR v207,a63
 v_mul_f32 v204, v204, v200
 v_mul_f32 v205, v205, v200
 v_mul_f32 v206, v206, v200
 v_mul_f32 v207, v207, v200
 AW a60,v204
 AW a61,v205
 AW a62,v206
 AW a63,v207
 AR v204,a72
 AR v205,a73
 AR v206,a74
 AR v207,a75
 v_mul_f32 v204, v204, v200
 v_mul_f32 v205, v205, v200
 v_mul_f32 v206, v206, v200
 v_mul_f32 v207, v207, v200
 AW a72,v204
 AW a73,v205
 AW a74,v206
 AW a75,v207
 AR v204,a84
 AR v205,a85
 AR v206,a86
 AR v207,a87
 v_mul_f32 v204, v204, v200
 v_mul_f32 v205, v205, v200
 v_mul_f32 v206, v206, v200
 v_mul_f32 v207, v207, v200
 AW a84,v204
 AW a85,v205
 AW a86,v206
 AW a87,v207
 AR v204,a96
 AR v205,a97
 AR v206,a98
 AR v207,a99
 v_mul_f32 v204, v204, v200
 v_mul_f32 v205, v205, v200
 v_mul_f32 v206, v206, v200
 v_mul_f32 v207, v207, v200
 AW a96,v204
 AW a97,v205
 AW a98,v206
 AW a99,v207
 AR v204,a108
 AR v205,a109
 AR v206,a110
 AR v207,a111
 v_mul_f32 v204, v204, v200
 v_mul_f32 v205, v205, v200
 v_mul_f32 v206, v206, v200
 v_mul_f32 v207, v207, v200
 AW a108,v204
 AW a109,v205
 AW a110,v206
 AW a111,v207
 AR v204,a120
 AR v205,a121
 AR v206,a122
 AR v207,a123
 v_mul_f32 v204, v204, v200
 v_mul_f32 v205, v205, v200
 v_mul_f32 v206, v206, v200
 v_mul_f32 v207, v207, v200
 AW a120,v204
 AW a121,v205
 AW a122,v206
 AW a123,v207
 AR v204,a132
 AR v205,a133
 AR v206,a134
 AR v207,a135
 v_mul_f32 v204, v204, v200
 v_mul_f32 v205, v205, v200
 v_mul_f32 v206, v206, v200
 v_mul_f32 v207, v207, v200
 AW a132,v204
 AW a133,v205
 AW a134,v206
 AW a135,v207
 AR v204,a144
 AR v205,a145
 AR v206,a146
 AR v207,a147
 v_mul_f32 v204, v204, v200
 v_mul_f32 v205, v205, v200
 v_mul_f32 v206, v206, v200
 v_mul_f32 v207, v207, v200
 AW a144,v204
 AW a145,v205
 AW a146,v206
 AW a147,v207
 AR v204,a156
 AR v205,a157
 AR v206,a158
 AR v207,a159
 v_mul_f32 v204, v204, v200
 v_mul_f32 v205, v205, v200
 v_mul_f32 v206, v206, v200
 v_mul_f32 v207, v207, v200
 AW a156,v204
 AW a157,v205
 AW a158,v206
 AW a159,v207
 AR v204,a168
 AR v205,a169
 AR v206,a170
 AR v207,a171
 v_mul_f32 v204, v204, v200
 v_mul_f32 v205, v205, v200
 v_mul_f32 v206, v206, v200
 v_mul_f32 v207, v207, v200
 AW a168,v204
 AW a169,v205
 AW a170,v206
 AW a171,v207
 AR v204,a180
 AR v205,a181
 AR v206,a182
 AR v207,a183
 v_mul_f32 v204, v204, v200
 v_mul_f32 v205, v205, v200
 v_mul_f32 v206, v206, v200
 v_mul_f32 v207, v207, v200
 AW a180,v204
 AW a181,v205
 AW a182,v206
 AW a183,v207
 AR v204,a192
 AR v205,a193
 AR v206,a194
 AR v207,a195
 v_mul_f32 v204, v204, v200
 v_mul_f32 v205, v205, v200
 v_mul_f32 v206, v206, v200
 v_mul_f32 v207, v207, v200
 AW a192,v204
 AW a193,v205
 AW a194,v206
 AW a195,v207
 AR v204,a4
 AR v205,a5
 AR v206,a6
 AR v207,a7
 v_mul_f32 v204, v204, v201
 v_mul_f32 v205, v205, v201
 v_mul_f32 v206, v206, v201
 v_mul_f32 v207, v207, v201
 AW a4,v204
 AW a5,v205
 AW a6,v206
 AW a7,v207
 AR v204,a16
 AR v205,a17
 AR v206,a18
 AR v207,a19
 v_mul_f32 v204, v204, v201
 v_mul_f32 v205, v205, v201
 v_mul_f32 v206, v206, v201
 v_mul_f32 v207, v207, v201
 AW a16,v204
 AW a17,v205
 AW a18,v206
 AW a19,v207
 AR v204,a28
 AR v205,a29
 AR v206,a30
 AR v207,a31
 v_mul_f32 v204, v204, v201
 v_mul_f32 v205, v205, v201
 v_mul_f32 v206, v206, v201
 v_mul_f32 v207, v207, v201
 AW a28,v204
 AW a29,v205
 AW a30,v206
 AW a31,v207
 AR v204,a40
 AR v205,a41
 AR v206,a42
 AR v207,a43
 v_mul_f32 v204, v204, v201
 v_mul_f32 v205, v205, v201
 v_mul_f32 v206, v206, v201
 v_mul_f32 v207, v207, v201
 AW a40,v204
 AW a41,v205
 AW a42,v206
 AW a43,v207
 AR v204,a52
 AR v205,a53
 AR v206,a54
 AR v207,a55
 v_mul_f32 v204, v204, v201
 v_mul_f32 v205, v205, v201
 v_mul_f32 v206, v206, v201
 v_mul_f32 v207, v207, v201
 AW a52,v204
 AW a53,v205
 AW a54,v206
 AW a55,v207
 AR v204,a64
 AR v205,a65
 AR v206,a66
 AR v207,a67
 v_mul_f32 v204, v204, v201
 v_mul_f32 v205, v205, v201
 v_mul_f32 v206, v206, v201
 v_mul_f32 v207, v207, v201
 AW a64,v204
 AW a65,v205
 AW a66,v206
 AW a67,v207
 AR v204,a76
 AR v205,a77
 AR v206,a78
 AR v207,a79
 v_mul_f32 v204, v204, v201
 v_mul_f32 v205, v205, v201
 v_mul_f32 v206, v206, v201
 v_mul_f32 v207, v207, v201
 AW a76,v204
 AW a77,v205
 AW a78,v206
 AW a79,v207
 AR v204,a88
 AR v205,a89
 AR v206,a90
 AR v207,a91
 v_mul_f32 v204, v204, v201
 v_mul_f32 v205, v205, v201
 v_mul_f32 v206, v206, v201
 v_mul_f32 v207, v207, v201
 AW a88,v204
 AW a89,v205
 AW a90,v206
 AW a91,v207
 AR v204,a100
 AR v205,a101
 AR v206,a102
 AR v207,a103
 v_mul_f32 v204, v204, v201
 v_mul_f32 v205, v205, v201
 v_mul_f32 v206, v206, v201
 v_mul_f32 v207, v207, v201
 AW a100,v204
 AW a101,v205
 AW a102,v206
 AW a103,v207
 AR v204,a112
 AR v205,a113
 AR v206,a114
 AR v207,a115
 v_mul_f32 v204, v204, v201
 v_mul_f32 v205, v205, v201
 v_mul_f32 v206, v206, v201
 v_mul_f32 v207, v207, v201
 AW a112,v204
 AW a113,v205
 AW a114,v206
 AW a115,v207
 AR v204,a124
 AR v205,a125
 AR v206,a126
 AR v207,a127
 v_mul_f32 v204, v204, v201
 v_mul_f32 v205, v205, v201
 v_mul_f32 v206, v206, v201
 v_mul_f32 v207, v207, v201
 AW a124,v204
 AW a125,v205
 AW a126,v206
 AW a127,v207
 AR v204,a136
 AR v205,a137
 AR v206,a138
 AR v207,a139
 v_mul_f32 v204, v204, v201
 v_mul_f32 v205, v205, v201
 v_mul_f32 v206, v206, v201
 v_mul_f32 v207, v207, v201
 AW a136,v204
 AW a137,v205
 AW a138,v206
 AW a139,v207
 AR v204,a148
 AR v205,a149
 AR v206,a150
 AR v207,a151
 v_mul_f32 v204, v204, v201
 v_mul_f32 v205, v205, v201
 v_mul_f32 v206, v206, v201
 v_mul_f32 v207, v207, v201
 AW a148,v204
 AW a149,v205
 AW a150,v206
 AW a151,v207
 AR v204,a160
 AR v205,a161
 AR v206,a162
 AR v207,a163
 v_mul_f32 v204, v204, v201
 v_mul_f32 v205, v205, v201
 v_mul_f32 v206, v206, v201
 v_mul_f32 v207, v207, v201
 AW a160,v204
 AW a161,v205
 AW a162,v206
 AW a163,v207
 AR v204,a172
 AR v205,a173
 AR v206,a174
 AR v207,a175
 v_mul_f32 v204, v204, v201
 v_mul_f32 v205, v205, v201
 v_mul_f32 v206, v206, v201
 v_mul_f32 v207, v207, v201
 AW a172,v204
 AW a173,v205
 AW a174,v206
 AW a175,v207
 AR v204,a184
 AR v205,a185
 AR v206,a186
 AR v207,a187
 v_mul_f32 v204, v204, v201
 v_mul_f32 v205, v205, v201
 v_mul_f32 v206, v206, v201
 v_mul_f32 v207, v207, v201
 AW a184,v204
 AW a185,v205
 AW a186,v206
 AW a187,v207
 AR v204,a196
 AR v205,a197
 AR v206,a198
 AR v207,a199
 v_mul_f32 v204, v204, v201
 v_mul_f32 v205, v205, v201
 v_mul_f32 v206, v206, v201
 v_mul_f32 v207, v207, v201
 AW a196,v204
 AW a197,v205
 AW a198,v206
 AW a199,v207
 AR v204,a8
 AR v205,a9
 AR v206,a10
 AR v207,a11
 v_mul_f32 v204, v204, v202
 v_mul_f32 v205, v205, v202
 v_mul_f32 v206, v206, v202
 v_mul_f32 v207, v207, v202
 AW a8,v204
 AW a9,v205
 AW a10,v206
 AW a11,v207
 AR v204,a20
 AR v205,a21
 AR v206,a22
 AR v207,a23
 v_mul_f32 v204, v204, v202
 v_mul_f32 v205, v205, v202
 v_mul_f32 v206, v206, v202
 v_mul_f32 v207, v207, v202
 AW a20,v204
 AW a21,v205
 AW a22,v206
 AW a23,v207
 AR v204,a32
 AR v205,a33
 AR v206,a34
 AR v207,a35
 v_mul_f32 v204, v204, v202
 v_mul_f32 v205, v205, v202
 v_mul_f32 v206, v206, v202
 v_mul_f32 v207, v207, v202
 AW a32,v204
 AW a33,v205
 AW a34,v206
 AW a35,v207
 AR v204,a44
 AR v205,a45
 AR v206,a46
 AR v207,a47
 v_mul_f32 v204, v204, v202
 v_mul_f32 v205, v205, v202
 v_mul_f32 v206, v206, v202
 v_mul_f32 v207, v207, v202
 AW a44,v204
 AW a45,v205
 AW a46,v206
 AW a47,v207
 AR v204,a56
 AR v205,a57
 AR v206,a58
 AR v207,a59
 v_mul_f32 v204, v204, v202
 v_mul_f32 v205, v205, v202
 v_mul_f32 v206, v206, v202
 v_mul_f32 v207, v207, v202
 AW a56,v204
 AW a57,v205
 AW a58,v206
 AW a59,v207
 AR v204,a68
 AR v205,a69
 AR v206,a70
 AR v207,a71
 v_mul_f32 v204, v204, v202
 v_mul_f32 v205, v205, v202
 v_mul_f32 v206, v206, v202
 v_mul_f32 v207, v207, v202
 AW a68,v204
 AW a69,v205
 AW a70,v206
 AW a71,v207
 AR v204,a80
 AR v205,a81
 AR v206,a82
 AR v207,a83
 v_mul_f32 v204, v204, v202
 v_mul_f32 v205, v205, v202
 v_mul_f32 v206, v206, v202
 v_mul_f32 v207, v207, v202
 AW a80,v204
 AW a81,v205
 AW a82,v206
 AW a83,v207
 AR v204,a92
 AR v205,a93
 AR v206,a94
 AR v207,a95
 v_mul_f32 v204, v204, v202
 v_mul_f32 v205, v205, v202
 v_mul_f32 v206, v206, v202
 v_mul_f32 v207, v207, v202
 AW a92,v204
 AW a93,v205
 AW a94,v206
 AW a95,v207
 AR v204,a104
 AR v205,a105
 AR v206,a106
 AR v207,a107
 v_mul_f32 v204, v204, v202
 v_mul_f32 v205, v205, v202
 v_mul_f32 v206, v206, v202
 v_mul_f32 v207, v207, v202
 AW a104,v204
 AW a105,v205
 AW a106,v206
 AW a107,v207
 AR v204,a116
 AR v205,a117
 AR v206,a118
 AR v207,a119
 v_mul_f32 v204, v204, v202
 v_mul_f32 v205, v205, v202
 v_mul_f32 v206, v206, v202
 v_mul_f32 v207, v207, v202
 AW a116,v204
 AW a117,v205
 AW a118,v206
 AW a119,v207
 AR v204,a128
 AR v205,a129
 AR v206,a130
 AR v207,a131
 v_mul_f32 v204, v204, v202
 v_mul_f32 v205, v205, v202
 v_mul_f32 v206, v206, v202
 v_mul_f32 v207, v207, v202
 AW a128,v204
 AW a129,v205
 AW a130,v206
 AW a131,v207
 AR v204,a140
 AR v205,a141
 AR v206,a142
 AR v207,a143
 v_mul_f32 v204, v204, v202
 v_mul_f32 v205, v205, v202
 v_mul_f32 v206, v206, v202
 v_mul_f32 v207, v207, v202
 AW a140,v204
 AW a141,v205
 AW a142,v206
 AW a143,v207
 AR v204,a152
 AR v205,a153
 AR v206,a154
 AR v207,a155
 v_mul_f32 v204, v204, v202
 v_mul_f32 v205, v205, v202
 v_mul_f32 v206, v206, v202
 v_mul_f32 v207, v207, v202
 AW a152,v204
 AW a153,v205
 AW a154,v206
 AW a155,v207
 AR v204,a164
 AR v205,a165
 AR v206,a166
 AR v207,a167
 v_mul_f32 v204, v204, v202
 v_mul_f32 v205, v205, v202
 v_mul_f32 v206, v206, v202
 v_mul_f32 v207, v207, v202
 AW a164,v204
 AW a165,v205
 AW a166,v206
 AW a167,v207
 AR v204,a176
 AR v205,a177
 AR v206,a178
 AR v207,a179
 v_mul_f32 v204, v204, v202
 v_mul_f32 v205, v205, v202
 v_mul_f32 v206, v206, v202
 v_mul_f32 v207, v207, v202
 AW a176,v204
 AW a177,v205
 AW a178,v206
 AW a179,v207
 AR v204,a188
 AR v205,a189
 AR v206,a190
 AR v207,a191
 v_mul_f32 v204, v204, v202
 v_mul_f32 v205, v205, v202
 v_mul_f32 v206, v206, v202
 v_mul_f32 v207, v207, v202
 AW a188,v204
 AW a189,v205
 AW a190,v206
 AW a191,v207
 AR v204,a200
 AR v205,a201
 AR v206,a202
 AR v207,a203
 v_mul_f32 v204, v204, v202
 v_mul_f32 v205, v205, v202
 v_mul_f32 v206, v206, v202
 v_mul_f32 v207, v207, v202
 AW a200,v204
 AW a201,v205
 AW a202,v206
 AW a203,v207
 s_nop 1
 s_setpc_b64 s[86:87]
.p2align 6
L_typeB0:
 s_mul_i32 s88, s86, 86016
 s_add_u32 s56, s14, s88
 s_addc_u32 s57, s15, 0
 s_mov_b32 s58, 86016
 s_mov_b32 s59, 0x20000
 s_lshl_b32 s88, s85, 10
 s_add_u32 s48, s20, s88
 s_addc_u32 s49, s21, 0
 s_sub_u32 s48, s48, 512
 s_subb_u32 s49, s49, 0
 s_sub_u32 s50, 3670528, s88
 s_mov_b32 s51, 0x20000
 s_lshl_b32 s88, s85, 10
 s_add_u32 s88, s88, 512
 s_add_u32 s52, s20, s88
 s_addc_u32 s53, s21, 0
 s_sub_u32 s52, s52, 512
 s_subb_u32 s53, s53, 0
 s_sub_u32 s54, 3670528, s88
 s_mov_b32 s55, 0x20000
 s_mul_i32 s88, s86, 7
 s_lshr_b32 s88, s88, 4
 s_lshl_b32 s76, s88, 19
 s_mov_b32 s77, s76
 s_lshr_b32 s78, s76, 12
 s_mul_i32 s79, s28, 3072
 s_add_u32 s79, s79, 101376
 s_add_u32 m0, s79, 0
 s_nop 0
 buffer_load_dwordx4 v247, s[56:59], s78 offen offset:0 lds
 buffer_load_dwordx4 v248, s[56:59], s78 offen offset:1024 lds
 buffer_load_dwordx4 v249, s[56:59], s78 offen offset:2048 lds
 s_add_u32 s78, s78, 128
 s_cmp_eq_u32 s78, 896
 s_cselect_b32 s78, 0, s78
 s_mov_b32 m0, s93
 s_nop 0
 buffer_load_dwordx4 v8, s[48:51], s76 offen offset:0 lds
 buffer_load_dwordx4 v9, s[48:51], s76 offen offset:1056 lds
 buffer_load_dwordx4 v10, s[48:51], s76 offen offset:2112 lds
 buffer_load_dwordx4 v11, s[48:51], s76 offen offset:3168 lds
 s_add_u32 m0, s93, 4224
 s_add_u32 s3, s76, 65536
 buffer_load_dwordx4 v8, s[48:51], s3 offen offset:0 lds
 buffer_load_dwordx4 v9, s[48:51], s3 offen offset:1056 lds
 buffer_load_dwordx4 v10, s[48:51], s3 offen offset:2112 lds
 buffer_load_dwordx4 v11, s[48:51], s3 offen offset:3168 lds
 s_add_u32 s76, s76, 524288
 s_cmp_ge_u32 s76, 3670016
 s_cselect_b32 s7, 3670016, 0
 s_sub_u32 s76, s76, s7
 s_add_u32 m0, s79, 12288
 s_nop 0
 buffer_load_dwordx4 v247, s[56:59], s78 offen offset:0 lds
 buffer_load_dwordx4 v248, s[56:59], s78 offen offset:1024 lds
 buffer_load_dwordx4 v249, s[56:59], s78 offen offset:2048 lds
 s_add_u32 s78, s78, 128
 s_cmp_eq_u32 s78, 896
 s_cselect_b32 s78, 0, s78
 s_mov_b32 m0, s89
 s_nop 0
 buffer_load_dwordx4 v8, s[48:51], s76 offen offset:0 lds
 buffer_load_dwordx4 v9, s[48:51], s76 offen offset:1056 lds
 buffer_load_dwordx4 v10, s[48:51], s76 offen offset:2112 lds
 buffer_load_dwordx4 v11, s[48:51], s76 offen offset:3168 lds
 s_add_u32 m0, s89, 4224
 s_add_u32 s3, s76, 65536
 buffer_load_dwordx4 v8, s[48:51], s3 offen offset:0 lds
 buffer_load_dwordx4 v9, s[48:51], s3 offen offset:1056 lds
 buffer_load_dwordx4 v10, s[48:51], s3 offen offset:2112 lds
 buffer_load_dwordx4 v11, s[48:51], s3 offen offset:3168 lds
 s_add_u32 s76, s76, 524288
 s_cmp_ge_u32 s76, 3670016
 s_cselect_b32 s7, 3670016, 0
 s_sub_u32 s76, s76, s7
 s_lshl_b32 s88, s86, 3
 s_add_u32 s88, s88, s85
 s_lshl_b32 s88, s88, 20
 s_add_u32 s32, s16, s88
 s_addc_u32 s33, s17, 0
 s_sub_u32 s32, s32, 512
 s_subb_u32 s33, s33, 0
 s_mov_b32 s34, 524800
 s_mov_b32 s35, 0x20000
 s_add_u32 s40, s18, s88
 s_addc_u32 s41, s19, 0
 s_sub_u32 s40, s40, 512
 s_subb_u32 s41, s41, 0
 s_mov_b32 s42, 524800
 s_mov_b32 s43, 0x20000
 s_lshl_b32 s88, s86, 3
 s_add_u32 s88, s88, s85
 s_lshl_b32 s88, s88, 20
 s_add_u32 s88, s88, 524288
 s_add_u32 s36, s16, s88
 s_addc_u32 s37, s17, 0
 s_sub_u32 s36, s36, 512
 s_subb_u32 s37, s37, 0
 s_mov_b32 s38, 524800
 s_mov_b32 s39, 0x20000
 s_add_u32 s44, s18, s88
 s_addc_u32 s45, s19, 0
 s_sub_u32 s44, s44, 512
 s_subb_u32 s45, s45, 0
 s_mov_b32 s46, 524800
 s_mov_b32 s47, 0x20000
 s_mov_b32 s72, 0
 s_mov_b32 s73, 0
 s_mov_b32 s74, 0
 s_mov_b32 s75, 0
 s_mul_i32 s88, s85, 458752
 s_add_u32 s64, s22, s88
 s_addc_u32 s65, s23, 0
 s_sub_u32 s64, s64, 512
 s_subb_u32 s65, s65, 0
 s_mov_b32 s66, 459264
 s_mov_b32 s67, 0x20000
 s_mul_i32 s88, s85, 458752
 s_add_u32 s88, s88, 229376
 s_add_u32 s68, s22, s88
 s_addc_u32 s69, s23, 0
 s_sub_u32 s68, s68, 512
 s_subb_u32 s69, s69, 0
 s_mov_b32 s70, 229888
 s_mov_b32 s71, 0x20000
 s_lshl_b32 s88, s86, 3
 s_add_u32 s88, s88, s85
 s_add_u32 s88, s88, 128
 s_mul_i32 s88, s88, 86016
 s_mul_i32 s23, s87, 43008
 s_add_u32 s88, s88, s23
 s_add_u32 s60, s30, s88
 s_addc_u32 s61, s31, 0
 s_mov_b32 s62, 43008
 s_mov_b32 s63, 0x20000
 s_mov_b32 s5, s86
 s_lshl_b32 s6, s85, 2
 s_add_u32 s6, s6, s28
 s_lshl_b32 s4, s86, 3
 s_add_u32 s4, s4, 128
 s_mul_i32 s23, s86, 7
 s_lshr_b32 s23, s23, 4
 s_lshl_b32 s80, s23, 7
 s_add_u32 s81, s80, 114688
 s_mul_i32 s83, s23, 6144
 s_add_u32 s84, s83, 3072
 s_mul_i32 s88, s87, 12288
 s_add_u32 s88, s88, 135168
 v_add_u32 v251, s88, v250
 v_and_b32 v16, 7, v0
 s_lshl_b32 s88, s86, 10
 s_add_u32 s88, s88, 50348032
 s_lshl_b32 s23, s85, 7
 s_add_u32 s23, s23, s88
 v_lshl_add_u32 v17, v16, 2, s23
 global_load_dword a254, v17, s[30:31] sc1
 s_lshl_b32 s23, s85, 2
 s_add_u32 s23, s23, s88
 v_lshl_add_u32 v17, v16, 7, s23
 global_load_dword a253, v17, s[30:31] sc1
 v_add_u32 v253, 101376, v253
 v_add_u32 v254, 101376, v254
 s_waitcnt vmcnt(13)
 s_barrier
 ds_read_b128 a[0:3], v253 offset:0
 ds_read_b128 a[4:7], v253 offset:2048
 ds_read_b128 a[8:11], v253 offset:4096
 ds_read_b128 a[12:15], v254 offset:0
 ds_read_b128 a[16:19], v254 offset:2048
 ds_read_b128 a[20:23], v254 offset:4096
 TR v[208:209],v15,0
 TR v[210:211],v15,512
 TR v[212:213],v15,32
 TR v[214:215],v15,544
 TR v[216:217],v15,64
 TR v[218:219],v15,576
 s_waitcnt lgkmcnt(4)
 TR v[220:221],v15,96
 MM v[16:19],v[208:211],a[0:3],0
 TR v[222:223],v15,608
 MM v[20:23],v[208:211],a[4:7],0
 TR v[224:225],v15,128
 MM v[24:27],v[208:211],a[8:11],0
 s_waitcnt lgkmcnt(5)
 s_add_u32 m0, s79, 24576
 TR v[226:227],v15,640
 MM v[28:31],v[212:215],a[0:3],0
 buffer_load_dwordx4 v247, s[56:59], s78 offen offset:0 lds
 MM v[32:35],v[212:215],a[4:7],0
 TR v[228:229],v15,160
 buffer_load_dwordx4 v248, s[56:59], s78 offen offset:1024 lds
 MM v[36:39],v[212:215],a[8:11],0
 s_waitcnt lgkmcnt(3)
 TR v[230:231],v15,672
 MM v[40:43],v[216:219],a[0:3],0
 TR v[232:233],v15,192
 MM v[44:47],v[216:219],a[4:7],0
 TR v[234:235],v15,704
 MM v[48:51],v[216:219],a[8:11],0
 buffer_load_dwordx4 v249, s[56:59], s78 offen offset:2048 lds
 MM v[52:55],v[220:223],a[0:3],0
 s_add_u32 s78, s78, 128
 s_cmp_eq_u32 s78, 896
 s_cselect_b32 s78, 0, s78
 TR v[236:237],v15,224
 MM v[56:59],v[220:223],a[4:7],0
 TR v[238:239],v15,736
 MM v[60:63],v[220:223],a[8:11],0
 s_waitcnt lgkmcnt(4)
 TR v[208:209],v15,16896
 MM v[64:67],v[224:227],a[0:3],0
 s_mov_b32 m0, s91
 TR v[210:211],v15,17408
 MM v[68:71],v[224:227],a[4:7],0
 buffer_load_dwordx4 v8, s[48:51], s76 offen offset:0 lds
 MM v[72:75],v[224:227],a[8:11],0
 TR v[212:213],v15,16928
 buffer_load_dwordx4 v9, s[48:51], s76 offen offset:1056 lds
 MM v[76:79],v[228:231],a[0:3],0
 TR v[214:215],v15,17440
 MM v[80:83],v[228:231],a[4:7],0
 TR v[216:217],v15,16960
 MM v[84:87],v[228:231],a[8:11],0
 s_waitcnt lgkmcnt(5)
 buffer_load_dwordx4 v10, s[48:51], s76 offen offset:2112 lds
 MM v[88:91],v[232:235],a[0:3],0
 TR v[218:219],v15,17472
 MM v[92:95],v[232:235],a[4:7],0
 TR v[220:221],v15,16992
 buffer_load_dwordx4 v11, s[48:51], s76 offen offset:3168 lds
 MM v[96:99],v[232:235],a[8:11],0
 TR v[222:223],v15,17504
 MM v[100:103],v[236:239],a[0:3],0
 s_add_u32 m0, s91, 4224
 s_add_u32 s3, s76, 65536
 TR v[224:225],v15,17024
 MM v[104:107],v[236:239],a[4:7],0
 buffer_load_dwordx4 v8, s[48:51], s3 offen offset:0 lds
 MM v[108:111],v[236:239],a[8:11],0
 s_waitcnt lgkmcnt(5)
 TR v[226:227],v15,17536
 MM v[16:19],v[208:211],a[12:15],v[16:19]
 TR v[228:229],v15,17056
 MM v[20:23],v[208:211],a[16:19],v[20:23]
 TR v[230:231],v15,17568
 MM v[24:27],v[208:211],a[20:23],v[24:27]
 TR v[232:233],v15,17088
 MM v[28:31],v[212:215],a[12:15],v[28:31]
 buffer_load_dwordx4 v9, s[48:51], s3 offen offset:1056 lds
 MM v[32:35],v[212:215],a[16:19],v[32:35]
 TR v[234:235],v15,17600
 MM v[36:39],v[212:215],a[20:23],v[36:39]
 s_waitcnt lgkmcnt(6)
 TR v[236:237],v15,17120
 MM v[40:43],v[216:219],a[12:15],v[40:43]
 TR v[238:239],v15,17632
 MM v[44:47],v[216:219],a[16:19],v[44:47]
 buffer_load_dwordx4 v10, s[48:51], s3 offen offset:2112 lds
 MM v[48:51],v[216:219],a[20:23],v[48:51]
 buffer_load_dwordx4 v11, s[48:51], s3 offen offset:3168 lds
 MM v[52:55],v[220:223],a[12:15],v[52:55]
 s_add_u32 s76, s76, 524288
 s_cmp_ge_u32 s76, 3670016
 s_cselect_b32 s7, 3670016, 0
 s_sub_u32 s76, s76, s7
 MM v[56:59],v[220:223],a[16:19],v[56:59]
 MM v[60:63],v[220:223],a[20:23],v[60:63]
 s_waitcnt lgkmcnt(6)
 MM v[64:67],v[224:227],a[12:15],v[64:67]
 MM v[68:71],v[224:227],a[16:19],v[68:71]
 MM v[72:75],v[224:227],a[20:23],v[72:75]
 s_waitcnt lgkmcnt(0) vmcnt(13)
 s_barrier
 TR v[208:209],v14,0
 MM v[76:79],v[228:231],a[12:15],v[76:79]
 TR v[210:211],v14,512
 ds_read_b128 a[24:27], v253 offset:12288
 ds_read_b128 a[28:31], v253 offset:14336
 MM v[80:83],v[228:231],a[16:19],v[80:83]
 ds_read_b128 a[32:35], v253 offset:16384
 ds_read_b128 a[36:39], v254 offset:12288
 ds_read_b128 a[40:43], v254 offset:14336
 MM v[84:87],v[228:231],a[20:23],v[84:87]
 TR v[212:213],v14,32
 ds_read_b128 a[44:47], v254 offset:16384
 MM v[88:91],v[232:235],a[12:15],v[88:91]
 TR v[214:215],v14,544
 MM v[92:95],v[232:235],a[16:19],v[92:95]
 MM v[96:99],v[232:235],a[20:23],v[96:99]
 TR v[216:217],v14,64
 MM v[100:103],v[236:239],a[12:15],v[100:103]
 TR v[218:219],v14,576
 MM v[104:107],v[236:239],a[16:19],v[104:107]
 MM v[108:111],v[236:239],a[20:23],v[108:111]
 s_waitcnt lgkmcnt(10)
 s_waitcnt lgkmcnt(3)
 TR v[220:221],v14,96
 MM v[16:19],v[208:211],a[24:27],v[16:19]
 TR v[222:223],v14,608
 MM v[20:23],v[208:211],a[28:31],v[20:23]
 TR v[224:225],v14,128
 MM v[24:27],v[208:211],a[32:35],v[24:27]
 s_waitcnt lgkmcnt(5)
 s_add_u32 m0, s79, 36864
 TR v[226:227],v14,640
 MM v[28:31],v[212:215],a[24:27],v[28:31]
 buffer_load_dwordx4 v247, s[56:59], s78 offen offset:0 lds
 MM v[32:35],v[212:215],a[28:31],v[32:35]
 TR v[228:229],v14,160
 buffer_load_dwordx4 v248, s[56:59], s78 offen offset:1024 lds
 MM v[36:39],v[212:215],a[32:35],v[36:39]
 s_waitcnt lgkmcnt(3)
 TR v[230:231],v14,672
 buffer_load_dwordx4 v249, s[56:59], s78 offen offset:2048 lds
 MM v[40:43],v[216:219],a[24:27],v[40:43]
 s_add_u32 s78, s78, 128
 s_cmp_eq_u32 s78, 896
 s_cselect_b32 s78, 0, s78
 TR v[232:233],v14,192
 MM v[44:47],v[216:219],a[28:31],v[44:47]
 s_add_u32 m0, s79, 49152
 TR v[234:235],v14,704
 MM v[48:51],v[216:219],a[32:35],v[48:51]
 buffer_load_dwordx4 v247, s[56:59], s78 offen offset:0 lds
 MM v[52:55],v[220:223],a[24:27],v[52:55]
 TR v[236:237],v14,224
 MM v[56:59],v[220:223],a[28:31],v[56:59]
 TR v[238:239],v14,736
 buffer_load_dwordx4 v248, s[56:59], s78 offen offset:1024 lds
 MM v[60:63],v[220:223],a[32:35],v[60:63]
 s_waitcnt lgkmcnt(4)
 TR v[208:209],v14,16896
 MM v[64:67],v[224:227],a[24:27],v[64:67]
 TR v[210:211],v14,17408
 MM v[68:71],v[224:227],a[28:31],v[68:71]
 buffer_load_dwordx4 v249, s[56:59], s78 offen offset:2048 lds
 MM v[72:75],v[224:227],a[32:35],v[72:75]
 s_add_u32 s78, s78, 128
 s_cmp_eq_u32 s78, 896
 s_cselect_b32 s78, 0, s78
 TR v[212:213],v14,16928
 MM v[76:79],v[228:231],a[24:27],v[76:79]
 TR v[214:215],v14,17440
 MM v[80:83],v[228:231],a[28:31],v[80:83]
 s_mov_b32 m0, s93
 TR v[216:217],v14,16960
 MM v[84:87],v[228:231],a[32:35],v[84:87]
 s_waitcnt lgkmcnt(5)
 buffer_load_dwordx4 v8, s[48:51], s76 offen offset:0 lds
 MM v[88:91],v[232:235],a[24:27],v[88:91]
 TR v[218:219],v14,17472
 buffer_load_dwordx4 v9, s[48:51], s76 offen offset:1056 lds
 MM v[92:95],v[232:235],a[28:31],v[92:95]
 TR v[220:221],v14,16992
 MM v[96:99],v[232:235],a[32:35],v[96:99]
 TR v[222:223],v14,17504
 MM v[100:103],v[236:239],a[24:27],v[100:103]
 TR v[224:225],v14,17024
 MM v[104:107],v[236:239],a[28:31],v[104:107]
 buffer_load_dwordx4 v10, s[48:51], s76 offen offset:2112 lds
 MM v[108:111],v[236:239],a[32:35],v[108:111]
 s_waitcnt lgkmcnt(5)
 TR v[226:227],v14,17536
 buffer_load_dwordx4 v11, s[48:51], s76 offen offset:3168 lds
 MM v[16:19],v[208:211],a[36:39],v[16:19]
 TR v[228:229],v14,17056
 MM v[20:23],v[208:211],a[40:43],v[20:23]
 TR v[230:231],v14,17568
 MM v[24:27],v[208:211],a[44:47],v[24:27]
 s_add_u32 m0, s93, 4224
 s_add_u32 s3, s76, 65536
 TR v[232:233],v14,17088
 MM v[28:31],v[212:215],a[36:39],v[28:31]
 buffer_load_dwordx4 v8, s[48:51], s3 offen offset:0 lds
 MM v[32:35],v[212:215],a[40:43],v[32:35]
 TR v[234:235],v14,17600
 buffer_load_dwordx4 v9, s[48:51], s3 offen offset:1056 lds
 MM v[36:39],v[212:215],a[44:47],v[36:39]
 s_waitcnt lgkmcnt(6)
 TR v[236:237],v14,17120
 MM v[40:43],v[216:219],a[36:39],v[40:43]
 TR v[238:239],v14,17632
 MM v[44:47],v[216:219],a[40:43],v[44:47]
 buffer_load_dwordx4 v10, s[48:51], s3 offen offset:2112 lds
 MM v[48:51],v[216:219],a[44:47],v[48:51]
 MM v[52:55],v[220:223],a[36:39],v[52:55]
 buffer_load_dwordx4 v11, s[48:51], s3 offen offset:3168 lds
 MM v[56:59],v[220:223],a[40:43],v[56:59]
 s_add_u32 s76, s76, 524288
 s_cmp_ge_u32 s76, 3670016
 s_cselect_b32 s7, 3670016, 0
 s_sub_u32 s76, s76, s7
 MM v[60:63],v[220:223],a[44:47],v[60:63]
 s_waitcnt lgkmcnt(6)
 MM v[64:67],v[224:227],a[36:39],v[64:67]
 MM v[68:71],v[224:227],a[40:43],v[68:71]
 MM v[72:75],v[224:227],a[44:47],v[72:75]
 s_waitcnt lgkmcnt(0) vmcnt(14)
 s_barrier
 TR v[208:209],v14,33792
 MM v[76:79],v[228:231],a[36:39],v[76:79]
 TR v[210:211],v14,34304
 ds_read_b128 a[48:51], v253 offset:24576
 ds_read_b128 a[52:55], v253 offset:26624
 MM v[80:83],v[228:231],a[40:43],v[80:83]
 ds_read_b128 a[56:59], v253 offset:28672
 ds_read_b128 a[60:63], v254 offset:24576
 ds_read_b128 a[64:67], v254 offset:26624
 MM v[84:87],v[228:231],a[44:47],v[84:87]
 TR v[212:213],v14,33824
 ds_read_b128 a[68:71], v254 offset:28672
 MM v[88:91],v[232:235],a[36:39],v[88:91]
 TR v[214:215],v14,34336
 MM v[92:95],v[232:235],a[40:43],v[92:95]
 MM v[96:99],v[232:235],a[44:47],v[96:99]
 TR v[216:217],v14,33856
 MM v[100:103],v[236:239],a[36:39],v[100:103]
 TR v[218:219],v14,34368
 MM v[104:107],v[236:239],a[40:43],v[104:107]
 MM v[108:111],v[236:239],a[44:47],v[108:111]
 s_waitcnt lgkmcnt(10)
 s_waitcnt lgkmcnt(3)
 TR v[220:221],v14,33888
 MM v[16:19],v[208:211],a[48:51],v[16:19]
 TR v[222:223],v14,34400
 MM v[20:23],v[208:211],a[52:55],v[20:23]
 TR v[224:225],v14,33920
 MM v[24:27],v[208:211],a[56:59],v[24:27]
 s_waitcnt lgkmcnt(5)
 s_add_u32 m0, s79, 0
 TR v[226:227],v14,34432
 MM v[28:31],v[212:215],a[48:51],v[28:31]
 buffer_load_dwordx4 v247, s[56:59], s78 offen offset:0 lds
 MM v[32:35],v[212:215],a[52:55],v[32:35]
 TR v[228:229],v14,33952
 buffer_load_dwordx4 v248, s[56:59], s78 offen offset:1024 lds
 MM v[36:39],v[212:215],a[56:59],v[36:39]
 s_waitcnt lgkmcnt(3)
 TR v[230:231],v14,34464
 buffer_load_dwordx4 v249, s[56:59], s78 offen offset:2048 lds
 MM v[40:43],v[216:219],a[48:51],v[40:43]
 s_add_u32 s78, s78, 128
 s_cmp_eq_u32 s78, 896
 s_cselect_b32 s78, 0, s78
 TR v[232:233],v14,33984
 MM v[44:47],v[216:219],a[52:55],v[44:47]
 s_add_u32 m0, s79, 12288
 TR v[234:235],v14,34496
 MM v[48:51],v[216:219],a[56:59],v[48:51]
 buffer_load_dwordx4 v247, s[56:59], s78 offen offset:0 lds
 MM v[52:55],v[220:223],a[48:51],v[52:55]
 TR v[236:237],v14,34016
 MM v[56:59],v[220:223],a[52:55],v[56:59]
 TR v[238:239],v14,34528
 buffer_load_dwordx4 v248, s[56:59], s78 offen offset:1024 lds
 MM v[60:63],v[220:223],a[56:59],v[60:63]
 s_waitcnt lgkmcnt(4)
 TR v[208:209],v14,50688
 MM v[64:67],v[224:227],a[48:51],v[64:67]
 TR v[210:211],v14,51200
 MM v[68:71],v[224:227],a[52:55],v[68:71]
 buffer_load_dwordx4 v249, s[56:59], s78 offen offset:2048 lds
 MM v[72:75],v[224:227],a[56:59],v[72:75]
 s_add_u32 s78, s78, 128
 s_cmp_eq_u32 s78, 896
 s_cselect_b32 s78, 0, s78
 TR v[212:213],v14,50720
 MM v[76:79],v[228:231],a[48:51],v[76:79]
 TR v[214:215],v14,51232
 MM v[80:83],v[228:231],a[52:55],v[80:83]
 s_mov_b32 m0, s89
 TR v[216:217],v14,50752
 MM v[84:87],v[228:231],a[56:59],v[84:87]
 s_waitcnt lgkmcnt(5)
 buffer_load_dwordx4 v8, s[48:51], s76 offen offset:0 lds
 MM v[88:91],v[232:235],a[48:51],v[88:91]
 TR v[218:219],v14,51264
 buffer_load_dwordx4 v9, s[48:51], s76 offen offset:1056 lds
 MM v[92:95],v[232:235],a[52:55],v[92:95]
 TR v[220:221],v14,50784
 MM v[96:99],v[232:235],a[56:59],v[96:99]
 TR v[222:223],v14,51296
 MM v[100:103],v[236:239],a[48:51],v[100:103]
 TR v[224:225],v14,50816
 MM v[104:107],v[236:239],a[52:55],v[104:107]
 buffer_load_dwordx4 v10, s[48:51], s76 offen offset:2112 lds
 MM v[108:111],v[236:239],a[56:59],v[108:111]
 s_waitcnt lgkmcnt(5)
 TR v[226:227],v14,51328
 buffer_load_dwordx4 v11, s[48:51], s76 offen offset:3168 lds
 MM v[16:19],v[208:211],a[60:63],v[16:19]
 TR v[228:229],v14,50848
 MM v[20:23],v[208:211],a[64:67],v[20:23]
 TR v[230:231],v14,51360
 MM v[24:27],v[208:211],a[68:71],v[24:27]
 s_add_u32 m0, s89, 4224
 s_add_u32 s3, s76, 65536
 TR v[232:233],v14,50880
 MM v[28:31],v[212:215],a[60:63],v[28:31]
 buffer_load_dwordx4 v8, s[48:51], s3 offen offset:0 lds
 MM v[32:35],v[212:215],a[64:67],v[32:35]
 TR v[234:235],v14,51392
 buffer_load_dwordx4 v9, s[48:51], s3 offen offset:1056 lds
 MM v[36:39],v[212:215],a[68:71],v[36:39]
 s_waitcnt lgkmcnt(6)
 TR v[236:237],v14,50912
 MM v[40:43],v[216:219],a[60:63],v[40:43]
 TR v[238:239],v14,51424
 MM v[44:47],v[216:219],a[64:67],v[44:47]
 buffer_load_dwordx4 v10, s[48:51], s3 offen offset:2112 lds
 MM v[48:51],v[216:219],a[68:71],v[48:51]
 MM v[52:55],v[220:223],a[60:63],v[52:55]
 buffer_load_dwordx4 v11, s[48:51], s3 offen offset:3168 lds
 MM v[56:59],v[220:223],a[64:67],v[56:59]
 s_add_u32 s76, s76, 524288
 s_cmp_ge_u32 s76, 3670016
 s_cselect_b32 s7, 3670016, 0
 s_sub_u32 s76, s76, s7
 MM v[60:63],v[220:223],a[68:71],v[60:63]
 s_waitcnt lgkmcnt(6)
 MM v[64:67],v[224:227],a[60:63],v[64:67]
 MM v[68:71],v[224:227],a[64:67],v[68:71]
 MM v[72:75],v[224:227],a[68:71],v[72:75]
 s_waitcnt lgkmcnt(0) vmcnt(14)
 s_barrier
 TR v[208:209],v15,0
 MM v[76:79],v[228:231],a[60:63],v[76:79]
 TR v[210:211],v15,512
 ds_read_b128 a[72:75], v253 offset:36864
 ds_read_b128 a[76:79], v253 offset:38912
 MM v[80:83],v[228:231],a[64:67],v[80:83]
 ds_read_b128 a[80:83], v253 offset:40960
 ds_read_b128 a[84:87], v254 offset:36864
 ds_read_b128 a[88:91], v254 offset:38912
 MM v[84:87],v[228:231],a[68:71],v[84:87]
 TR v[212:213],v15,32
 ds_read_b128 a[92:95], v254 offset:40960
 MM v[88:91],v[232:235],a[60:63],v[88:91]
 TR v[214:215],v15,544
 MM v[92:95],v[232:235],a[64:67],v[92:95]
 MM v[96:99],v[232:235],a[68:71],v[96:99]
 TR v[216:217],v15,64
 MM v[100:103],v[236:239],a[60:63],v[100:103]
 TR v[218:219],v15,576
 MM v[104:107],v[236:239],a[64:67],v[104:107]
 MM v[108:111],v[236:239],a[68:71],v[108:111]
 s_waitcnt lgkmcnt(10)
 s_waitcnt lgkmcnt(3)
 TR v[220:221],v15,96
 MM v[16:19],v[208:211],a[72:75],v[16:19]
 TR v[222:223],v15,608
 ds_read_b128 a[96:99], v253 offset:49152
 MM v[20:23],v[208:211],a[76:79],v[20:23]
 TR v[224:225],v15,128
 MM v[24:27],v[208:211],a[80:83],v[24:27]
 s_waitcnt lgkmcnt(6)
 s_mov_b32 m0, s91
 TR v[226:227],v15,640
 MM v[28:31],v[212:215],a[72:75],v[28:31]
 buffer_load_dwordx4 v8, s[48:51], s76 offen offset:0 lds
 MM v[32:35],v[212:215],a[76:79],v[32:35]
 TR v[228:229],v15,160
 buffer_load_dwordx4 v9, s[48:51], s76 offen offset:1056 lds
 MM v[36:39],v[212:215],a[80:83],v[36:39]
 s_waitcnt lgkmcnt(4)
 TR v[230:231],v15,672
 MM v[40:43],v[216:219],a[72:75],v[40:43]
 TR v[232:233],v15,192
 ds_read_b128 a[100:103], v253 offset:51200
 MM v[44:47],v[216:219],a[76:79],v[44:47]
 TR v[234:235],v15,704
 MM v[48:51],v[216:219],a[80:83],v[48:51]
 buffer_load_dwordx4 v10, s[48:51], s76 offen offset:2112 lds
 MM v[52:55],v[220:223],a[72:75],v[52:55]
 TR v[236:237],v15,224
 MM v[56:59],v[220:223],a[76:79],v[56:59]
 TR v[238:239],v15,736
 ds_read_b128 a[104:107], v253 offset:53248
 MM v[60:63],v[220:223],a[80:83],v[60:63]
 s_waitcnt lgkmcnt(6)
 TR v[208:209],v15,16896
 MM v[64:67],v[224:227],a[72:75],v[64:67]
 TR v[210:211],v15,17408
 MM v[68:71],v[224:227],a[76:79],v[68:71]
 buffer_load_dwordx4 v11, s[48:51], s76 offen offset:3168 lds
 MM v[72:75],v[224:227],a[80:83],v[72:75]
 TR v[212:213],v15,16928
 ds_read_b128 a[108:111], v254 offset:49152
 MM v[76:79],v[228:231],a[72:75],v[76:79]
 TR v[214:215],v15,17440
 MM v[80:83],v[228:231],a[76:79],v[80:83]
 s_add_u32 m0, s91, 4224
 s_add_u32 s3, s76, 65536
 TR v[216:217],v15,16960
 MM v[84:87],v[228:231],a[80:83],v[84:87]
 s_waitcnt lgkmcnt(7)
 buffer_load_dwordx4 v8, s[48:51], s3 offen offset:0 lds
 MM v[88:91],v[232:235],a[72:75],v[88:91]
 TR v[218:219],v15,17472
 MM v[92:95],v[232:235],a[76:79],v[92:95]
 TR v[220:221],v15,16992
 MM v[96:99],v[232:235],a[80:83],v[96:99]
 TR v[222:223],v15,17504
 ds_read_b128 a[112:115], v254 offset:51200
 MM v[100:103],v[236:239],a[72:75],v[100:103]
 TR v[224:225],v15,17024
 MM v[104:107],v[236:239],a[76:79],v[104:107]
 buffer_load_dwordx4 v9, s[48:51], s3 offen offset:1056 lds
 MM v[108:111],v[236:239],a[80:83],v[108:111]
 s_waitcnt lgkmcnt(6)
 TR v[226:227],v15,17536
 MM v[16:19],v[208:211],a[84:87],v[16:19]
 TR v[228:229],v15,17056
 ds_read_b128 a[116:119], v254 offset:53248
 MM v[20:23],v[208:211],a[88:91],v[20:23]
 TR v[230:231],v15,17568
 MM v[24:27],v[208:211],a[92:95],v[24:27]
 TR v[232:233],v15,17088
 MM v[28:31],v[212:215],a[84:87],v[28:31]
 buffer_load_dwordx4 v10, s[48:51], s3 offen offset:2112 lds
 MM v[32:35],v[212:215],a[88:91],v[32:35]
 TR v[234:235],v15,17600
 MM v[36:39],v[212:215],a[92:95],v[36:39]
 s_waitcnt lgkmcnt(8)
 TR v[236:237],v15,17120
 MM v[40:43],v[216:219],a[84:87],v[40:43]
 TR v[238:239],v15,17632
 MM v[44:47],v[216:219],a[88:91],v[44:47]
 buffer_load_dwordx4 v11, s[48:51], s3 offen offset:3168 lds
 MM v[48:51],v[216:219],a[92:95],v[48:51]
 s_add_u32 s76, s76, 524288
 s_cmp_ge_u32 s76, 3670016
 s_cselect_b32 s7, 3670016, 0
 s_sub_u32 s76, s76, s7
 MM v[52:55],v[220:223],a[84:87],v[52:55]
 MM v[56:59],v[220:223],a[88:91],v[56:59]
 MM v[60:63],v[220:223],a[92:95],v[60:63]
 s_waitcnt lgkmcnt(7)
 MM v[64:67],v[224:227],a[84:87],v[64:67]
 MM v[68:71],v[224:227],a[88:91],v[68:71]
 MM v[72:75],v[224:227],a[92:95],v[72:75]
 s_waitcnt lgkmcnt(0) vmcnt(8)
 s_barrier
 TR v[208:209],v14,0
 MM v[76:79],v[228:231],a[84:87],v[76:79]
 TR v[210:211],v14,512
 MM v[80:83],v[228:231],a[88:91],v[80:83]
 MM v[84:87],v[228:231],a[92:95],v[84:87]
 TR v[212:213],v14,32
 MM v[88:91],v[232:235],a[84:87],v[88:91]
 TR v[214:215],v14,544
 MM v[92:95],v[232:235],a[88:91],v[92:95]
 MM v[96:99],v[232:235],a[92:95],v[96:99]
 TR v[216:217],v14,64
 MM v[100:103],v[236:239],a[84:87],v[100:103]
 TR v[218:219],v14,576
 MM v[104:107],v[236:239],a[88:91],v[104:107]
 MM v[108:111],v[236:239],a[92:95],v[108:111]
 s_waitcnt lgkmcnt(4)
 TR v[220:221],v14,96
 MM v[16:19],v[208:211],a[96:99],v[16:19]
 TR v[222:223],v14,608
 v_mov_b32 v2, 0x3f803f80
 MM v[20:23],v[208:211],a[100:103],v[20:23]
 TR v[224:225],v14,128
 MM v[24:27],v[208:211],a[104:107],v[24:27]
 s_waitcnt lgkmcnt(5)
 s_mov_b32 m0, s93
 TR v[226:227],v14,640
 MM v[28:31],v[212:215],a[96:99],v[28:31]
 buffer_load_dwordx4 v8, s[48:51], s76 offen offset:0 lds
 MM v[32:35],v[212:215],a[100:103],v[32:35]
 TR v[228:229],v14,160
 buffer_load_dwordx4 v9, s[48:51], s76 offen offset:1056 lds
 MM v[36:39],v[212:215],a[104:107],v[36:39]
 s_waitcnt lgkmcnt(3)
 TR v[230:231],v14,672
 MM v[40:43],v[216:219],a[96:99],v[40:43]
 TR v[232:233],v14,192
 MM v[44:47],v[216:219],a[100:103],v[44:47]
 TR v[234:235],v14,704
 MM v[48:51],v[216:219],a[104:107],v[48:51]
 buffer_load_dwordx4 v10, s[48:51], s76 offen offset:2112 lds
 MM v[52:55],v[220:223],a[96:99],v[52:55]
 TR v[236:237],v14,224
 AW a204,v2
 MM v[56:59],v[220:223],a[100:103],v[56:59]
 TR v[238:239],v14,736
 MM v[60:63],v[220:223],a[104:107],v[60:63]
 s_waitcnt lgkmcnt(4)
 TR v[208:209],v14,16896
 MM v[64:67],v[224:227],a[96:99],v[64:67]
 TR v[210:211],v14,17408
 MM v[68:71],v[224:227],a[100:103],v[68:71]
 buffer_load_dwordx4 v11, s[48:51], s76 offen offset:3168 lds
 MM v[72:75],v[224:227],a[104:107],v[72:75]
 TR v[212:213],v14,16928
 MM v[76:79],v[228:231],a[96:99],v[76:79]
 TR v[214:215],v14,17440
 MM v[80:83],v[228:231],a[100:103],v[80:83]
 s_add_u32 m0, s93, 4224
 s_add_u32 s3, s76, 65536
 TR v[216:217],v14,16960
 MM v[84:87],v[228:231],a[104:107],v[84:87]
 s_waitcnt lgkmcnt(5)
 buffer_load_dwordx4 v8, s[48:51], s3 offen offset:0 lds
 MM v[88:91],v[232:235],a[96:99],v[88:91]
 TR v[218:219],v14,17472
 AW a205,v2
 MM v[92:95],v[232:235],a[100:103],v[92:95]
 TR v[220:221],v14,16992
 MM v[96:99],v[232:235],a[104:107],v[96:99]
 TR v[222:223],v14,17504
 MM v[100:103],v[236:239],a[96:99],v[100:103]
 TR v[224:225],v14,17024
 MM v[104:107],v[236:239],a[100:103],v[104:107]
 buffer_load_dwordx4 v9, s[48:51], s3 offen offset:1056 lds
 MM v[108:111],v[236:239],a[104:107],v[108:111]
 s_waitcnt lgkmcnt(5)
 TR v[226:227],v14,17536
 MM v[16:19],v[208:211],a[108:111],v[16:19]
 TR v[228:229],v14,17056
 MM v[20:23],v[208:211],a[112:115],v[20:23]
 TR v[230:231],v14,17568
 AW a206,v2
 MM v[24:27],v[208:211],a[116:119],v[24:27]
 TR v[232:233],v14,17088
 MM v[28:31],v[212:215],a[108:111],v[28:31]
 buffer_load_dwordx4 v10, s[48:51], s3 offen offset:2112 lds
 MM v[32:35],v[212:215],a[112:115],v[32:35]
 TR v[234:235],v14,17600
 MM v[36:39],v[212:215],a[116:119],v[36:39]
 s_waitcnt lgkmcnt(6)
 TR v[236:237],v14,17120
 MM v[40:43],v[216:219],a[108:111],v[40:43]
 TR v[238:239],v14,17632
 MM v[44:47],v[216:219],a[112:115],v[44:47]
 buffer_load_dwordx4 v11, s[48:51], s3 offen offset:3168 lds
 MM v[48:51],v[216:219],a[116:119],v[48:51]
 s_add_u32 s76, s76, 524288
 s_cmp_ge_u32 s76, 3670016
 s_cselect_b32 s7, 3670016, 0
 s_sub_u32 s76, s76, s7
 MM v[52:55],v[220:223],a[108:111],v[52:55]
 AW a207,v2
 MM v[56:59],v[220:223],a[112:115],v[56:59]
 MM v[60:63],v[220:223],a[116:119],v[60:63]
 s_waitcnt lgkmcnt(6)
 MM v[64:67],v[224:227],a[108:111],v[64:67]
 MM v[68:71],v[224:227],a[112:115],v[68:71]
 v_subrev_u32 v247, 33792, v251
 MM v[72:75],v[224:227],a[116:119],v[72:75]
 s_waitcnt lgkmcnt(0) vmcnt(8)
 s_barrier
 TR v[208:209],v14,33792
 MM v[76:79],v[228:231],a[108:111],v[76:79]
 TR v[210:211],v14,34304
 ds_read_b128 a[120:123], v253 offset:0
 ds_read_b128 a[124:127], v253 offset:2048
 MM v[80:83],v[228:231],a[112:115],v[80:83]
 ds_read_b128 a[128:131], v253 offset:4096
 ds_read_b128 a[132:135], v254 offset:0
 ds_read_b128 a[136:139], v254 offset:2048
 MM v[84:87],v[228:231],a[116:119],v[84:87]
 TR v[212:213],v14,33824
 ds_read_b128 a[140:143], v254 offset:4096
 MM v[88:91],v[232:235],a[108:111],v[88:91]
 TR v[214:215],v14,34336
 MM v[92:95],v[232:235],a[112:115],v[92:95]
 MM v[96:99],v[232:235],a[116:119],v[96:99]
 TR v[216:217],v14,33856
 MM v[100:103],v[236:239],a[108:111],v[100:103]
 TR v[218:219],v14,34368
 MM v[104:107],v[236:239],a[112:115],v[104:107]
 MM v[108:111],v[236:239],a[116:119],v[108:111]
 s_waitcnt lgkmcnt(10)
 s_waitcnt lgkmcnt(3)
 TR v[220:221],v14,33888
 MM v[16:19],v[208:211],a[120:123],v[16:19]
 TR v[222:223],v14,34400
 ds_read_b128 a[144:147], v253 offset:12288
 MM v[20:23],v[208:211],a[124:127],v[20:23]
 TR v[224:225],v14,33920
 MM v[24:27],v[208:211],a[128:131],v[24:27]
 s_waitcnt lgkmcnt(6)
 s_mov_b32 m0, s90
 TR v[226:227],v14,34432
 MM v[28:31],v[212:215],a[120:123],v[28:31]
 buffer_load_dwordx4 v4, s[32:35], s72 offen offset:0 nt lds
 MM v[32:35],v[212:215],a[124:127],v[32:35]
 TR v[228:229],v14,33952
 buffer_load_dwordx4 v5, s[32:35], s72 offen offset:1056 nt lds
 MM v[36:39],v[212:215],a[128:131],v[36:39]
 s_waitcnt lgkmcnt(4)
 TR v[230:231],v14,34464
 buffer_load_dwordx4 v6, s[32:35], s72 offen offset:2112 nt lds
 MM v[40:43],v[216:219],a[120:123],v[40:43]
 TR v[232:233],v14,33984
 ds_read_b128 a[148:151], v253 offset:14336
 MM v[44:47],v[216:219],a[124:127],v[44:47]
 TR v[234:235],v14,34496
 MM v[48:51],v[216:219],a[128:131],v[48:51]
 buffer_load_dwordx4 v7, s[32:35], s72 offen offset:3168 nt lds
 MM v[52:55],v[220:223],a[120:123],v[52:55]
 s_add_u32 m0, s90, 4224
 s_add_u32 s3, s72, 4096
 TR v[236:237],v14,34016
 MM v[56:59],v[220:223],a[124:127],v[56:59]
 TR v[238:239],v14,34528
 buffer_load_dwordx4 v4, s[32:35], s3 offen offset:0 nt lds
 MM v[60:63],v[220:223],a[128:131],v[60:63]
 s_waitcnt lgkmcnt(5)
 TR v[208:209],v14,50688
 MM v[64:67],v[224:227],a[120:123],v[64:67]
 TR v[210:211],v14,51200
 ds_read_b128 a[152:155], v253 offset:16384
 MM v[68:71],v[224:227],a[124:127],v[68:71]
 buffer_load_dwordx4 v5, s[32:35], s3 offen offset:1056 nt lds
 MM v[72:75],v[224:227],a[128:131],v[72:75]
 TR v[212:213],v14,50720
 buffer_load_dwordx4 v6, s[32:35], s3 offen offset:2112 nt lds
 MM v[76:79],v[228:231],a[120:123],v[76:79]
 TR v[214:215],v14,51232
 MM v[80:83],v[228:231],a[124:127],v[80:83]
 TR v[216:217],v14,50752
 ds_read_b128 a[156:159], v254 offset:12288
 MM v[84:87],v[228:231],a[128:131],v[84:87]
 s_waitcnt lgkmcnt(7)
 buffer_load_dwordx4 v7, s[32:35], s3 offen offset:3168 nt lds
 MM v[88:91],v[232:235],a[120:123],v[88:91]
 s_add_u32 s72, s72, 16384
 TR v[218:219],v14,51264
 MM v[92:95],v[232:235],a[124:127],v[92:95]
 TR v[220:221],v14,50784
 MM v[96:99],v[232:235],a[128:131],v[96:99]
 TR v[222:223],v14,51296
 ds_read_b128 a[160:163], v254 offset:14336
 MM v[100:103],v[236:239],a[120:123],v[100:103]
 s_mov_b32 m0, s89
 TR v[224:225],v14,50816
 MM v[104:107],v[236:239],a[124:127],v[104:107]
 buffer_load_dwordx4 v4, s[32:35], s72 offen offset:0 nt lds
 MM v[108:111],v[236:239],a[128:131],v[108:111]
 s_waitcnt lgkmcnt(7)
 TR v[226:227],v14,51328
 buffer_load_dwordx4 v5, s[32:35], s72 offen offset:1056 nt lds
 MM v[16:19],v[208:211],a[132:135],v[16:19]
 TR v[228:229],v14,50848
 buffer_load_dwordx4 v6, s[32:35], s72 offen offset:2112 nt lds
 MM v[20:23],v[208:211],a[136:139],v[20:23]
 TR v[230:231],v14,51360
 ds_read_b128 a[164:167], v254 offset:16384
 MM v[24:27],v[208:211],a[140:143],v[24:27]
 TR v[232:233],v14,50880
 MM v[28:31],v[212:215],a[132:135],v[28:31]
 buffer_load_dwordx4 v7, s[32:35], s72 offen offset:3168 nt lds
 MM v[32:35],v[212:215],a[136:139],v[32:35]
 TR v[234:235],v14,51392
 MM v[36:39],v[212:215],a[140:143],v[36:39]
 s_waitcnt lgkmcnt(8)
 TR v[236:237],v14,50912
 MM v[40:43],v[216:219],a[132:135],v[40:43]
 s_add_u32 m0, s89, 4224
 s_add_u32 s3, s72, 4096
 TR v[238:239],v14,51424
 MM v[44:47],v[216:219],a[136:139],v[44:47]
 buffer_load_dwordx4 v4, s[32:35], s3 offen offset:0 nt lds
 MM v[48:51],v[216:219],a[140:143],v[48:51]
 buffer_load_dwordx4 v5, s[32:35], s3 offen offset:1056 nt lds
 MM v[52:55],v[220:223],a[132:135],v[52:55]
 buffer_load_dwordx4 v6, s[32:35], s3 offen offset:2112 nt lds
 MM v[56:59],v[220:223],a[136:139],v[56:59]
 buffer_load_dwordx4 v7, s[32:35], s3 offen offset:3168 nt lds
 MM v[60:63],v[220:223],a[140:143],v[60:63]
 s_waitcnt lgkmcnt(7)
 s_add_u32 s72, s72, 16384
 MM v[64:67],v[224:227],a[132:135],v[64:67]
 MM v[68:71],v[224:227],a[136:139],v[68:71]
 MM v[72:75],v[224:227],a[140:143],v[72:75]
 s_waitcnt lgkmcnt(0) vmcnt(16)
 s_barrier
 TR v[208:209],v15,0
 MM v[76:79],v[228:231],a[132:135],v[76:79]
 TR v[210:211],v15,512
 MM v[80:83],v[228:231],a[136:139],v[80:83]
 MM v[84:87],v[228:231],a[140:143],v[84:87]
 TR v[212:213],v15,16896
 MM v[88:91],v[232:235],a[132:135],v[88:91]
 TR v[214:215],v15,17408
 MM v[92:95],v[232:235],a[136:139],v[92:95]
 MM v[96:99],v[232:235],a[140:143],v[96:99]
 TR v[216:217],v15,32
 MM v[100:103],v[236:239],a[132:135],v[100:103]
 TR v[218:219],v15,544
 MM v[104:107],v[236:239],a[136:139],v[104:107]
 MM v[108:111],v[236:239],a[140:143],v[108:111]
 s_waitcnt lgkmcnt(4)
 TR v[220:221],v15,16928
 MM v[16:19],v[208:211],a[144:147],v[16:19]
 TR v[222:223],v15,17440
 MM v[20:23],v[208:211],a[148:151],v[20:23]
 TR v[224:225],v15,64
 MM v[24:27],v[208:211],a[152:155],v[24:27]
 s_waitcnt lgkmcnt(5)
 s_mov_b32 m0, s91
 TR v[226:227],v15,576
 MM v[16:19],v[212:215],a[156:159],v[16:19]
 buffer_load_dwordx4 v4, s[40:43], s74 offen offset:0 nt lds
 MM v[20:23],v[212:215],a[160:163],v[20:23]
 TR v[228:229],v15,16960
 buffer_load_dwordx4 v5, s[40:43], s74 offen offset:1056 nt lds
 MM v[24:27],v[212:215],a[164:167],v[24:27]
 s_waitcnt lgkmcnt(3)
 TR v[230:231],v15,17472
 MM v[28:31],v[216:219],a[144:147],v[28:31]
 TR v[232:233],v15,96
 MM v[32:35],v[216:219],a[148:151],v[32:35]
 TR v[234:235],v15,608
 MM v[36:39],v[216:219],a[152:155],v[36:39]
 buffer_load_dwordx4 v6, s[40:43], s74 offen offset:2112 nt lds
 MM v[28:31],v[220:223],a[156:159],v[28:31]
 TR v[236:237],v15,16992
 MM v[32:35],v[220:223],a[160:163],v[32:35]
 TR v[238:239],v15,17504
 MM v[36:39],v[220:223],a[164:167],v[36:39]
 s_waitcnt lgkmcnt(4)
 TR v[208:209],v15,128
 MM v[40:43],v[224:227],a[144:147],v[40:43]
 TR v[210:211],v15,640
 MM v[44:47],v[224:227],a[148:151],v[44:47]
 buffer_load_dwordx4 v7, s[40:43], s74 offen offset:3168 nt lds
 CV v16,v16,v17
 CV v17,v18,v19
 CV v18,v28,v29
 CV v19,v30,v31
 MM v[48:51],v[224:227],a[152:155],v[48:51]
 TR v[212:213],v15,17024
 CV v20,v20,v21
 CV v21,v22,v23
 CV v22,v32,v33
 MM v[40:43],v[228:231],a[156:159],v[40:43]
 TR v[214:215],v15,17536
 CV v23,v34,v35
 CV v24,v24,v25
 CV v25,v26,v27
 MM v[44:47],v[228:231],a[160:163],v[44:47]
 s_add_u32 m0, s91, 4224
 s_add_u32 s3, s74, 4096
 TR v[216:217],v15,160
 CV v26,v36,v37
 CV v27,v38,v39
 MM v[48:51],v[228:231],a[164:167],v[48:51]
 s_waitcnt lgkmcnt(5)
 buffer_load_dwordx4 v4, s[40:43], s3 offen offset:0 nt lds
 v_permlane32_swap_b32 v16, v18
 MM v[52:55],v[232:235],a[144:147],v[52:55]
 TR v[218:219],v15,672
 v_permlane32_swap_b32 v17, v19
 v_permlane32_swap_b32 v20, v22
 MM v[56:59],v[232:235],a[148:151],v[56:59]
 TR v[220:221],v15,17056
 v_permlane32_swap_b32 v21, v23
 MM v[60:63],v[232:235],a[152:155],v[60:63]
 TR v[222:223],v15,17568
 v_permlane32_swap_b32 v24, v26
 v_permlane32_swap_b32 v25, v27
 MM v[52:55],v[236:239],a[156:159],v[52:55]
 TR v[224:225],v15,192
 v_permlane16_swap_b32 v16, v18
 MM v[56:59],v[236:239],a[160:163],v[56:59]
 buffer_load_dwordx4 v5, s[40:43], s3 offen offset:1056 nt lds
 v_permlane16_swap_b32 v17, v19
 v_permlane16_swap_b32 v20, v22
 MM v[60:63],v[236:239],a[164:167],v[60:63]
 s_waitcnt lgkmcnt(5)
 TR v[226:227],v15,704
 v_permlane16_swap_b32 v21, v23
 MM v[64:67],v[208:211],a[144:147],v[64:67]
 TR v[228:229],v15,17088
 v_permlane16_swap_b32 v24, v26
 v_permlane16_swap_b32 v25, v27
 MM v[68:71],v[208:211],a[148:151],v[68:71]
 TR v[230:231],v15,17600
 CV v28,v40,v41
 CV v29,v42,v43
 CV v30,v52,v53
 MM v[72:75],v[208:211],a[152:155],v[72:75]
 TR v[232:233],v15,224
 CV v31,v54,v55
 CV v32,v44,v45
 CV v33,v46,v47
 MM v[64:67],v[212:215],a[156:159],v[64:67]
 buffer_load_dwordx4 v6, s[40:43], s3 offen offset:2112 nt lds
 CV v34,v56,v57
 CV v35,v58,v59
 MM v[68:71],v[212:215],a[160:163],v[68:71]
 TR v[234:235],v15,736
 CV v36,v48,v49
 CV v37,v50,v51
 CV v38,v60,v61
 MM v[72:75],v[212:215],a[164:167],v[72:75]
 s_waitcnt lgkmcnt(6)
 TR v[236:237],v15,17120
 CV v39,v62,v63
 v_permlane32_swap_b32 v28, v30
 MM v[76:79],v[216:219],a[144:147],v[76:79]
 TR v[238:239],v15,17632
 v_permlane32_swap_b32 v29, v31
 MM v[80:83],v[216:219],a[148:151],v[80:83]
 buffer_load_dwordx4 v7, s[40:43], s3 offen offset:3168 nt lds
 v_permlane32_swap_b32 v32, v34
 MM v[84:87],v[216:219],a[152:155],v[84:87]
 s_add_u32 s74, s74, 16384
 v_permlane32_swap_b32 v33, v35
 v_permlane32_swap_b32 v36, v38
 MM v[76:79],v[220:223],a[156:159],v[76:79]
 v_permlane32_swap_b32 v37, v39
 v_permlane16_swap_b32 v28, v30
 MM v[80:83],v[220:223],a[160:163],v[80:83]
 v_permlane16_swap_b32 v29, v31
 MM v[84:87],v[220:223],a[164:167],v[84:87]
 s_waitcnt lgkmcnt(6)
 v_permlane16_swap_b32 v32, v34
 v_permlane16_swap_b32 v33, v35
 MM v[88:91],v[224:227],a[144:147],v[88:91]
 v_permlane16_swap_b32 v36, v38
 v_permlane16_swap_b32 v37, v39
 MM v[92:95],v[224:227],a[148:151],v[92:95]
 CV v40,v64,v65
 CV v41,v66,v67
 CV v42,v76,v77
 CV v43,v78,v79
 MM v[96:99],v[224:227],a[152:155],v[96:99]
 s_waitcnt lgkmcnt(0) vmcnt(16)
 s_barrier
 ds_read_b128 v[208:211], v12 offset:16896
 CV v44,v68,v69
 MM v[88:91],v[228:231],a[156:159],v[88:91]
 CV v45,v70,v71
 CV v46,v80,v81
 CV v47,v82,v83
 MM v[92:95],v[228:231],a[160:163],v[92:95]
 CV v48,v72,v73
 CV v49,v74,v75
 CV v50,v84,v85
 CV v51,v86,v87
 MM v[96:99],v[228:231],a[164:167],v[96:99]
 ds_read_b128 v[212:215], v12 offset:17408
 v_permlane32_swap_b32 v40, v42
 MM v[100:103],v[232:235],a[144:147],v[100:103]
 v_permlane32_swap_b32 v41, v43
 v_permlane32_swap_b32 v44, v46
 MM v[104:107],v[232:235],a[148:151],v[104:107]
 v_permlane32_swap_b32 v45, v47
 MM v[108:111],v[232:235],a[152:155],v[108:111]
 ds_read_b128 v[216:219], v12 offset:16960
 v_permlane32_swap_b32 v48, v50
 MM v[100:103],v[236:239],a[156:159],v[100:103]
 v_permlane32_swap_b32 v49, v51
 v_permlane16_swap_b32 v40, v42
 MM v[104:107],v[236:239],a[160:163],v[104:107]
 v_permlane16_swap_b32 v41, v43
 v_permlane16_swap_b32 v44, v46
 MM v[108:111],v[236:239],a[164:167],v[108:111]
 s_waitcnt lgkmcnt(2)
 ds_read_b128 v[220:223], v12 offset:17472
 v_permlane16_swap_b32 v45, v47
 MM v[112:115],v[208:211],v[16:19],0
 s_mov_b32 m0, s93
 v_permlane16_swap_b32 v48, v50
 v_permlane16_swap_b32 v49, v51
 MM v[116:119],v[208:211],v[20:23],0
 ds_read_b128 v[224:227], v12 offset:17024
 buffer_load_dwordx4 v4, s[32:35], s72 offen offset:0 nt lds
 CV v52,v88,v89
 CV v53,v90,v91
 MM v[120:123],v[208:211],v[24:27],0
 s_waitcnt lgkmcnt(3)
 CV v54,v100,v101
 CV v55,v102,v103
 CV v56,v92,v93
 CV v57,v94,v95
 MM v[124:127],v[212:215],v[16:19],0
 CV v58,v104,v105
 CV v59,v106,v107
 CV v60,v96,v97
 CV v61,v98,v99
 MM v[128:131],v[212:215],v[20:23],0
 ds_read_b128 v[228:231], v12 offset:17536
 buffer_load_dwordx4 v5, s[32:35], s72 offen offset:1056 nt lds
 CV v62,v108,v109
 MM v[132:135],v[212:215],v[24:27],0
 s_waitcnt lgkmcnt(2)
 CV v63,v110,v111
 v_permlane32_swap_b32 v52, v54
 MM v[112:115],v[216:219],v[28:31],v[112:115]
 ds_read_b128 v[232:235], v12 offset:17088
 v_permlane32_swap_b32 v53, v55
 MM v[116:119],v[216:219],v[32:35],v[116:119]
 v_permlane32_swap_b32 v56, v58
 v_permlane32_swap_b32 v57, v59
 MM v[120:123],v[216:219],v[36:39],v[120:123]
 v_permlane32_swap_b32 v60, v62
 v_permlane32_swap_b32 v61, v63
 MM v[124:127],v[220:223],v[28:31],v[124:127]
 ds_read_b128 v[236:239], v12 offset:17600
 buffer_load_dwordx4 v6, s[32:35], s72 offen offset:2112 nt lds
 v_permlane16_swap_b32 v52, v54
 MM v[128:131],v[220:223],v[32:35],v[128:131]
 v_permlane16_swap_b32 v53, v55
 v_permlane16_swap_b32 v56, v58
 MM v[132:135],v[220:223],v[36:39],v[132:135]
 s_waitcnt lgkmcnt(2)
 ds_read_b128 v[208:211], v12 offset:17152
 v_permlane16_swap_b32 v57, v59
 MM v[112:115],v[224:227],v[40:43],v[112:115]
 v_permlane16_swap_b32 v60, v62
 v_permlane16_swap_b32 v61, v63
 MM v[116:119],v[224:227],v[44:47],v[116:119]
 MM v[120:123],v[224:227],v[48:51],v[120:123]
 s_barrier
 ds_read_b128 v[212:215], v12 offset:17664
 buffer_load_dwordx4 v7, s[32:35], s72 offen offset:3168 nt lds
 ds_read_b128 v[64:67], v251 offset:0
 MM v[124:127],v[228:231],v[40:43],v[124:127]
 ds_read_b128 v[68:71], v251 offset:1024
 ds_read_b128 v[72:75], v251 offset:2048
 ds_read_b128 v[76:79], v251 offset:3072
 MM v[128:131],v[228:231],v[44:47],v[128:131]
 ds_read_b128 v[216:219], v12 offset:17216
 ds_read_b128 v[80:83], v251 offset:4096
 ds_read_b128 v[84:87], v251 offset:5120
 MM v[132:135],v[228:231],v[48:51],v[132:135]
 s_waitcnt lgkmcnt(9)
 ds_read_b128 v[88:91], v251 offset:6144
 ds_read_b128 v[92:95], v251 offset:7168
 ds_read_b128 v[96:99], v251 offset:8192
 MM v[112:115],v[232:235],v[52:55],v[112:115]
 s_add_u32 m0, s93, 4224
 s_add_u32 s3, s72, 4096
 ds_read_b128 v[100:103], v251 offset:9216
 ds_read_b128 v[104:107], v251 offset:10240
 MM v[116:119],v[232:235],v[56:59],v[116:119]
 ds_read_b128 v[220:223], v12 offset:17728
 buffer_load_dwordx4 v4, s[32:35], s3 offen offset:0 nt lds
 ds_read_b128 v[108:111], v251 offset:11264
 MM v[120:123],v[232:235],v[60:63],v[120:123]
 MM v[124:127],v[236:239],v[52:55],v[124:127]
 ds_read_b128 v[224:227], v12 offset:17280
 buffer_load_dwordx4 v5, s[32:35], s3 offen offset:1056 nt lds
 MM v[128:131],v[236:239],v[56:59],v[128:131]
 MM v[132:135],v[236:239],v[60:63],v[132:135]
 s_waitcnt lgkmcnt(15)
 s_waitcnt lgkmcnt(12)
 MM v[112:115],v[208:211],v[64:67],v[112:115]
 ds_read_b128 v[228:231], v12 offset:17792
 MM v[116:119],v[208:211],v[68:71],v[116:119]
 MM v[120:123],v[208:211],v[72:75],v[120:123]
 ds_read_b128 v[232:235], v12 offset:17344
 buffer_load_dwordx4 v6, s[32:35], s3 offen offset:2112 nt lds
 MM v[124:127],v[212:215],v[64:67],v[124:127]
 MM v[128:131],v[212:215],v[68:71],v[128:131]
 MM v[132:135],v[212:215],v[72:75],v[132:135]
 s_waitcnt lgkmcnt(4)
 ds_read_b128 v[236:239], v12 offset:17856
 buffer_load_dwordx4 v7, s[32:35], s3 offen offset:3168 nt lds
 MM v[112:115],v[216:219],v[76:79],v[112:115]
 s_add_u32 s72, s72, 16384
 MM v[116:119],v[216:219],v[80:83],v[116:119]
 MM v[120:123],v[216:219],v[84:87],v[120:123]
 MM v[124:127],v[220:223],v[76:79],v[124:127]
 MM v[128:131],v[220:223],v[80:83],v[128:131]
 MM v[132:135],v[220:223],v[84:87],v[132:135]
 s_waitcnt lgkmcnt(3)
 MM v[112:115],v[224:227],v[88:91],v[112:115]
 MM v[116:119],v[224:227],v[92:95],v[116:119]
 MM v[120:123],v[224:227],v[96:99],v[120:123]
 s_waitcnt lgkmcnt(0) vmcnt(16)
 s_barrier
 ds_read_b128 v[208:211], v12 offset:0
 MM v[124:127],v[228:231],v[88:91],v[124:127]
 MM v[128:131],v[228:231],v[92:95],v[128:131]
 MM v[132:135],v[228:231],v[96:99],v[132:135]
 ds_read_b128 v[212:215], v12 offset:64
 MM v[112:115],v[232:235],v[100:103],v[112:115]
 MM v[116:119],v[232:235],v[104:107],v[116:119]
 MM v[120:123],v[232:235],v[108:111],v[120:123]
 ds_read_b128 v[216:219], v12 offset:128
 MM v[124:127],v[236:239],v[100:103],v[124:127]
 MM v[128:131],v[236:239],v[104:107],v[128:131]
 MM v[132:135],v[236:239],v[108:111],v[132:135]
 s_nop 1
 v_max3_f32 v196, v112, v113, v114
 s_nop 2
 v_max3_f32 v196, v196, v115, v124
 v_max3_f32 v196, v196, v125, v126
 v_max_f32 v196, v196, v127
 v_max3_f32 v197, v116, v117, v118
 v_max3_f32 v197, v197, v119, v128
 v_max3_f32 v197, v197, v129, v130
 v_max_f32 v197, v197, v131
 v_max3_f32 v198, v120, v121, v122
 v_max3_f32 v198, v198, v123, v132
 v_max3_f32 v198, v198, v133, v134
 v_max_f32 v198, v198, v135
 v_mov_b32 v200, v196
 v_mov_b32 v201, v197
 v_mov_b32 v202, v198
 v_permlane32_swap_b32 v196, v200
 v_permlane32_swap_b32 v197, v201
 v_permlane32_swap_b32 v198, v202
 v_max_f32 v196, v196, v200
 v_max_f32 v197, v197, v201
 v_max_f32 v198, v198, v202
 v_mov_b32 v200, v196
 v_mov_b32 v201, v197
 v_mov_b32 v202, v198
 v_permlane16_swap_b32 v196, v200
 v_permlane16_swap_b32 v197, v201
 v_permlane16_swap_b32 v198, v202
 v_max_f32 v196, v196, v200
 v_max_f32 v197, v197, v201
 v_max_f32 v198, v198, v202
 v_mul_f32 v184, s82, v196
 v_mul_f32 v185, s82, v197
 v_mul_f32 v186, s82, v198
 v_sub_f32 v184, 0, v184
 v_sub_f32 v185, 0, v185
 v_sub_f32 v186, 0, v186
 v_fma_f32 v112, v112, s82, v184
 v_fma_f32 v113, v113, s82, v184
 v_fma_f32 v114, v114, s82, v184
 v_fma_f32 v115, v115, s82, v184
 v_fma_f32 v116, v116, s82, v185
 v_fma_f32 v117, v117, s82, v185
 v_fma_f32 v118, v118, s82, v185
 v_fma_f32 v119, v119, s82, v185
 v_fma_f32 v120, v120, s82, v186
 v_fma_f32 v121, v121, s82, v186
 v_fma_f32 v122, v122, s82, v186
 v_fma_f32 v123, v123, s82, v186
 v_fma_f32 v124, v124, s82, v184
 v_fma_f32 v125, v125, s82, v184
 v_fma_f32 v126, v126, s82, v184
 v_fma_f32 v127, v127, s82, v184
 v_fma_f32 v128, v128, s82, v185
 v_fma_f32 v129, v129, s82, v185
 v_fma_f32 v130, v130, s82, v185
 v_fma_f32 v131, v131, s82, v185
 v_fma_f32 v132, v132, s82, v186
 v_fma_f32 v133, v133, s82, v186
 v_fma_f32 v134, v134, s82, v186
 v_fma_f32 v135, v135, s82, v186
 s_waitcnt lgkmcnt(2)
 ds_read_b128 v[220:223], v12 offset:192
 MM v[136:139],v[208:211],v[16:19],0
 s_mov_b32 m0, s95
 v_exp_f32 v112, v112
 MM v[140:143],v[208:211],v[20:23],0
 ds_read_b128 v[224:227], v12 offset:256
 buffer_load_dwordx4 v4, s[40:43], s74 offen offset:0 nt lds
 MM v[144:147],v[208:211],v[24:27],0
 s_waitcnt lgkmcnt(3)
 v_exp_f32 v113, v113
 MM v[136:139],v[212:215],v[28:31],v[136:139]
 v_exp_f32 v114, v114
 MM v[140:143],v[212:215],v[32:35],v[140:143]
 ds_read_b128 v[228:231], v12 offset:320
 buffer_load_dwordx4 v5, s[40:43], s74 offen offset:1056 nt lds
 MM v[144:147],v[212:215],v[36:39],v[144:147]
 s_waitcnt lgkmcnt(2)
 v_exp_f32 v115, v115
 MM v[136:139],v[216:219],v[40:43],v[136:139]
 ds_read_b128 v[232:235], v12 offset:384
 CV v160,v112,v113
 MM v[140:143],v[216:219],v[44:47],v[140:143]
 v_exp_f32 v124, v124
 MM v[144:147],v[216:219],v[48:51],v[144:147]
 v_exp_f32 v125, v125
 MM v[136:139],v[220:223],v[52:55],v[136:139]
 ds_read_b128 v[236:239], v12 offset:448
 buffer_load_dwordx4 v6, s[40:43], s74 offen offset:2112 nt lds
 MM v[140:143],v[220:223],v[56:59],v[140:143]
 CV v161,v114,v115
 CV v162,v124,v125
 MM v[144:147],v[220:223],v[60:63],v[144:147]
 s_waitcnt lgkmcnt(2)
 ds_read_b128 v[208:211], v12 offset:512
 MM v[136:139],v[224:227],v[64:67],v[136:139]
 v_exp_f32 v126, v126
 MM v[140:143],v[224:227],v[68:71],v[140:143]
 v_exp_f32 v127, v127
 MM v[144:147],v[224:227],v[72:75],v[144:147]
 ds_read_b128 v[212:215], v12 offset:576
 buffer_load_dwordx4 v7, s[40:43], s74 offen offset:3168 nt lds
 MM v[136:139],v[228:231],v[76:79],v[136:139]
 v_exp_f32 v116, v116
 MM v[140:143],v[228:231],v[80:83],v[140:143]
 ds_read_b128 v[216:219], v12 offset:640
 CV v163,v126,v127
 MM v[144:147],v[228:231],v[84:87],v[144:147]
 s_waitcnt lgkmcnt(3)
 v_exp_f32 v117, v117
 MM v[136:139],v[232:235],v[88:91],v[136:139]
 s_add_u32 m0, s95, 4224
 s_add_u32 s3, s74, 4096
 CV v164,v116,v117
 MM v[140:143],v[232:235],v[92:95],v[140:143]
 ds_read_b128 v[220:223], v12 offset:704
 buffer_load_dwordx4 v4, s[40:43], s3 offen offset:0 nt lds
 MM v[144:147],v[232:235],v[96:99],v[144:147]
 v_exp_f32 v118, v118
 MM v[136:139],v[236:239],v[100:103],v[136:139]
 ds_read_b128 v[224:227], v12 offset:768
 buffer_load_dwordx4 v5, s[40:43], s3 offen offset:1056 nt lds
 MM v[140:143],v[236:239],v[104:107],v[140:143]
 v_exp_f32 v119, v119
 MM v[144:147],v[236:239],v[108:111],v[144:147]
 s_waitcnt lgkmcnt(3)
 v_exp_f32 v128, v128
 MM v[148:151],v[208:211],v[16:19],0
 ds_read_b128 v[228:231], v12 offset:832
 CV v165,v118,v119
 MM v[152:155],v[208:211],v[20:23],0
 v_exp_f32 v129, v129
 MM v[156:159],v[208:211],v[24:27],0
 ds_read_b128 v[232:235], v12 offset:896
 buffer_load_dwordx4 v6, s[40:43], s3 offen offset:2112 nt lds
 MM v[148:151],v[212:215],v[28:31],v[148:151]
 v_exp_f32 v130, v130
 MM v[152:155],v[212:215],v[32:35],v[152:155]
 v_exp_f32 v131, v131
 MM v[156:159],v[212:215],v[36:39],v[156:159]
 s_waitcnt lgkmcnt(3)
 ds_read_b128 v[236:239], v12 offset:960
 buffer_load_dwordx4 v7, s[40:43], s3 offen offset:3168 nt lds
 MM v[148:151],v[216:219],v[40:43],v[148:151]
 s_add_u32 s74, s74, 16384
 CV v166,v128,v129
 CV v167,v130,v131
 MM v[152:155],v[216:219],v[44:47],v[152:155]
 v_exp_f32 v120, v120
 MM v[156:159],v[216:219],v[48:51],v[156:159]
 v_exp_f32 v121, v121
 MM v[148:151],v[220:223],v[52:55],v[148:151]
 v_exp_f32 v122, v122
 MM v[152:155],v[220:223],v[56:59],v[152:155]
 v_exp_f32 v123, v123
 MM v[156:159],v[220:223],v[60:63],v[156:159]
 s_waitcnt lgkmcnt(3)
 CV v168,v120,v121
 CV v169,v122,v123
 MM v[148:151],v[224:227],v[64:67],v[148:151]
 v_exp_f32 v132, v132
 MM v[152:155],v[224:227],v[68:71],v[152:155]
 v_exp_f32 v133, v133
 MM v[156:159],v[224:227],v[72:75],v[156:159]
 s_waitcnt lgkmcnt(0) vmcnt(16)
 s_barrier
 TR v[208:209],v14,33792
 MM v[148:151],v[228:231],v[76:79],v[148:151]
 TR v[210:211],v14,34304
 CV v170,v132,v133
 MM v[152:155],v[228:231],v[80:83],v[152:155]
 v_exp_f32 v134, v134
 MM v[156:159],v[228:231],v[84:87],v[156:159]
 TR v[212:213],v14,33824
 TR v[214:215],v14,34336
 MM v[148:151],v[232:235],v[88:91],v[148:151]
 v_exp_f32 v135, v135
 MM v[152:155],v[232:235],v[92:95],v[152:155]
 CV v171,v134,v135
 MM v[156:159],v[232:235],v[96:99],v[156:159]
 TR v[216:217],v14,33856
 TR v[218:219],v14,34368
 MM v[148:151],v[236:239],v[100:103],v[148:151]
 MM v[152:155],v[236:239],v[104:107],v[152:155]
 MM v[156:159],v[236:239],v[108:111],v[156:159]
 MM a[192:195],a[204:207],v[160:163],0
 MM a[196:199],a[204:207],v[164:167],0
 MM a[200:203],a[204:207],v[168:171],0
 s_waitcnt lgkmcnt(4)
 TR v[220:221],v14,33888
 MM a[0:3],v[208:211],v[160:163],0
 TR v[222:223],v14,34400
 v_fma_f32 v136, v136, s82, v184
 MM a[4:7],v[208:211],v[164:167],0
 TR v[224:225],v14,33920
 v_fma_f32 v137, v137, s82, v184
 MM a[8:11],v[208:211],v[168:171],0
 s_waitcnt lgkmcnt(5)
 s_mov_b32 m0, s89
 TR v[226:227],v14,34432
 MM a[12:15],v[212:215],v[160:163],0
 buffer_load_dwordx4 v4, s[32:35], s72 offen offset:0 nt lds
 v_fma_f32 v138, v138, s82, v184
 MM a[16:19],v[212:215],v[164:167],0
 TR v[228:229],v14,33952
 buffer_load_dwordx4 v5, s[32:35], s72 offen offset:1056 nt lds
 MM a[20:23],v[212:215],v[168:171],0
 s_waitcnt lgkmcnt(3)
 TR v[230:231],v14,34464
 v_fma_f32 v139, v139, s82, v184
 MM a[24:27],v[216:219],v[160:163],0
 TR v[232:233],v14,33984
 MM a[28:31],v[216:219],v[164:167],0
 TR v[234:235],v14,34496
 v_fma_f32 v140, v140, s82, v185
 MM a[32:35],v[216:219],v[168:171],0
 buffer_load_dwordx4 v6, s[32:35], s72 offen offset:2112 nt lds
 v_fma_f32 v141, v141, s82, v185
 MM a[36:39],v[220:223],v[160:163],0
 TR v[236:237],v14,34016
 v_fma_f32 v142, v142, s82, v185
 MM a[40:43],v[220:223],v[164:167],0
 TR v[238:239],v14,34528
 MM a[44:47],v[220:223],v[168:171],0
 s_waitcnt lgkmcnt(4)
 TR v[208:209],v14,34048
 v_fma_f32 v143, v143, s82, v185
 MM a[48:51],v[224:227],v[160:163],0
 TR v[210:211],v14,34560
 v_max3_f32 v253, v136, v137, v138
 MM a[52:55],v[224:227],v[164:167],0
 buffer_load_dwordx4 v7, s[32:35], s72 offen offset:3168 nt lds
 v_max3_f32 v254, v139, v140, v141
 MM a[56:59],v[224:227],v[168:171],0
 TR v[212:213],v14,34080
 v_fma_f32 v144, v144, s82, v186
 MM a[60:63],v[228:231],v[160:163],0
 TR v[214:215],v14,34592
 MM a[64:67],v[228:231],v[164:167],0
 s_add_u32 m0, s89, 4224
 s_add_u32 s3, s72, 4096
 TR v[216:217],v14,34112
 MM a[68:71],v[228:231],v[168:171],0
 s_waitcnt lgkmcnt(5)
 buffer_load_dwordx4 v4, s[32:35], s3 offen offset:0 nt lds
 v_fma_f32 v145, v145, s82, v186
 MM a[72:75],v[232:235],v[160:163],0
 TR v[218:219],v14,34624
 v_max3_f32 v253, v253, v142, v143
 MM a[76:79],v[232:235],v[164:167],0
 TR v[220:221],v14,34144
 v_fma_f32 v146, v146, s82, v186
 MM a[80:83],v[232:235],v[168:171],0
 TR v[222:223],v14,34656
 MM a[84:87],v[236:239],v[160:163],0
 TR v[224:225],v14,34176
 v_fma_f32 v147, v147, s82, v186
 MM a[88:91],v[236:239],v[164:167],0
 buffer_load_dwordx4 v5, s[32:35], s3 offen offset:1056 nt lds
 v_max3_f32 v254, v254, v144, v145
 MM a[92:95],v[236:239],v[168:171],0
 s_waitcnt lgkmcnt(5)
 TR v[226:227],v14,34688
 v_fma_f32 v148, v148, s82, v184
 MM a[96:99],v[208:211],v[160:163],0
 TR v[228:229],v14,34208
 MM a[100:103],v[208:211],v[164:167],0
 TR v[230:231],v14,34720
 v_fma_f32 v149, v149, s82, v184
 MM a[104:107],v[208:211],v[168:171],0
 TR v[232:233],v14,34240
 v_max3_f32 v253, v253, v146, v147
 MM a[108:111],v[212:215],v[160:163],0
 buffer_load_dwordx4 v6, s[32:35], s3 offen offset:2112 nt lds
 v_fma_f32 v150, v150, s82, v184
 MM a[112:115],v[212:215],v[164:167],0
 TR v[234:235],v14,34752
 v_fma_f32 v151, v151, s82, v184
 MM a[116:119],v[212:215],v[168:171],0
 s_waitcnt lgkmcnt(6)
 TR v[236:237],v14,34272
 MM a[120:123],v[216:219],v[160:163],0
 TR v[238:239],v14,34784
 v_max3_f32 v254, v254, v148, v149
 MM a[124:127],v[216:219],v[164:167],0
 buffer_load_dwordx4 v7, s[32:35], s3 offen offset:3168 nt lds
 v_fma_f32 v152, v152, s82, v185
 MM a[128:131],v[216:219],v[168:171],0
 s_add_u32 s72, s72, 16384
 v_fma_f32 v153, v153, s82, v185
 MM a[132:135],v[220:223],v[160:163],0
 v_max3_f32 v253, v253, v150, v151
 v_fma_f32 v154, v154, s82, v185
 MM a[136:139],v[220:223],v[164:167],0
 v_fma_f32 v155, v155, s82, v185
 MM a[140:143],v[220:223],v[168:171],0
 s_waitcnt lgkmcnt(6)
 v_max3_f32 v254, v254, v152, v153
 v_fma_f32 v156, v156, s82, v186
 MM a[144:147],v[224:227],v[160:163],0
 v_fma_f32 v157, v157, s82, v186
 v_max3_f32 v253, v253, v154, v155
 MM a[148:151],v[224:227],v[164:167],0
 v_fma_f32 v158, v158, s82, v186
 MM a[152:155],v[224:227],v[168:171],0
 s_waitcnt lgkmcnt(0) vmcnt(16)
 s_barrier
 ds_read_b128 v[208:211], v13 offset:0
 MM a[156:159],v[228:231],v[160:163],0
 v_fma_f32 v159, v159, s82, v186
 v_max3_f32 v254, v254, v156, v157
 MM a[160:163],v[228:231],v[164:167],0
 v_max3_f32 v253, v253, v158, v159
 MM a[164:167],v[228:231],v[168:171],0
 ds_read_b128 v[212:215], v13 offset:64
 v_max_f32 v253, v253, v254
 MM a[168:171],v[232:235],v[160:163],0
 v_cmp_lt_f32 vcc, 0x41800000, v253
 MM a[172:175],v[232:235],v[164:167],0
 MM a[176:179],v[232:235],v[168:171],0
 ds_read_b128 v[216:219], v13 offset:128
 MM a[180:183],v[236:239],v[160:163],0
 MM a[184:187],v[236:239],v[164:167],0
 MM a[188:191],v[236:239],v[168:171],0
 s_mov_b32 s79, 0
LB0_loop10:
 s_cbranch_vccnz LB0_t0
LB0_r0:
 s_waitcnt lgkmcnt(2)
 ds_read_b128 v[220:223], v13 offset:192
 MM v[112:115],v[208:211],v[16:19],0
 s_mov_b32 m0, s91
 v_exp_f32 v136, v136
 MM v[116:119],v[208:211],v[20:23],0
 ds_read_b128 v[224:227], v13 offset:256
 buffer_load_dwordx4 v4, s[40:43], s74 offen offset:0 nt lds
 MM v[120:123],v[208:211],v[24:27],0
 s_waitcnt lgkmcnt(3)
 v_exp_f32 v137, v137
 MM v[112:115],v[212:215],v[28:31],v[112:115]
 v_exp_f32 v138, v138
 MM v[116:119],v[212:215],v[32:35],v[116:119]
 ds_read_b128 v[228:231], v13 offset:320
 buffer_load_dwordx4 v5, s[40:43], s74 offen offset:1056 nt lds
 MM v[120:123],v[212:215],v[36:39],v[120:123]
 s_waitcnt lgkmcnt(2)
 v_exp_f32 v139, v139
 MM v[112:115],v[216:219],v[40:43],v[112:115]
 ds_read_b128 v[232:235], v13 offset:384
 CV v160,v136,v137
 MM v[116:119],v[216:219],v[44:47],v[116:119]
 v_exp_f32 v148, v148
 MM v[120:123],v[216:219],v[48:51],v[120:123]
 v_exp_f32 v149, v149
 MM v[112:115],v[220:223],v[52:55],v[112:115]
 ds_read_b128 v[236:239], v13 offset:448
 buffer_load_dwordx4 v6, s[40:43], s74 offen offset:2112 nt lds
 MM v[116:119],v[220:223],v[56:59],v[116:119]
 CV v161,v138,v139
 CV v162,v148,v149
 MM v[120:123],v[220:223],v[60:63],v[120:123]
 s_waitcnt lgkmcnt(2)
 ds_read_b128 v[208:211], v13 offset:512
 MM v[112:115],v[224:227],v[64:67],v[112:115]
 v_exp_f32 v150, v150
 MM v[116:119],v[224:227],v[68:71],v[116:119]
 v_exp_f32 v151, v151
 MM v[120:123],v[224:227],v[72:75],v[120:123]
 ds_read_b128 v[212:215], v13 offset:576
 buffer_load_dwordx4 v7, s[40:43], s74 offen offset:3168 nt lds
 MM v[112:115],v[228:231],v[76:79],v[112:115]
 v_exp_f32 v140, v140
 MM v[116:119],v[228:231],v[80:83],v[116:119]
 ds_read_b128 v[216:219], v13 offset:640
 CV v163,v150,v151
 MM v[120:123],v[228:231],v[84:87],v[120:123]
 s_waitcnt lgkmcnt(3)
 v_exp_f32 v141, v141
 MM v[112:115],v[232:235],v[88:91],v[112:115]
 s_add_u32 m0, s91, 4224
 s_add_u32 s3, s74, 4096
 CV v164,v140,v141
 MM v[116:119],v[232:235],v[92:95],v[116:119]
 ds_read_b128 v[220:223], v13 offset:704
 buffer_load_dwordx4 v4, s[40:43], s3 offen offset:0 nt lds
 MM v[120:123],v[232:235],v[96:99],v[120:123]
 v_exp_f32 v142, v142
 MM v[112:115],v[236:239],v[100:103],v[112:115]
 ds_read_b128 v[224:227], v13 offset:768
 buffer_load_dwordx4 v5, s[40:43], s3 offen offset:1056 nt lds
 MM v[116:119],v[236:239],v[104:107],v[116:119]
 v_exp_f32 v143, v143
 MM v[120:123],v[236:239],v[108:111],v[120:123]
 s_waitcnt lgkmcnt(3)
 v_exp_f32 v152, v152
 MM v[124:127],v[208:211],v[16:19],0
 ds_read_b128 v[228:231], v13 offset:832
 CV v165,v142,v143
 MM v[128:131],v[208:211],v[20:23],0
 v_exp_f32 v153, v153
 MM v[132:135],v[208:211],v[24:27],0
 ds_read_b128 v[232:235], v13 offset:896
 buffer_load_dwordx4 v6, s[40:43], s3 offen offset:2112 nt lds
 MM v[124:127],v[212:215],v[28:31],v[124:127]
 v_exp_f32 v154, v154
 MM v[128:131],v[212:215],v[32:35],v[128:131]
 v_exp_f32 v155, v155
 MM v[132:135],v[212:215],v[36:39],v[132:135]
 s_waitcnt lgkmcnt(3)
 ds_read_b128 v[236:239], v13 offset:960
 buffer_load_dwordx4 v7, s[40:43], s3 offen offset:3168 nt lds
 MM v[124:127],v[216:219],v[40:43],v[124:127]
 s_add_u32 s74, s74, 16384
 CV v166,v152,v153
 CV v167,v154,v155
 MM v[128:131],v[216:219],v[44:47],v[128:131]
 v_exp_f32 v144, v144
 MM v[132:135],v[216:219],v[48:51],v[132:135]
 v_exp_f32 v145, v145
 MM v[124:127],v[220:223],v[52:55],v[124:127]
 v_exp_f32 v146, v146
 MM v[128:131],v[220:223],v[56:59],v[128:131]
 v_exp_f32 v147, v147
 MM v[132:135],v[220:223],v[60:63],v[132:135]
 s_waitcnt lgkmcnt(3)
 CV v168,v144,v145
 CV v169,v146,v147
 MM v[124:127],v[224:227],v[64:67],v[124:127]
 v_exp_f32 v156, v156
 MM v[128:131],v[224:227],v[68:71],v[128:131]
 v_exp_f32 v157, v157
 MM v[132:135],v[224:227],v[72:75],v[132:135]
 s_waitcnt lgkmcnt(0) vmcnt(16)
 s_barrier
 TR v[208:209],v15,33792
 MM v[124:127],v[228:231],v[76:79],v[124:127]
 TR v[210:211],v15,34304
 CV v170,v156,v157
 MM v[128:131],v[228:231],v[80:83],v[128:131]
 v_exp_f32 v158, v158
 MM v[132:135],v[228:231],v[84:87],v[132:135]
 TR v[212:213],v15,33824
 TR v[214:215],v15,34336
 MM v[124:127],v[232:235],v[88:91],v[124:127]
 v_exp_f32 v159, v159
 MM v[128:131],v[232:235],v[92:95],v[128:131]
 CV v171,v158,v159
 MM v[132:135],v[232:235],v[96:99],v[132:135]
 TR v[216:217],v15,33856
 TR v[218:219],v15,34368
 MM v[124:127],v[236:239],v[100:103],v[124:127]
 MM v[128:131],v[236:239],v[104:107],v[128:131]
 MM v[132:135],v[236:239],v[108:111],v[132:135]
 MM a[192:195],a[204:207],v[160:163],a[192:195]
 MM a[196:199],a[204:207],v[164:167],a[196:199]
 MM a[200:203],a[204:207],v[168:171],a[200:203]
 s_waitcnt lgkmcnt(4)
 TR v[220:221],v15,33888
 MM a[0:3],v[208:211],v[160:163],a[0:3]
 TR v[222:223],v15,34400
 v_fma_f32 v112, v112, s82, v184
 MM a[4:7],v[208:211],v[164:167],a[4:7]
 TR v[224:225],v15,33920
 v_fma_f32 v113, v113, s82, v184
 MM a[8:11],v[208:211],v[168:171],a[8:11]
 s_waitcnt lgkmcnt(5)
 s_mov_b32 m0, s93
 TR v[226:227],v15,34432
 MM a[12:15],v[212:215],v[160:163],a[12:15]
 buffer_load_dwordx4 v4, s[32:35], s72 offen offset:0 nt lds
 v_fma_f32 v114, v114, s82, v184
 MM a[16:19],v[212:215],v[164:167],a[16:19]
 TR v[228:229],v15,33952
 buffer_load_dwordx4 v5, s[32:35], s72 offen offset:1056 nt lds
 MM a[20:23],v[212:215],v[168:171],a[20:23]
 s_waitcnt lgkmcnt(3)
 TR v[230:231],v15,34464
 v_fma_f32 v115, v115, s82, v184
 MM a[24:27],v[216:219],v[160:163],a[24:27]
 TR v[232:233],v15,33984
 MM a[28:31],v[216:219],v[164:167],a[28:31]
 TR v[234:235],v15,34496
 v_fma_f32 v116, v116, s82, v185
 MM a[32:35],v[216:219],v[168:171],a[32:35]
 buffer_load_dwordx4 v6, s[32:35], s72 offen offset:2112 nt lds
 v_fma_f32 v117, v117, s82, v185
 MM a[36:39],v[220:223],v[160:163],a[36:39]
 TR v[236:237],v15,34016
 v_fma_f32 v118, v118, s82, v185
 MM a[40:43],v[220:223],v[164:167],a[40:43]
 TR v[238:239],v15,34528
 MM a[44:47],v[220:223],v[168:171],a[44:47]
 s_waitcnt lgkmcnt(4)
 TR v[208:209],v15,34048
 v_fma_f32 v119, v119, s82, v185
 MM a[48:51],v[224:227],v[160:163],a[48:51]
 TR v[210:211],v15,34560
 v_max3_f32 v253, v112, v113, v114
 MM a[52:55],v[224:227],v[164:167],a[52:55]
 buffer_load_dwordx4 v7, s[32:35], s72 offen offset:3168 nt lds
 v_max3_f32 v254, v115, v116, v117
 MM a[56:59],v[224:227],v[168:171],a[56:59]
 TR v[212:213],v15,34080
 v_fma_f32 v120, v120, s82, v186
 MM a[60:63],v[228:231],v[160:163],a[60:63]
 TR v[214:215],v15,34592
 MM a[64:67],v[228:231],v[164:167],a[64:67]
 s_add_u32 m0, s93, 4224
 s_add_u32 s3, s72, 4096
 TR v[216:217],v15,34112
 MM a[68:71],v[228:231],v[168:171],a[68:71]
 s_waitcnt lgkmcnt(5)
 buffer_load_dwordx4 v4, s[32:35], s3 offen offset:0 nt lds
 v_fma_f32 v121, v121, s82, v186
 MM a[72:75],v[232:235],v[160:163],a[72:75]
 TR v[218:219],v15,34624
 v_max3_f32 v253, v253, v118, v119
 MM a[76:79],v[232:235],v[164:167],a[76:79]
 TR v[220:221],v15,34144
 v_fma_f32 v122, v122, s82, v186
 MM a[80:83],v[232:235],v[168:171],a[80:83]
 TR v[222:223],v15,34656
 MM a[84:87],v[236:239],v[160:163],a[84:87]
 TR v[224:225],v15,34176
 v_fma_f32 v123, v123, s82, v186
 MM a[88:91],v[236:239],v[164:167],a[88:91]
 buffer_load_dwordx4 v5, s[32:35], s3 offen offset:1056 nt lds
 v_max3_f32 v254, v254, v120, v121
 MM a[92:95],v[236:239],v[168:171],a[92:95]
 s_waitcnt lgkmcnt(5)
 TR v[226:227],v15,34688
 v_fma_f32 v124, v124, s82, v184
 MM a[96:99],v[208:211],v[160:163],a[96:99]
 TR v[228:229],v15,34208
 MM a[100:103],v[208:211],v[164:167],a[100:103]
 TR v[230:231],v15,34720
 v_fma_f32 v125, v125, s82, v184
 MM a[104:107],v[208:211],v[168:171],a[104:107]
 TR v[232:233],v15,34240
 v_max3_f32 v253, v253, v122, v123
 MM a[108:111],v[212:215],v[160:163],a[108:111]
 buffer_load_dwordx4 v6, s[32:35], s3 offen offset:2112 nt lds
 v_fma_f32 v126, v126, s82, v184
 MM a[112:115],v[212:215],v[164:167],a[112:115]
 TR v[234:235],v15,34752
 v_fma_f32 v127, v127, s82, v184
 MM a[116:119],v[212:215],v[168:171],a[116:119]
 s_waitcnt lgkmcnt(6)
 TR v[236:237],v15,34272
 MM a[120:123],v[216:219],v[160:163],a[120:123]
 TR v[238:239],v15,34784
 v_max3_f32 v254, v254, v124, v125
 MM a[124:127],v[216:219],v[164:167],a[124:127]
 buffer_load_dwordx4 v7, s[32:35], s3 offen offset:3168 nt lds
 v_fma_f32 v128, v128, s82, v185
 MM a[128:131],v[216:219],v[168:171],a[128:131]
 s_add_u32 s72, s72, 16384
 v_fma_f32 v129, v129, s82, v185
 MM a[132:135],v[220:223],v[160:163],a[132:135]
 v_max3_f32 v253, v253, v126, v127
 v_fma_f32 v130, v130, s82, v185
 MM a[136:139],v[220:223],v[164:167],a[136:139]
 v_fma_f32 v131, v131, s82, v185
 MM a[140:143],v[220:223],v[168:171],a[140:143]
 s_waitcnt lgkmcnt(6)
 v_max3_f32 v254, v254, v128, v129
 v_fma_f32 v132, v132, s82, v186
 MM a[144:147],v[224:227],v[160:163],a[144:147]
 v_fma_f32 v133, v133, s82, v186
 v_max3_f32 v253, v253, v130, v131
 MM a[148:151],v[224:227],v[164:167],a[148:151]
 v_fma_f32 v134, v134, s82, v186
 MM a[152:155],v[224:227],v[168:171],a[152:155]
 s_waitcnt lgkmcnt(0) vmcnt(16)
 s_barrier
 ds_read_b128 v[208:211], v12 offset:0
 MM a[156:159],v[228:231],v[160:163],a[156:159]
 v_fma_f32 v135, v135, s82, v186
 v_max3_f32 v254, v254, v132, v133
 MM a[160:163],v[228:231],v[164:167],a[160:163]
 v_max3_f32 v253, v253, v134, v135
 MM a[164:167],v[228:231],v[168:171],a[164:167]
 ds_read_b128 v[212:215], v12 offset:64
 v_max_f32 v253, v253, v254
 MM a[168:171],v[232:235],v[160:163],a[168:171]
 v_cmp_lt_f32 vcc, 0x41800000, v253
 MM a[172:175],v[232:235],v[164:167],a[172:175]
 MM a[176:179],v[232:235],v[168:171],a[176:179]
 ds_read_b128 v[216:219], v12 offset:128
 MM a[180:183],v[236:239],v[160:163],a[180:183]
 MM a[184:187],v[236:239],v[164:167],a[184:187]
 MM a[188:191],v[236:239],v[168:171],a[188:191]
 s_cbranch_vccnz LB0_t1
LB0_r1:
 s_waitcnt lgkmcnt(2)
 ds_read_b128 v[220:223], v12 offset:192
 MM v[136:139],v[208:211],v[16:19],0
 s_mov_b32 m0, s95
 v_exp_f32 v112, v112
 MM v[140:143],v[208:211],v[20:23],0
 ds_read_b128 v[224:227], v12 offset:256
 buffer_load_dwordx4 v4, s[40:43], s74 offen offset:0 nt lds
 MM v[144:147],v[208:211],v[24:27],0
 s_waitcnt lgkmcnt(3)
 v_exp_f32 v113, v113
 MM v[136:139],v[212:215],v[28:31],v[136:139]
 v_exp_f32 v114, v114
 MM v[140:143],v[212:215],v[32:35],v[140:143]
 ds_read_b128 v[228:231], v12 offset:320
 buffer_load_dwordx4 v5, s[40:43], s74 offen offset:1056 nt lds
 MM v[144:147],v[212:215],v[36:39],v[144:147]
 s_waitcnt lgkmcnt(2)
 v_exp_f32 v115, v115
 MM v[136:139],v[216:219],v[40:43],v[136:139]
 ds_read_b128 v[232:235], v12 offset:384
 CV v160,v112,v113
 MM v[140:143],v[216:219],v[44:47],v[140:143]
 v_exp_f32 v124, v124
 MM v[144:147],v[216:219],v[48:51],v[144:147]
 v_exp_f32 v125, v125
 MM v[136:139],v[220:223],v[52:55],v[136:139]
 ds_read_b128 v[236:239], v12 offset:448
 buffer_load_dwordx4 v6, s[40:43], s74 offen offset:2112 nt lds
 MM v[140:143],v[220:223],v[56:59],v[140:143]
 CV v161,v114,v115
 CV v162,v124,v125
 MM v[144:147],v[220:223],v[60:63],v[144:147]
 s_waitcnt lgkmcnt(2)
 ds_read_b128 v[208:211], v12 offset:512
 MM v[136:139],v[224:227],v[64:67],v[136:139]
 v_exp_f32 v126, v126
 MM v[140:143],v[224:227],v[68:71],v[140:143]
 v_exp_f32 v127, v127
 MM v[144:147],v[224:227],v[72:75],v[144:147]
 ds_read_b128 v[212:215], v12 offset:576
 buffer_load_dwordx4 v7, s[40:43], s74 offen offset:3168 nt lds
 MM v[136:139],v[228:231],v[76:79],v[136:139]
 v_exp_f32 v116, v116
 MM v[140:143],v[228:231],v[80:83],v[140:143]
 ds_read_b128 v[216:219], v12 offset:640
 CV v163,v126,v127
 MM v[144:147],v[228:231],v[84:87],v[144:147]
 s_waitcnt lgkmcnt(3)
 v_exp_f32 v117, v117
 MM v[136:139],v[232:235],v[88:91],v[136:139]
 s_add_u32 m0, s95, 4224
 s_add_u32 s3, s74, 4096
 CV v164,v116,v117
 MM v[140:143],v[232:235],v[92:95],v[140:143]
 ds_read_b128 v[220:223], v12 offset:704
 buffer_load_dwordx4 v4, s[40:43], s3 offen offset:0 nt lds
 MM v[144:147],v[232:235],v[96:99],v[144:147]
 v_exp_f32 v118, v118
 MM v[136:139],v[236:239],v[100:103],v[136:139]
 ds_read_b128 v[224:227], v12 offset:768
 buffer_load_dwordx4 v5, s[40:43], s3 offen offset:1056 nt lds
 MM v[140:143],v[236:239],v[104:107],v[140:143]
 v_exp_f32 v119, v119
 MM v[144:147],v[236:239],v[108:111],v[144:147]
 s_waitcnt lgkmcnt(3)
 v_exp_f32 v128, v128
 MM v[148:151],v[208:211],v[16:19],0
 ds_read_b128 v[228:231], v12 offset:832
 CV v165,v118,v119
 MM v[152:155],v[208:211],v[20:23],0
 v_exp_f32 v129, v129
 MM v[156:159],v[208:211],v[24:27],0
 ds_read_b128 v[232:235], v12 offset:896
 buffer_load_dwordx4 v6, s[40:43], s3 offen offset:2112 nt lds
 MM v[148:151],v[212:215],v[28:31],v[148:151]
 v_exp_f32 v130, v130
 MM v[152:155],v[212:215],v[32:35],v[152:155]
 v_exp_f32 v131, v131
 MM v[156:159],v[212:215],v[36:39],v[156:159]
 s_waitcnt lgkmcnt(3)
 ds_read_b128 v[236:239], v12 offset:960
 buffer_load_dwordx4 v7, s[40:43], s3 offen offset:3168 nt lds
 MM v[148:151],v[216:219],v[40:43],v[148:151]
 s_add_u32 s74, s74, 16384
 CV v166,v128,v129
 CV v167,v130,v131
 MM v[152:155],v[216:219],v[44:47],v[152:155]
 v_exp_f32 v120, v120
 MM v[156:159],v[216:219],v[48:51],v[156:159]
 v_exp_f32 v121, v121
 MM v[148:151],v[220:223],v[52:55],v[148:151]
 v_exp_f32 v122, v122
 MM v[152:155],v[220:223],v[56:59],v[152:155]
 v_exp_f32 v123, v123
 MM v[156:159],v[220:223],v[60:63],v[156:159]
 s_waitcnt lgkmcnt(3)
 CV v168,v120,v121
 CV v169,v122,v123
 MM v[148:151],v[224:227],v[64:67],v[148:151]
 v_exp_f32 v132, v132
 MM v[152:155],v[224:227],v[68:71],v[152:155]
 v_exp_f32 v133, v133
 MM v[156:159],v[224:227],v[72:75],v[156:159]
 s_waitcnt lgkmcnt(0) vmcnt(16)
 s_barrier
 TR v[208:209],v14,33792
 MM v[148:151],v[228:231],v[76:79],v[148:151]
 TR v[210:211],v14,34304
 CV v170,v132,v133
 MM v[152:155],v[228:231],v[80:83],v[152:155]
 v_exp_f32 v134, v134
 MM v[156:159],v[228:231],v[84:87],v[156:159]
 TR v[212:213],v14,33824
 TR v[214:215],v14,34336
 MM v[148:151],v[232:235],v[88:91],v[148:151]
 v_exp_f32 v135, v135
 MM v[152:155],v[232:235],v[92:95],v[152:155]
 CV v171,v134,v135
 MM v[156:159],v[232:235],v[96:99],v[156:159]
 TR v[216:217],v14,33856
 TR v[218:219],v14,34368
 MM v[148:151],v[236:239],v[100:103],v[148:151]
 MM v[152:155],v[236:239],v[104:107],v[152:155]
 MM v[156:159],v[236:239],v[108:111],v[156:159]
 MM a[192:195],a[204:207],v[160:163],a[192:195]
 MM a[196:199],a[204:207],v[164:167],a[196:199]
 MM a[200:203],a[204:207],v[168:171],a[200:203]
 s_waitcnt lgkmcnt(4)
 TR v[220:221],v14,33888
 MM a[0:3],v[208:211],v[160:163],a[0:3]
 TR v[222:223],v14,34400
 v_fma_f32 v136, v136, s82, v184
 MM a[4:7],v[208:211],v[164:167],a[4:7]
 TR v[224:225],v14,33920
 v_fma_f32 v137, v137, s82, v184
 MM a[8:11],v[208:211],v[168:171],a[8:11]
 s_waitcnt lgkmcnt(5)
 s_mov_b32 m0, s89
 TR v[226:227],v14,34432
 MM a[12:15],v[212:215],v[160:163],a[12:15]
 buffer_load_dwordx4 v4, s[32:35], s72 offen offset:0 nt lds
 v_fma_f32 v138, v138, s82, v184
 MM a[16:19],v[212:215],v[164:167],a[16:19]
 TR v[228:229],v14,33952
 buffer_load_dwordx4 v5, s[32:35], s72 offen offset:1056 nt lds
 MM a[20:23],v[212:215],v[168:171],a[20:23]
 s_waitcnt lgkmcnt(3)
 TR v[230:231],v14,34464
 v_fma_f32 v139, v139, s82, v184
 MM a[24:27],v[216:219],v[160:163],a[24:27]
 TR v[232:233],v14,33984
 MM a[28:31],v[216:219],v[164:167],a[28:31]
 TR v[234:235],v14,34496
 v_fma_f32 v140, v140, s82, v185
 MM a[32:35],v[216:219],v[168:171],a[32:35]
 buffer_load_dwordx4 v6, s[32:35], s72 offen offset:2112 nt lds
 v_fma_f32 v141, v141, s82, v185
 MM a[36:39],v[220:223],v[160:163],a[36:39]
 TR v[236:237],v14,34016
 v_fma_f32 v142, v142, s82, v185
 MM a[40:43],v[220:223],v[164:167],a[40:43]
 TR v[238:239],v14,34528
 MM a[44:47],v[220:223],v[168:171],a[44:47]
 s_waitcnt lgkmcnt(4)
 TR v[208:209],v14,34048
 v_fma_f32 v143, v143, s82, v185
 MM a[48:51],v[224:227],v[160:163],a[48:51]
 TR v[210:211],v14,34560
 v_max3_f32 v253, v136, v137, v138
 MM a[52:55],v[224:227],v[164:167],a[52:55]
 buffer_load_dwordx4 v7, s[32:35], s72 offen offset:3168 nt lds
 v_max3_f32 v254, v139, v140, v141
 MM a[56:59],v[224:227],v[168:171],a[56:59]
 TR v[212:213],v14,34080
 v_fma_f32 v144, v144, s82, v186
 MM a[60:63],v[228:231],v[160:163],a[60:63]
 TR v[214:215],v14,34592
 MM a[64:67],v[228:231],v[164:167],a[64:67]
 s_add_u32 m0, s89, 4224
 s_add_u32 s3, s72, 4096
 TR v[216:217],v14,34112
 MM a[68:71],v[228:231],v[168:171],a[68:71]
 s_waitcnt lgkmcnt(5)
 buffer_load_dwordx4 v4, s[32:35], s3 offen offset:0 nt lds
 v_fma_f32 v145, v145, s82, v186
 MM a[72:75],v[232:235],v[160:163],a[72:75]
 TR v[218:219],v14,34624
 v_max3_f32 v253, v253, v142, v143
 MM a[76:79],v[232:235],v[164:167],a[76:79]
 TR v[220:221],v14,34144
 v_fma_f32 v146, v146, s82, v186
 MM a[80:83],v[232:235],v[168:171],a[80:83]
 TR v[222:223],v14,34656
 MM a[84:87],v[236:239],v[160:163],a[84:87]
 TR v[224:225],v14,34176
 v_fma_f32 v147, v147, s82, v186
 MM a[88:91],v[236:239],v[164:167],a[88:91]
 buffer_load_dwordx4 v5, s[32:35], s3 offen offset:1056 nt lds
 v_max3_f32 v254, v254, v144, v145
 MM a[92:95],v[236:239],v[168:171],a[92:95]
 s_waitcnt lgkmcnt(5)
 TR v[226:227],v14,34688
 v_fma_f32 v148, v148, s82, v184
 MM a[96:99],v[208:211],v[160:163],a[96:99]
 TR v[228:229],v14,34208
 MM a[100:103],v[208:211],v[164:167],a[100:103]
 TR v[230:231],v14,34720
 v_fma_f32 v149, v149, s82, v184
 MM a[104:107],v[208:211],v[168:171],a[104:107]
 TR v[232:233],v14,34240
 v_max3_f32 v253, v253, v146, v147
 MM a[108:111],v[212:215],v[160:163],a[108:111]
 buffer_load_dwordx4 v6, s[32:35], s3 offen offset:2112 nt lds
 v_fma_f32 v150, v150, s82, v184
 MM a[112:115],v[212:215],v[164:167],a[112:115]
 TR v[234:235],v14,34752
 v_fma_f32 v151, v151, s82, v184
 MM a[116:119],v[212:215],v[168:171],a[116:119]
 s_waitcnt lgkmcnt(6)
 TR v[236:237],v14,34272
 MM a[120:123],v[216:219],v[160:163],a[120:123]
 TR v[238:239],v14,34784
 v_max3_f32 v254, v254, v148, v149
 MM a[124:127],v[216:219],v[164:167],a[124:127]
 buffer_load_dwordx4 v7, s[32:35], s3 offen offset:3168 nt lds
 v_fma_f32 v152, v152, s82, v185
 MM a[128:131],v[216:219],v[168:171],a[128:131]
 s_add_u32 s72, s72, 16384
 v_fma_f32 v153, v153, s82, v185
 MM a[132:135],v[220:223],v[160:163],a[132:135]
 v_max3_f32 v253, v253, v150, v151
 v_fma_f32 v154, v154, s82, v185
 MM a[136:139],v[220:223],v[164:167],a[136:139]
 v_fma_f32 v155, v155, s82, v185
 MM a[140:143],v[220:223],v[168:171],a[140:143]
 s_waitcnt lgkmcnt(6)
 v_max3_f32 v254, v254, v152, v153
 v_fma_f32 v156, v156, s82, v186
 MM a[144:147],v[224:227],v[160:163],a[144:147]
 v_fma_f32 v157, v157, s82, v186
 v_max3_f32 v253, v253, v154, v155
 MM a[148:151],v[224:227],v[164:167],a[148:151]
 v_fma_f32 v158, v158, s82, v186
 MM a[152:155],v[224:227],v[168:171],a[152:155]
 s_waitcnt lgkmcnt(0) vmcnt(16)
 s_barrier
 ds_read_b128 v[208:211], v13 offset:0
 MM a[156:159],v[228:231],v[160:163],a[156:159]
 v_fma_f32 v159, v159, s82, v186
 v_max3_f32 v254, v254, v156, v157
 MM a[160:163],v[228:231],v[164:167],a[160:163]
 v_max3_f32 v253, v253, v158, v159
 MM a[164:167],v[228:231],v[168:171],a[164:167]
 ds_read_b128 v[212:215], v13 offset:64
 v_max_f32 v253, v253, v254
 MM a[168:171],v[232:235],v[160:163],a[168:171]
 v_cmp_lt_f32 vcc, 0x41800000, v253
 MM a[172:175],v[232:235],v[164:167],a[172:175]
 MM a[176:179],v[232:235],v[168:171],a[176:179]
 ds_read_b128 v[216:219], v13 offset:128
 MM a[180:183],v[236:239],v[160:163],a[180:183]
 MM a[184:187],v[236:239],v[164:167],a[184:187]
 MM a[188:191],v[236:239],v[168:171],a[188:191]
 s_add_u32 s79, s79, 1
 s_cmp_lt_u32 s79, 14
 s_cbranch_scc1 LB0_loop10
 s_cbranch_vccnz LB0_t28
LB0_r28:
 s_waitcnt lgkmcnt(2)
 ds_read_b128 v[220:223], v13 offset:192
 MM v[112:115],v[208:211],v[16:19],0
 s_mov_b32 m0, s91
 v_exp_f32 v136, v136
 MM v[116:119],v[208:211],v[20:23],0
 ds_read_b128 v[224:227], v13 offset:256
 buffer_load_dwordx4 v4, s[40:43], s74 offen offset:0 nt lds
 MM v[120:123],v[208:211],v[24:27],0
 s_waitcnt lgkmcnt(3)
 v_exp_f32 v137, v137
 MM v[112:115],v[212:215],v[28:31],v[112:115]
 v_exp_f32 v138, v138
 MM v[116:119],v[212:215],v[32:35],v[116:119]
 ds_read_b128 v[228:231], v13 offset:320
 buffer_load_dwordx4 v5, s[40:43], s74 offen offset:1056 nt lds
 MM v[120:123],v[212:215],v[36:39],v[120:123]
 s_waitcnt lgkmcnt(2)
 v_exp_f32 v139, v139
 MM v[112:115],v[216:219],v[40:43],v[112:115]
 ds_read_b128 v[232:235], v13 offset:384
 CV v160,v136,v137
 MM v[116:119],v[216:219],v[44:47],v[116:119]
 v_exp_f32 v148, v148
 MM v[120:123],v[216:219],v[48:51],v[120:123]
 v_exp_f32 v149, v149
 MM v[112:115],v[220:223],v[52:55],v[112:115]
 ds_read_b128 v[236:239], v13 offset:448
 buffer_load_dwordx4 v6, s[40:43], s74 offen offset:2112 nt lds
 MM v[116:119],v[220:223],v[56:59],v[116:119]
 CV v161,v138,v139
 CV v162,v148,v149
 MM v[120:123],v[220:223],v[60:63],v[120:123]
 s_waitcnt lgkmcnt(2)
 ds_read_b128 v[208:211], v13 offset:512
 MM v[112:115],v[224:227],v[64:67],v[112:115]
 v_exp_f32 v150, v150
 MM v[116:119],v[224:227],v[68:71],v[116:119]
 v_exp_f32 v151, v151
 MM v[120:123],v[224:227],v[72:75],v[120:123]
 ds_read_b128 v[212:215], v13 offset:576
 buffer_load_dwordx4 v7, s[40:43], s74 offen offset:3168 nt lds
 MM v[112:115],v[228:231],v[76:79],v[112:115]
 v_exp_f32 v140, v140
 MM v[116:119],v[228:231],v[80:83],v[116:119]
 ds_read_b128 v[216:219], v13 offset:640
 CV v163,v150,v151
 MM v[120:123],v[228:231],v[84:87],v[120:123]
 s_waitcnt lgkmcnt(3)
 v_exp_f32 v141, v141
 MM v[112:115],v[232:235],v[88:91],v[112:115]
 s_add_u32 m0, s91, 4224
 s_add_u32 s3, s74, 4096
 CV v164,v140,v141
 MM v[116:119],v[232:235],v[92:95],v[116:119]
 ds_read_b128 v[220:223], v13 offset:704
 buffer_load_dwordx4 v4, s[40:43], s3 offen offset:0 nt lds
 MM v[120:123],v[232:235],v[96:99],v[120:123]
 v_exp_f32 v142, v142
 MM v[112:115],v[236:239],v[100:103],v[112:115]
 ds_read_b128 v[224:227], v13 offset:768
 buffer_load_dwordx4 v5, s[40:43], s3 offen offset:1056 nt lds
 MM v[116:119],v[236:239],v[104:107],v[116:119]
 v_exp_f32 v143, v143
 MM v[120:123],v[236:239],v[108:111],v[120:123]
 s_waitcnt lgkmcnt(3)
 v_exp_f32 v152, v152
 MM v[124:127],v[208:211],v[16:19],0
 ds_read_b128 v[228:231], v13 offset:832
 CV v165,v142,v143
 MM v[128:131],v[208:211],v[20:23],0
 v_exp_f32 v153, v153
 MM v[132:135],v[208:211],v[24:27],0
 ds_read_b128 v[232:235], v13 offset:896
 buffer_load_dwordx4 v6, s[40:43], s3 offen offset:2112 nt lds
 MM v[124:127],v[212:215],v[28:31],v[124:127]
 v_exp_f32 v154, v154
 MM v[128:131],v[212:215],v[32:35],v[128:131]
 v_exp_f32 v155, v155
 MM v[132:135],v[212:215],v[36:39],v[132:135]
 s_waitcnt lgkmcnt(3)
 ds_read_b128 v[236:239], v13 offset:960
 buffer_load_dwordx4 v7, s[40:43], s3 offen offset:3168 nt lds
 MM v[124:127],v[216:219],v[40:43],v[124:127]
 s_add_u32 s74, s74, 16384
 CV v166,v152,v153
 CV v167,v154,v155
 MM v[128:131],v[216:219],v[44:47],v[128:131]
 v_exp_f32 v144, v144
 MM v[132:135],v[216:219],v[48:51],v[132:135]
 v_exp_f32 v145, v145
 MM v[124:127],v[220:223],v[52:55],v[124:127]
 v_exp_f32 v146, v146
 MM v[128:131],v[220:223],v[56:59],v[128:131]
 v_exp_f32 v147, v147
 MM v[132:135],v[220:223],v[60:63],v[132:135]
 s_waitcnt lgkmcnt(3)
 CV v168,v144,v145
 CV v169,v146,v147
 MM v[124:127],v[224:227],v[64:67],v[124:127]
 v_exp_f32 v156, v156
 MM v[128:131],v[224:227],v[68:71],v[128:131]
 v_exp_f32 v157, v157
 MM v[132:135],v[224:227],v[72:75],v[132:135]
 s_waitcnt lgkmcnt(0) vmcnt(16)
 s_barrier
 TR v[208:209],v15,33792
 MM v[124:127],v[228:231],v[76:79],v[124:127]
 TR v[210:211],v15,34304
 CV v170,v156,v157
 MM v[128:131],v[228:231],v[80:83],v[128:131]
 v_exp_f32 v158, v158
 MM v[132:135],v[228:231],v[84:87],v[132:135]
 TR v[212:213],v15,33824
 TR v[214:215],v15,34336
 MM v[124:127],v[232:235],v[88:91],v[124:127]
 v_exp_f32 v159, v159
 MM v[128:131],v[232:235],v[92:95],v[128:131]
 CV v171,v158,v159
 MM v[132:135],v[232:235],v[96:99],v[132:135]
 TR v[216:217],v15,33856
 TR v[218:219],v15,34368
 MM v[124:127],v[236:239],v[100:103],v[124:127]
 MM v[128:131],v[236:239],v[104:107],v[128:131]
 MM v[132:135],v[236:239],v[108:111],v[132:135]
 MM a[192:195],a[204:207],v[160:163],a[192:195]
 MM a[196:199],a[204:207],v[164:167],a[196:199]
 MM a[200:203],a[204:207],v[168:171],a[200:203]
 s_waitcnt lgkmcnt(4)
 TR v[220:221],v15,33888
 MM a[0:3],v[208:211],v[160:163],a[0:3]
 TR v[222:223],v15,34400
 v_fma_f32 v112, v112, s82, v184
 MM a[4:7],v[208:211],v[164:167],a[4:7]
 TR v[224:225],v15,33920
 v_fma_f32 v113, v113, s82, v184
 MM a[8:11],v[208:211],v[168:171],a[8:11]
 s_waitcnt lgkmcnt(5)
 s_mov_b32 m0, s93
 TR v[226:227],v15,34432
 MM a[12:15],v[212:215],v[160:163],a[12:15]
 buffer_load_dwordx4 v4, s[40:43], s74 offen offset:0 nt lds
 v_fma_f32 v114, v114, s82, v184
 MM a[16:19],v[212:215],v[164:167],a[16:19]
 TR v[228:229],v15,33952
 buffer_load_dwordx4 v5, s[40:43], s74 offen offset:1056 nt lds
 MM a[20:23],v[212:215],v[168:171],a[20:23]
 s_waitcnt lgkmcnt(3)
 TR v[230:231],v15,34464
 v_fma_f32 v115, v115, s82, v184
 MM a[24:27],v[216:219],v[160:163],a[24:27]
 TR v[232:233],v15,33984
 MM a[28:31],v[216:219],v[164:167],a[28:31]
 TR v[234:235],v15,34496
 v_fma_f32 v116, v116, s82, v185
 MM a[32:35],v[216:219],v[168:171],a[32:35]
 buffer_load_dwordx4 v6, s[40:43], s74 offen offset:2112 nt lds
 v_fma_f32 v117, v117, s82, v185
 MM a[36:39],v[220:223],v[160:163],a[36:39]
 TR v[236:237],v15,34016
 v_fma_f32 v118, v118, s82, v185
 MM a[40:43],v[220:223],v[164:167],a[40:43]
 TR v[238:239],v15,34528
 MM a[44:47],v[220:223],v[168:171],a[44:47]
 s_waitcnt lgkmcnt(4)
 TR v[208:209],v15,34048
 v_fma_f32 v119, v119, s82, v185
 MM a[48:51],v[224:227],v[160:163],a[48:51]
 TR v[210:211],v15,34560
 v_max3_f32 v253, v112, v113, v114
 MM a[52:55],v[224:227],v[164:167],a[52:55]
 buffer_load_dwordx4 v7, s[40:43], s74 offen offset:3168 nt lds
 v_max3_f32 v254, v115, v116, v117
 MM a[56:59],v[224:227],v[168:171],a[56:59]
 TR v[212:213],v15,34080
 v_fma_f32 v120, v120, s82, v186
 MM a[60:63],v[228:231],v[160:163],a[60:63]
 TR v[214:215],v15,34592
 MM a[64:67],v[228:231],v[164:167],a[64:67]
 s_add_u32 m0, s93, 4224
 s_add_u32 s3, s74, 4096
 TR v[216:217],v15,34112
 MM a[68:71],v[228:231],v[168:171],a[68:71]
 s_waitcnt lgkmcnt(5)
 buffer_load_dwordx4 v4, s[40:43], s3 offen offset:0 nt lds
 v_fma_f32 v121, v121, s82, v186
 MM a[72:75],v[232:235],v[160:163],a[72:75]
 TR v[218:219],v15,34624
 v_max3_f32 v253, v253, v118, v119
 MM a[76:79],v[232:235],v[164:167],a[76:79]
 TR v[220:221],v15,34144
 v_fma_f32 v122, v122, s82, v186
 MM a[80:83],v[232:235],v[168:171],a[80:83]
 TR v[222:223],v15,34656
 MM a[84:87],v[236:239],v[160:163],a[84:87]
 TR v[224:225],v15,34176
 v_fma_f32 v123, v123, s82, v186
 MM a[88:91],v[236:239],v[164:167],a[88:91]
 buffer_load_dwordx4 v5, s[40:43], s3 offen offset:1056 nt lds
 v_max3_f32 v254, v254, v120, v121
 MM a[92:95],v[236:239],v[168:171],a[92:95]
 s_waitcnt lgkmcnt(5)
 TR v[226:227],v15,34688
 v_fma_f32 v124, v124, s82, v184
 MM a[96:99],v[208:211],v[160:163],a[96:99]
 TR v[228:229],v15,34208
 MM a[100:103],v[208:211],v[164:167],a[100:103]
 TR v[230:231],v15,34720
 v_fma_f32 v125, v125, s82, v184
 MM a[104:107],v[208:211],v[168:171],a[104:107]
 TR v[232:233],v15,34240
 v_max3_f32 v253, v253, v122, v123
 MM a[108:111],v[212:215],v[160:163],a[108:111]
 buffer_load_dwordx4 v6, s[40:43], s3 offen offset:2112 nt lds
 v_fma_f32 v126, v126, s82, v184
 MM a[112:115],v[212:215],v[164:167],a[112:115]
 TR v[234:235],v15,34752
 v_fma_f32 v127, v127, s82, v184
 MM a[116:119],v[212:215],v[168:171],a[116:119]
 s_waitcnt lgkmcnt(6)
 TR v[236:237],v15,34272
 MM a[120:123],v[216:219],v[160:163],a[120:123]
 TR v[238:239],v15,34784
 v_max3_f32 v254, v254, v124, v125
 MM a[124:127],v[216:219],v[164:167],a[124:127]
 buffer_load_dwordx4 v7, s[40:43], s3 offen offset:3168 nt lds
 v_fma_f32 v128, v128, s82, v185
 MM a[128:131],v[216:219],v[168:171],a[128:131]
 s_add_u32 s74, s74, 16384
 v_fma_f32 v129, v129, s82, v185
 MM a[132:135],v[220:223],v[160:163],a[132:135]
 v_max3_f32 v253, v253, v126, v127
 v_fma_f32 v130, v130, s82, v185
 MM a[136:139],v[220:223],v[164:167],a[136:139]
 v_fma_f32 v131, v131, s82, v185
 MM a[140:143],v[220:223],v[168:171],a[140:143]
 s_waitcnt lgkmcnt(6)
 v_max3_f32 v254, v254, v128, v129
 v_fma_f32 v132, v132, s82, v186
 MM a[144:147],v[224:227],v[160:163],a[144:147]
 v_fma_f32 v133, v133, s82, v186
 v_max3_f32 v253, v253, v130, v131
 MM a[148:151],v[224:227],v[164:167],a[148:151]
 v_fma_f32 v134, v134, s82, v186
 MM a[152:155],v[224:227],v[168:171],a[152:155]
 s_waitcnt lgkmcnt(0) vmcnt(16)
 s_barrier
 ds_read_b128 v[208:211], v12 offset:0
 MM a[156:159],v[228:231],v[160:163],a[156:159]
 v_fma_f32 v135, v135, s82, v186
 v_max3_f32 v254, v254, v132, v133
 MM a[160:163],v[228:231],v[164:167],a[160:163]
 v_max3_f32 v253, v253, v134, v135
 MM a[164:167],v[228:231],v[168:171],a[164:167]
 ds_read_b128 v[212:215], v12 offset:64
 v_max_f32 v253, v253, v254
 MM a[168:171],v[232:235],v[160:163],a[168:171]
 v_cmp_lt_f32 vcc, 0x41800000, v253
 MM a[172:175],v[232:235],v[164:167],a[172:175]
 MM a[176:179],v[232:235],v[168:171],a[176:179]
 ds_read_b128 v[216:219], v12 offset:128
 MM a[180:183],v[236:239],v[160:163],a[180:183]
 MM a[184:187],v[236:239],v[164:167],a[184:187]
 MM a[188:191],v[236:239],v[168:171],a[188:191]
 s_cbranch_vccnz LB0_t29
LB0_r29:
 s_waitcnt lgkmcnt(2)
 ds_read_b128 v[220:223], v12 offset:192
 MM v[136:139],v[208:211],v[16:19],0
 s_mov_b32 m0, s95
 v_exp_f32 v112, v112
 MM v[140:143],v[208:211],v[20:23],0
 ds_read_b128 v[224:227], v12 offset:256
 buffer_load_dwordx4 v240, s[64:67], s80 offen offset:0 lds
 MM v[144:147],v[208:211],v[24:27],0
 s_waitcnt lgkmcnt(3)
 v_exp_f32 v113, v113
 MM v[136:139],v[212:215],v[28:31],v[136:139]
 v_exp_f32 v114, v114
 MM v[140:143],v[212:215],v[32:35],v[140:143]
 ds_read_b128 v[228:231], v12 offset:320
 buffer_load_dwordx4 v241, s[64:67], s80 offen offset:1056 lds
 MM v[144:147],v[212:215],v[36:39],v[144:147]
 s_waitcnt lgkmcnt(2)
 v_exp_f32 v115, v115
 MM v[136:139],v[216:219],v[40:43],v[136:139]
 ds_read_b128 v[232:235], v12 offset:384
 CV v160,v112,v113
 MM v[140:143],v[216:219],v[44:47],v[140:143]
 v_exp_f32 v124, v124
 MM v[144:147],v[216:219],v[48:51],v[144:147]
 v_exp_f32 v125, v125
 MM v[136:139],v[220:223],v[52:55],v[136:139]
 ds_read_b128 v[236:239], v12 offset:448
 buffer_load_dwordx4 v242, s[64:67], s80 offen offset:2112 lds
 MM v[140:143],v[220:223],v[56:59],v[140:143]
 CV v161,v114,v115
 CV v162,v124,v125
 MM v[144:147],v[220:223],v[60:63],v[144:147]
 s_waitcnt lgkmcnt(2)
 ds_read_b128 v[208:211], v12 offset:512
 MM v[136:139],v[224:227],v[64:67],v[136:139]
 v_exp_f32 v126, v126
 MM v[140:143],v[224:227],v[68:71],v[140:143]
 v_exp_f32 v127, v127
 MM v[144:147],v[224:227],v[72:75],v[144:147]
 ds_read_b128 v[212:215], v12 offset:576
 buffer_load_dwordx4 v243, s[64:67], s80 offen offset:3168 lds
 MM v[136:139],v[228:231],v[76:79],v[136:139]
 v_exp_f32 v116, v116
 MM v[140:143],v[228:231],v[80:83],v[140:143]
 ds_read_b128 v[216:219], v12 offset:640
 CV v163,v126,v127
 MM v[144:147],v[228:231],v[84:87],v[144:147]
 s_waitcnt lgkmcnt(3)
 v_exp_f32 v117, v117
 MM v[136:139],v[232:235],v[88:91],v[136:139]
 s_add_u32 m0, s95, 4224
 s_add_u32 s3, s80, 3584
 CV v164,v116,v117
 MM v[140:143],v[232:235],v[92:95],v[140:143]
 ds_read_b128 v[220:223], v12 offset:704
 buffer_load_dwordx4 v240, s[64:67], s3 offen offset:0 lds
 MM v[144:147],v[232:235],v[96:99],v[144:147]
 v_exp_f32 v118, v118
 MM v[136:139],v[236:239],v[100:103],v[136:139]
 ds_read_b128 v[224:227], v12 offset:768
 buffer_load_dwordx4 v241, s[64:67], s3 offen offset:1056 lds
 MM v[140:143],v[236:239],v[104:107],v[140:143]
 v_exp_f32 v119, v119
 MM v[144:147],v[236:239],v[108:111],v[144:147]
 s_waitcnt lgkmcnt(3)
 v_exp_f32 v128, v128
 MM v[148:151],v[208:211],v[16:19],0
 ds_read_b128 v[228:231], v12 offset:832
 CV v165,v118,v119
 MM v[152:155],v[208:211],v[20:23],0
 v_exp_f32 v129, v129
 MM v[156:159],v[208:211],v[24:27],0
 ds_read_b128 v[232:235], v12 offset:896
 buffer_load_dwordx4 v242, s[64:67], s3 offen offset:2112 lds
 MM v[148:151],v[212:215],v[28:31],v[148:151]
 v_exp_f32 v130, v130
 MM v[152:155],v[212:215],v[32:35],v[152:155]
 v_exp_f32 v131, v131
 MM v[156:159],v[212:215],v[36:39],v[156:159]
 s_waitcnt lgkmcnt(3)
 ds_read_b128 v[236:239], v12 offset:960
 buffer_load_dwordx4 v243, s[64:67], s3 offen offset:3168 lds
 MM v[148:151],v[216:219],v[40:43],v[148:151]
 CV v166,v128,v129
 CV v167,v130,v131
 MM v[152:155],v[216:219],v[44:47],v[152:155]
 v_exp_f32 v120, v120
 MM v[156:159],v[216:219],v[48:51],v[156:159]
 v_exp_f32 v121, v121
 MM v[148:151],v[220:223],v[52:55],v[148:151]
 v_exp_f32 v122, v122
 MM v[152:155],v[220:223],v[56:59],v[152:155]
 v_exp_f32 v123, v123
 MM v[156:159],v[220:223],v[60:63],v[156:159]
 s_waitcnt lgkmcnt(3)
 CV v168,v120,v121
 CV v169,v122,v123
 MM v[148:151],v[224:227],v[64:67],v[148:151]
 v_exp_f32 v132, v132
 MM v[152:155],v[224:227],v[68:71],v[152:155]
 v_exp_f32 v133, v133
 MM v[156:159],v[224:227],v[72:75],v[156:159]
 s_waitcnt lgkmcnt(0) vmcnt(16)
 s_barrier
 TR v[208:209],v14,33792
 MM v[148:151],v[228:231],v[76:79],v[148:151]
 TR v[210:211],v14,34304
 CV v170,v132,v133
 MM v[152:155],v[228:231],v[80:83],v[152:155]
 v_exp_f32 v134, v134
 MM v[156:159],v[228:231],v[84:87],v[156:159]
 TR v[212:213],v14,33824
 TR v[214:215],v14,34336
 MM v[148:151],v[232:235],v[88:91],v[148:151]
 v_exp_f32 v135, v135
 MM v[152:155],v[232:235],v[92:95],v[152:155]
 CV v171,v134,v135
 MM v[156:159],v[232:235],v[96:99],v[156:159]
 TR v[216:217],v14,33856
 TR v[218:219],v14,34368
 MM v[148:151],v[236:239],v[100:103],v[148:151]
 MM v[152:155],v[236:239],v[104:107],v[152:155]
 MM v[156:159],v[236:239],v[108:111],v[156:159]
 MM a[192:195],a[204:207],v[160:163],a[192:195]
 MM a[196:199],a[204:207],v[164:167],a[196:199]
 MM a[200:203],a[204:207],v[168:171],a[200:203]
 s_waitcnt lgkmcnt(4)
 TR v[220:221],v14,33888
 MM a[0:3],v[208:211],v[160:163],a[0:3]
 TR v[222:223],v14,34400
 v_fma_f32 v136, v136, s82, v184
 MM a[4:7],v[208:211],v[164:167],a[4:7]
 TR v[224:225],v14,33920
 v_fma_f32 v137, v137, s82, v184
 MM a[8:11],v[208:211],v[168:171],a[8:11]
 s_waitcnt lgkmcnt(5)
 s_mov_b32 m0, s89
 TR v[226:227],v14,34432
 MM a[12:15],v[212:215],v[160:163],a[12:15]
 buffer_load_dwordx4 v240, s[64:67], s81 offen offset:0 lds
 v_fma_f32 v138, v138, s82, v184
 MM a[16:19],v[212:215],v[164:167],a[16:19]
 TR v[228:229],v14,33952
 buffer_load_dwordx4 v241, s[64:67], s81 offen offset:1056 lds
 MM a[20:23],v[212:215],v[168:171],a[20:23]
 s_waitcnt lgkmcnt(3)
 TR v[230:231],v14,34464
 v_fma_f32 v139, v139, s82, v184
 MM a[24:27],v[216:219],v[160:163],a[24:27]
 TR v[232:233],v14,33984
 v_fma_f32 v140, v140, s82, v185
 MM a[28:31],v[216:219],v[164:167],a[28:31]
 TR v[234:235],v14,34496
 v_fma_f32 v141, v141, s82, v185
 MM a[32:35],v[216:219],v[168:171],a[32:35]
 buffer_load_dwordx4 v242, s[64:67], s81 offen offset:2112 lds
 MM a[36:39],v[220:223],v[160:163],a[36:39]
 TR v[236:237],v14,34016
 v_fma_f32 v142, v142, s82, v185
 MM a[40:43],v[220:223],v[164:167],a[40:43]
 TR v[238:239],v14,34528
 v_fma_f32 v143, v143, s82, v185
 MM a[44:47],v[220:223],v[168:171],a[44:47]
 s_waitcnt lgkmcnt(4)
 TR v[208:209],v14,34048
 v_max3_f32 v253, v136, v137, v138
 MM a[48:51],v[224:227],v[160:163],a[48:51]
 TR v[210:211],v14,34560
 v_max3_f32 v254, v139, v140, v141
 MM a[52:55],v[224:227],v[164:167],a[52:55]
 buffer_load_dwordx4 v243, s[64:67], s81 offen offset:3168 lds
 v_fma_f32 v144, v144, s82, v186
 MM a[56:59],v[224:227],v[168:171],a[56:59]
 TR v[212:213],v14,34080
 MM a[60:63],v[228:231],v[160:163],a[60:63]
 TR v[214:215],v14,34592
 v_fma_f32 v145, v145, s82, v186
 MM a[64:67],v[228:231],v[164:167],a[64:67]
 s_add_u32 m0, s89, 4224
 s_add_u32 s3, s81, 3584
 TR v[216:217],v14,34112
 MM a[68:71],v[228:231],v[168:171],a[68:71]
 s_waitcnt lgkmcnt(5)
 buffer_load_dwordx4 v240, s[64:67], s3 offen offset:0 lds
 v_max3_f32 v253, v253, v142, v143
 MM a[72:75],v[232:235],v[160:163],a[72:75]
 TR v[218:219],v14,34624
 v_fma_f32 v146, v146, s82, v186
 MM a[76:79],v[232:235],v[164:167],a[76:79]
 TR v[220:221],v14,34144
 v_fma_f32 v147, v147, s82, v186
 MM a[80:83],v[232:235],v[168:171],a[80:83]
 TR v[222:223],v14,34656
 v_max3_f32 v254, v254, v144, v145
 MM a[84:87],v[236:239],v[160:163],a[84:87]
 TR v[224:225],v14,34176
 MM a[88:91],v[236:239],v[164:167],a[88:91]
 buffer_load_dwordx4 v241, s[64:67], s3 offen offset:1056 lds
 v_fma_f32 v148, v148, s82, v184
 MM a[92:95],v[236:239],v[168:171],a[92:95]
 s_waitcnt lgkmcnt(5)
 TR v[226:227],v14,34688
 v_fma_f32 v149, v149, s82, v184
 MM a[96:99],v[208:211],v[160:163],a[96:99]
 TR v[228:229],v14,34208
 v_max3_f32 v253, v253, v146, v147
 MM a[100:103],v[208:211],v[164:167],a[100:103]
 TR v[230:231],v14,34720
 v_fma_f32 v150, v150, s82, v184
 MM a[104:107],v[208:211],v[168:171],a[104:107]
 TR v[232:233],v14,34240
 v_fma_f32 v151, v151, s82, v184
 MM a[108:111],v[212:215],v[160:163],a[108:111]
 buffer_load_dwordx4 v242, s[64:67], s3 offen offset:2112 lds
 v_max3_f32 v254, v254, v148, v149
 MM a[112:115],v[212:215],v[164:167],a[112:115]
 TR v[234:235],v14,34752
 MM a[116:119],v[212:215],v[168:171],a[116:119]
 s_waitcnt lgkmcnt(6)
 TR v[236:237],v14,34272
 v_fma_f32 v152, v152, s82, v185
 MM a[120:123],v[216:219],v[160:163],a[120:123]
 TR v[238:239],v14,34784
 v_fma_f32 v153, v153, s82, v185
 MM a[124:127],v[216:219],v[164:167],a[124:127]
 buffer_load_dwordx4 v243, s[64:67], s3 offen offset:3168 lds
 v_max3_f32 v253, v253, v150, v151
 MM a[128:131],v[216:219],v[168:171],a[128:131]
 s_add_u32 s80, s80, 128
 s_cmp_eq_u32 s80, 896
 s_cselect_b32 s80, 0, s80
 s_add_u32 s81, s80, 114688
 MM a[132:135],v[220:223],v[160:163],a[132:135]
 v_fma_f32 v154, v154, s82, v185
 v_fma_f32 v155, v155, s82, v185
 MM a[136:139],v[220:223],v[164:167],a[136:139]
 v_max3_f32 v254, v254, v152, v153
 MM a[140:143],v[220:223],v[168:171],a[140:143]
 s_waitcnt lgkmcnt(6)
 v_fma_f32 v156, v156, s82, v186
 v_fma_f32 v157, v157, s82, v186
 MM a[144:147],v[224:227],v[160:163],a[144:147]
 v_max3_f32 v253, v253, v154, v155
 v_fma_f32 v158, v158, s82, v186
 MM a[148:151],v[224:227],v[164:167],a[148:151]
 v_fma_f32 v159, v159, s82, v186
 MM a[152:155],v[224:227],v[168:171],a[152:155]
 s_waitcnt lgkmcnt(0) vmcnt(16)
 s_barrier
 TR v[208:209],v15,0
 MM a[156:159],v[228:231],v[160:163],a[156:159]
 TR v[210:211],v15,512
 v_max3_f32 v254, v254, v156, v157
 MM a[160:163],v[228:231],v[164:167],a[160:163]
 v_max3_f32 v253, v253, v158, v159
 v_max_f32 v253, v253, v254
 MM a[164:167],v[228:231],v[168:171],a[164:167]
 TR v[212:213],v15,32
 v_cmp_lt_f32 vcc, 0x41800000, v253
 MM a[168:171],v[232:235],v[160:163],a[168:171]
 TR v[214:215],v15,544
 MM a[172:175],v[232:235],v[164:167],a[172:175]
 MM a[176:179],v[232:235],v[168:171],a[176:179]
 TR v[216:217],v15,64
 MM a[180:183],v[236:239],v[160:163],a[180:183]
 TR v[218:219],v15,576
 MM a[184:187],v[236:239],v[164:167],a[184:187]
 MM a[188:191],v[236:239],v[168:171],a[188:191]
 s_cbranch_vccnz LB0_t30
LB0_r30:
 v_exp_f32 v136, v136
 v_exp_f32 v137, v137
 v_exp_f32 v138, v138
 v_exp_f32 v139, v139
 v_exp_f32 v148, v148
 CV v160,v136,v137
 CV v161,v138,v139
 v_exp_f32 v149, v149
 v_exp_f32 v150, v150
 v_exp_f32 v151, v151
 v_exp_f32 v140, v140
 CV v162,v148,v149
 CV v163,v150,v151
 v_exp_f32 v141, v141
 v_exp_f32 v142, v142
 v_exp_f32 v143, v143
 v_exp_f32 v152, v152
 CV v164,v140,v141
 CV v165,v142,v143
 v_exp_f32 v153, v153
 v_exp_f32 v154, v154
 v_exp_f32 v155, v155
 v_exp_f32 v144, v144
 CV v166,v152,v153
 CV v167,v154,v155
 v_exp_f32 v145, v145
 v_exp_f32 v146, v146
 v_exp_f32 v147, v147
 v_exp_f32 v156, v156
 CV v168,v144,v145
 CV v169,v146,v147
 v_exp_f32 v157, v157
 v_exp_f32 v158, v158
 v_exp_f32 v159, v159
 CV v170,v156,v157
 CV v171,v158,v159
 MM a[192:195],a[204:207],v[160:163],a[192:195]
 MM a[196:199],a[204:207],v[164:167],a[196:199]
 MM a[200:203],a[204:207],v[168:171],a[200:203]
 s_waitcnt lgkmcnt(4)
 TR v[220:221],v15,96
 MM a[0:3],v[208:211],v[160:163],a[0:3]
 TR v[222:223],v15,608
 MM a[4:7],v[208:211],v[164:167],a[4:7]
 TR v[224:225],v15,128
 MM a[8:11],v[208:211],v[168:171],a[8:11]
 s_waitcnt lgkmcnt(5)
 s_mov_b32 m0, s91
 TR v[226:227],v15,640
 AR v244,a192
 MM a[12:15],v[212:215],v[160:163],a[12:15]
 buffer_load_dwordx4 v240, s[64:67], s80 offen offset:0 lds
 AR v245,a196
 AR v246,a200
 MM a[16:19],v[212:215],v[164:167],a[16:19]
 TR v[228:229],v15,160
 buffer_load_dwordx4 v241, s[64:67], s80 offen offset:1056 lds
 MM a[20:23],v[212:215],v[168:171],a[20:23]
 s_waitcnt lgkmcnt(3)
 TR v[230:231],v15,672
 v_rcp_f32 v244, v244
 MM a[24:27],v[216:219],v[160:163],a[24:27]
 TR v[232:233],v15,192
 v_rcp_f32 v245, v245
 MM a[28:31],v[216:219],v[164:167],a[28:31]
 TR v[234:235],v15,704
 v_rcp_f32 v246, v246
 MM a[32:35],v[216:219],v[168:171],a[32:35]
 buffer_load_dwordx4 v242, s[64:67], s80 offen offset:2112 lds
 AR v196,a0
 AR v197,a1
 AR v198,a2
 AR v199,a3
 AR v200,a12
 MM a[36:39],v[220:223],v[160:163],a[36:39]
 TR v[236:237],v15,224
 AR v201,a13
 AR v202,a14
 AR v203,a15
 v_mul_f32 v196, v196, v244
 MM a[40:43],v[220:223],v[164:167],a[40:43]
 TR v[238:239],v15,736
 v_mul_f32 v197, v197, v244
 v_mul_f32 v198, v198, v244
 v_mul_f32 v199, v199, v244
 v_mul_f32 v200, v200, v244
 MM a[44:47],v[220:223],v[168:171],a[44:47]
 s_waitcnt lgkmcnt(4)
 TR v[208:209],v15,256
 v_mul_f32 v201, v201, v244
 v_mul_f32 v202, v202, v244
 v_mul_f32 v203, v203, v244
 CV v16,v196,v197
 MM a[48:51],v[224:227],v[160:163],a[48:51]
 TR v[210:211],v15,768
 CV v17,v198,v199
 CV v18,v200,v201
 CV v19,v202,v203
 AR v196,a4
 MM a[52:55],v[224:227],v[164:167],a[52:55]
 buffer_load_dwordx4 v243, s[64:67], s80 offen offset:3168 lds
 AR v197,a5
 AR v198,a6
 AR v199,a7
 AR v200,a16
 MM a[56:59],v[224:227],v[168:171],a[56:59]
 TR v[212:213],v15,288
 AR v201,a17
 AR v202,a18
 AR v203,a19
 v_mul_f32 v196, v196, v245
 MM a[60:63],v[228:231],v[160:163],a[60:63]
 TR v[214:215],v15,800
 v_mul_f32 v197, v197, v245
 v_mul_f32 v198, v198, v245
 v_mul_f32 v199, v199, v245
 v_mul_f32 v200, v200, v245
 MM a[64:67],v[228:231],v[164:167],a[64:67]
 s_add_u32 m0, s91, 4224
 s_add_u32 s3, s80, 3584
 TR v[216:217],v15,320
 v_mul_f32 v201, v201, v245
 v_mul_f32 v202, v202, v245
 v_mul_f32 v203, v203, v245
 MM a[68:71],v[228:231],v[168:171],a[68:71]
 s_waitcnt lgkmcnt(5)
 buffer_load_dwordx4 v240, s[64:67], s3 offen offset:0 lds
 CV v20,v196,v197
 CV v21,v198,v199
 CV v22,v200,v201
 CV v23,v202,v203
 MM a[72:75],v[232:235],v[160:163],a[72:75]
 TR v[218:219],v15,832
 AR v196,a8
 AR v197,a9
 AR v198,a10
 AR v199,a11
 MM a[76:79],v[232:235],v[164:167],a[76:79]
 TR v[220:221],v15,352
 AR v200,a20
 AR v201,a21
 AR v202,a22
 AR v203,a23
 MM a[80:83],v[232:235],v[168:171],a[80:83]
 TR v[222:223],v15,864
 v_mul_f32 v196, v196, v246
 v_mul_f32 v197, v197, v246
 v_mul_f32 v198, v198, v246
 v_mul_f32 v199, v199, v246
 MM a[84:87],v[236:239],v[160:163],a[84:87]
 TR v[224:225],v15,384
 v_mul_f32 v200, v200, v246
 v_mul_f32 v201, v201, v246
 v_mul_f32 v202, v202, v246
 v_mul_f32 v203, v203, v246
 MM a[88:91],v[236:239],v[164:167],a[88:91]
 buffer_load_dwordx4 v241, s[64:67], s3 offen offset:1056 lds
 CV v24,v196,v197
 CV v25,v198,v199
 CV v26,v200,v201
 CV v27,v202,v203
 MM a[92:95],v[236:239],v[168:171],a[92:95]
 s_waitcnt lgkmcnt(5)
 TR v[226:227],v15,896
 AR v196,a24
 AR v197,a25
 AR v198,a26
 AR v199,a27
 MM a[96:99],v[208:211],v[160:163],a[96:99]
 TR v[228:229],v15,416
 AR v200,a36
 AR v201,a37
 AR v202,a38
 AR v203,a39
 MM a[100:103],v[208:211],v[164:167],a[100:103]
 TR v[230:231],v15,928
 v_mul_f32 v196, v196, v244
 v_mul_f32 v197, v197, v244
 v_mul_f32 v198, v198, v244
 MM a[104:107],v[208:211],v[168:171],a[104:107]
 TR v[232:233],v15,448
 v_mul_f32 v199, v199, v244
 v_mul_f32 v200, v200, v244
 v_mul_f32 v201, v201, v244
 v_mul_f32 v202, v202, v244
 MM a[108:111],v[212:215],v[160:163],a[108:111]
 buffer_load_dwordx4 v242, s[64:67], s3 offen offset:2112 lds
 v_mul_f32 v203, v203, v244
 CV v28,v196,v197
 CV v29,v198,v199
 CV v30,v200,v201
 MM a[112:115],v[212:215],v[164:167],a[112:115]
 TR v[234:235],v15,960
 CV v31,v202,v203
 AR v196,a28
 AR v197,a29
 MM a[116:119],v[212:215],v[168:171],a[116:119]
 s_waitcnt lgkmcnt(6)
 TR v[236:237],v15,480
 AR v198,a30
 AR v199,a31
 AR v200,a40
 AR v201,a41
 MM a[120:123],v[216:219],v[160:163],a[120:123]
 TR v[238:239],v15,992
 AR v202,a42
 AR v203,a43
 v_mul_f32 v196, v196, v245
 v_mul_f32 v197, v197, v245
 MM a[124:127],v[216:219],v[164:167],a[124:127]
 buffer_load_dwordx4 v243, s[64:67], s3 offen offset:3168 lds
 v_mul_f32 v198, v198, v245
 v_mul_f32 v199, v199, v245
 v_mul_f32 v200, v200, v245
 MM a[128:131],v[216:219],v[168:171],a[128:131]
 v_mul_f32 v201, v201, v245
 v_mul_f32 v202, v202, v245
 v_mul_f32 v203, v203, v245
 CV v32,v196,v197
 CV v33,v198,v199
 MM a[132:135],v[220:223],v[160:163],a[132:135]
 CV v34,v200,v201
 CV v35,v202,v203
 AR v196,a32
 AR v197,a33
 MM a[136:139],v[220:223],v[164:167],a[136:139]
 AR v198,a34
 AR v199,a35
 AR v200,a44
 AR v201,a45
 AR v202,a46
 MM a[140:143],v[220:223],v[168:171],a[140:143]
 s_waitcnt lgkmcnt(6)
 AR v203,a47
 v_mul_f32 v196, v196, v246
 v_mul_f32 v197, v197, v246
 v_mul_f32 v198, v198, v246
 MM a[144:147],v[224:227],v[160:163],a[144:147]
 v_mul_f32 v199, v199, v246
 v_mul_f32 v200, v200, v246
 v_mul_f32 v201, v201, v246
 v_mul_f32 v202, v202, v246
 v_mul_f32 v203, v203, v246
 MM a[148:151],v[224:227],v[164:167],a[148:151]
 CV v36,v196,v197
 CV v37,v198,v199
 CV v38,v200,v201
 CV v39,v202,v203
 MM a[152:155],v[224:227],v[168:171],a[152:155]
 s_waitcnt lgkmcnt(0) vmcnt(16)
 s_barrier
 TR v[208:209],v15,33792
 AR v196,a48
 AR v197,a49
 AR v198,a50
 MM a[156:159],v[228:231],v[160:163],a[156:159]
 TR v[210:211],v15,33920
 AR v199,a51
 AR v200,a60
 AR v201,a61
 AR v202,a62
 MM a[160:163],v[228:231],v[164:167],a[160:163]
 AR v203,a63
 v_mul_f32 v196, v196, v244
 v_mul_f32 v197, v197, v244
 v_mul_f32 v198, v198, v244
 v_mul_f32 v199, v199, v244
 MM a[164:167],v[228:231],v[168:171],a[164:167]
 TR v[212:213],v15,33824
 v_mul_f32 v200, v200, v244
 v_mul_f32 v201, v201, v244
 v_mul_f32 v202, v202, v244
 v_mul_f32 v203, v203, v244
 MM a[168:171],v[232:235],v[160:163],a[168:171]
 TR v[214:215],v15,33952
 CV v40,v196,v197
 CV v41,v198,v199
 CV v42,v200,v201
 CV v43,v202,v203
 MM a[172:175],v[232:235],v[164:167],a[172:175]
 AR v196,a52
 AR v197,a53
 AR v198,a54
 AR v199,a55
 AR v200,a64
 MM a[176:179],v[232:235],v[168:171],a[176:179]
 TR v[216:217],v15,33856
 AR v201,a65
 AR v202,a66
 AR v203,a67
 v_mul_f32 v196, v196, v245
 MM a[180:183],v[236:239],v[160:163],a[180:183]
 TR v[218:219],v15,33984
 v_mul_f32 v197, v197, v245
 v_mul_f32 v198, v198, v245
 v_mul_f32 v199, v199, v245
 v_mul_f32 v200, v200, v245
 MM a[184:187],v[236:239],v[164:167],a[184:187]
 v_mul_f32 v201, v201, v245
 v_mul_f32 v202, v202, v245
 v_mul_f32 v203, v203, v245
 CV v44,v196,v197
 CV v45,v198,v199
 MM a[188:191],v[236:239],v[168:171],a[188:191]
 s_waitcnt lgkmcnt(4)
 TR v[220:221],v15,33888
 CV v46,v200,v201
 CV v47,v202,v203
 AR v196,a56
 AR v197,a57
 MM v[112:115],v[208:211],v[16:19],0
 TR v[222:223],v15,34016
 AR v198,a58
 AR v199,a59
 AR v200,a68
 AR v201,a69
 MM v[116:119],v[208:211],v[20:23],0
 TR v[224:225],v15,34048
 AR v202,a70
 AR v203,a71
 v_mul_f32 v196, v196, v246
 v_mul_f32 v197, v197, v246
 MM v[120:123],v[208:211],v[24:27],0
 s_waitcnt lgkmcnt(5)
 s_mov_b32 m0, s93
 TR v[226:227],v15,34176
 v_mul_f32 v198, v198, v246
 v_mul_f32 v199, v199, v246
 v_mul_f32 v200, v200, v246
 MM v[124:127],v[212:215],v[16:19],0
 buffer_load_dwordx4 v240, s[64:67], s81 offen offset:0 lds
 v_mul_f32 v201, v201, v246
 v_mul_f32 v202, v202, v246
 v_mul_f32 v203, v203, v246
 CV v48,v196,v197
 MM v[128:131],v[212:215],v[20:23],0
 TR v[228:229],v15,34080
 buffer_load_dwordx4 v241, s[64:67], s81 offen offset:1056 lds
 CV v49,v198,v199
 CV v50,v200,v201
 CV v51,v202,v203
 MM v[132:135],v[212:215],v[24:27],0
 s_waitcnt lgkmcnt(3)
 TR v[230:231],v15,34208
 AR v196,a72
 AR v197,a73
 AR v198,a74
 AR v199,a75
 AR v200,a84
 MM v[136:139],v[216:219],v[16:19],0
 TR v[232:233],v15,34112
 AR v201,a85
 AR v202,a86
 AR v203,a87
 v_mul_f32 v196, v196, v244
 MM v[140:143],v[216:219],v[20:23],0
 TR v[234:235],v15,34240
 v_mul_f32 v197, v197, v244
 v_mul_f32 v198, v198, v244
 v_mul_f32 v199, v199, v244
 v_mul_f32 v200, v200, v244
 MM v[144:147],v[216:219],v[24:27],0
 buffer_load_dwordx4 v242, s[64:67], s81 offen offset:2112 lds
 v_mul_f32 v201, v201, v244
 v_mul_f32 v202, v202, v244
 v_mul_f32 v203, v203, v244
 CV v52,v196,v197
 MM v[148:151],v[220:223],v[16:19],0
 TR v[236:237],v15,34144
 CV v53,v198,v199
 CV v54,v200,v201
 CV v55,v202,v203
 AR v196,a76
 MM v[152:155],v[220:223],v[20:23],0
 TR v[238:239],v15,34272
 AR v197,a77
 AR v198,a78
 AR v199,a79
 AR v200,a88
 MM v[156:159],v[220:223],v[24:27],0
 s_waitcnt lgkmcnt(4)
 TR v[208:209],v15,34304
 AR v201,a89
 AR v202,a90
 AR v203,a91
 v_mul_f32 v196, v196, v245
 MM v[112:115],v[224:227],v[28:31],v[112:115]
 TR v[210:211],v15,34432
 v_mul_f32 v197, v197, v245
 v_mul_f32 v198, v198, v245
 v_mul_f32 v199, v199, v245
 v_mul_f32 v200, v200, v245
 MM v[116:119],v[224:227],v[32:35],v[116:119]
 buffer_load_dwordx4 v243, s[64:67], s81 offen offset:3168 lds
 v_mul_f32 v201, v201, v245
 v_mul_f32 v202, v202, v245
 v_mul_f32 v203, v203, v245
 CV v56,v196,v197
 MM v[120:123],v[224:227],v[36:39],v[120:123]
 TR v[212:213],v15,34336
 CV v57,v198,v199
 CV v58,v200,v201
 CV v59,v202,v203
 AR v196,a80
 MM v[124:127],v[228:231],v[28:31],v[124:127]
 TR v[214:215],v15,34464
 AR v197,a81
 AR v198,a82
 AR v199,a83
 AR v200,a92
 MM v[128:131],v[228:231],v[32:35],v[128:131]
 s_add_u32 m0, s93, 4224
 s_add_u32 s3, s81, 3584
 TR v[216:217],v15,34368
 AR v201,a93
 AR v202,a94
 AR v203,a95
 MM v[132:135],v[228:231],v[36:39],v[132:135]
 s_waitcnt lgkmcnt(5)
 buffer_load_dwordx4 v240, s[64:67], s3 offen offset:0 lds
 v_mul_f32 v196, v196, v246
 v_mul_f32 v197, v197, v246
 v_mul_f32 v198, v198, v246
 v_mul_f32 v199, v199, v246
 MM v[136:139],v[232:235],v[28:31],v[136:139]
 TR v[218:219],v15,34496
 v_mul_f32 v200, v200, v246
 v_mul_f32 v201, v201, v246
 v_mul_f32 v202, v202, v246
 v_mul_f32 v203, v203, v246
 MM v[140:143],v[232:235],v[32:35],v[140:143]
 TR v[220:221],v15,34400
 CV v60,v196,v197
 CV v61,v198,v199
 CV v62,v200,v201
 CV v63,v202,v203
 MM v[144:147],v[232:235],v[36:39],v[144:147]
 TR v[222:223],v15,34528
 AR v196,a96
 AR v197,a97
 AR v198,a98
 AR v199,a99
 MM v[148:151],v[236:239],v[28:31],v[148:151]
 TR v[224:225],v15,34560
 AR v200,a108
 AR v201,a109
 AR v202,a110
 AR v203,a111
 MM v[152:155],v[236:239],v[32:35],v[152:155]
 buffer_load_dwordx4 v241, s[64:67], s3 offen offset:1056 lds
 v_mul_f32 v196, v196, v244
 v_mul_f32 v197, v197, v244
 v_mul_f32 v198, v198, v244
 v_mul_f32 v199, v199, v244
 MM v[156:159],v[236:239],v[36:39],v[156:159]
 s_waitcnt lgkmcnt(5)
 TR v[226:227],v15,34688
 v_mul_f32 v200, v200, v244
 v_mul_f32 v201, v201, v244
 v_mul_f32 v202, v202, v244
 v_mul_f32 v203, v203, v244
 MM v[112:115],v[208:211],v[40:43],v[112:115]
 TR v[228:229],v15,34592
 CV v64,v196,v197
 CV v65,v198,v199
 CV v66,v200,v201
 CV v67,v202,v203
 MM v[116:119],v[208:211],v[44:47],v[116:119]
 TR v[230:231],v15,34720
 AR v196,a100
 AR v197,a101
 AR v198,a102
 AR v199,a103
 MM v[120:123],v[208:211],v[48:51],v[120:123]
 TR v[232:233],v15,34624
 AR v200,a112
 AR v201,a113
 AR v202,a114
 AR v203,a115
 MM v[124:127],v[212:215],v[40:43],v[124:127]
 buffer_load_dwordx4 v242, s[64:67], s3 offen offset:2112 lds
 v_mul_f32 v196, v196, v245
 v_mul_f32 v197, v197, v245
 v_mul_f32 v198, v198, v245
 v_mul_f32 v199, v199, v245
 MM v[128:131],v[212:215],v[44:47],v[128:131]
 TR v[234:235],v15,34752
 v_mul_f32 v200, v200, v245
 v_mul_f32 v201, v201, v245
 v_mul_f32 v202, v202, v245
 v_mul_f32 v203, v203, v245
 MM v[132:135],v[212:215],v[48:51],v[132:135]
 s_waitcnt lgkmcnt(6)
 TR v[236:237],v15,34656
 CV v68,v196,v197
 CV v69,v198,v199
 CV v70,v200,v201
 CV v71,v202,v203
 MM v[136:139],v[216:219],v[40:43],v[136:139]
 TR v[238:239],v15,34784
 AR v196,a104
 AR v197,a105
 AR v198,a106
 AR v199,a107
 MM v[140:143],v[216:219],v[44:47],v[140:143]
 buffer_load_dwordx4 v243, s[64:67], s3 offen offset:3168 lds
 AR v200,a116
 AR v201,a117
 AR v202,a118
 AR v203,a119
 MM v[144:147],v[216:219],v[48:51],v[144:147]
 s_add_u32 s80, s80, 128
 s_cmp_eq_u32 s80, 896
 s_cselect_b32 s80, 0, s80
 s_add_u32 s81, s80, 114688
 v_mul_f32 v196, v196, v246
 v_mul_f32 v197, v197, v246
 MM v[148:151],v[220:223],v[40:43],v[148:151]
 v_mul_f32 v198, v198, v246
 v_mul_f32 v199, v199, v246
 v_mul_f32 v200, v200, v246
 v_mul_f32 v201, v201, v246
 v_mul_f32 v202, v202, v246
 MM v[152:155],v[220:223],v[44:47],v[152:155]
 v_mul_f32 v203, v203, v246
 CV v72,v196,v197
 CV v73,v198,v199
 CV v74,v200,v201
 CV v75,v202,v203
 MM v[156:159],v[220:223],v[48:51],v[156:159]
 s_waitcnt lgkmcnt(6)
 AR v196,a120
 AR v197,a121
 AR v198,a122
 AR v199,a123
 AR v200,a132
 MM v[112:115],v[224:227],v[52:55],v[112:115]
 AR v201,a133
 AR v202,a134
 AR v203,a135
 v_mul_f32 v196, v196, v244
 v_mul_f32 v197, v197, v244
 MM v[116:119],v[224:227],v[56:59],v[116:119]
 v_mul_f32 v198, v198, v244
 v_mul_f32 v199, v199, v244
 v_mul_f32 v200, v200, v244
 v_mul_f32 v201, v201, v244
 v_mul_f32 v202, v202, v244
 MM v[120:123],v[224:227],v[60:63],v[120:123]
 s_waitcnt lgkmcnt(0) vmcnt(16)
 s_barrier
 TR v[208:209],v14,0
 v_mul_f32 v203, v203, v244
 MM v[124:127],v[228:231],v[52:55],v[124:127]
 TR v[210:211],v14,128
 CV v76,v196,v197
 CV v77,v198,v199
 CV v78,v200,v201
 CV v79,v202,v203
 MM v[128:131],v[228:231],v[56:59],v[128:131]
 AR v196,a124
 AR v197,a125
 AR v198,a126
 AR v199,a127
 AR v200,a136
 MM v[132:135],v[228:231],v[60:63],v[132:135]
 TR v[212:213],v14,32
 AR v201,a137
 AR v202,a138
 AR v203,a139
 v_mul_f32 v196, v196, v245
 MM v[136:139],v[232:235],v[52:55],v[136:139]
 TR v[214:215],v14,160
 v_mul_f32 v197, v197, v245
 v_mul_f32 v198, v198, v245
 v_mul_f32 v199, v199, v245
 MM v[140:143],v[232:235],v[56:59],v[140:143]
 v_mul_f32 v200, v200, v245
 v_mul_f32 v201, v201, v245
 v_mul_f32 v202, v202, v245
 v_mul_f32 v203, v203, v245
 CV v80,v196,v197
 MM v[144:147],v[232:235],v[60:63],v[144:147]
 TR v[216:217],v14,64
 CV v81,v198,v199
 CV v82,v200,v201
 CV v83,v202,v203
 AR v196,a128
 MM v[148:151],v[236:239],v[52:55],v[148:151]
 TR v[218:219],v14,192
 AR v197,a129
 AR v198,a130
 AR v199,a131
 AR v200,a140
 MM v[152:155],v[236:239],v[56:59],v[152:155]
 AR v201,a141
 AR v202,a142
 AR v203,a143
 v_mul_f32 v196, v196, v246
 MM v[156:159],v[236:239],v[60:63],v[156:159]
 s_waitcnt lgkmcnt(4)
 TR v[220:221],v14,96
 v_mul_f32 v197, v197, v246
 v_mul_f32 v198, v198, v246
 v_mul_f32 v199, v199, v246
 v_mul_f32 v200, v200, v246
 MM v[112:115],v[208:211],v[64:67],v[112:115]
 TR v[222:223],v14,224
 v_mul_f32 v201, v201, v246
 v_mul_f32 v202, v202, v246
 v_mul_f32 v203, v203, v246
 CV v84,v196,v197
 MM v[116:119],v[208:211],v[68:71],v[116:119]
 TR v[224:225],v14,256
 CV v85,v198,v199
 CV v86,v200,v201
 CV v87,v202,v203
 MM v[120:123],v[208:211],v[72:75],v[120:123]
 s_waitcnt lgkmcnt(5)
 s_mov_b32 m0, s95
 TR v[226:227],v14,384
 AR v196,a144
 AR v197,a145
 AR v198,a146
 AR v199,a147
 MM v[124:127],v[212:215],v[64:67],v[124:127]
 buffer_load_dwordx4 v240, s[64:67], s80 offen offset:0 lds
 AR v200,a156
 AR v201,a157
 AR v202,a158
 AR v203,a159
 MM v[128:131],v[212:215],v[68:71],v[128:131]
 TR v[228:229],v14,288
 buffer_load_dwordx4 v241, s[64:67], s80 offen offset:1056 lds
 v_mul_f32 v196, v196, v244
 v_mul_f32 v197, v197, v244
 v_mul_f32 v198, v198, v244
 MM v[132:135],v[212:215],v[72:75],v[132:135]
 s_waitcnt lgkmcnt(3)
 TR v[230:231],v14,416
 v_mul_f32 v199, v199, v244
 v_mul_f32 v200, v200, v244
 v_mul_f32 v201, v201, v244
 v_mul_f32 v202, v202, v244
 v_mul_f32 v203, v203, v244
 MM v[136:139],v[216:219],v[64:67],v[136:139]
 TR v[232:233],v14,320
 CV v88,v196,v197
 CV v89,v198,v199
 CV v90,v200,v201
 CV v91,v202,v203
 MM v[140:143],v[216:219],v[68:71],v[140:143]
 TR v[234:235],v14,448
 AR v196,a148
 AR v197,a149
 AR v198,a150
 AR v199,a151
 MM v[144:147],v[216:219],v[72:75],v[144:147]
 buffer_load_dwordx4 v242, s[64:67], s80 offen offset:2112 lds
 AR v200,a160
 AR v201,a161
 AR v202,a162
 AR v203,a163
 MM v[148:151],v[220:223],v[64:67],v[148:151]
 TR v[236:237],v14,352
 v_mul_f32 v196, v196, v245
 v_mul_f32 v197, v197, v245
 v_mul_f32 v198, v198, v245
 v_mul_f32 v199, v199, v245
 MM v[152:155],v[220:223],v[68:71],v[152:155]
 TR v[238:239],v14,480
 v_mul_f32 v200, v200, v245
 v_mul_f32 v201, v201, v245
 v_mul_f32 v202, v202, v245
 v_mul_f32 v203, v203, v245
 MM v[156:159],v[220:223],v[72:75],v[156:159]
 s_waitcnt lgkmcnt(4)
 TR v[208:209],v14,512
 CV v92,v196,v197
 CV v93,v198,v199
 CV v94,v200,v201
 CV v95,v202,v203
 AR v196,a152
 MM v[112:115],v[224:227],v[76:79],v[112:115]
 TR v[210:211],v14,640
 AR v197,a153
 AR v198,a154
 AR v199,a155
 AR v200,a164
 MM v[116:119],v[224:227],v[80:83],v[116:119]
 buffer_load_dwordx4 v243, s[64:67], s80 offen offset:3168 lds
 AR v201,a165
 AR v202,a166
 AR v203,a167
 v_mul_f32 v196, v196, v246
 MM v[120:123],v[224:227],v[84:87],v[120:123]
 TR v[212:213],v14,544
 v_mul_f32 v197, v197, v246
 v_mul_f32 v198, v198, v246
 v_mul_f32 v199, v199, v246
 v_mul_f32 v200, v200, v246
 MM v[124:127],v[228:231],v[76:79],v[124:127]
 TR v[214:215],v14,672
 v_mul_f32 v201, v201, v246
 v_mul_f32 v202, v202, v246
 v_mul_f32 v203, v203, v246
 CV v96,v196,v197
 MM v[128:131],v[228:231],v[80:83],v[128:131]
 s_add_u32 m0, s95, 4224
 s_add_u32 s3, s80, 3584
 TR v[216:217],v14,576
 CV v97,v198,v199
 CV v98,v200,v201
 CV v99,v202,v203
 MM v[132:135],v[228:231],v[84:87],v[132:135]
 s_waitcnt lgkmcnt(5)
 buffer_load_dwordx4 v240, s[64:67], s3 offen offset:0 lds
 AR v196,a168
 AR v197,a169
 AR v198,a170
 AR v199,a171
 MM v[136:139],v[232:235],v[76:79],v[136:139]
 TR v[218:219],v14,704
 AR v200,a180
 AR v201,a181
 AR v202,a182
 AR v203,a183
 MM v[140:143],v[232:235],v[80:83],v[140:143]
 TR v[220:221],v14,608
 v_mul_f32 v196, v196, v244
 v_mul_f32 v197, v197, v244
 v_mul_f32 v198, v198, v244
 v_mul_f32 v199, v199, v244
 MM v[144:147],v[232:235],v[84:87],v[144:147]
 TR v[222:223],v14,736
 v_mul_f32 v200, v200, v244
 v_mul_f32 v201, v201, v244
 v_mul_f32 v202, v202, v244
 v_mul_f32 v203, v203, v244
 MM v[148:151],v[236:239],v[76:79],v[148:151]
 TR v[224:225],v14,768
 CV v100,v196,v197
 CV v101,v198,v199
 CV v102,v200,v201
 CV v103,v202,v203
 MM v[152:155],v[236:239],v[80:83],v[152:155]
 buffer_load_dwordx4 v241, s[64:67], s3 offen offset:1056 lds
 AR v196,a172
 AR v197,a173
 AR v198,a174
 AR v199,a175
 MM v[156:159],v[236:239],v[84:87],v[156:159]
 s_waitcnt lgkmcnt(5)
 TR v[226:227],v14,896
 AR v200,a184
 AR v201,a185
 AR v202,a186
 AR v203,a187
 MM v[112:115],v[208:211],v[88:91],v[112:115]
 TR v[228:229],v14,800
 v_mul_f32 v196, v196, v245
 v_mul_f32 v197, v197, v245
 v_mul_f32 v198, v198, v245
 v_mul_f32 v199, v199, v245
 MM v[116:119],v[208:211],v[92:95],v[116:119]
 TR v[230:231],v14,928
 v_mul_f32 v200, v200, v245
 v_mul_f32 v201, v201, v245
 v_mul_f32 v202, v202, v245
 v_mul_f32 v203, v203, v245
 MM v[120:123],v[208:211],v[96:99],v[120:123]
 TR v[232:233],v14,832
 CV v104,v196,v197
 CV v105,v198,v199
 CV v106,v200,v201
 CV v107,v202,v203
 MM v[124:127],v[212:215],v[88:91],v[124:127]
 buffer_load_dwordx4 v242, s[64:67], s3 offen offset:2112 lds
 AR v196,a176
 AR v197,a177
 AR v198,a178
 AR v199,a179
 MM v[128:131],v[212:215],v[92:95],v[128:131]
 TR v[234:235],v14,960
 AR v200,a188
 AR v201,a189
 AR v202,a190
 AR v203,a191
 MM v[132:135],v[212:215],v[96:99],v[132:135]
 s_waitcnt lgkmcnt(6)
 TR v[236:237],v14,864
 v_mul_f32 v196, v196, v246
 v_mul_f32 v197, v197, v246
 v_mul_f32 v198, v198, v246
 v_mul_f32 v199, v199, v246
 MM v[136:139],v[216:219],v[88:91],v[136:139]
 TR v[238:239],v14,992
 v_mul_f32 v200, v200, v246
 v_mul_f32 v201, v201, v246
 v_mul_f32 v202, v202, v246
 v_mul_f32 v203, v203, v246
 MM v[140:143],v[216:219],v[92:95],v[140:143]
 buffer_load_dwordx4 v243, s[64:67], s3 offen offset:3168 lds
 CV v108,v196,v197
 CV v109,v198,v199
 CV v110,v200,v201
 CV v111,v202,v203
 MM v[144:147],v[216:219],v[96:99],v[144:147]
 MM v[148:151],v[220:223],v[88:91],v[148:151]
 MM v[152:155],v[220:223],v[92:95],v[152:155]
 MM v[156:159],v[220:223],v[96:99],v[156:159]
 s_waitcnt lgkmcnt(6)
 MM v[112:115],v[224:227],v[100:103],v[112:115]
 MM v[116:119],v[224:227],v[104:107],v[116:119]
 MM v[120:123],v[224:227],v[108:111],v[120:123]
 s_waitcnt lgkmcnt(0) vmcnt(16)
 s_barrier
 TR v[208:209],v14,33792
 MM v[124:127],v[228:231],v[100:103],v[124:127]
 TR v[210:211],v14,33920
 MM v[128:131],v[228:231],v[104:107],v[128:131]
 MM v[132:135],v[228:231],v[108:111],v[132:135]
 TR v[212:213],v14,33824
 MM v[136:139],v[232:235],v[100:103],v[136:139]
 TR v[214:215],v14,33952
 MM v[140:143],v[232:235],v[104:107],v[140:143]
 MM v[144:147],v[232:235],v[108:111],v[144:147]
 TR v[216:217],v14,33856
 MM v[148:151],v[236:239],v[100:103],v[148:151]
 TR v[218:219],v14,33984
 MM v[152:155],v[236:239],v[104:107],v[152:155]
 MM v[156:159],v[236:239],v[108:111],v[156:159]
 s_waitcnt lgkmcnt(4)
 TR v[220:221],v14,33888
 MM v[160:163],v[208:211],v[16:19],0
 TR v[222:223],v14,34016
 MM v[164:167],v[208:211],v[20:23],0
 TR v[224:225],v14,34048
 MM v[168:171],v[208:211],v[24:27],0
 s_waitcnt lgkmcnt(5)
 s_mov_b32 m0, s89
 TR v[226:227],v14,34176
 MM v[172:175],v[212:215],v[16:19],0
 buffer_load_dwordx4 v240, s[64:67], s81 offen offset:0 lds
 MM v[176:179],v[212:215],v[20:23],0
 TR v[228:229],v14,34080
 buffer_load_dwordx4 v241, s[64:67], s81 offen offset:1056 lds
 MM v[180:183],v[212:215],v[24:27],0
 s_waitcnt lgkmcnt(3)
 TR v[230:231],v14,34208
 MM v[184:187],v[216:219],v[16:19],0
 TR v[232:233],v14,34112
 MM v[188:191],v[216:219],v[20:23],0
 TR v[234:235],v14,34240
 MM v[192:195],v[216:219],v[24:27],0
 buffer_load_dwordx4 v242, s[64:67], s81 offen offset:2112 lds
 MM v[196:199],v[220:223],v[16:19],0
 TR v[236:237],v14,34144
 MM v[200:203],v[220:223],v[20:23],0
 TR v[238:239],v14,34272
 MM v[204:207],v[220:223],v[24:27],0
 s_waitcnt lgkmcnt(4)
 TR v[208:209],v14,34304
 MM v[160:163],v[224:227],v[28:31],v[160:163]
 TR v[210:211],v14,34432
 MM v[164:167],v[224:227],v[32:35],v[164:167]
 buffer_load_dwordx4 v243, s[64:67], s81 offen offset:3168 lds
 MM v[168:171],v[224:227],v[36:39],v[168:171]
 TR v[212:213],v14,34336
 MM v[172:175],v[228:231],v[28:31],v[172:175]
 TR v[214:215],v14,34464
 MM v[176:179],v[228:231],v[32:35],v[176:179]
 s_add_u32 m0, s89, 4224
 s_add_u32 s3, s81, 3584
 TR v[216:217],v14,34368
 MM v[180:183],v[228:231],v[36:39],v[180:183]
 s_waitcnt lgkmcnt(5)
 buffer_load_dwordx4 v240, s[64:67], s3 offen offset:0 lds
 MM v[184:187],v[232:235],v[28:31],v[184:187]
 TR v[218:219],v14,34496
 MM v[188:191],v[232:235],v[32:35],v[188:191]
 TR v[220:221],v14,34400
 MM v[192:195],v[232:235],v[36:39],v[192:195]
 TR v[222:223],v14,34528
 MM v[196:199],v[236:239],v[28:31],v[196:199]
 TR v[224:225],v14,34560
 MM v[200:203],v[236:239],v[32:35],v[200:203]
 buffer_load_dwordx4 v241, s[64:67], s3 offen offset:1056 lds
 MM v[204:207],v[236:239],v[36:39],v[204:207]
 s_waitcnt lgkmcnt(5)
 TR v[226:227],v14,34688
 MM v[160:163],v[208:211],v[40:43],v[160:163]
 TR v[228:229],v14,34592
 MM v[164:167],v[208:211],v[44:47],v[164:167]
 TR v[230:231],v14,34720
 MM v[168:171],v[208:211],v[48:51],v[168:171]
 TR v[232:233],v14,34624
 MM v[172:175],v[212:215],v[40:43],v[172:175]
 buffer_load_dwordx4 v242, s[64:67], s3 offen offset:2112 lds
 MM v[176:179],v[212:215],v[44:47],v[176:179]
 TR v[234:235],v14,34752
 MM v[180:183],v[212:215],v[48:51],v[180:183]
 s_waitcnt lgkmcnt(6)
 TR v[236:237],v14,34656
 MM v[184:187],v[216:219],v[40:43],v[184:187]
 TR v[238:239],v14,34784
 MM v[188:191],v[216:219],v[44:47],v[188:191]
 buffer_load_dwordx4 v243, s[64:67], s3 offen offset:3168 lds
 MM v[192:195],v[216:219],v[48:51],v[192:195]
 s_add_u32 s80, s80, 128
 s_cmp_eq_u32 s80, 896
 s_cselect_b32 s80, 0, s80
 s_add_u32 s81, s80, 114688
 MM v[196:199],v[220:223],v[40:43],v[196:199]
 MM v[200:203],v[220:223],v[44:47],v[200:203]
 MM v[204:207],v[220:223],v[48:51],v[204:207]
 s_waitcnt lgkmcnt(6)
 MM v[160:163],v[224:227],v[52:55],v[160:163]
 MM v[164:167],v[224:227],v[56:59],v[164:167]
 MM v[168:171],v[224:227],v[60:63],v[168:171]
 s_waitcnt lgkmcnt(0) vmcnt(16)
 s_barrier
 TR v[208:209],v15,0
 MM v[172:175],v[228:231],v[52:55],v[172:175]
 TR v[210:211],v15,128
 MM v[176:179],v[228:231],v[56:59],v[176:179]
 MM v[180:183],v[228:231],v[60:63],v[180:183]
 TR v[212:213],v15,32
 MM v[184:187],v[232:235],v[52:55],v[184:187]
 TR v[214:215],v15,160
 MM v[188:191],v[232:235],v[56:59],v[188:191]
 MM v[192:195],v[232:235],v[60:63],v[192:195]
 TR v[216:217],v15,64
 MM v[196:199],v[236:239],v[52:55],v[196:199]
 TR v[218:219],v15,192
 MM v[200:203],v[236:239],v[56:59],v[200:203]
 MM v[204:207],v[236:239],v[60:63],v[204:207]
 s_waitcnt lgkmcnt(4)
 TR v[220:221],v15,96
 MM v[160:163],v[208:211],v[64:67],v[160:163]
 TR v[222:223],v15,224
 MM v[164:167],v[208:211],v[68:71],v[164:167]
 TR v[224:225],v15,256
 MM v[168:171],v[208:211],v[72:75],v[168:171]
 s_waitcnt lgkmcnt(5)
 s_mov_b32 m0, s91
 TR v[226:227],v15,384
 MM v[172:175],v[212:215],v[64:67],v[172:175]
 buffer_load_dwordx4 v240, s[64:67], s80 offen offset:0 lds
 MM v[176:179],v[212:215],v[68:71],v[176:179]
 TR v[228:229],v15,288
 buffer_load_dwordx4 v241, s[64:67], s80 offen offset:1056 lds
 MM v[180:183],v[212:215],v[72:75],v[180:183]
 s_waitcnt lgkmcnt(3)
 TR v[230:231],v15,416
 MM v[184:187],v[216:219],v[64:67],v[184:187]
 TR v[232:233],v15,320
 MM v[188:191],v[216:219],v[68:71],v[188:191]
 TR v[234:235],v15,448
 MM v[192:195],v[216:219],v[72:75],v[192:195]
 buffer_load_dwordx4 v242, s[64:67], s80 offen offset:2112 lds
 MM v[196:199],v[220:223],v[64:67],v[196:199]
 TR v[236:237],v15,352
 MM v[200:203],v[220:223],v[68:71],v[200:203]
 TR v[238:239],v15,480
 MM v[204:207],v[220:223],v[72:75],v[204:207]
 s_waitcnt lgkmcnt(4)
 TR v[208:209],v15,512
 MM v[160:163],v[224:227],v[76:79],v[160:163]
 TR v[210:211],v15,640
 MM v[164:167],v[224:227],v[80:83],v[164:167]
 buffer_load_dwordx4 v243, s[64:67], s80 offen offset:3168 lds
 MM v[168:171],v[224:227],v[84:87],v[168:171]
 TR v[212:213],v15,544
 MM v[172:175],v[228:231],v[76:79],v[172:175]
 TR v[214:215],v15,672
 MM v[176:179],v[228:231],v[80:83],v[176:179]
 s_add_u32 m0, s91, 4224
 s_add_u32 s3, s80, 3584
 TR v[216:217],v15,576
 MM v[180:183],v[228:231],v[84:87],v[180:183]
 s_waitcnt lgkmcnt(5)
 buffer_load_dwordx4 v240, s[64:67], s3 offen offset:0 lds
 MM v[184:187],v[232:235],v[76:79],v[184:187]
 TR v[218:219],v15,704
 MM v[188:191],v[232:235],v[80:83],v[188:191]
 TR v[220:221],v15,608
 MM v[192:195],v[232:235],v[84:87],v[192:195]
 TR v[222:223],v15,736
 MM v[196:199],v[236:239],v[76:79],v[196:199]
 TR v[224:225],v15,768
 MM v[200:203],v[236:239],v[80:83],v[200:203]
 buffer_load_dwordx4 v241, s[64:67], s3 offen offset:1056 lds
 MM v[204:207],v[236:239],v[84:87],v[204:207]
 s_waitcnt lgkmcnt(5)
 TR v[226:227],v15,896
 MM v[160:163],v[208:211],v[88:91],v[160:163]
 TR v[228:229],v15,800
 MM v[164:167],v[208:211],v[92:95],v[164:167]
 TR v[230:231],v15,928
 MM v[168:171],v[208:211],v[96:99],v[168:171]
 TR v[232:233],v15,832
 MM v[172:175],v[212:215],v[88:91],v[172:175]
 buffer_load_dwordx4 v242, s[64:67], s3 offen offset:2112 lds
 MM v[176:179],v[212:215],v[92:95],v[176:179]
 TR v[234:235],v15,960
 MM v[180:183],v[212:215],v[96:99],v[180:183]
 s_waitcnt lgkmcnt(6)
 TR v[236:237],v15,864
 MM v[184:187],v[216:219],v[88:91],v[184:187]
 TR v[238:239],v15,992
 MM v[188:191],v[216:219],v[92:95],v[188:191]
 buffer_load_dwordx4 v243, s[64:67], s3 offen offset:3168 lds
 MM v[192:195],v[216:219],v[96:99],v[192:195]
 MM v[196:199],v[220:223],v[88:91],v[196:199]
 MM v[200:203],v[220:223],v[92:95],v[200:203]
 MM v[204:207],v[220:223],v[96:99],v[204:207]
 s_waitcnt lgkmcnt(6)
 MM v[160:163],v[224:227],v[100:103],v[160:163]
 MM v[164:167],v[224:227],v[104:107],v[164:167]
 MM v[168:171],v[224:227],v[108:111],v[168:171]
 s_waitcnt lgkmcnt(0) vmcnt(16)
 s_barrier
 TR v[208:209],v15,33792
 MM v[172:175],v[228:231],v[100:103],v[172:175]
 TR v[210:211],v15,33920
 MM v[176:179],v[228:231],v[104:107],v[176:179]
 MM v[180:183],v[228:231],v[108:111],v[180:183]
 TR v[212:213],v15,33824
 MM v[184:187],v[232:235],v[100:103],v[184:187]
 TR v[214:215],v15,33952
 MM v[188:191],v[232:235],v[104:107],v[188:191]
 MM v[192:195],v[232:235],v[108:111],v[192:195]
 TR v[216:217],v15,33856
 MM v[196:199],v[236:239],v[100:103],v[196:199]
 TR v[218:219],v15,33984
 MM v[200:203],v[236:239],v[104:107],v[200:203]
 MM v[204:207],v[236:239],v[108:111],v[204:207]
 s_waitcnt lgkmcnt(4)
 TR v[220:221],v15,33888
 MM a[0:3],v[208:211],v[16:19],0
 TR v[222:223],v15,34016
 MM a[4:7],v[208:211],v[20:23],0
 TR v[224:225],v15,34048
 MM a[8:11],v[208:211],v[24:27],0
 s_waitcnt lgkmcnt(5)
 s_mov_b32 m0, s93
 TR v[226:227],v15,34176
 MM a[12:15],v[212:215],v[16:19],0
 buffer_load_dwordx4 v240, s[64:67], s81 offen offset:0 lds
 MM a[16:19],v[212:215],v[20:23],0
 TR v[228:229],v15,34080
 buffer_load_dwordx4 v241, s[64:67], s81 offen offset:1056 lds
 MM a[20:23],v[212:215],v[24:27],0
 s_waitcnt lgkmcnt(3)
 TR v[230:231],v15,34208
 MM a[24:27],v[216:219],v[16:19],0
 TR v[232:233],v15,34112
 MM a[28:31],v[216:219],v[20:23],0
 TR v[234:235],v15,34240
 MM a[32:35],v[216:219],v[24:27],0
 buffer_load_dwordx4 v242, s[64:67], s81 offen offset:2112 lds
 MM a[36:39],v[220:223],v[16:19],0
 TR v[236:237],v15,34144
 MM a[40:43],v[220:223],v[20:23],0
 TR v[238:239],v15,34272
 MM a[44:47],v[220:223],v[24:27],0
 s_waitcnt lgkmcnt(4)
 TR v[208:209],v15,34304
 MM a[0:3],v[224:227],v[28:31],a[0:3]
 TR v[210:211],v15,34432
 MM a[4:7],v[224:227],v[32:35],a[4:7]
 buffer_load_dwordx4 v243, s[64:67], s81 offen offset:3168 lds
 MM a[8:11],v[224:227],v[36:39],a[8:11]
 TR v[212:213],v15,34336
 MM a[12:15],v[228:231],v[28:31],a[12:15]
 TR v[214:215],v15,34464
 MM a[16:19],v[228:231],v[32:35],a[16:19]
 s_add_u32 m0, s93, 4224
 s_add_u32 s3, s81, 3584
 TR v[216:217],v15,34368
 MM a[20:23],v[228:231],v[36:39],a[20:23]
 s_waitcnt lgkmcnt(5)
 buffer_load_dwordx4 v240, s[64:67], s3 offen offset:0 lds
 MM a[24:27],v[232:235],v[28:31],a[24:27]
 TR v[218:219],v15,34496
 MM a[28:31],v[232:235],v[32:35],a[28:31]
 TR v[220:221],v15,34400
 MM a[32:35],v[232:235],v[36:39],a[32:35]
 TR v[222:223],v15,34528
 MM a[36:39],v[236:239],v[28:31],a[36:39]
 TR v[224:225],v15,34560
 MM a[40:43],v[236:239],v[32:35],a[40:43]
 buffer_load_dwordx4 v241, s[64:67], s3 offen offset:1056 lds
 MM a[44:47],v[236:239],v[36:39],a[44:47]
 s_waitcnt lgkmcnt(5)
 TR v[226:227],v15,34688
 MM a[0:3],v[208:211],v[40:43],a[0:3]
 TR v[228:229],v15,34592
 MM a[4:7],v[208:211],v[44:47],a[4:7]
 TR v[230:231],v15,34720
 MM a[8:11],v[208:211],v[48:51],a[8:11]
 TR v[232:233],v15,34624
 MM a[12:15],v[212:215],v[40:43],a[12:15]
 buffer_load_dwordx4 v242, s[64:67], s3 offen offset:2112 lds
 MM a[16:19],v[212:215],v[44:47],a[16:19]
 TR v[234:235],v15,34752
 MM a[20:23],v[212:215],v[48:51],a[20:23]
 s_waitcnt lgkmcnt(6)
 TR v[236:237],v15,34656
 MM a[24:27],v[216:219],v[40:43],a[24:27]
 TR v[238:239],v15,34784
 MM a[28:31],v[216:219],v[44:47],a[28:31]
 buffer_load_dwordx4 v243, s[64:67], s3 offen offset:3168 lds
 MM a[32:35],v[216:219],v[48:51],a[32:35]
 s_add_u32 s80, s80, 128
 s_cmp_eq_u32 s80, 896
 s_cselect_b32 s80, 0, s80
 s_add_u32 s81, s80, 114688
 MM a[36:39],v[220:223],v[40:43],a[36:39]
 MM a[40:43],v[220:223],v[44:47],a[40:43]
 MM a[44:47],v[220:223],v[48:51],a[44:47]
 s_waitcnt lgkmcnt(6)
 MM a[0:3],v[224:227],v[52:55],a[0:3]
 MM a[4:7],v[224:227],v[56:59],a[4:7]
 MM a[8:11],v[224:227],v[60:63],a[8:11]
 s_waitcnt lgkmcnt(0) vmcnt(16)
 s_barrier
 TR v[208:209],v14,0
 MM a[12:15],v[228:231],v[52:55],a[12:15]
 TR v[210:211],v14,128
 MM a[16:19],v[228:231],v[56:59],a[16:19]
 s_add_u32 s76, s83, 18432
 s_cmp_ge_u32 s76, 43008
 s_cselect_b32 s88, 43008, 0
 s_sub_u32 s76, s76, s88
 s_mul_i32 s76, s76, 683
 s_lshr_b32 s76, s76, 22
 s_lshl_b32 s76, s76, 7
 s_add_u32 s77, s76, 114688
 MM a[20:23],v[228:231],v[60:63],a[20:23]
 TR v[212:213],v14,32
 MM a[24:27],v[232:235],v[52:55],a[24:27]
 TR v[214:215],v14,160
 MM a[28:31],v[232:235],v[56:59],a[28:31]
 MM a[32:35],v[232:235],v[60:63],a[32:35]
 TR v[216:217],v14,64
 MM a[36:39],v[236:239],v[52:55],a[36:39]
 TR v[218:219],v14,192
 MM a[40:43],v[236:239],v[56:59],a[40:43]
 MM a[44:47],v[236:239],v[60:63],a[44:47]
 s_waitcnt lgkmcnt(4)
 TR v[220:221],v14,96
 MM a[0:3],v[208:211],v[64:67],a[0:3]
 TR v[222:223],v14,224
 MM a[4:7],v[208:211],v[68:71],a[4:7]
 TR v[224:225],v14,256
 MM a[8:11],v[208:211],v[72:75],a[8:11]
 s_waitcnt lgkmcnt(5)
 s_mov_b32 m0, s95
 TR v[226:227],v14,384
 MM a[12:15],v[212:215],v[64:67],a[12:15]
 buffer_load_dwordx4 v240, s[64:67], s80 offen offset:0 lds
 MM a[16:19],v[212:215],v[68:71],a[16:19]
 TR v[228:229],v14,288
 buffer_load_dwordx4 v241, s[64:67], s80 offen offset:1056 lds
 MM a[20:23],v[212:215],v[72:75],a[20:23]
 s_waitcnt lgkmcnt(3)
 TR v[230:231],v14,416
 MM a[24:27],v[216:219],v[64:67],a[24:27]
 TR v[232:233],v14,320
 MM a[28:31],v[216:219],v[68:71],a[28:31]
 TR v[234:235],v14,448
 MM a[32:35],v[216:219],v[72:75],a[32:35]
 buffer_load_dwordx4 v242, s[64:67], s80 offen offset:2112 lds
 MM a[36:39],v[220:223],v[64:67],a[36:39]
 TR v[236:237],v14,352
 MM a[40:43],v[220:223],v[68:71],a[40:43]
 TR v[238:239],v14,480
 MM a[44:47],v[220:223],v[72:75],a[44:47]
 s_waitcnt lgkmcnt(4)
 TR v[208:209],v14,512
 MM a[0:3],v[224:227],v[76:79],a[0:3]
 TR v[210:211],v14,640
 MM a[4:7],v[224:227],v[80:83],a[4:7]
 buffer_load_dwordx4 v243, s[64:67], s80 offen offset:3168 lds
 MM a[8:11],v[224:227],v[84:87],a[8:11]
 TR v[212:213],v14,544
 MM a[12:15],v[228:231],v[76:79],a[12:15]
 TR v[214:215],v14,672
 MM a[16:19],v[228:231],v[80:83],a[16:19]
 s_add_u32 m0, s95, 4224
 s_add_u32 s3, s80, 3584
 TR v[216:217],v14,576
 MM a[20:23],v[228:231],v[84:87],a[20:23]
 s_waitcnt lgkmcnt(5)
 buffer_load_dwordx4 v240, s[64:67], s3 offen offset:0 lds
 MM a[24:27],v[232:235],v[76:79],a[24:27]
 TR v[218:219],v14,704
 MM a[28:31],v[232:235],v[80:83],a[28:31]
 TR v[220:221],v14,608
 MM a[32:35],v[232:235],v[84:87],a[32:35]
 TR v[222:223],v14,736
 MM a[36:39],v[236:239],v[76:79],a[36:39]
 TR v[224:225],v14,768
 MM a[40:43],v[236:239],v[80:83],a[40:43]
 buffer_load_dwordx4 v241, s[64:67], s3 offen offset:1056 lds
 MM a[44:47],v[236:239],v[84:87],a[44:47]
 s_waitcnt lgkmcnt(5)
 TR v[226:227],v14,896
 MM a[0:3],v[208:211],v[88:91],a[0:3]
 TR v[228:229],v14,800
 MM a[4:7],v[208:211],v[92:95],a[4:7]
 TR v[230:231],v14,928
 MM a[8:11],v[208:211],v[96:99],a[8:11]
 TR v[232:233],v14,832
 MM a[12:15],v[212:215],v[88:91],a[12:15]
 buffer_load_dwordx4 v242, s[64:67], s3 offen offset:2112 lds
 MM a[16:19],v[212:215],v[92:95],a[16:19]
 TR v[234:235],v14,960
 MM a[20:23],v[212:215],v[96:99],a[20:23]
 s_waitcnt lgkmcnt(6)
 TR v[236:237],v14,864
 MM a[24:27],v[216:219],v[88:91],a[24:27]
 TR v[238:239],v14,992
 MM a[28:31],v[216:219],v[92:95],a[28:31]
 buffer_load_dwordx4 v243, s[64:67], s3 offen offset:3168 lds
 MM a[32:35],v[216:219],v[96:99],a[32:35]
 MM a[36:39],v[220:223],v[88:91],a[36:39]
 MM a[40:43],v[220:223],v[92:95],a[40:43]
 MM a[44:47],v[220:223],v[96:99],a[44:47]
 s_waitcnt lgkmcnt(6)
 MM a[0:3],v[224:227],v[100:103],a[0:3]
 MM a[4:7],v[224:227],v[104:107],a[4:7]
 MM a[8:11],v[224:227],v[108:111],a[8:11]
 s_waitcnt lgkmcnt(0) vmcnt(16)
 s_barrier
 TR v[208:209],v14,33792
 MM a[12:15],v[228:231],v[100:103],a[12:15]
 TR v[210:211],v14,33920
 MM a[16:19],v[228:231],v[104:107],a[16:19]
 MM a[20:23],v[228:231],v[108:111],a[20:23]
 TR v[212:213],v14,33824
 MM a[24:27],v[232:235],v[100:103],a[24:27]
 TR v[214:215],v14,33952
 MM a[28:31],v[232:235],v[104:107],a[28:31]
 MM a[32:35],v[232:235],v[108:111],a[32:35]
 TR v[216:217],v14,33856
 MM a[36:39],v[236:239],v[100:103],a[36:39]
 TR v[218:219],v14,33984
 MM a[40:43],v[236:239],v[104:107],a[40:43]
 MM a[44:47],v[236:239],v[108:111],a[44:47]
 s_waitcnt lgkmcnt(4)
 TR v[220:221],v14,33888
 MM a[48:51],v[208:211],v[16:19],0
 TR v[222:223],v14,34016
 MM a[52:55],v[208:211],v[20:23],0
 TR v[224:225],v14,34048
 MM a[56:59],v[208:211],v[24:27],0
 s_waitcnt lgkmcnt(5)
 s_mov_b32 m0, s89
 TR v[226:227],v14,34176
 MM a[60:63],v[212:215],v[16:19],0
 buffer_load_dwordx4 v240, s[64:67], s81 offen offset:0 lds
 MM a[64:67],v[212:215],v[20:23],0
 TR v[228:229],v14,34080
 buffer_load_dwordx4 v241, s[64:67], s81 offen offset:1056 lds
 MM a[68:71],v[212:215],v[24:27],0
 s_waitcnt lgkmcnt(3)
 TR v[230:231],v14,34208
 MM a[72:75],v[216:219],v[16:19],0
 TR v[232:233],v14,34112
 MM a[76:79],v[216:219],v[20:23],0
 TR v[234:235],v14,34240
 MM a[80:83],v[216:219],v[24:27],0
 buffer_load_dwordx4 v242, s[64:67], s81 offen offset:2112 lds
 MM a[84:87],v[220:223],v[16:19],0
 TR v[236:237],v14,34144
 MM a[88:91],v[220:223],v[20:23],0
 TR v[238:239],v14,34272
 MM a[92:95],v[220:223],v[24:27],0
 s_waitcnt lgkmcnt(4)
 TR v[208:209],v14,34304
 MM a[48:51],v[224:227],v[28:31],a[48:51]
 TR v[210:211],v14,34432
 MM a[52:55],v[224:227],v[32:35],a[52:55]
 buffer_load_dwordx4 v243, s[64:67], s81 offen offset:3168 lds
 MM a[56:59],v[224:227],v[36:39],a[56:59]
 TR v[212:213],v14,34336
 MM a[60:63],v[228:231],v[28:31],a[60:63]
 TR v[214:215],v14,34464
 MM a[64:67],v[228:231],v[32:35],a[64:67]
 s_add_u32 m0, s89, 4224
 s_add_u32 s3, s81, 3584
 TR v[216:217],v14,34368
 MM a[68:71],v[228:231],v[36:39],a[68:71]
 s_waitcnt lgkmcnt(5)
 buffer_load_dwordx4 v240, s[64:67], s3 offen offset:0 lds
 MM a[72:75],v[232:235],v[28:31],a[72:75]
 TR v[218:219],v14,34496
 MM a[76:79],v[232:235],v[32:35],a[76:79]
 TR v[220:221],v14,34400
 MM a[80:83],v[232:235],v[36:39],a[80:83]
 TR v[222:223],v14,34528
 MM a[84:87],v[236:239],v[28:31],a[84:87]
 TR v[224:225],v14,34560
 MM a[88:91],v[236:239],v[32:35],a[88:91]
 buffer_load_dwordx4 v241, s[64:67], s3 offen offset:1056 lds
 MM a[92:95],v[236:239],v[36:39],a[92:95]
 s_waitcnt lgkmcnt(5)
 TR v[226:227],v14,34688
 MM a[48:51],v[208:211],v[40:43],a[48:51]
 TR v[228:229],v14,34592
 MM a[52:55],v[208:211],v[44:47],a[52:55]
 TR v[230:231],v14,34720
 MM a[56:59],v[208:211],v[48:51],a[56:59]
 TR v[232:233],v14,34624
 MM a[60:63],v[212:215],v[40:43],a[60:63]
 buffer_load_dwordx4 v242, s[64:67], s3 offen offset:2112 lds
 MM a[64:67],v[212:215],v[44:47],a[64:67]
 TR v[234:235],v14,34752
 MM a[68:71],v[212:215],v[48:51],a[68:71]
 s_waitcnt lgkmcnt(6)
 TR v[236:237],v14,34656
 MM a[72:75],v[216:219],v[40:43],a[72:75]
 TR v[238:239],v14,34784
 MM a[76:79],v[216:219],v[44:47],a[76:79]
 buffer_load_dwordx4 v243, s[64:67], s3 offen offset:3168 lds
 MM a[80:83],v[216:219],v[48:51],a[80:83]
 s_add_u32 s80, s80, 128
 s_cmp_eq_u32 s80, 896
 s_cselect_b32 s80, 0, s80
 s_add_u32 s81, s80, 114688
 MM a[84:87],v[220:223],v[40:43],a[84:87]
 MM a[88:91],v[220:223],v[44:47],a[88:91]
 MM a[92:95],v[220:223],v[48:51],a[92:95]
 s_waitcnt lgkmcnt(6)
 MM a[48:51],v[224:227],v[52:55],a[48:51]
 MM a[52:55],v[224:227],v[56:59],a[52:55]
 MM a[56:59],v[224:227],v[60:63],a[56:59]
 s_waitcnt lgkmcnt(0) vmcnt(16)
 s_barrier
 TR v[208:209],v15,0
 MM a[60:63],v[228:231],v[52:55],a[60:63]
 TR v[210:211],v15,128
 MM a[64:67],v[228:231],v[56:59],a[64:67]
 MM a[68:71],v[228:231],v[60:63],a[68:71]
 TR v[212:213],v15,32
 MM a[72:75],v[232:235],v[52:55],a[72:75]
 TR v[214:215],v15,160
 MM a[76:79],v[232:235],v[56:59],a[76:79]
 MM a[80:83],v[232:235],v[60:63],a[80:83]
 TR v[216:217],v15,64
 MM a[84:87],v[236:239],v[52:55],a[84:87]
 TR v[218:219],v15,192
 MM a[88:91],v[236:239],v[56:59],a[88:91]
 MM a[92:95],v[236:239],v[60:63],a[92:95]
 s_waitcnt lgkmcnt(4)
 TR v[220:221],v15,96
 MM a[48:51],v[208:211],v[64:67],a[48:51]
 TR v[222:223],v15,224
 MM a[52:55],v[208:211],v[68:71],a[52:55]
 TR v[224:225],v15,256
 MM a[56:59],v[208:211],v[72:75],a[56:59]
 s_waitcnt lgkmcnt(5)
 s_mov_b32 m0, s91
 TR v[226:227],v15,384
 MM a[60:63],v[212:215],v[64:67],a[60:63]
 buffer_load_dwordx4 v240, s[64:67], s80 offen offset:0 lds
 MM a[64:67],v[212:215],v[68:71],a[64:67]
 TR v[228:229],v15,288
 buffer_load_dwordx4 v241, s[64:67], s80 offen offset:1056 lds
 MM a[68:71],v[212:215],v[72:75],a[68:71]
 s_waitcnt lgkmcnt(3)
 TR v[230:231],v15,416
 MM a[72:75],v[216:219],v[64:67],a[72:75]
 TR v[232:233],v15,320
 MM a[76:79],v[216:219],v[68:71],a[76:79]
 TR v[234:235],v15,448
 MM a[80:83],v[216:219],v[72:75],a[80:83]
 buffer_load_dwordx4 v242, s[64:67], s80 offen offset:2112 lds
 MM a[84:87],v[220:223],v[64:67],a[84:87]
 TR v[236:237],v15,352
 MM a[88:91],v[220:223],v[68:71],a[88:91]
 TR v[238:239],v15,480
 MM a[92:95],v[220:223],v[72:75],a[92:95]
 s_waitcnt lgkmcnt(4)
 TR v[208:209],v15,512
 MM a[48:51],v[224:227],v[76:79],a[48:51]
 TR v[210:211],v15,640
 MM a[52:55],v[224:227],v[80:83],a[52:55]
 buffer_load_dwordx4 v243, s[64:67], s80 offen offset:3168 lds
 MM a[56:59],v[224:227],v[84:87],a[56:59]
 TR v[212:213],v15,544
 MM a[60:63],v[228:231],v[76:79],a[60:63]
 TR v[214:215],v15,672
 MM a[64:67],v[228:231],v[80:83],a[64:67]
 s_add_u32 m0, s91, 4224
 s_add_u32 s3, s80, 3584
 TR v[216:217],v15,576
 MM a[68:71],v[228:231],v[84:87],a[68:71]
 s_waitcnt lgkmcnt(5)
 buffer_load_dwordx4 v240, s[64:67], s3 offen offset:0 lds
 MM a[72:75],v[232:235],v[76:79],a[72:75]
 TR v[218:219],v15,704
 MM a[76:79],v[232:235],v[80:83],a[76:79]
 TR v[220:221],v15,608
 MM a[80:83],v[232:235],v[84:87],a[80:83]
 TR v[222:223],v15,736
 MM a[84:87],v[236:239],v[76:79],a[84:87]
 TR v[224:225],v15,768
 MM a[88:91],v[236:239],v[80:83],a[88:91]
 buffer_load_dwordx4 v241, s[64:67], s3 offen offset:1056 lds
 MM a[92:95],v[236:239],v[84:87],a[92:95]
 s_waitcnt lgkmcnt(5)
 TR v[226:227],v15,896
 MM a[48:51],v[208:211],v[88:91],a[48:51]
 TR v[228:229],v15,800
 MM a[52:55],v[208:211],v[92:95],a[52:55]
 TR v[230:231],v15,928
 MM a[56:59],v[208:211],v[96:99],a[56:59]
 TR v[232:233],v15,832
 MM a[60:63],v[212:215],v[88:91],a[60:63]
 buffer_load_dwordx4 v242, s[64:67], s3 offen offset:2112 lds
 MM a[64:67],v[212:215],v[92:95],a[64:67]
 TR v[234:235],v15,960
 MM a[68:71],v[212:215],v[96:99],a[68:71]
 s_waitcnt lgkmcnt(6)
 TR v[236:237],v15,864
 MM a[72:75],v[216:219],v[88:91],a[72:75]
 TR v[238:239],v15,992
 MM a[76:79],v[216:219],v[92:95],a[76:79]
 buffer_load_dwordx4 v243, s[64:67], s3 offen offset:3168 lds
 MM a[80:83],v[216:219],v[96:99],a[80:83]
 MM a[84:87],v[220:223],v[88:91],a[84:87]
 MM a[88:91],v[220:223],v[92:95],a[88:91]
 MM a[92:95],v[220:223],v[96:99],a[92:95]
 s_waitcnt lgkmcnt(6)
 MM a[48:51],v[224:227],v[100:103],a[48:51]
 MM a[52:55],v[224:227],v[104:107],a[52:55]
 MM a[56:59],v[224:227],v[108:111],a[56:59]
 s_waitcnt lgkmcnt(0) vmcnt(16)
 s_barrier
 TR v[208:209],v15,33792
 MM a[60:63],v[228:231],v[100:103],a[60:63]
 TR v[210:211],v15,33920
 MM a[64:67],v[228:231],v[104:107],a[64:67]
 MM a[68:71],v[228:231],v[108:111],a[68:71]
 TR v[212:213],v15,33824
 MM a[72:75],v[232:235],v[100:103],a[72:75]
 TR v[214:215],v15,33952
 MM a[76:79],v[232:235],v[104:107],a[76:79]
 MM a[80:83],v[232:235],v[108:111],a[80:83]
 TR v[216:217],v15,33856
 MM a[84:87],v[236:239],v[100:103],a[84:87]
 TR v[218:219],v15,33984
 MM a[88:91],v[236:239],v[104:107],a[88:91]
 MM a[92:95],v[236:239],v[108:111],a[92:95]
 s_waitcnt lgkmcnt(4)
 TR v[220:221],v15,33888
 MM a[96:99],v[208:211],v[16:19],0
 TR v[222:223],v15,34016
 MM a[100:103],v[208:211],v[20:23],0
 TR v[224:225],v15,34048
 MM a[104:107],v[208:211],v[24:27],0
 s_waitcnt lgkmcnt(5)
 s_mov_b32 m0, s93
 TR v[226:227],v15,34176
 MM a[108:111],v[212:215],v[16:19],0
 buffer_load_dwordx4 v240, s[64:67], s81 offen offset:0 lds
 MM a[112:115],v[212:215],v[20:23],0
 TR v[228:229],v15,34080
 buffer_load_dwordx4 v241, s[64:67], s81 offen offset:1056 lds
 MM a[116:119],v[212:215],v[24:27],0
 s_waitcnt lgkmcnt(3)
 TR v[230:231],v15,34208
 MM a[120:123],v[216:219],v[16:19],0
 TR v[232:233],v15,34112
 MM a[124:127],v[216:219],v[20:23],0
 TR v[234:235],v15,34240
 MM a[128:131],v[216:219],v[24:27],0
 buffer_load_dwordx4 v242, s[64:67], s81 offen offset:2112 lds
 MM a[132:135],v[220:223],v[16:19],0
 TR v[236:237],v15,34144
 MM a[136:139],v[220:223],v[20:23],0
 TR v[238:239],v15,34272
 MM a[140:143],v[220:223],v[24:27],0
 s_waitcnt lgkmcnt(4)
 TR v[208:209],v15,34304
 MM a[96:99],v[224:227],v[28:31],a[96:99]
 TR v[210:211],v15,34432
 MM a[100:103],v[224:227],v[32:35],a[100:103]
 buffer_load_dwordx4 v243, s[64:67], s81 offen offset:3168 lds
 MM a[104:107],v[224:227],v[36:39],a[104:107]
 TR v[212:213],v15,34336
 MM a[108:111],v[228:231],v[28:31],a[108:111]
 TR v[214:215],v15,34464
 MM a[112:115],v[228:231],v[32:35],a[112:115]
 s_add_u32 m0, s93, 4224
 s_add_u32 s3, s81, 3584
 TR v[216:217],v15,34368
 MM a[116:119],v[228:231],v[36:39],a[116:119]
 s_waitcnt lgkmcnt(5)
 buffer_load_dwordx4 v240, s[64:67], s3 offen offset:0 lds
 MM a[120:123],v[232:235],v[28:31],a[120:123]
 TR v[218:219],v15,34496
 MM a[124:127],v[232:235],v[32:35],a[124:127]
 TR v[220:221],v15,34400
 MM a[128:131],v[232:235],v[36:39],a[128:131]
 TR v[222:223],v15,34528
 MM a[132:135],v[236:239],v[28:31],a[132:135]
 TR v[224:225],v15,34560
 MM a[136:139],v[236:239],v[32:35],a[136:139]
 buffer_load_dwordx4 v241, s[64:67], s3 offen offset:1056 lds
 MM a[140:143],v[236:239],v[36:39],a[140:143]
 s_waitcnt lgkmcnt(5)
 TR v[226:227],v15,34688
 MM a[96:99],v[208:211],v[40:43],a[96:99]
 TR v[228:229],v15,34592
 MM a[100:103],v[208:211],v[44:47],a[100:103]
 TR v[230:231],v15,34720
 MM a[104:107],v[208:211],v[48:51],a[104:107]
 TR v[232:233],v15,34624
 MM a[108:111],v[212:215],v[40:43],a[108:111]
 buffer_load_dwordx4 v242, s[64:67], s3 offen offset:2112 lds
 MM a[112:115],v[212:215],v[44:47],a[112:115]
 TR v[234:235],v15,34752
 MM a[116:119],v[212:215],v[48:51],a[116:119]
 s_waitcnt lgkmcnt(6)
 TR v[236:237],v15,34656
 MM a[120:123],v[216:219],v[40:43],a[120:123]
 TR v[238:239],v15,34784
 MM a[124:127],v[216:219],v[44:47],a[124:127]
 buffer_load_dwordx4 v243, s[64:67], s3 offen offset:3168 lds
 MM a[128:131],v[216:219],v[48:51],a[128:131]
 s_add_u32 s80, s80, 128
 s_cmp_eq_u32 s80, 896
 s_cselect_b32 s80, 0, s80
 s_add_u32 s81, s80, 114688
 MM a[132:135],v[220:223],v[40:43],a[132:135]
 MM a[136:139],v[220:223],v[44:47],a[136:139]
 MM a[140:143],v[220:223],v[48:51],a[140:143]
 s_waitcnt lgkmcnt(6)
 MM a[96:99],v[224:227],v[52:55],a[96:99]
 MM a[100:103],v[224:227],v[56:59],a[100:103]
 MM a[104:107],v[224:227],v[60:63],a[104:107]
 s_waitcnt lgkmcnt(0) vmcnt(16)
 s_barrier
 TR v[208:209],v14,0
 MM a[108:111],v[228:231],v[52:55],a[108:111]
 TR v[210:211],v14,128
 MM a[112:115],v[228:231],v[56:59],a[112:115]
 MM a[116:119],v[228:231],v[60:63],a[116:119]
 TR v[212:213],v14,32
 MM a[120:123],v[232:235],v[52:55],a[120:123]
 TR v[214:215],v14,160
 MM a[124:127],v[232:235],v[56:59],a[124:127]
 MM a[128:131],v[232:235],v[60:63],a[128:131]
 TR v[216:217],v14,64
 MM a[132:135],v[236:239],v[52:55],a[132:135]
 TR v[218:219],v14,192
 MM a[136:139],v[236:239],v[56:59],a[136:139]
 MM a[140:143],v[236:239],v[60:63],a[140:143]
 s_waitcnt lgkmcnt(4)
 TR v[220:221],v14,96
 MM a[96:99],v[208:211],v[64:67],a[96:99]
 TR v[222:223],v14,224
 MM a[100:103],v[208:211],v[68:71],a[100:103]
 TR v[224:225],v14,256
 MM a[104:107],v[208:211],v[72:75],a[104:107]
 s_waitcnt lgkmcnt(5)
 s_mov_b32 m0, s95
 TR v[226:227],v14,384
 MM a[108:111],v[212:215],v[64:67],a[108:111]
 buffer_load_dwordx4 v240, s[64:67], s80 offen offset:0 lds
 MM a[112:115],v[212:215],v[68:71],a[112:115]
 TR v[228:229],v14,288
 buffer_load_dwordx4 v241, s[64:67], s80 offen offset:1056 lds
 MM a[116:119],v[212:215],v[72:75],a[116:119]
 s_waitcnt lgkmcnt(3)
 TR v[230:231],v14,416
 MM a[120:123],v[216:219],v[64:67],a[120:123]
 TR v[232:233],v14,320
 MM a[124:127],v[216:219],v[68:71],a[124:127]
 TR v[234:235],v14,448
 MM a[128:131],v[216:219],v[72:75],a[128:131]
 buffer_load_dwordx4 v242, s[64:67], s80 offen offset:2112 lds
 MM a[132:135],v[220:223],v[64:67],a[132:135]
 TR v[236:237],v14,352
 MM a[136:139],v[220:223],v[68:71],a[136:139]
 TR v[238:239],v14,480
 MM a[140:143],v[220:223],v[72:75],a[140:143]
 s_waitcnt lgkmcnt(4)
 TR v[208:209],v14,512
 MM a[96:99],v[224:227],v[76:79],a[96:99]
 TR v[210:211],v14,640
 MM a[100:103],v[224:227],v[80:83],a[100:103]
 buffer_load_dwordx4 v243, s[64:67], s80 offen offset:3168 lds
 MM a[104:107],v[224:227],v[84:87],a[104:107]
 TR v[212:213],v14,544
 MM a[108:111],v[228:231],v[76:79],a[108:111]
 TR v[214:215],v14,672
 MM a[112:115],v[228:231],v[80:83],a[112:115]
 s_add_u32 m0, s95, 4224
 s_add_u32 s3, s80, 3584
 TR v[216:217],v14,576
 MM a[116:119],v[228:231],v[84:87],a[116:119]
 s_waitcnt lgkmcnt(5)
 buffer_load_dwordx4 v240, s[64:67], s3 offen offset:0 lds
 MM a[120:123],v[232:235],v[76:79],a[120:123]
 TR v[218:219],v14,704
 MM a[124:127],v[232:235],v[80:83],a[124:127]
 TR v[220:221],v14,608
 MM a[128:131],v[232:235],v[84:87],a[128:131]
 TR v[222:223],v14,736
 MM a[132:135],v[236:239],v[76:79],a[132:135]
 TR v[224:225],v14,768
 MM a[136:139],v[236:239],v[80:83],a[136:139]
 buffer_load_dwordx4 v241, s[64:67], s3 offen offset:1056 lds
 MM a[140:143],v[236:239],v[84:87],a[140:143]
 s_waitcnt lgkmcnt(5)
 TR v[226:227],v14,896
 MM a[96:99],v[208:211],v[88:91],a[96:99]
 TR v[228:229],v14,800
 MM a[100:103],v[208:211],v[92:95],a[100:103]
 TR v[230:231],v14,928
 MM a[104:107],v[208:211],v[96:99],a[104:107]
 TR v[232:233],v14,832
 MM a[108:111],v[212:215],v[88:91],a[108:111]
 buffer_load_dwordx4 v242, s[64:67], s3 offen offset:2112 lds
 MM a[112:115],v[212:215],v[92:95],a[112:115]
 TR v[234:235],v14,960
 MM a[116:119],v[212:215],v[96:99],a[116:119]
 s_waitcnt lgkmcnt(6)
 TR v[236:237],v14,864
 MM a[120:123],v[216:219],v[88:91],a[120:123]
 TR v[238:239],v14,992
 MM a[124:127],v[216:219],v[92:95],a[124:127]
 buffer_load_dwordx4 v243, s[64:67], s3 offen offset:3168 lds
 MM a[128:131],v[216:219],v[96:99],a[128:131]
 MM a[132:135],v[220:223],v[88:91],a[132:135]
 MM a[136:139],v[220:223],v[92:95],a[136:139]
 MM a[140:143],v[220:223],v[96:99],a[140:143]
 s_waitcnt lgkmcnt(6)
 MM a[96:99],v[224:227],v[100:103],a[96:99]
 MM a[100:103],v[224:227],v[104:107],a[100:103]
 MM a[104:107],v[224:227],v[108:111],a[104:107]
 s_waitcnt lgkmcnt(0) vmcnt(16)
 s_barrier
 TR v[208:209],v14,33792
 MM a[108:111],v[228:231],v[100:103],a[108:111]
 TR v[210:211],v14,33920
 MM a[112:115],v[228:231],v[104:107],a[112:115]
 MM a[116:119],v[228:231],v[108:111],a[116:119]
 TR v[212:213],v14,33824
 MM a[120:123],v[232:235],v[100:103],a[120:123]
 TR v[214:215],v14,33952
 MM a[124:127],v[232:235],v[104:107],a[124:127]
 MM a[128:131],v[232:235],v[108:111],a[128:131]
 TR v[216:217],v14,33856
 MM a[132:135],v[236:239],v[100:103],a[132:135]
 TR v[218:219],v14,33984
 MM a[136:139],v[236:239],v[104:107],a[136:139]
 MM a[140:143],v[236:239],v[108:111],a[140:143]
 s_waitcnt lgkmcnt(4)
 TR v[220:221],v14,33888
 MM a[144:147],v[208:211],v[16:19],0
 TR v[222:223],v14,34016
 MM a[148:151],v[208:211],v[20:23],0
 TR v[224:225],v14,34048
 MM a[152:155],v[208:211],v[24:27],0
 s_waitcnt lgkmcnt(5)
 s_mov_b32 m0, s89
 TR v[226:227],v14,34176
 MM a[156:159],v[212:215],v[16:19],0
 buffer_load_dwordx4 v240, s[64:67], s81 offen offset:0 lds
 MM a[160:163],v[212:215],v[20:23],0
 TR v[228:229],v14,34080
 buffer_load_dwordx4 v241, s[64:67], s81 offen offset:1056 lds
 MM a[164:167],v[212:215],v[24:27],0
 s_waitcnt lgkmcnt(3)
 TR v[230:231],v14,34208
 MM a[168:171],v[216:219],v[16:19],0
 TR v[232:233],v14,34112
 MM a[172:175],v[216:219],v[20:23],0
 TR v[234:235],v14,34240
 MM a[176:179],v[216:219],v[24:27],0
 buffer_load_dwordx4 v242, s[64:67], s81 offen offset:2112 lds
 MM a[180:183],v[220:223],v[16:19],0
 TR v[236:237],v14,34144
 MM a[184:187],v[220:223],v[20:23],0
 TR v[238:239],v14,34272
 MM a[188:191],v[220:223],v[24:27],0
 s_waitcnt lgkmcnt(4)
 TR v[208:209],v14,34304
 MM a[144:147],v[224:227],v[28:31],a[144:147]
 TR v[210:211],v14,34432
 MM a[148:151],v[224:227],v[32:35],a[148:151]
 buffer_load_dwordx4 v243, s[64:67], s81 offen offset:3168 lds
 MM a[152:155],v[224:227],v[36:39],a[152:155]
 TR v[212:213],v14,34336
 MM a[156:159],v[228:231],v[28:31],a[156:159]
 TR v[214:215],v14,34464
 MM a[160:163],v[228:231],v[32:35],a[160:163]
 s_add_u32 m0, s89, 4224
 s_add_u32 s3, s81, 3584
 TR v[216:217],v14,34368
 MM a[164:167],v[228:231],v[36:39],a[164:167]
 s_waitcnt lgkmcnt(5)
 buffer_load_dwordx4 v240, s[64:67], s3 offen offset:0 lds
 MM a[168:171],v[232:235],v[28:31],a[168:171]
 TR v[218:219],v14,34496
 MM a[172:175],v[232:235],v[32:35],a[172:175]
 TR v[220:221],v14,34400
 MM a[176:179],v[232:235],v[36:39],a[176:179]
 TR v[222:223],v14,34528
 MM a[180:183],v[236:239],v[28:31],a[180:183]
 TR v[224:225],v14,34560
 MM a[184:187],v[236:239],v[32:35],a[184:187]
 buffer_load_dwordx4 v241, s[64:67], s3 offen offset:1056 lds
 MM a[188:191],v[236:239],v[36:39],a[188:191]
 s_waitcnt lgkmcnt(5)
 TR v[226:227],v14,34688
 MM a[144:147],v[208:211],v[40:43],a[144:147]
 TR v[228:229],v14,34592
 MM a[148:151],v[208:211],v[44:47],a[148:151]
 TR v[230:231],v14,34720
 MM a[152:155],v[208:211],v[48:51],a[152:155]
 TR v[232:233],v14,34624
 MM a[156:159],v[212:215],v[40:43],a[156:159]
 buffer_load_dwordx4 v242, s[64:67], s3 offen offset:2112 lds
 MM a[160:163],v[212:215],v[44:47],a[160:163]
 TR v[234:235],v14,34752
 MM a[164:167],v[212:215],v[48:51],a[164:167]
 s_waitcnt lgkmcnt(6)
 TR v[236:237],v14,34656
 MM a[168:171],v[216:219],v[40:43],a[168:171]
 TR v[238:239],v14,34784
 MM a[172:175],v[216:219],v[44:47],a[172:175]
 buffer_load_dwordx4 v243, s[64:67], s3 offen offset:3168 lds
 MM a[176:179],v[216:219],v[48:51],a[176:179]
 s_add_u32 s80, s80, 128
 s_cmp_eq_u32 s80, 896
 s_cselect_b32 s80, 0, s80
 s_add_u32 s81, s80, 114688
 MM a[180:183],v[220:223],v[40:43],a[180:183]
 MM a[184:187],v[220:223],v[44:47],a[184:187]
 MM a[188:191],v[220:223],v[48:51],a[188:191]
 s_waitcnt lgkmcnt(6)
 MM a[144:147],v[224:227],v[52:55],a[144:147]
 MM a[148:151],v[224:227],v[56:59],a[148:151]
 MM a[152:155],v[224:227],v[60:63],a[152:155]
 s_waitcnt lgkmcnt(0) vmcnt(16)
 s_barrier
 TR v[208:209],v15,0
 MM a[156:159],v[228:231],v[52:55],a[156:159]
 TR v[210:211],v15,128
 MM a[160:163],v[228:231],v[56:59],a[160:163]
 MM a[164:167],v[228:231],v[60:63],a[164:167]
 TR v[212:213],v15,32
 MM a[168:171],v[232:235],v[52:55],a[168:171]
 TR v[214:215],v15,160
 MM a[172:175],v[232:235],v[56:59],a[172:175]
 MM a[176:179],v[232:235],v[60:63],a[176:179]
 TR v[216:217],v15,64
 MM a[180:183],v[236:239],v[52:55],a[180:183]
 TR v[218:219],v15,192
 MM a[184:187],v[236:239],v[56:59],a[184:187]
 MM a[188:191],v[236:239],v[60:63],a[188:191]
 s_waitcnt lgkmcnt(4)
 TR v[220:221],v15,96
 MM a[144:147],v[208:211],v[64:67],a[144:147]
 TR v[222:223],v15,224
 MM a[148:151],v[208:211],v[68:71],a[148:151]
 TR v[224:225],v15,256
 MM a[152:155],v[208:211],v[72:75],a[152:155]
 s_waitcnt lgkmcnt(5)
 TR v[226:227],v15,384
 MM a[156:159],v[212:215],v[64:67],a[156:159]
 MM a[160:163],v[212:215],v[68:71],a[160:163]
 TR v[228:229],v15,288
 MM a[164:167],v[212:215],v[72:75],a[164:167]
 s_waitcnt lgkmcnt(3)
 TR v[230:231],v15,416
 MM a[168:171],v[216:219],v[64:67],a[168:171]
 TR v[232:233],v15,320
 MM a[172:175],v[216:219],v[68:71],a[172:175]
 TR v[234:235],v15,448
 MM a[176:179],v[216:219],v[72:75],a[176:179]
 MM a[180:183],v[220:223],v[64:67],a[180:183]
 TR v[236:237],v15,352
 MM a[184:187],v[220:223],v[68:71],a[184:187]
 TR v[238:239],v15,480
 MM a[188:191],v[220:223],v[72:75],a[188:191]
 s_waitcnt lgkmcnt(4)
 TR v[208:209],v15,512
 MM a[144:147],v[224:227],v[76:79],a[144:147]
 TR v[210:211],v15,640
 MM a[148:151],v[224:227],v[80:83],a[148:151]
 MM a[152:155],v[224:227],v[84:87],a[152:155]
 TR v[212:213],v15,544
 MM a[156:159],v[228:231],v[76:79],a[156:159]
 TR v[214:215],v15,672
 MM a[160:163],v[228:231],v[80:83],a[160:163]
 TR v[216:217],v15,576
 MM a[164:167],v[228:231],v[84:87],a[164:167]
 s_waitcnt lgkmcnt(5)
 MM a[168:171],v[232:235],v[76:79],a[168:171]
 TR v[218:219],v15,704
 MM a[172:175],v[232:235],v[80:83],a[172:175]
 TR v[220:221],v15,608
 MM a[176:179],v[232:235],v[84:87],a[176:179]
 TR v[222:223],v15,736
 MM a[180:183],v[236:239],v[76:79],a[180:183]
 TR v[224:225],v15,768
 MM a[184:187],v[236:239],v[80:83],a[184:187]
 MM a[188:191],v[236:239],v[84:87],a[188:191]
 s_waitcnt lgkmcnt(5)
 TR v[226:227],v15,896
 MM a[144:147],v[208:211],v[88:91],a[144:147]
 TR v[228:229],v15,800
 MM a[148:151],v[208:211],v[92:95],a[148:151]
 TR v[230:231],v15,928
 MM a[152:155],v[208:211],v[96:99],a[152:155]
 TR v[232:233],v15,832
 MM a[156:159],v[212:215],v[88:91],a[156:159]
 MM a[160:163],v[212:215],v[92:95],a[160:163]
 TR v[234:235],v15,960
 MM a[164:167],v[212:215],v[96:99],a[164:167]
 s_waitcnt lgkmcnt(6)
 TR v[236:237],v15,864
 MM a[168:171],v[216:219],v[88:91],a[168:171]
 TR v[238:239],v15,992
 MM a[172:175],v[216:219],v[92:95],a[172:175]
 MM a[176:179],v[216:219],v[96:99],a[176:179]
 MM a[180:183],v[220:223],v[88:91],a[180:183]
 MM a[184:187],v[220:223],v[92:95],a[184:187]
 MM a[188:191],v[220:223],v[96:99],a[188:191]
 s_waitcnt lgkmcnt(6)
 MM a[144:147],v[224:227],v[100:103],a[144:147]
 MM a[148:151],v[224:227],v[104:107],a[148:151]
 MM a[152:155],v[224:227],v[108:111],a[152:155]
 s_waitcnt lgkmcnt(0) vmcnt(8)
 s_barrier
 TR v[208:209],v15,33792
 MM a[156:159],v[228:231],v[100:103],a[156:159]
 TR v[210:211],v15,33920
 MM a[160:163],v[228:231],v[104:107],a[160:163]
 MM a[164:167],v[228:231],v[108:111],a[164:167]
 TR v[212:213],v15,33824
 MM a[168:171],v[232:235],v[100:103],a[168:171]
 TR v[214:215],v15,33952
 MM a[172:175],v[232:235],v[104:107],a[172:175]
 MM a[176:179],v[232:235],v[108:111],a[176:179]
 TR v[216:217],v15,33856
 MM a[180:183],v[236:239],v[100:103],a[180:183]
 TR v[218:219],v15,33984
 MM a[184:187],v[236:239],v[104:107],a[184:187]
 MM a[188:191],v[236:239],v[108:111],a[188:191]
 s_waitcnt lgkmcnt(4)
 TR v[220:221],v15,33888
 MM a[192:195],v[208:211],v[16:19],0
 TR v[222:223],v15,34016
 MM a[196:199],v[208:211],v[20:23],0
 TR v[224:225],v15,34048
 MM a[200:203],v[208:211],v[24:27],0
 s_waitcnt lgkmcnt(5)
 TR v[226:227],v15,34176
 MM a[204:207],v[212:215],v[16:19],0
 MM a[208:211],v[212:215],v[20:23],0
 TR v[228:229],v15,34080
 MM a[212:215],v[212:215],v[24:27],0
 s_waitcnt lgkmcnt(3)
 TR v[230:231],v15,34208
 MM a[216:219],v[216:219],v[16:19],0
 TR v[232:233],v15,34112
 MM a[220:223],v[216:219],v[20:23],0
 TR v[234:235],v15,34240
 MM a[224:227],v[216:219],v[24:27],0
 MM a[228:231],v[220:223],v[16:19],0
 TR v[236:237],v15,34144
 MM a[232:235],v[220:223],v[20:23],0
 TR v[238:239],v15,34272
 MM a[236:239],v[220:223],v[24:27],0
 s_waitcnt lgkmcnt(4)
 TR v[208:209],v15,34304
 MM a[192:195],v[224:227],v[28:31],a[192:195]
 TR v[210:211],v15,34432
 MM a[196:199],v[224:227],v[32:35],a[196:199]
 MM a[200:203],v[224:227],v[36:39],a[200:203]
 TR v[212:213],v15,34336
 MM a[204:207],v[228:231],v[28:31],a[204:207]
 TR v[214:215],v15,34464
 MM a[208:211],v[228:231],v[32:35],a[208:211]
 TR v[216:217],v15,34368
 MM a[212:215],v[228:231],v[36:39],a[212:215]
 s_waitcnt lgkmcnt(5)
 MM a[216:219],v[232:235],v[28:31],a[216:219]
 TR v[218:219],v15,34496
 MM a[220:223],v[232:235],v[32:35],a[220:223]
 TR v[220:221],v15,34400
 MM a[224:227],v[232:235],v[36:39],a[224:227]
 TR v[222:223],v15,34528
 MM a[228:231],v[236:239],v[28:31],a[228:231]
 TR v[224:225],v15,34560
 MM a[232:235],v[236:239],v[32:35],a[232:235]
 MM a[236:239],v[236:239],v[36:39],a[236:239]
 s_waitcnt lgkmcnt(5)
 TR v[226:227],v15,34688
 MM a[192:195],v[208:211],v[40:43],a[192:195]
 TR v[228:229],v15,34592
 MM a[196:199],v[208:211],v[44:47],a[196:199]
 TR v[230:231],v15,34720
 MM a[200:203],v[208:211],v[48:51],a[200:203]
 TR v[232:233],v15,34624
 MM a[204:207],v[212:215],v[40:43],a[204:207]
 MM a[208:211],v[212:215],v[44:47],a[208:211]
 TR v[234:235],v15,34752
 MM a[212:215],v[212:215],v[48:51],a[212:215]
 s_waitcnt lgkmcnt(6)
 TR v[236:237],v15,34656
 MM a[216:219],v[216:219],v[40:43],a[216:219]
 TR v[238:239],v15,34784
 MM a[220:223],v[216:219],v[44:47],a[220:223]
 MM a[224:227],v[216:219],v[48:51],a[224:227]
 MM a[228:231],v[220:223],v[40:43],a[228:231]
 MM a[232:235],v[220:223],v[44:47],a[232:235]
 MM a[236:239],v[220:223],v[48:51],a[236:239]
 s_waitcnt lgkmcnt(6)
 MM a[192:195],v[224:227],v[52:55],a[192:195]
 MM a[196:199],v[224:227],v[56:59],a[196:199]
 MM a[200:203],v[224:227],v[60:63],a[200:203]
 s_waitcnt lgkmcnt(0) vmcnt(0)
 s_barrier
 TR v[208:209],v14,0
 MM a[204:207],v[228:231],v[52:55],a[204:207]
 TR v[210:211],v14,128
 MM a[208:211],v[228:231],v[56:59],a[208:211]
 MM a[212:215],v[228:231],v[60:63],a[212:215]
 TR v[212:213],v14,32
 MM a[216:219],v[232:235],v[52:55],a[216:219]
 TR v[214:215],v14,160
 MM a[220:223],v[232:235],v[56:59],a[220:223]
 MM a[224:227],v[232:235],v[60:63],a[224:227]
 TR v[216:217],v14,64
 MM a[228:231],v[236:239],v[52:55],a[228:231]
 TR v[218:219],v14,192
 MM a[232:235],v[236:239],v[56:59],a[232:235]
 MM a[236:239],v[236:239],v[60:63],a[236:239]
 s_waitcnt lgkmcnt(4)
 TR v[220:221],v14,96
 MM a[192:195],v[208:211],v[64:67],a[192:195]
 TR v[222:223],v14,224
 MM a[196:199],v[208:211],v[68:71],a[196:199]
 TR v[224:225],v14,256
 MM a[200:203],v[208:211],v[72:75],a[200:203]
 s_waitcnt lgkmcnt(5)
 TR v[226:227],v14,384
 MM a[204:207],v[212:215],v[64:67],a[204:207]
 MM a[208:211],v[212:215],v[68:71],a[208:211]
 TR v[228:229],v14,288
 MM a[212:215],v[212:215],v[72:75],a[212:215]
 s_waitcnt lgkmcnt(3)
 TR v[230:231],v14,416
 MM a[216:219],v[216:219],v[64:67],a[216:219]
 TR v[232:233],v14,320
 MM a[220:223],v[216:219],v[68:71],a[220:223]
 TR v[234:235],v14,448
 MM a[224:227],v[216:219],v[72:75],a[224:227]
 MM a[228:231],v[220:223],v[64:67],a[228:231]
 TR v[236:237],v14,352
 MM a[232:235],v[220:223],v[68:71],a[232:235]
 TR v[238:239],v14,480
 MM a[236:239],v[220:223],v[72:75],a[236:239]
 s_waitcnt lgkmcnt(4)
 TR v[208:209],v14,512
 MM a[192:195],v[224:227],v[76:79],a[192:195]
 TR v[210:211],v14,640
 MM a[196:199],v[224:227],v[80:83],a[196:199]
 MM a[200:203],v[224:227],v[84:87],a[200:203]
 TR v[212:213],v14,544
 MM a[204:207],v[228:231],v[76:79],a[204:207]
 TR v[214:215],v14,672
 MM a[208:211],v[228:231],v[80:83],a[208:211]
 TR v[216:217],v14,576
 MM a[212:215],v[228:231],v[84:87],a[212:215]
 s_waitcnt lgkmcnt(5)
 MM a[216:219],v[232:235],v[76:79],a[216:219]
 TR v[218:219],v14,704
 MM a[220:223],v[232:235],v[80:83],a[220:223]
 TR v[220:221],v14,608
 MM a[224:227],v[232:235],v[84:87],a[224:227]
 TR v[222:223],v14,736
 MM a[228:231],v[236:239],v[76:79],a[228:231]
 TR v[224:225],v14,768
 MM a[232:235],v[236:239],v[80:83],a[232:235]
 MM a[236:239],v[236:239],v[84:87],a[236:239]
 s_waitcnt lgkmcnt(5)
 TR v[226:227],v14,896
 MM a[192:195],v[208:211],v[88:91],a[192:195]
 TR v[228:229],v14,800
 MM a[196:199],v[208:211],v[92:95],a[196:199]
 TR v[230:231],v14,928
 MM a[200:203],v[208:211],v[96:99],a[200:203]
 TR v[232:233],v14,832
 MM a[204:207],v[212:215],v[88:91],a[204:207]
 MM a[208:211],v[212:215],v[92:95],a[208:211]
 TR v[234:235],v14,960
 MM a[212:215],v[212:215],v[96:99],a[212:215]
 s_waitcnt lgkmcnt(6)
 TR v[236:237],v14,864
 MM a[216:219],v[216:219],v[88:91],a[216:219]
 TR v[238:239],v14,992
 MM a[220:223],v[216:219],v[92:95],a[220:223]
 MM a[224:227],v[216:219],v[96:99],a[224:227]
 MM a[228:231],v[220:223],v[88:91],a[228:231]
 MM a[232:235],v[220:223],v[92:95],a[232:235]
 MM a[236:239],v[220:223],v[96:99],a[236:239]
 s_waitcnt lgkmcnt(6)
 MM a[192:195],v[224:227],v[100:103],a[192:195]
 MM a[196:199],v[224:227],v[104:107],a[196:199]
 MM a[200:203],v[224:227],v[108:111],a[200:203]
 s_waitcnt lgkmcnt(0)
 s_barrier
 MM a[204:207],v[228:231],v[100:103],a[204:207]
 MM a[208:211],v[228:231],v[104:107],a[208:211]
 MM a[212:215],v[228:231],v[108:111],a[212:215]
 MM a[216:219],v[232:235],v[100:103],a[216:219]
 MM a[220:223],v[232:235],v[104:107],a[220:223]
 MM a[224:227],v[232:235],v[108:111],a[224:227]
 MM a[228:231],v[236:239],v[100:103],a[228:231]
 MM a[232:235],v[236:239],v[104:107],a[232:235]
 MM a[236:239],v[236:239],v[108:111],a[236:239]
 s_mov_b32 m0, s91
 s_nop 0
 buffer_load_dwordx4 v240, s[68:71], s76 offen offset:0 lds
 buffer_load_dwordx4 v241, s[68:71], s76 offen offset:1056 lds
 buffer_load_dwordx4 v242, s[68:71], s76 offen offset:2112 lds
 buffer_load_dwordx4 v243, s[68:71], s76 offen offset:3168 lds
 s_add_u32 m0, s91, 4224
 s_add_u32 s3, s76, 3584
 buffer_load_dwordx4 v240, s[68:71], s3 offen offset:0 lds
 buffer_load_dwordx4 v241, s[68:71], s3 offen offset:1056 lds
 buffer_load_dwordx4 v242, s[68:71], s3 offen offset:2112 lds
 buffer_load_dwordx4 v243, s[68:71], s3 offen offset:3168 lds
 s_mov_b32 m0, s93
 s_nop 0
 buffer_load_dwordx4 v240, s[68:71], s77 offen offset:0 lds
 buffer_load_dwordx4 v241, s[68:71], s77 offen offset:1056 lds
 buffer_load_dwordx4 v242, s[68:71], s77 offen offset:2112 lds
 buffer_load_dwordx4 v243, s[68:71], s77 offen offset:3168 lds
 s_add_u32 m0, s93, 4224
 s_add_u32 s3, s77, 3584
 buffer_load_dwordx4 v240, s[68:71], s3 offen offset:0 lds
 buffer_load_dwordx4 v241, s[68:71], s3 offen offset:1056 lds
 buffer_load_dwordx4 v242, s[68:71], s3 offen offset:2112 lds
 buffer_load_dwordx4 v243, s[68:71], s3 offen offset:3168 lds
 s_add_u32 s76, s76, 128
 s_cmp_eq_u32 s76, 896
 s_cselect_b32 s76, 0, s76
 s_add_u32 s77, s76, 114688
 s_barrier
 s_mov_b32 m0, s89
 s_nop 0
 buffer_load_dwordx4 v240, s[68:71], s76 offen offset:0 lds
 buffer_load_dwordx4 v241, s[68:71], s76 offen offset:1056 lds
 buffer_load_dwordx4 v242, s[68:71], s76 offen offset:2112 lds
 buffer_load_dwordx4 v243, s[68:71], s76 offen offset:3168 lds
 s_add_u32 m0, s89, 4224
 s_add_u32 s3, s76, 3584
 buffer_load_dwordx4 v240, s[68:71], s3 offen offset:0 lds
 buffer_load_dwordx4 v241, s[68:71], s3 offen offset:1056 lds
 buffer_load_dwordx4 v242, s[68:71], s3 offen offset:2112 lds
 buffer_load_dwordx4 v243, s[68:71], s3 offen offset:3168 lds
 s_mov_b32 m0, s92
 s_nop 0
 buffer_load_dwordx4 v240, s[68:71], s80 offen offset:0 lds
 buffer_load_dwordx4 v241, s[68:71], s80 offen offset:1056 lds
 buffer_load_dwordx4 v242, s[68:71], s80 offen offset:2112 lds
 buffer_load_dwordx4 v243, s[68:71], s80 offen offset:3168 lds
 s_add_u32 m0, s92, 4224
 s_add_u32 s3, s80, 3584
 buffer_load_dwordx4 v240, s[68:71], s3 offen offset:0 lds
 buffer_load_dwordx4 v241, s[68:71], s3 offen offset:1056 lds
 buffer_load_dwordx4 v242, s[68:71], s3 offen offset:2112 lds
 buffer_load_dwordx4 v243, s[68:71], s3 offen offset:3168 lds
 s_barrier
 s_mov_b32 m0, s94
 s_nop 0
 buffer_load_dwordx4 v240, s[68:71], s77 offen offset:0 lds
 buffer_load_dwordx4 v241, s[68:71], s77 offen offset:1056 lds
 buffer_load_dwordx4 v242, s[68:71], s77 offen offset:2112 lds
 buffer_load_dwordx4 v243, s[68:71], s77 offen offset:3168 lds
 s_add_u32 m0, s94, 4224
 s_add_u32 s3, s77, 3584
 buffer_load_dwordx4 v240, s[68:71], s3 offen offset:0 lds
 buffer_load_dwordx4 v241, s[68:71], s3 offen offset:1056 lds
 buffer_load_dwordx4 v242, s[68:71], s3 offen offset:2112 lds
 buffer_load_dwordx4 v243, s[68:71], s3 offen offset:3168 lds
 s_add_u32 s76, s76, 128
 s_cmp_eq_u32 s76, 896
 s_cselect_b32 s76, 0, s76
 s_add_u32 s77, s76, 114688
 s_barrier
 ds_write_b128 v251, a[48:51] offset:0
 ds_write_b128 v251, a[52:55] offset:1024
 ds_write_b128 v251, a[56:59] offset:2048
 ds_write_b128 v251, a[60:63] offset:3072
 ds_write_b128 v251, a[64:67] offset:4096
 ds_write_b128 v251, a[68:71] offset:5120
 ds_write_b128 v251, a[72:75] offset:6144
 ds_write_b128 v251, a[76:79] offset:7168
 ds_write_b128 v251, a[80:83] offset:8192
 ds_write_b128 v251, a[84:87] offset:9216
 ds_write_b128 v251, a[88:91] offset:10240
 ds_write_b128 v251, a[92:95] offset:11264
 s_waitcnt lgkmcnt(0) vmcnt(32)
 s_barrier
 s_mov_b32 m0, s90
 s_nop 0
 buffer_load_dwordx4 v240, s[68:71], s81 offen offset:0 lds
 buffer_load_dwordx4 v241, s[68:71], s81 offen offset:1056 lds
 buffer_load_dwordx4 v242, s[68:71], s81 offen offset:2112 lds
 buffer_load_dwordx4 v243, s[68:71], s81 offen offset:3168 lds
 s_add_u32 m0, s90, 4224
 s_add_u32 s3, s81, 3584
 buffer_load_dwordx4 v240, s[68:71], s3 offen offset:0 lds
 buffer_load_dwordx4 v241, s[68:71], s3 offen offset:1056 lds
 buffer_load_dwordx4 v242, s[68:71], s3 offen offset:2112 lds
 buffer_load_dwordx4 v243, s[68:71], s3 offen offset:3168 lds
 s_add_u32 s80, s80, 128
 s_cmp_eq_u32 s80, 896
 s_cselect_b32 s80, 0, s80
 s_add_u32 s81, s80, 114688
 s_waitcnt vmcnt(32)
 s_barrier
 ds_read_b128 v[16:19], v247 offset:0
 ds_read_b128 v[20:23], v247 offset:1024
 ds_read_b128 v[24:27], v247 offset:2048
 ds_read_b128 v[28:31], v247 offset:3072
 ds_read_b128 v[32:35], v247 offset:4096
 ds_read_b128 v[36:39], v247 offset:5120
 ds_read_b128 v[40:43], v247 offset:6144
 ds_read_b128 v[44:47], v247 offset:7168
 ds_read_b128 v[48:51], v247 offset:8192
 ds_read_b128 v[52:55], v247 offset:9216
 ds_read_b128 v[56:59], v247 offset:10240
 ds_read_b128 v[60:63], v247 offset:11264
 s_mov_b32 m0, s91
 s_nop 0
 buffer_load_dwordx4 v240, s[68:71], s76 offen offset:0 lds
 buffer_load_dwordx4 v241, s[68:71], s76 offen offset:1056 lds
 buffer_load_dwordx4 v242, s[68:71], s76 offen offset:2112 lds
 buffer_load_dwordx4 v243, s[68:71], s76 offen offset:3168 lds
 s_add_u32 m0, s91, 4224
 s_add_u32 s3, s76, 3584
 buffer_load_dwordx4 v240, s[68:71], s3 offen offset:0 lds
 buffer_load_dwordx4 v241, s[68:71], s3 offen offset:1056 lds
 buffer_load_dwordx4 v242, s[68:71], s3 offen offset:2112 lds
 buffer_load_dwordx4 v243, s[68:71], s3 offen offset:3168 lds
 s_waitcnt lgkmcnt(0)
 ds_write_b128 v247, a[96:99] offset:0
 ds_write_b128 v247, a[100:103] offset:1024
 ds_write_b128 v247, a[104:107] offset:2048
 ds_write_b128 v247, a[108:111] offset:3072
 ds_write_b128 v247, a[112:115] offset:4096
 ds_write_b128 v247, a[116:119] offset:5120
 ds_write_b128 v247, a[120:123] offset:6144
 ds_write_b128 v247, a[124:127] offset:7168
 ds_write_b128 v247, a[128:131] offset:8192
 ds_write_b128 v247, a[132:135] offset:9216
 ds_write_b128 v247, a[136:139] offset:10240
 ds_write_b128 v247, a[140:143] offset:11264
 s_waitcnt lgkmcnt(0) vmcnt(24)
 s_barrier
 TR v[208:209],v14,50688
 TR v[210:211],v14,50816
 TR v[212:213],v14,50720
 TR v[214:215],v14,50848
 TR v[216:217],v14,50752
 TR v[218:219],v14,50880
 ds_read_b128 v[64:67], v251 offset:0
 ds_read_b128 v[68:71], v251 offset:1024
 ds_read_b128 v[72:75], v251 offset:2048
 ds_read_b128 v[76:79], v251 offset:3072
 ds_read_b128 v[80:83], v251 offset:4096
 ds_read_b128 v[84:87], v251 offset:5120
 ds_read_b128 v[88:91], v251 offset:6144
 ds_read_b128 v[92:95], v251 offset:7168
 ds_read_b128 v[96:99], v251 offset:8192
 ds_read_b128 v[100:103], v251 offset:9216
 ds_read_b128 v[104:107], v251 offset:10240
 ds_read_b128 v[108:111], v251 offset:11264
 s_waitcnt lgkmcnt(15)
 TR v[220:221],v14,50784
 MM v[112:115],v[208:211],v[16:19],v[112:115]
 TR v[222:223],v14,50912
 MM v[116:119],v[208:211],v[20:23],v[116:119]
 TR v[224:225],v14,50944
 MM v[120:123],v[208:211],v[24:27],v[120:123]
 s_waitcnt lgkmcnt(15)
 s_mov_b32 m0, s93
 TR v[226:227],v14,51072
 MM v[124:127],v[212:215],v[16:19],v[124:127]
 buffer_load_dwordx4 v240, s[68:71], s77 offen offset:0 lds
 MM v[128:131],v[212:215],v[20:23],v[128:131]
 TR v[228:229],v14,50976
 buffer_load_dwordx4 v241, s[68:71], s77 offen offset:1056 lds
 MM v[132:135],v[212:215],v[24:27],v[132:135]
 s_waitcnt lgkmcnt(3)
 TR v[230:231],v14,51104
 MM v[136:139],v[216:219],v[16:19],v[136:139]
 TR v[232:233],v14,51008
 MM v[140:143],v[216:219],v[20:23],v[140:143]
 TR v[234:235],v14,51136
 MM v[144:147],v[216:219],v[24:27],v[144:147]
 buffer_load_dwordx4 v242, s[68:71], s77 offen offset:2112 lds
 MM v[148:151],v[220:223],v[16:19],v[148:151]
 TR v[236:237],v14,51040
 MM v[152:155],v[220:223],v[20:23],v[152:155]
 TR v[238:239],v14,51168
 MM v[156:159],v[220:223],v[24:27],v[156:159]
 s_waitcnt lgkmcnt(4)
 TR v[208:209],v14,51200
 MM v[112:115],v[224:227],v[28:31],v[112:115]
 TR v[210:211],v14,51328
 MM v[116:119],v[224:227],v[32:35],v[116:119]
 buffer_load_dwordx4 v243, s[68:71], s77 offen offset:3168 lds
 MM v[120:123],v[224:227],v[36:39],v[120:123]
 TR v[212:213],v14,51232
 MM v[124:127],v[228:231],v[28:31],v[124:127]
 TR v[214:215],v14,51360
 MM v[128:131],v[228:231],v[32:35],v[128:131]
 s_add_u32 m0, s93, 4224
 s_add_u32 s3, s77, 3584
 TR v[216:217],v14,51264
 MM v[132:135],v[228:231],v[36:39],v[132:135]
 s_waitcnt lgkmcnt(5)
 buffer_load_dwordx4 v240, s[68:71], s3 offen offset:0 lds
 MM v[136:139],v[232:235],v[28:31],v[136:139]
 TR v[218:219],v14,51392
 MM v[140:143],v[232:235],v[32:35],v[140:143]
 TR v[220:221],v14,51296
 MM v[144:147],v[232:235],v[36:39],v[144:147]
 TR v[222:223],v14,51424
 MM v[148:151],v[236:239],v[28:31],v[148:151]
 TR v[224:225],v14,51456
 MM v[152:155],v[236:239],v[32:35],v[152:155]
 buffer_load_dwordx4 v241, s[68:71], s3 offen offset:1056 lds
 MM v[156:159],v[236:239],v[36:39],v[156:159]
 s_waitcnt lgkmcnt(5)
 TR v[226:227],v14,51584
 MM v[112:115],v[208:211],v[40:43],v[112:115]
 TR v[228:229],v14,51488
 MM v[116:119],v[208:211],v[44:47],v[116:119]
 TR v[230:231],v14,51616
 MM v[120:123],v[208:211],v[48:51],v[120:123]
 TR v[232:233],v14,51520
 MM v[124:127],v[212:215],v[40:43],v[124:127]
 buffer_load_dwordx4 v242, s[68:71], s3 offen offset:2112 lds
 MM v[128:131],v[212:215],v[44:47],v[128:131]
 TR v[234:235],v14,51648
 MM v[132:135],v[212:215],v[48:51],v[132:135]
 s_waitcnt lgkmcnt(6)
 TR v[236:237],v14,51552
 MM v[136:139],v[216:219],v[40:43],v[136:139]
 TR v[238:239],v14,51680
 MM v[140:143],v[216:219],v[44:47],v[140:143]
 buffer_load_dwordx4 v243, s[68:71], s3 offen offset:3168 lds
 MM v[144:147],v[216:219],v[48:51],v[144:147]
 s_add_u32 s76, s76, 128
 s_cmp_eq_u32 s76, 896
 s_cselect_b32 s76, 0, s76
 s_add_u32 s77, s76, 114688
 MM v[148:151],v[220:223],v[40:43],v[148:151]
 MM v[152:155],v[220:223],v[44:47],v[152:155]
 MM v[156:159],v[220:223],v[48:51],v[156:159]
 s_waitcnt lgkmcnt(6)
 MM v[112:115],v[224:227],v[52:55],v[112:115]
 MM v[116:119],v[224:227],v[56:59],v[116:119]
 MM v[120:123],v[224:227],v[60:63],v[120:123]
 s_waitcnt lgkmcnt(0) vmcnt(16)
 s_barrier
 TR v[208:209],v14,16896
 MM v[124:127],v[228:231],v[52:55],v[124:127]
 TR v[210:211],v14,17024
 MM v[128:131],v[228:231],v[56:59],v[128:131]
 MM v[132:135],v[228:231],v[60:63],v[132:135]
 TR v[212:213],v14,16928
 MM v[136:139],v[232:235],v[52:55],v[136:139]
 TR v[214:215],v14,17056
 MM v[140:143],v[232:235],v[56:59],v[140:143]
 MM v[144:147],v[232:235],v[60:63],v[144:147]
 TR v[216:217],v14,16960
 MM v[148:151],v[236:239],v[52:55],v[148:151]
 TR v[218:219],v14,17088
 MM v[152:155],v[236:239],v[56:59],v[152:155]
 MM v[156:159],v[236:239],v[60:63],v[156:159]
 s_waitcnt lgkmcnt(4)
 TR v[220:221],v14,16992
 MM v[112:115],v[208:211],v[64:67],v[112:115]
 TR v[222:223],v14,17120
 ds_write_b128 v251, a[144:147] offset:0
 MM v[116:119],v[208:211],v[68:71],v[116:119]
 TR v[224:225],v14,17152
 ds_write_b128 v251, a[148:151] offset:1024
 MM v[120:123],v[208:211],v[72:75],v[120:123]
 s_waitcnt lgkmcnt(7)
 s_mov_b32 m0, s89
 TR v[226:227],v14,17280
 MM v[124:127],v[212:215],v[64:67],v[124:127]
 buffer_load_dwordx4 v240, s[68:71], s80 offen offset:0 lds
 MM v[128:131],v[212:215],v[68:71],v[128:131]
 TR v[228:229],v14,17184
 buffer_load_dwordx4 v241, s[68:71], s80 offen offset:1056 lds
 MM v[132:135],v[212:215],v[72:75],v[132:135]
 s_waitcnt lgkmcnt(5)
 TR v[230:231],v14,17312
 buffer_load_dwordx4 v242, s[68:71], s80 offen offset:2112 lds
 MM v[136:139],v[216:219],v[64:67],v[136:139]
 TR v[232:233],v14,17216
 ds_write_b128 v251, a[152:155] offset:2048
 MM v[140:143],v[216:219],v[68:71],v[140:143]
 TR v[234:235],v14,17344
 MM v[144:147],v[216:219],v[72:75],v[144:147]
 buffer_load_dwordx4 v243, s[68:71], s80 offen offset:3168 lds
 ds_write_b128 v251, a[156:159] offset:3072
 MM v[148:151],v[220:223],v[64:67],v[148:151]
 s_add_u32 m0, s89, 4224
 s_add_u32 s3, s80, 3584
 TR v[236:237],v14,17248
 MM v[152:155],v[220:223],v[68:71],v[152:155]
 TR v[238:239],v14,17376
 buffer_load_dwordx4 v240, s[68:71], s3 offen offset:0 lds
 MM v[156:159],v[220:223],v[72:75],v[156:159]
 s_waitcnt lgkmcnt(6)
 TR v[208:209],v14,17408
 MM v[112:115],v[224:227],v[76:79],v[112:115]
 TR v[210:211],v14,17536
 ds_write_b128 v251, a[160:163] offset:4096
 MM v[116:119],v[224:227],v[80:83],v[116:119]
 buffer_load_dwordx4 v241, s[68:71], s3 offen offset:1056 lds
 MM v[120:123],v[224:227],v[84:87],v[120:123]
 TR v[212:213],v14,17440
 buffer_load_dwordx4 v242, s[68:71], s3 offen offset:2112 lds
 MM v[124:127],v[228:231],v[76:79],v[124:127]
 TR v[214:215],v14,17568
 ds_write_b128 v251, a[164:167] offset:5120
 MM v[128:131],v[228:231],v[80:83],v[128:131]
 TR v[216:217],v14,17472
 MM v[132:135],v[228:231],v[84:87],v[132:135]
 s_waitcnt lgkmcnt(7)
 buffer_load_dwordx4 v243, s[68:71], s3 offen offset:3168 lds
 ds_write_b128 v251, a[168:171] offset:6144
 MM v[136:139],v[232:235],v[76:79],v[136:139]
 s_mov_b32 m0, s92
 TR v[218:219],v14,17600
 MM v[140:143],v[232:235],v[80:83],v[140:143]
 TR v[220:221],v14,17504
 buffer_load_dwordx4 v240, s[68:71], s81 offen offset:0 lds
 MM v[144:147],v[232:235],v[84:87],v[144:147]
 TR v[222:223],v14,17632
 ds_write_b128 v251, a[172:175] offset:7168
 MM v[148:151],v[236:239],v[76:79],v[148:151]
 TR v[224:225],v14,17664
 MM v[152:155],v[236:239],v[80:83],v[152:155]
 buffer_load_dwordx4 v241, s[68:71], s81 offen offset:1056 lds
 ds_write_b128 v251, a[176:179] offset:8192
 MM v[156:159],v[236:239],v[84:87],v[156:159]
 s_waitcnt lgkmcnt(9)
 TR v[226:227],v14,17792
 buffer_load_dwordx4 v242, s[68:71], s81 offen offset:2112 lds
 MM v[112:115],v[208:211],v[88:91],v[112:115]
 TR v[228:229],v14,17696
 buffer_load_dwordx4 v243, s[68:71], s81 offen offset:3168 lds
 MM v[116:119],v[208:211],v[92:95],v[116:119]
 TR v[230:231],v14,17824
 MM v[120:123],v[208:211],v[96:99],v[120:123]
 s_add_u32 m0, s92, 4224
 s_add_u32 s3, s81, 3584
 TR v[232:233],v14,17728
 MM v[124:127],v[212:215],v[88:91],v[124:127]
 buffer_load_dwordx4 v240, s[68:71], s3 offen offset:0 lds
 ds_write_b128 v251, a[180:183] offset:9216
 MM v[128:131],v[212:215],v[92:95],v[128:131]
 TR v[234:235],v14,17856
 buffer_load_dwordx4 v241, s[68:71], s3 offen offset:1056 lds
 MM v[132:135],v[212:215],v[96:99],v[132:135]
 s_waitcnt lgkmcnt(9)
 TR v[236:237],v14,17760
 MM v[136:139],v[216:219],v[88:91],v[136:139]
 TR v[238:239],v14,17888
 ds_write_b128 v251, a[184:187] offset:10240
 MM v[140:143],v[216:219],v[92:95],v[140:143]
 buffer_load_dwordx4 v242, s[68:71], s3 offen offset:2112 lds
 MM v[144:147],v[216:219],v[96:99],v[144:147]
 buffer_load_dwordx4 v243, s[68:71], s3 offen offset:3168 lds
 ds_write_b128 v251, a[188:191] offset:11264
 MM v[148:151],v[220:223],v[88:91],v[148:151]
 s_add_u32 s80, s80, 128
 s_cmp_eq_u32 s80, 896
 s_cselect_b32 s80, 0, s80
 s_add_u32 s81, s80, 114688
 MM v[152:155],v[220:223],v[92:95],v[152:155]
 s_mov_b32 m0, s95
 MM v[156:159],v[220:223],v[96:99],v[156:159]
 s_waitcnt lgkmcnt(9)
 buffer_load_dwordx4 v240, s[68:71], s76 offen offset:0 lds
 MM v[112:115],v[224:227],v[100:103],v[112:115]
 buffer_load_dwordx4 v241, s[68:71], s76 offen offset:1056 lds
 MM v[116:119],v[224:227],v[104:107],v[116:119]
 buffer_load_dwordx4 v242, s[68:71], s76 offen offset:2112 lds
 MM v[120:123],v[224:227],v[108:111],v[120:123]
 s_waitcnt lgkmcnt(0) vmcnt(11)
 s_barrier
 TR v[208:209],v14,0
 buffer_load_dwordx4 v243, s[68:71], s76 offen offset:3168 lds
 MM v[124:127],v[228:231],v[100:103],v[124:127]
 s_add_u32 m0, s95, 4224
 s_add_u32 s3, s76, 3584
 TR v[210:211],v14,128
 MM v[128:131],v[228:231],v[104:107],v[128:131]
 buffer_load_dwordx4 v240, s[68:71], s3 offen offset:0 lds
 MM v[132:135],v[228:231],v[108:111],v[132:135]
 TR v[212:213],v14,32
 buffer_load_dwordx4 v241, s[68:71], s3 offen offset:1056 lds
 MM v[136:139],v[232:235],v[100:103],v[136:139]
 TR v[214:215],v14,160
 buffer_load_dwordx4 v242, s[68:71], s3 offen offset:2112 lds
 MM v[140:143],v[232:235],v[104:107],v[140:143]
 buffer_load_dwordx4 v243, s[68:71], s3 offen offset:3168 lds
 MM v[144:147],v[232:235],v[108:111],v[144:147]
 TR v[216:217],v14,64
 MM v[148:151],v[236:239],v[100:103],v[148:151]
 TR v[218:219],v14,192
 MM v[152:155],v[236:239],v[104:107],v[152:155]
 MM v[156:159],v[236:239],v[108:111],v[156:159]
 s_waitcnt lgkmcnt(4)
 TR v[220:221],v14,96
 MM v[160:163],v[208:211],v[16:19],v[160:163]
 TR v[222:223],v14,224
 MM v[164:167],v[208:211],v[20:23],v[164:167]
 TR v[224:225],v14,256
 MM v[168:171],v[208:211],v[24:27],v[168:171]
 s_waitcnt lgkmcnt(5)
 s_mov_b32 m0, s96
 TR v[226:227],v14,384
 CV v112,v112,v113
 CV v113,v114,v115
 MM v[172:175],v[212:215],v[16:19],v[172:175]
 buffer_load_dwordx4 v240, s[68:71], s80 offen offset:0 lds
 CV v114,v124,v125
 CV v115,v126,v127
 buffer_store_dwordx4 v[112:115], v250, s[60:63], s83 offen offset:0 sc1
 MM v[176:179],v[212:215],v[20:23],v[176:179]
 TR v[228:229],v14,288
 buffer_load_dwordx4 v241, s[68:71], s80 offen offset:1056 lds
 CV v116,v116,v117
 CV v117,v118,v119
 MM v[180:183],v[212:215],v[24:27],v[180:183]
 s_waitcnt lgkmcnt(3)
 TR v[230:231],v14,416
 buffer_load_dwordx4 v242, s[68:71], s80 offen offset:2112 lds
 CV v118,v128,v129
 CV v119,v130,v131
 MM v[184:187],v[216:219],v[16:19],v[184:187]
 TR v[232:233],v14,320
 buffer_store_dwordx4 v[116:119], v250, s[60:63], s83 offen offset:1024 sc1
 CV v120,v120,v121
 CV v121,v122,v123
 MM v[188:191],v[216:219],v[20:23],v[188:191]
 TR v[234:235],v14,448
 CV v122,v132,v133
 CV v123,v134,v135
 buffer_store_dwordx4 v[120:123], v250, s[60:63], s83 offen offset:2048 sc1
 MM v[192:195],v[216:219],v[24:27],v[192:195]
 buffer_load_dwordx4 v243, s[68:71], s80 offen offset:3168 lds
 CV v136,v136,v137
 CV v137,v138,v139
 CV v138,v148,v149
 MM v[196:199],v[220:223],v[16:19],v[196:199]
 s_add_u32 m0, s96, 4224
 s_add_u32 s3, s80, 3584
 TR v[236:237],v14,352
 CV v139,v150,v151
 buffer_store_dwordx4 v[136:139], v250, s[60:63], s84 offen offset:0 sc1
 MM v[200:203],v[220:223],v[20:23],v[200:203]
 TR v[238:239],v14,480
 buffer_load_dwordx4 v240, s[68:71], s3 offen offset:0 lds
 CV v140,v140,v141
 CV v141,v142,v143
 MM v[204:207],v[220:223],v[24:27],v[204:207]
 s_waitcnt lgkmcnt(4)
 TR v[208:209],v14,512
 CV v142,v152,v153
 CV v143,v154,v155
 buffer_store_dwordx4 v[140:143], v250, s[60:63], s84 offen offset:1024 sc1
 MM v[160:163],v[224:227],v[28:31],v[160:163]
 TR v[210:211],v14,640
 CV v144,v144,v145
 CV v145,v146,v147
 CV v146,v156,v157
 MM v[164:167],v[224:227],v[32:35],v[164:167]
 buffer_load_dwordx4 v241, s[68:71], s3 offen offset:1056 lds
 CV v147,v158,v159
 buffer_store_dwordx4 v[144:147], v250, s[60:63], s84 offen offset:2048 sc1
 MM v[168:171],v[224:227],v[36:39],v[168:171]
 TR v[212:213],v14,544
 buffer_load_dwordx4 v242, s[68:71], s3 offen offset:2112 lds
 MM v[172:175],v[228:231],v[28:31],v[172:175]
 TR v[214:215],v14,672
 MM v[176:179],v[228:231],v[32:35],v[176:179]
 TR v[216:217],v14,576
 MM v[180:183],v[228:231],v[36:39],v[180:183]
 s_waitcnt lgkmcnt(5)
 buffer_load_dwordx4 v243, s[68:71], s3 offen offset:3168 lds
 MM v[184:187],v[232:235],v[28:31],v[184:187]
 s_mov_b32 m0, s94
 TR v[218:219],v14,704
 MM v[188:191],v[232:235],v[32:35],v[188:191]
 TR v[220:221],v14,608
 buffer_load_dwordx4 v240, s[68:71], s77 offen offset:0 lds
 MM v[192:195],v[232:235],v[36:39],v[192:195]
 TR v[222:223],v14,736
 MM v[196:199],v[236:239],v[28:31],v[196:199]
 TR v[224:225],v14,768
 MM v[200:203],v[236:239],v[32:35],v[200:203]
 buffer_load_dwordx4 v241, s[68:71], s77 offen offset:1056 lds
 MM v[204:207],v[236:239],v[36:39],v[204:207]
 s_waitcnt lgkmcnt(5)
 TR v[226:227],v14,896
 buffer_load_dwordx4 v242, s[68:71], s77 offen offset:2112 lds
 MM v[160:163],v[208:211],v[40:43],v[160:163]
 TR v[228:229],v14,800
 buffer_load_dwordx4 v243, s[68:71], s77 offen offset:3168 lds
 MM v[164:167],v[208:211],v[44:47],v[164:167]
 TR v[230:231],v14,928
 MM v[168:171],v[208:211],v[48:51],v[168:171]
 s_add_u32 m0, s94, 4224
 s_add_u32 s3, s77, 3584
 TR v[232:233],v14,832
 MM v[172:175],v[212:215],v[40:43],v[172:175]
 buffer_load_dwordx4 v240, s[68:71], s3 offen offset:0 lds
 MM v[176:179],v[212:215],v[44:47],v[176:179]
 TR v[234:235],v14,960
 buffer_load_dwordx4 v241, s[68:71], s3 offen offset:1056 lds
 MM v[180:183],v[212:215],v[48:51],v[180:183]
 s_waitcnt lgkmcnt(6)
 TR v[236:237],v14,864
 MM v[184:187],v[216:219],v[40:43],v[184:187]
 TR v[238:239],v14,992
 MM v[188:191],v[216:219],v[44:47],v[188:191]
 buffer_load_dwordx4 v242, s[68:71], s3 offen offset:2112 lds
 MM v[192:195],v[216:219],v[48:51],v[192:195]
 buffer_load_dwordx4 v243, s[68:71], s3 offen offset:3168 lds
 MM v[196:199],v[220:223],v[40:43],v[196:199]
 s_add_u32 s76, s76, 128
 s_cmp_eq_u32 s76, 896
 s_cselect_b32 s76, 0, s76
 s_add_u32 s77, s76, 114688
 MM v[200:203],v[220:223],v[44:47],v[200:203]
 s_mov_b32 m0, s90
 MM v[204:207],v[220:223],v[48:51],v[204:207]
 s_waitcnt lgkmcnt(6)
 buffer_load_dwordx4 v240, s[68:71], s81 offen offset:0 lds
 MM v[160:163],v[224:227],v[52:55],v[160:163]
 buffer_load_dwordx4 v241, s[68:71], s81 offen offset:1056 lds
 MM v[164:167],v[224:227],v[56:59],v[164:167]
 buffer_load_dwordx4 v242, s[68:71], s81 offen offset:2112 lds
 MM v[168:171],v[224:227],v[60:63],v[168:171]
 s_waitcnt lgkmcnt(0) vmcnt(27)
 s_barrier
 TR v[208:209],v14,50688
 buffer_load_dwordx4 v243, s[68:71], s81 offen offset:3168 lds
 MM v[172:175],v[228:231],v[52:55],v[172:175]
 s_add_u32 m0, s90, 4224
 s_add_u32 s3, s81, 3584
 TR v[210:211],v14,50816
 MM v[176:179],v[228:231],v[56:59],v[176:179]
 buffer_load_dwordx4 v240, s[68:71], s3 offen offset:0 lds
 MM v[180:183],v[228:231],v[60:63],v[180:183]
 TR v[212:213],v14,50720
 buffer_load_dwordx4 v241, s[68:71], s3 offen offset:1056 lds
 MM v[184:187],v[232:235],v[52:55],v[184:187]
 TR v[214:215],v14,50848
 buffer_load_dwordx4 v242, s[68:71], s3 offen offset:2112 lds
 MM v[188:191],v[232:235],v[56:59],v[188:191]
 buffer_load_dwordx4 v243, s[68:71], s3 offen offset:3168 lds
 MM v[192:195],v[232:235],v[60:63],v[192:195]
 s_add_u32 s80, s80, 128
 s_cmp_eq_u32 s80, 896
 s_cselect_b32 s80, 0, s80
 s_add_u32 s81, s80, 114688
 TR v[216:217],v14,50752
 MM v[196:199],v[236:239],v[52:55],v[196:199]
 TR v[218:219],v14,50880
 MM v[200:203],v[236:239],v[56:59],v[200:203]
 s_add_u32 s83, s83, 6144
 s_cmp_ge_u32 s83, 43008
 s_cselect_b32 s88, 43008, 0
 s_sub_u32 s83, s83, s88
 s_add_u32 s84, s83, 3072
 MM v[204:207],v[236:239],v[60:63],v[204:207]
 s_waitcnt lgkmcnt(4)
 TR v[220:221],v14,50784
 MM v[160:163],v[208:211],v[64:67],v[160:163]
 TR v[222:223],v14,50912
 ds_write_b128 v251, a[192:195] offset:0
 MM v[164:167],v[208:211],v[68:71],v[164:167]
 TR v[224:225],v14,50944
 MM v[168:171],v[208:211],v[72:75],v[168:171]
 s_waitcnt lgkmcnt(6)
 TR v[226:227],v14,51072
 MM v[172:175],v[212:215],v[64:67],v[172:175]
 ds_write_b128 v251, a[196:199] offset:1024
 MM v[176:179],v[212:215],v[68:71],v[176:179]
 TR v[228:229],v14,50976
 MM v[180:183],v[212:215],v[72:75],v[180:183]
 s_waitcnt lgkmcnt(5)
 TR v[230:231],v14,51104
 MM v[184:187],v[216:219],v[64:67],v[184:187]
 TR v[232:233],v14,51008
 ds_write_b128 v251, a[200:203] offset:2048
 MM v[188:191],v[216:219],v[68:71],v[188:191]
 TR v[234:235],v14,51136
 MM v[192:195],v[216:219],v[72:75],v[192:195]
 MM v[196:199],v[220:223],v[64:67],v[196:199]
 TR v[236:237],v14,51040
 ds_write_b128 v251, a[204:207] offset:3072
 MM v[200:203],v[220:223],v[68:71],v[200:203]
 TR v[238:239],v14,51168
 MM v[204:207],v[220:223],v[72:75],v[204:207]
 s_waitcnt lgkmcnt(6)
 TR v[208:209],v14,51200
 MM v[160:163],v[224:227],v[76:79],v[160:163]
 TR v[210:211],v14,51328
 ds_write_b128 v251, a[208:211] offset:4096
 MM v[164:167],v[224:227],v[80:83],v[164:167]
 MM v[168:171],v[224:227],v[84:87],v[168:171]
 TR v[212:213],v14,51232
 MM v[172:175],v[228:231],v[76:79],v[172:175]
 TR v[214:215],v14,51360
 ds_write_b128 v251, a[212:215] offset:5120
 MM v[176:179],v[228:231],v[80:83],v[176:179]
 TR v[216:217],v14,51264
 MM v[180:183],v[228:231],v[84:87],v[180:183]
 s_waitcnt lgkmcnt(7)
 MM v[184:187],v[232:235],v[76:79],v[184:187]
 TR v[218:219],v14,51392
 ds_write_b128 v251, a[216:219] offset:6144
 MM v[188:191],v[232:235],v[80:83],v[188:191]
 TR v[220:221],v14,51296
 MM v[192:195],v[232:235],v[84:87],v[192:195]
 TR v[222:223],v14,51424
 MM v[196:199],v[236:239],v[76:79],v[196:199]
 TR v[224:225],v14,51456
 MM v[200:203],v[236:239],v[80:83],v[200:203]
 ds_write_b128 v251, a[220:223] offset:7168
 MM v[204:207],v[236:239],v[84:87],v[204:207]
 s_waitcnt lgkmcnt(8)
 TR v[226:227],v14,51584
 MM v[160:163],v[208:211],v[88:91],v[160:163]
 TR v[228:229],v14,51488
 ds_write_b128 v251, a[224:227] offset:8192
 MM v[164:167],v[208:211],v[92:95],v[164:167]
 TR v[230:231],v14,51616
 MM v[168:171],v[208:211],v[96:99],v[168:171]
 TR v[232:233],v14,51520
 MM v[172:175],v[212:215],v[88:91],v[172:175]
 ds_write_b128 v251, a[228:231] offset:9216
 MM v[176:179],v[212:215],v[92:95],v[176:179]
 TR v[234:235],v14,51648
 MM v[180:183],v[212:215],v[96:99],v[180:183]
 s_waitcnt lgkmcnt(9)
 TR v[236:237],v14,51552
 MM v[184:187],v[216:219],v[88:91],v[184:187]
 TR v[238:239],v14,51680
 MM v[188:191],v[216:219],v[92:95],v[188:191]
 ds_write_b128 v251, a[232:235] offset:10240
 MM v[192:195],v[216:219],v[96:99],v[192:195]
 MM v[196:199],v[220:223],v[88:91],v[196:199]
 ds_write_b128 v251, a[236:239] offset:11264
 MM v[200:203],v[220:223],v[92:95],v[200:203]
 MM v[204:207],v[220:223],v[96:99],v[204:207]
 s_waitcnt lgkmcnt(10)
 MM v[160:163],v[224:227],v[100:103],v[160:163]
 MM v[164:167],v[224:227],v[104:107],v[164:167]
 MM v[168:171],v[224:227],v[108:111],v[168:171]
 s_waitcnt lgkmcnt(0) vmcnt(16)
 s_barrier
 TR v[208:209],v15,50688
 MM v[172:175],v[228:231],v[100:103],v[172:175]
 TR v[210:211],v15,50816
 MM v[176:179],v[228:231],v[104:107],v[176:179]
 MM v[180:183],v[228:231],v[108:111],v[180:183]
 TR v[212:213],v15,50720
 MM v[184:187],v[232:235],v[100:103],v[184:187]
 TR v[214:215],v15,50848
 MM v[188:191],v[232:235],v[104:107],v[188:191]
 MM v[192:195],v[232:235],v[108:111],v[192:195]
 TR v[216:217],v15,50752
 MM v[196:199],v[236:239],v[100:103],v[196:199]
 TR v[218:219],v15,50880
 MM v[200:203],v[236:239],v[104:107],v[200:203]
 MM v[204:207],v[236:239],v[108:111],v[204:207]
 s_waitcnt lgkmcnt(4)
 TR v[220:221],v15,50784
 MM a[0:3],v[208:211],v[16:19],a[0:3]
 TR v[222:223],v15,50912
 MM a[4:7],v[208:211],v[20:23],a[4:7]
 TR v[224:225],v15,50944
 MM a[8:11],v[208:211],v[24:27],a[8:11]
 s_waitcnt lgkmcnt(5)
 TR v[226:227],v15,51072
 CV v160,v160,v161
 CV v161,v162,v163
 MM a[12:15],v[212:215],v[16:19],a[12:15]
 CV v162,v172,v173
 MM a[16:19],v[212:215],v[20:23],a[16:19]
 TR v[228:229],v15,50976
 MM a[20:23],v[212:215],v[24:27],a[20:23]
 s_waitcnt lgkmcnt(3)
 TR v[230:231],v15,51104
 CV v163,v174,v175
 MM a[24:27],v[216:219],v[16:19],a[24:27]
 TR v[232:233],v15,51008
 MM a[28:31],v[216:219],v[20:23],a[28:31]
 TR v[234:235],v15,51136
 buffer_store_dwordx4 v[160:163], v250, s[60:63], s83 offen offset:0 sc1
 MM a[32:35],v[216:219],v[24:27],a[32:35]
 MM a[36:39],v[220:223],v[16:19],a[36:39]
 TR v[236:237],v15,51040
 CV v164,v164,v165
 MM a[40:43],v[220:223],v[20:23],a[40:43]
 TR v[238:239],v15,51168
 MM a[44:47],v[220:223],v[24:27],a[44:47]
 s_waitcnt lgkmcnt(4)
 TR v[208:209],v15,51200
 CV v165,v166,v167
 MM a[0:3],v[224:227],v[28:31],a[0:3]
 TR v[210:211],v15,51328
 MM a[4:7],v[224:227],v[32:35],a[4:7]
 CV v166,v176,v177
 MM a[8:11],v[224:227],v[36:39],a[8:11]
 TR v[212:213],v15,51232
 MM a[12:15],v[228:231],v[28:31],a[12:15]
 TR v[214:215],v15,51360
 CV v167,v178,v179
 MM a[16:19],v[228:231],v[32:35],a[16:19]
 TR v[216:217],v15,51264
 MM a[20:23],v[228:231],v[36:39],a[20:23]
 s_waitcnt lgkmcnt(5)
 buffer_store_dwordx4 v[164:167], v250, s[60:63], s83 offen offset:1024 sc1
 MM a[24:27],v[232:235],v[28:31],a[24:27]
 TR v[218:219],v15,51392
 CV v168,v168,v169
 MM a[28:31],v[232:235],v[32:35],a[28:31]
 TR v[220:221],v15,51296
 MM a[32:35],v[232:235],v[36:39],a[32:35]
 TR v[222:223],v15,51424
 CV v169,v170,v171
 MM a[36:39],v[236:239],v[28:31],a[36:39]
 TR v[224:225],v15,51456
 MM a[40:43],v[236:239],v[32:35],a[40:43]
 CV v170,v180,v181
 MM a[44:47],v[236:239],v[36:39],a[44:47]
 s_waitcnt lgkmcnt(5)
 TR v[226:227],v15,51584
 MM a[0:3],v[208:211],v[40:43],a[0:3]
 TR v[228:229],v15,51488
 CV v171,v182,v183
 MM a[4:7],v[208:211],v[44:47],a[4:7]
 TR v[230:231],v15,51616
 MM a[8:11],v[208:211],v[48:51],a[8:11]
 TR v[232:233],v15,51520
 buffer_store_dwordx4 v[168:171], v250, s[60:63], s83 offen offset:2048 sc1
 MM a[12:15],v[212:215],v[40:43],a[12:15]
 MM a[16:19],v[212:215],v[44:47],a[16:19]
 TR v[234:235],v15,51648
 CV v184,v184,v185
 MM a[20:23],v[212:215],v[48:51],a[20:23]
 s_waitcnt lgkmcnt(6)
 TR v[236:237],v15,51552
 MM a[24:27],v[216:219],v[40:43],a[24:27]
 TR v[238:239],v15,51680
 CV v185,v186,v187
 MM a[28:31],v[216:219],v[44:47],a[28:31]
 CV v186,v196,v197
 MM a[32:35],v[216:219],v[48:51],a[32:35]
 MM a[36:39],v[220:223],v[40:43],a[36:39]
 CV v187,v198,v199
 MM a[40:43],v[220:223],v[44:47],a[40:43]
 MM a[44:47],v[220:223],v[48:51],a[44:47]
 s_waitcnt lgkmcnt(6)
 buffer_store_dwordx4 v[184:187], v250, s[60:63], s84 offen offset:0 sc1
 MM a[0:3],v[224:227],v[52:55],a[0:3]
 CV v188,v188,v189
 MM a[4:7],v[224:227],v[56:59],a[4:7]
 MM a[8:11],v[224:227],v[60:63],a[8:11]
 s_waitcnt lgkmcnt(0) vmcnt(0)
 s_barrier
 TR v[208:209],v14,16896
 CV v189,v190,v191
 MM a[12:15],v[228:231],v[52:55],a[12:15]
 TR v[210:211],v14,17024
 MM a[16:19],v[228:231],v[56:59],a[16:19]
 CV v190,v200,v201
 MM a[20:23],v[228:231],v[60:63],a[20:23]
 TR v[212:213],v14,16928
 MM a[24:27],v[232:235],v[52:55],a[24:27]
 TR v[214:215],v14,17056
 CV v191,v202,v203
 MM a[28:31],v[232:235],v[56:59],a[28:31]
 MM a[32:35],v[232:235],v[60:63],a[32:35]
 TR v[216:217],v14,16960
 buffer_store_dwordx4 v[188:191], v250, s[60:63], s84 offen offset:1024 sc1
 MM a[36:39],v[236:239],v[52:55],a[36:39]
 TR v[218:219],v14,17088
 MM a[40:43],v[236:239],v[56:59],a[40:43]
 CV v192,v192,v193
 MM a[44:47],v[236:239],v[60:63],a[44:47]
 s_waitcnt lgkmcnt(4)
 TR v[220:221],v14,16992
 CV v193,v194,v195
 MM a[0:3],v[208:211],v[64:67],a[0:3]
 TR v[222:223],v14,17120
 MM a[4:7],v[208:211],v[68:71],a[4:7]
 TR v[224:225],v14,17152
 CV v194,v204,v205
 MM a[8:11],v[208:211],v[72:75],a[8:11]
 s_waitcnt lgkmcnt(5)
 TR v[226:227],v14,17280
 MM a[12:15],v[212:215],v[64:67],a[12:15]
 CV v195,v206,v207
 MM a[16:19],v[212:215],v[68:71],a[16:19]
 TR v[228:229],v14,17184
 MM a[20:23],v[212:215],v[72:75],a[20:23]
 s_waitcnt lgkmcnt(3)
 TR v[230:231],v14,17312
 buffer_store_dwordx4 v[192:195], v250, s[60:63], s84 offen offset:2048 sc1
 MM a[24:27],v[216:219],v[64:67],a[24:27]
 TR v[232:233],v14,17216
 MM a[28:31],v[216:219],v[68:71],a[28:31]
 TR v[234:235],v14,17344
 MM a[32:35],v[216:219],v[72:75],a[32:35]
 MM a[36:39],v[220:223],v[64:67],a[36:39]
 TR v[236:237],v14,17248
 MM a[40:43],v[220:223],v[68:71],a[40:43]
 TR v[238:239],v14,17376
 MM a[44:47],v[220:223],v[72:75],a[44:47]
 s_waitcnt lgkmcnt(4)
 TR v[208:209],v14,17408
 MM a[0:3],v[224:227],v[76:79],a[0:3]
 TR v[210:211],v14,17536
 MM a[4:7],v[224:227],v[80:83],a[4:7]
 s_add_u32 s83, s83, 6144
 s_cmp_ge_u32 s83, 43008
 s_cselect_b32 s88, 43008, 0
 s_sub_u32 s83, s83, s88
 s_add_u32 s84, s83, 3072
 MM a[8:11],v[224:227],v[84:87],a[8:11]
 TR v[212:213],v14,17440
 MM a[12:15],v[228:231],v[76:79],a[12:15]
 TR v[214:215],v14,17568
 MM a[16:19],v[228:231],v[80:83],a[16:19]
 TR v[216:217],v14,17472
 MM a[20:23],v[228:231],v[84:87],a[20:23]
 s_waitcnt lgkmcnt(5)
 MM a[24:27],v[232:235],v[76:79],a[24:27]
 TR v[218:219],v14,17600
 MM a[28:31],v[232:235],v[80:83],a[28:31]
 TR v[220:221],v14,17504
 MM a[32:35],v[232:235],v[84:87],a[32:35]
 TR v[222:223],v14,17632
 MM a[36:39],v[236:239],v[76:79],a[36:39]
 TR v[224:225],v14,17664
 MM a[40:43],v[236:239],v[80:83],a[40:43]
 MM a[44:47],v[236:239],v[84:87],a[44:47]
 s_waitcnt lgkmcnt(5)
 TR v[226:227],v14,17792
 MM a[0:3],v[208:211],v[88:91],a[0:3]
 TR v[228:229],v14,17696
 MM a[4:7],v[208:211],v[92:95],a[4:7]
 TR v[230:231],v14,17824
 MM a[8:11],v[208:211],v[96:99],a[8:11]
 TR v[232:233],v14,17728
 MM a[12:15],v[212:215],v[88:91],a[12:15]
 MM a[16:19],v[212:215],v[92:95],a[16:19]
 TR v[234:235],v14,17856
 MM a[20:23],v[212:215],v[96:99],a[20:23]
 s_waitcnt lgkmcnt(6)
 TR v[236:237],v14,17760
 MM a[24:27],v[216:219],v[88:91],a[24:27]
 TR v[238:239],v14,17888
 MM a[28:31],v[216:219],v[92:95],a[28:31]
 MM a[32:35],v[216:219],v[96:99],a[32:35]
 MM a[36:39],v[220:223],v[88:91],a[36:39]
 MM a[40:43],v[220:223],v[92:95],a[40:43]
 MM a[44:47],v[220:223],v[96:99],a[44:47]
 s_waitcnt lgkmcnt(6)
 MM a[0:3],v[224:227],v[100:103],a[0:3]
 MM a[4:7],v[224:227],v[104:107],a[4:7]
 MM a[8:11],v[224:227],v[108:111],a[8:11]
 MM a[12:15],v[228:231],v[100:103],a[12:15]
 MM a[16:19],v[228:231],v[104:107],a[16:19]
 MM a[20:23],v[228:231],v[108:111],a[20:23]
 MM a[24:27],v[232:235],v[100:103],a[24:27]
 MM a[28:31],v[232:235],v[104:107],a[28:31]
 MM a[32:35],v[232:235],v[108:111],a[32:35]
 MM a[36:39],v[236:239],v[100:103],a[36:39]
 MM a[40:43],v[236:239],v[104:107],a[40:43]
 MM a[44:47],v[236:239],v[108:111],a[44:47]
 AR v160,a0
 AR v161,a1
 AR v162,a2
 AR v163,a3
 AR v164,a12
 AR v165,a13
 AR v166,a14
 AR v167,a15
 CV v160,v160,v161
 CV v161,v162,v163
 CV v162,v164,v165
 CV v163,v166,v167
 buffer_store_dwordx4 v[160:163], v250, s[60:63], s83 offen offset:0 sc1
 AR v168,a4
 AR v169,a5
 AR v170,a6
 AR v171,a7
 AR v172,a16
 AR v173,a17
 AR v174,a18
 AR v175,a19
 CV v168,v168,v169
 CV v169,v170,v171
 CV v170,v172,v173
 CV v171,v174,v175
 buffer_store_dwordx4 v[168:171], v250, s[60:63], s83 offen offset:1024 sc1
 AR v176,a8
 AR v177,a9
 AR v178,a10
 AR v179,a11
 AR v180,a20
 AR v181,a21
 AR v182,a22
 AR v183,a23
 CV v176,v176,v177
 CV v177,v178,v179
 CV v178,v180,v181
 CV v179,v182,v183
 buffer_store_dwordx4 v[176:179], v250, s[60:63], s83 offen offset:2048 sc1
 AR v184,a24
 AR v185,a25
 AR v186,a26
 AR v187,a27
 AR v188,a36
 AR v189,a37
 AR v190,a38
 AR v191,a39
 CV v184,v184,v185
 CV v185,v186,v187
 CV v186,v188,v189
 CV v187,v190,v191
 buffer_store_dwordx4 v[184:187], v250, s[60:63], s84 offen offset:0 sc1
 AR v192,a28
 AR v193,a29
 AR v194,a30
 AR v195,a31
 AR v196,a40
 AR v197,a41
 AR v198,a42
 AR v199,a43
 CV v192,v192,v193
 CV v193,v194,v195
 CV v194,v196,v197
 CV v195,v198,v199
 buffer_store_dwordx4 v[192:195], v250, s[60:63], s84 offen offset:1024 sc1
 AR v200,a32
 AR v201,a33
 AR v202,a34
 AR v203,a35
 AR v204,a44
 AR v205,a45
 AR v206,a46
 AR v207,a47
 CV v200,v200,v201
 CV v201,v202,v203
 CV v202,v204,v205
 CV v203,v206,v207
 buffer_store_dwordx4 v[200:203], v250, s[60:63], s84 offen offset:2048 sc1
 s_add_u32 s83, s83, 6144
 s_cmp_ge_u32 s83, 43008
 s_cselect_b32 s88, 43008, 0
 s_sub_u32 s83, s83, s88
 s_add_u32 s84, s83, 3072
L_tailB:
 v_and_b32 v1, 63, v0
 v_and_b32 v5, 7, v1
 s_lshr_b32 s47, s6, 2
 s_lshl_b32 s88, s5, 10
 s_add_u32 s88, s88, 50348032
 s_lshl_b32 s87, s47, 7
 s_add_u32 s87, s87, s88
 v_lshl_add_u32 v2, v5, 2, s87
 global_load_dword v3, v2, s[30:31] sc1
 s_lshl_b32 s87, s47, 2
 s_add_u32 s87, s87, s88
 v_lshl_add_u32 v10, v5, 7, s87
 AR v11,a253
 AR v12,a254
 v_add_u32 v11, 1, v11
 s_lshl_b32 s40, 1, s47
 v_mov_b32 v13, s4
 v_mov_b32 v14, s40
 v_and_b32 v4, 15, v1
 v_lshrrev_b32 v5, 4, v1
 v_and_b32 v6, 1, v4
 v_lshlrev_b32 v6, 4, v6
 v_mov_b32 v7, 0x3f80
 v_lshlrev_b32 v6, v6, v7
 v_bfe_u32 v7, v4, 2, 1
 v_lshlrev_b32 v7, 1, v7
 v_lshrrev_b32 v8, 3, v4
 v_bfe_u32 v9, v4, 1, 1
 v_lshl_add_u32 v8, v8, 1, v9
 v_sub_u32 v9, v5, v7
 v_lshl_add_u32 v9, v9, 2, v8
 v_cmp_eq_u32 vcc, 0, v9
 s_nop 1
 v_cndmask_b32 v208, 0, v6, vcc
 v_cmp_eq_u32 vcc, 1, v9
 s_nop 1
 v_cndmask_b32 v209, 0, v6, vcc
 v_cmp_eq_u32 vcc, 2, v9
 s_nop 1
 v_cndmask_b32 v210, 0, v6, vcc
 v_cmp_eq_u32 vcc, 3, v9
 s_nop 1
 v_cndmask_b32 v211, 0, v6, vcc
 v_cmp_eq_u32 vcc, 4, v9
 s_nop 1
 v_cndmask_b32 v212, 0, v6, vcc
 v_cmp_eq_u32 vcc, 5, v9
 s_nop 1
 v_cndmask_b32 v213, 0, v6, vcc
 v_cmp_eq_u32 vcc, 6, v9
 s_nop 1
 v_cndmask_b32 v214, 0, v6, vcc
 v_cmp_eq_u32 vcc, 7, v9
 s_nop 1
 v_cndmask_b32 v215, 0, v6, vcc
 v_mul_u32_u24 v4, 1792, v4
 v_lshl_add_u32 v4, v5, 4, v4
 v_mov_b32 v216, 0
 v_mov_b32 v217, 0
 v_mov_b32 v218, 0
 v_mov_b32 v219, 0
 v_mov_b32 v220, 0
 v_mov_b32 v221, 0
 v_mov_b32 v222, 0
 v_mov_b32 v223, 0
 v_mov_b32 v224, 0
 v_mov_b32 v225, 0
 v_mov_b32 v226, 0
 v_mov_b32 v227, 0
 v_mov_b32 v228, 0
 v_mov_b32 v229, 0
 v_mov_b32 v230, 0
 v_mov_b32 v231, 0
 v_mov_b32 v232, 0
 v_mov_b32 v233, 0
 v_mov_b32 v234, 0
 v_mov_b32 v235, 0
 v_mov_b32 v236, 0
 v_mov_b32 v237, 0
 v_mov_b32 v238, 0
 v_mov_b32 v239, 0
 s_mov_b32 s36, s24
 s_mov_b32 s37, s25
 s_mov_b32 s38, 2752512
 s_mov_b32 s39, 0x20000
 s_mul_i32 s84, s5, 688128
 s_add_u32 s84, s84, 11010048
 s_add_u32 s32, s30, s84
 s_addc_u32 s33, s31, 0
 s_mov_b32 s35, 0x20000
 s_mov_b32 s34, 688128
 s_mul_i32 s84, s5, 172032
 s_add_u32 s85, s6, 0
 s_cmp_ge_u32 s85, 42
 s_cselect_b32 s86, 42, 0
 s_cselect_b32 s87, 86016, 0
 s_sub_u32 s85, s85, s86
 s_mul_i32 s86, s85, 43
 s_lshr_b32 s86, s86, 7
 s_mul_i32 s88, s86, 3
 s_sub_u32 s85, s85, s88
 s_mul_i32 s85, s85, 28672
 s_lshl_b32 s86, s86, 6
 s_add_u32 s85, s85, s86
 s_add_u32 s85, s85, s87
 s_add_u32 s44, s85, s84
 s_add_u32 s85, s6, 32
 s_cmp_ge_u32 s85, 42
 s_cselect_b32 s86, 42, 0
 s_cselect_b32 s87, 86016, 0
 s_sub_u32 s85, s85, s86
 s_mul_i32 s86, s85, 43
 s_lshr_b32 s86, s86, 7
 s_mul_i32 s88, s86, 3
 s_sub_u32 s85, s85, s88
 s_mul_i32 s85, s85, 28672
 s_lshl_b32 s86, s86, 6
 s_add_u32 s85, s85, s86
 s_add_u32 s85, s85, s87
 s_add_u32 s45, s85, s84
 s_add_u32 s85, s6, 64
 s_cmp_ge_u32 s85, 42
 s_cselect_b32 s86, 42, 0
 s_cselect_b32 s87, 86016, 0
 s_sub_u32 s85, s85, s86
 s_mul_i32 s86, s85, 43
 s_lshr_b32 s86, s86, 7
 s_mul_i32 s88, s86, 3
 s_sub_u32 s85, s85, s88
 s_mul_i32 s85, s85, 28672
 s_lshl_b32 s86, s86, 6
 s_add_u32 s85, s85, s86
 s_add_u32 s85, s85, s87
 s_add_u32 s46, s85, s84
 s_lshl_b32 s42, s6, 10
 v_add_u32 v15, 32768, v250
 v_add_u32 v9, 65536, v250
 s_waitcnt vmcnt(0)
 s_barrier
 s_cmp_lg_u32 s28, 0
 s_cbranch_scc1 LB_sig
 s_mov_b64 exec, 0xff
 global_store_dword v10, v11, s[30:31] sc1
 s_mov_b64 exec, 1
 global_atomic_or v13, v14, s[26:27]
 s_mov_b64 exec, -1
LB_sig:
 s_mov_b32 s43, 0
 s_mov_b32 s23, 0
 s_mov_b32 s48, s40
LB_round:
 v_cmp_ne_u32 vcc, v3, v12
 s_nop 1
 s_and_b32 s85, vcc_lo, 0xff
 s_or_b32 s48, s48, s85
 s_andn2_b32 s41, s48, s43
 s_cmp_eq_u32 s41, 0
 s_cbranch_scc1 LB_next
 s_bitcmp1_b32 s41, 0
 s_cbranch_scc0 LB_l0
 s_add_u32 s84, s42, 0
 buffer_load_dwordx4 v[16:19], v250, s[32:35], s84 offen sc1
 buffer_load_dwordx4 v[20:23], v15, s[32:35], s84 offen sc1
 s_cmp_ge_u32 s6, 20
 s_cbranch_scc1 LB_l0
 buffer_load_dwordx4 v[24:27], v9, s[32:35], s84 offen sc1
LB_l0:
 s_bitcmp1_b32 s41, 1
 s_cbranch_scc0 LB_l1
 s_add_u32 s84, s42, 86016
 buffer_load_dwordx4 v[28:31], v250, s[32:35], s84 offen sc1
 buffer_load_dwordx4 v[32:35], v15, s[32:35], s84 offen sc1
 s_cmp_ge_u32 s6, 20
 s_cbranch_scc1 LB_l1
 buffer_load_dwordx4 v[36:39], v9, s[32:35], s84 offen sc1
LB_l1:
 s_bitcmp1_b32 s41, 2
 s_cbranch_scc0 LB_l2
 s_add_u32 s84, s42, 172032
 buffer_load_dwordx4 v[40:43], v250, s[32:35], s84 offen sc1
 buffer_load_dwordx4 v[44:47], v15, s[32:35], s84 offen sc1
 s_cmp_ge_u32 s6, 20
 s_cbranch_scc1 LB_l2
 buffer_load_dwordx4 v[48:51], v9, s[32:35], s84 offen sc1
LB_l2:
 s_bitcmp1_b32 s41, 3
 s_cbranch_scc0 LB_l3
 s_add_u32 s84, s42, 258048
 buffer_load_dwordx4 v[52:55], v250, s[32:35], s84 offen sc1
 buffer_load_dwordx4 v[56:59], v15, s[32:35], s84 offen sc1
 s_cmp_ge_u32 s6, 20
 s_cbranch_scc1 LB_l3
 buffer_load_dwordx4 v[60:63], v9, s[32:35], s84 offen sc1
LB_l3:
 s_bitcmp1_b32 s41, 4
 s_cbranch_scc0 LB_l4
 s_add_u32 s84, s42, 344064
 buffer_load_dwordx4 v[64:67], v250, s[32:35], s84 offen sc1
 buffer_load_dwordx4 v[68:71], v15, s[32:35], s84 offen sc1
 s_cmp_ge_u32 s6, 20
 s_cbranch_scc1 LB_l4
 buffer_load_dwordx4 v[72:75], v9, s[32:35], s84 offen sc1
LB_l4:
 s_bitcmp1_b32 s41, 5
 s_cbranch_scc0 LB_l5
 s_add_u32 s84, s42, 430080
 buffer_load_dwordx4 v[76:79], v250, s[32:35], s84 offen sc1
 buffer_load_dwordx4 v[80:83], v15, s[32:35], s84 offen sc1
 s_cmp_ge_u32 s6, 20
 s_cbranch_scc1 LB_l5
 buffer_load_dwordx4 v[84:87], v9, s[32:35], s84 offen sc1
LB_l5:
 s_bitcmp1_b32 s41, 6
 s_cbranch_scc0 LB_l6
 s_add_u32 s84, s42, 516096
 buffer_load_dwordx4 v[88:91], v250, s[32:35], s84 offen sc1
 buffer_load_dwordx4 v[92:95], v15, s[32:35], s84 offen sc1
 s_cmp_ge_u32 s6, 20
 s_cbranch_scc1 LB_l6
 buffer_load_dwordx4 v[96:99], v9, s[32:35], s84 offen sc1
LB_l6:
 s_bitcmp1_b32 s41, 7
 s_cbranch_scc0 LB_l7
 s_add_u32 s84, s42, 602112
 buffer_load_dwordx4 v[100:103], v250, s[32:35], s84 offen sc1
 buffer_load_dwordx4 v[104:107], v15, s[32:35], s84 offen sc1
 s_cmp_ge_u32 s6, 20
 s_cbranch_scc1 LB_l7
 buffer_load_dwordx4 v[108:111], v9, s[32:35], s84 offen sc1
LB_l7:
 s_or_b32 s43, s43, s41
 s_cmp_eq_u32 s43, 0xff
 s_cbranch_scc1 LB_nopoll
 global_load_dword v3, v2, s[30:31] sc1
LB_nopoll:
 s_waitcnt vmcnt(0)
 s_bitcmp1_b32 s41, 0
 s_cbranch_scc0 LB_m0
 MM v[216:219],v[208:211],v[16:19],v[216:219]
 MM v[220:223],v[212:215],v[16:19],v[220:223]
 MM v[224:227],v[208:211],v[20:23],v[224:227]
 MM v[228:231],v[212:215],v[20:23],v[228:231]
 MM v[232:235],v[208:211],v[24:27],v[232:235]
 MM v[236:239],v[212:215],v[24:27],v[236:239]
LB_m0:
 s_bitcmp1_b32 s41, 1
 s_cbranch_scc0 LB_m1
 MM v[216:219],v[208:211],v[28:31],v[216:219]
 MM v[220:223],v[212:215],v[28:31],v[220:223]
 MM v[224:227],v[208:211],v[32:35],v[224:227]
 MM v[228:231],v[212:215],v[32:35],v[228:231]
 MM v[232:235],v[208:211],v[36:39],v[232:235]
 MM v[236:239],v[212:215],v[36:39],v[236:239]
LB_m1:
 s_bitcmp1_b32 s41, 2
 s_cbranch_scc0 LB_m2
 MM v[216:219],v[208:211],v[40:43],v[216:219]
 MM v[220:223],v[212:215],v[40:43],v[220:223]
 MM v[224:227],v[208:211],v[44:47],v[224:227]
 MM v[228:231],v[212:215],v[44:47],v[228:231]
 MM v[232:235],v[208:211],v[48:51],v[232:235]
 MM v[236:239],v[212:215],v[48:51],v[236:239]
LB_m2:
 s_bitcmp1_b32 s41, 3
 s_cbranch_scc0 LB_m3
 MM v[216:219],v[208:211],v[52:55],v[216:219]
 MM v[220:223],v[212:215],v[52:55],v[220:223]
 MM v[224:227],v[208:211],v[56:59],v[224:227]
 MM v[228:231],v[212:215],v[56:59],v[228:231]
 MM v[232:235],v[208:211],v[60:63],v[232:235]
 MM v[236:239],v[212:215],v[60:63],v[236:239]
LB_m3:
 s_bitcmp1_b32 s41, 4
 s_cbranch_scc0 LB_m4
 MM v[216:219],v[208:211],v[64:67],v[216:219]
 MM v[220:223],v[212:215],v[64:67],v[220:223]
 MM v[224:227],v[208:211],v[68:71],v[224:227]
 MM v[228:231],v[212:215],v[68:71],v[228:231]
 MM v[232:235],v[208:211],v[72:75],v[232:235]
 MM v[236:239],v[212:215],v[72:75],v[236:239]
LB_m4:
 s_bitcmp1_b32 s41, 5
 s_cbranch_scc0 LB_m5
 MM v[216:219],v[208:211],v[76:79],v[216:219]
 MM v[220:223],v[212:215],v[76:79],v[220:223]
 MM v[224:227],v[208:211],v[80:83],v[224:227]
 MM v[228:231],v[212:215],v[80:83],v[228:231]
 MM v[232:235],v[208:211],v[84:87],v[232:235]
 MM v[236:239],v[212:215],v[84:87],v[236:239]
LB_m5:
 s_bitcmp1_b32 s41, 6
 s_cbranch_scc0 LB_m6
 MM v[216:219],v[208:211],v[88:91],v[216:219]
 MM v[220:223],v[212:215],v[88:91],v[220:223]
 MM v[224:227],v[208:211],v[92:95],v[224:227]
 MM v[228:231],v[212:215],v[92:95],v[228:231]
 MM v[232:235],v[208:211],v[96:99],v[232:235]
 MM v[236:239],v[212:215],v[96:99],v[236:239]
LB_m6:
 s_bitcmp1_b32 s41, 7
 s_cbranch_scc0 LB_m7
 MM v[216:219],v[208:211],v[100:103],v[216:219]
 MM v[220:223],v[212:215],v[100:103],v[220:223]
 MM v[224:227],v[208:211],v[104:107],v[224:227]
 MM v[228:231],v[212:215],v[104:107],v[228:231]
 MM v[232:235],v[208:211],v[108:111],v[232:235]
 MM v[236:239],v[212:215],v[108:111],v[236:239]
LB_m7:
 s_cmp_eq_u32 s43, 0xff
 s_cbranch_scc1 LB_fin
 s_branch LB_round
LB_next:
 s_add_u32 s23, s23, 1
 s_cmp_ge_u32 s23, 100000
 s_cbranch_scc1 LB_fin
 s_sleep 2
 s_and_b32 s85, s23, 63
 s_cmp_lg_u32 s85, 0
 s_cbranch_scc1 LB_again
 global_load_dword v7, v13, s[26:27] sc1
 s_waitcnt vmcnt(0)
 v_readfirstlane_b32 s85, v7
 s_nop 1
 s_and_b32 s85, s85, 0xff
 s_or_b32 s48, s48, s85
LB_again:
 global_load_dword v3, v2, s[30:31] sc1
 s_waitcnt vmcnt(0)
 s_branch LB_round
LB_fin:
 s_nop 7
 CV v112,v216,v217
 CV v113,v218,v219
 CV v114,v220,v221
 CV v115,v222,v223
 buffer_store_dwordx4 v[112:115], v4, s[36:39], s44 offen offset:896
 CV v116,v224,v225
 CV v117,v226,v227
 CV v118,v228,v229
 CV v119,v230,v231
 buffer_store_dwordx4 v[116:119], v4, s[36:39], s45 offen offset:896
 s_cmp_ge_u32 s6, 20
 s_cbranch_scc1 LB_done
 CV v120,v232,v233
 CV v121,v234,v235
 CV v122,v236,v237
 CV v123,v238,v239
 buffer_store_dwordx4 v[120:123], v4, s[36:39], s46 offen offset:896
LB_done:
 s_endpgm
LB0_t0:
 s_call_b64 s[86:87], L_rare1
 s_branch LB0_r0
LB0_t1:
 s_call_b64 s[86:87], L_rare0
 s_branch LB0_r1
LB0_t28:
 s_call_b64 s[86:87], L_rare1
 s_branch LB0_r28
LB0_t29:
 s_call_b64 s[86:87], L_rare0
 s_branch LB0_r29
LB0_t30:
 s_call_b64 s[86:87], L_rare1
 s_branch LB0_r30
.p2align 6
L_typeB1:
 s_mul_i32 s88, s86, 86016
 s_add_u32 s56, s14, s88
 s_addc_u32 s57, s15, 0
 s_mov_b32 s58, 86016
 s_mov_b32 s59, 0x20000
 s_lshl_b32 s88, s85, 10
 s_add_u32 s48, s20, s88
 s_addc_u32 s49, s21, 0
 s_sub_u32 s48, s48, 512
 s_subb_u32 s49, s49, 0
 s_sub_u32 s50, 3670528, s88
 s_mov_b32 s51, 0x20000
 s_lshl_b32 s88, s85, 10
 s_add_u32 s88, s88, 512
 s_add_u32 s52, s20, s88
 s_addc_u32 s53, s21, 0
 s_sub_u32 s52, s52, 512
 s_subb_u32 s53, s53, 0
 s_sub_u32 s54, 3670528, s88
 s_mov_b32 s55, 0x20000
 s_mul_i32 s88, s86, 7
 s_lshr_b32 s88, s88, 4
 s_lshl_b32 s76, s88, 19
 s_mov_b32 s77, s76
 s_lshr_b32 s78, s76, 12
 s_add_u32 s76, s76, 262144
 s_mul_i32 s79, s28, 3072
 s_add_u32 s79, s79, 101376
 s_add_u32 m0, s79, 0
 s_nop 0
 buffer_load_dwordx4 v247, s[56:59], s78 offen offset:0 lds
 buffer_load_dwordx4 v248, s[56:59], s78 offen offset:1024 lds
 buffer_load_dwordx4 v249, s[56:59], s78 offen offset:2048 lds
 s_add_u32 s78, s78, 128
 s_cmp_eq_u32 s78, 896
 s_cselect_b32 s78, 0, s78
 s_mov_b32 m0, s94
 s_nop 0
 buffer_load_dwordx4 v8, s[48:51], s76 offen offset:0 lds
 buffer_load_dwordx4 v9, s[48:51], s76 offen offset:1056 lds
 buffer_load_dwordx4 v10, s[48:51], s76 offen offset:2112 lds
 buffer_load_dwordx4 v11, s[48:51], s76 offen offset:3168 lds
 s_add_u32 m0, s94, 4224
 s_add_u32 s3, s76, 65536
 buffer_load_dwordx4 v8, s[48:51], s3 offen offset:0 lds
 buffer_load_dwordx4 v9, s[48:51], s3 offen offset:1056 lds
 buffer_load_dwordx4 v10, s[48:51], s3 offen offset:2112 lds
 buffer_load_dwordx4 v11, s[48:51], s3 offen offset:3168 lds
 s_add_u32 s76, s76, 524288
 s_cmp_ge_u32 s76, 3670016
 s_cselect_b32 s7, 3670016, 0
 s_sub_u32 s76, s76, s7
 s_add_u32 m0, s79, 12288
 s_nop 0
 buffer_load_dwordx4 v247, s[56:59], s78 offen offset:0 lds
 buffer_load_dwordx4 v248, s[56:59], s78 offen offset:1024 lds
 buffer_load_dwordx4 v249, s[56:59], s78 offen offset:2048 lds
 s_add_u32 s78, s78, 128
 s_cmp_eq_u32 s78, 896
 s_cselect_b32 s78, 0, s78
 s_mov_b32 m0, s90
 s_nop 0
 buffer_load_dwordx4 v8, s[48:51], s76 offen offset:0 lds
 buffer_load_dwordx4 v9, s[48:51], s76 offen offset:1056 lds
 buffer_load_dwordx4 v10, s[48:51], s76 offen offset:2112 lds
 buffer_load_dwordx4 v11, s[48:51], s76 offen offset:3168 lds
 s_add_u32 m0, s90, 4224
 s_add_u32 s3, s76, 65536
 buffer_load_dwordx4 v8, s[48:51], s3 offen offset:0 lds
 buffer_load_dwordx4 v9, s[48:51], s3 offen offset:1056 lds
 buffer_load_dwordx4 v10, s[48:51], s3 offen offset:2112 lds
 buffer_load_dwordx4 v11, s[48:51], s3 offen offset:3168 lds
 s_add_u32 s76, s76, 524288
 s_cmp_ge_u32 s76, 3670016
 s_cselect_b32 s7, 3670016, 0
 s_sub_u32 s76, s76, s7
 s_lshl_b32 s88, s86, 3
 s_add_u32 s88, s88, s85
 s_lshl_b32 s88, s88, 20
 s_add_u32 s32, s16, s88
 s_addc_u32 s33, s17, 0
 s_sub_u32 s32, s32, 512
 s_subb_u32 s33, s33, 0
 s_mov_b32 s34, 524800
 s_mov_b32 s35, 0x20000
 s_add_u32 s40, s18, s88
 s_addc_u32 s41, s19, 0
 s_sub_u32 s40, s40, 512
 s_subb_u32 s41, s41, 0
 s_mov_b32 s42, 524800
 s_mov_b32 s43, 0x20000
 s_lshl_b32 s88, s86, 3
 s_add_u32 s88, s88, s85
 s_lshl_b32 s88, s88, 20
 s_add_u32 s88, s88, 524288
 s_add_u32 s36, s16, s88
 s_addc_u32 s37, s17, 0
 s_sub_u32 s36, s36, 512
 s_subb_u32 s37, s37, 0
 s_mov_b32 s38, 524800
 s_mov_b32 s39, 0x20000
 s_add_u32 s44, s18, s88
 s_addc_u32 s45, s19, 0
 s_sub_u32 s44, s44, 512
 s_subb_u32 s45, s45, 0
 s_mov_b32 s46, 524800
 s_mov_b32 s47, 0x20000
 s_mov_b32 s72, 0
 s_mov_b32 s73, 0
 s_mov_b32 s74, 0
 s_mov_b32 s75, 0
 s_mul_i32 s88, s85, 458752
 s_add_u32 s64, s22, s88
 s_addc_u32 s65, s23, 0
 s_sub_u32 s64, s64, 512
 s_subb_u32 s65, s65, 0
 s_mov_b32 s66, 459264
 s_mov_b32 s67, 0x20000
 s_mul_i32 s88, s85, 458752
 s_add_u32 s88, s88, 229376
 s_add_u32 s68, s22, s88
 s_addc_u32 s69, s23, 0
 s_sub_u32 s68, s68, 512
 s_subb_u32 s69, s69, 0
 s_mov_b32 s70, 229888
 s_mov_b32 s71, 0x20000
 s_lshl_b32 s88, s86, 3
 s_add_u32 s88, s88, s85
 s_add_u32 s88, s88, 128
 s_mul_i32 s88, s88, 86016
 s_mul_i32 s23, s87, 43008
 s_add_u32 s88, s88, s23
 s_add_u32 s60, s30, s88
 s_addc_u32 s61, s31, 0
 s_mov_b32 s62, 43008
 s_mov_b32 s63, 0x20000
 s_mov_b32 s5, s86
 s_lshl_b32 s6, s85, 2
 s_add_u32 s6, s6, s28
 s_lshl_b32 s4, s86, 3
 s_add_u32 s4, s4, 128
 s_mul_i32 s23, s86, 7
 s_lshr_b32 s23, s23, 4
 s_lshl_b32 s80, s23, 7
 s_add_u32 s81, s80, 114688
 s_mul_i32 s83, s23, 6144
 s_add_u32 s83, s83, 18432
 s_cmp_ge_u32 s83, 43008
 s_cselect_b32 s88, 43008, 0
 s_sub_u32 s83, s83, s88
 s_add_u32 s84, s83, 3072
 s_mul_i32 s88, s87, 12288
 s_add_u32 s88, s88, 135168
 v_add_u32 v251, s88, v250
 v_and_b32 v16, 7, v0
 s_lshl_b32 s88, s86, 10
 s_add_u32 s88, s88, 50348032
 s_lshl_b32 s23, s85, 7
 s_add_u32 s23, s23, s88
 v_lshl_add_u32 v17, v16, 2, s23
 global_load_dword a254, v17, s[30:31] sc1
 s_lshl_b32 s23, s85, 2
 s_add_u32 s23, s23, s88
 v_lshl_add_u32 v17, v16, 7, s23
 global_load_dword a253, v17, s[30:31] sc1
 v_add_u32 v253, 101376, v253
 v_add_u32 v254, 101376, v254
 s_waitcnt vmcnt(13)
 s_barrier
 ds_read_b128 a[0:3], v253 offset:0
 ds_read_b128 a[4:7], v253 offset:2048
 ds_read_b128 a[8:11], v253 offset:4096
 ds_read_b128 a[12:15], v254 offset:0
 ds_read_b128 a[16:19], v254 offset:2048
 ds_read_b128 a[20:23], v254 offset:4096
 TR v[208:209],v15,256
 TR v[210:211],v15,768
 TR v[212:213],v15,288
 TR v[214:215],v15,800
 TR v[216:217],v15,320
 TR v[218:219],v15,832
 s_waitcnt lgkmcnt(4)
 TR v[220:221],v15,352
 MM v[112:115],v[208:211],a[0:3],0
 TR v[222:223],v15,864
 MM v[116:119],v[208:211],a[4:7],0
 TR v[224:225],v15,384
 MM v[120:123],v[208:211],a[8:11],0
 s_waitcnt lgkmcnt(5)
 s_add_u32 m0, s79, 24576
 TR v[226:227],v15,896
 MM v[124:127],v[212:215],a[0:3],0
 buffer_load_dwordx4 v247, s[56:59], s78 offen offset:0 lds
 MM v[128:131],v[212:215],a[4:7],0
 TR v[228:229],v15,416
 buffer_load_dwordx4 v248, s[56:59], s78 offen offset:1024 lds
 MM v[132:135],v[212:215],a[8:11],0
 s_waitcnt lgkmcnt(3)
 TR v[230:231],v15,928
 MM v[136:139],v[216:219],a[0:3],0
 TR v[232:233],v15,448
 MM v[140:143],v[216:219],a[4:7],0
 TR v[234:235],v15,960
 MM v[144:147],v[216:219],a[8:11],0
 buffer_load_dwordx4 v249, s[56:59], s78 offen offset:2048 lds
 MM v[148:151],v[220:223],a[0:3],0
 s_add_u32 s78, s78, 128
 s_cmp_eq_u32 s78, 896
 s_cselect_b32 s78, 0, s78
 TR v[236:237],v15,480
 MM v[152:155],v[220:223],a[4:7],0
 TR v[238:239],v15,992
 MM v[156:159],v[220:223],a[8:11],0
 s_waitcnt lgkmcnt(4)
 TR v[208:209],v15,17152
 MM v[160:163],v[224:227],a[0:3],0
 s_mov_b32 m0, s92
 TR v[210:211],v15,17664
 MM v[164:167],v[224:227],a[4:7],0
 buffer_load_dwordx4 v8, s[48:51], s76 offen offset:0 lds
 MM v[168:171],v[224:227],a[8:11],0
 TR v[212:213],v15,17184
 buffer_load_dwordx4 v9, s[48:51], s76 offen offset:1056 lds
 MM v[172:175],v[228:231],a[0:3],0
 TR v[214:215],v15,17696
 MM v[176:179],v[228:231],a[4:7],0
 TR v[216:217],v15,17216
 MM v[180:183],v[228:231],a[8:11],0
 s_waitcnt lgkmcnt(5)
 buffer_load_dwordx4 v10, s[48:51], s76 offen offset:2112 lds
 MM v[184:187],v[232:235],a[0:3],0
 TR v[218:219],v15,17728
 MM v[188:191],v[232:235],a[4:7],0
 TR v[220:221],v15,17248
 buffer_load_dwordx4 v11, s[48:51], s76 offen offset:3168 lds
 MM v[192:195],v[232:235],a[8:11],0
 TR v[222:223],v15,17760
 MM v[196:199],v[236:239],a[0:3],0
 s_add_u32 m0, s92, 4224
 s_add_u32 s3, s76, 65536
 TR v[224:225],v15,17280
 MM v[200:203],v[236:239],a[4:7],0
 buffer_load_dwordx4 v8, s[48:51], s3 offen offset:0 lds
 MM v[204:207],v[236:239],a[8:11],0
 s_waitcnt lgkmcnt(5)
 TR v[226:227],v15,17792
 MM v[112:115],v[208:211],a[12:15],v[112:115]
 TR v[228:229],v15,17312
 MM v[116:119],v[208:211],a[16:19],v[116:119]
 TR v[230:231],v15,17824
 MM v[120:123],v[208:211],a[20:23],v[120:123]
 TR v[232:233],v15,17344
 MM v[124:127],v[212:215],a[12:15],v[124:127]
 buffer_load_dwordx4 v9, s[48:51], s3 offen offset:1056 lds
 MM v[128:131],v[212:215],a[16:19],v[128:131]
 TR v[234:235],v15,17856
 MM v[132:135],v[212:215],a[20:23],v[132:135]
 s_waitcnt lgkmcnt(6)
 TR v[236:237],v15,17376
 MM v[136:139],v[216:219],a[12:15],v[136:139]
 TR v[238:239],v15,17888
 MM v[140:143],v[216:219],a[16:19],v[140:143]
 buffer_load_dwordx4 v10, s[48:51], s3 offen offset:2112 lds
 MM v[144:147],v[216:219],a[20:23],v[144:147]
 buffer_load_dwordx4 v11, s[48:51], s3 offen offset:3168 lds
 MM v[148:151],v[220:223],a[12:15],v[148:151]
 s_add_u32 s76, s76, 524288
 s_cmp_ge_u32 s76, 3670016
 s_cselect_b32 s7, 3670016, 0
 s_sub_u32 s76, s76, s7
 MM v[152:155],v[220:223],a[16:19],v[152:155]
 MM v[156:159],v[220:223],a[20:23],v[156:159]
 s_waitcnt lgkmcnt(6)
 MM v[160:163],v[224:227],a[12:15],v[160:163]
 MM v[164:167],v[224:227],a[16:19],v[164:167]
 MM v[168:171],v[224:227],a[20:23],v[168:171]
 s_waitcnt lgkmcnt(0) vmcnt(13)
 s_barrier
 TR v[208:209],v14,256
 MM v[172:175],v[228:231],a[12:15],v[172:175]
 TR v[210:211],v14,768
 ds_read_b128 a[24:27], v253 offset:12288
 ds_read_b128 a[28:31], v253 offset:14336
 MM v[176:179],v[228:231],a[16:19],v[176:179]
 ds_read_b128 a[32:35], v253 offset:16384
 ds_read_b128 a[36:39], v254 offset:12288
 ds_read_b128 a[40:43], v254 offset:14336
 MM v[180:183],v[228:231],a[20:23],v[180:183]
 TR v[212:213],v14,288
 ds_read_b128 a[44:47], v254 offset:16384
 MM v[184:187],v[232:235],a[12:15],v[184:187]
 TR v[214:215],v14,800
 MM v[188:191],v[232:235],a[16:19],v[188:191]
 MM v[192:195],v[232:235],a[20:23],v[192:195]
 TR v[216:217],v14,320
 MM v[196:199],v[236:239],a[12:15],v[196:199]
 TR v[218:219],v14,832
 MM v[200:203],v[236:239],a[16:19],v[200:203]
 MM v[204:207],v[236:239],a[20:23],v[204:207]
 s_waitcnt lgkmcnt(10)
 s_waitcnt lgkmcnt(3)
 TR v[220:221],v14,352
 MM v[112:115],v[208:211],a[24:27],v[112:115]
 TR v[222:223],v14,864
 MM v[116:119],v[208:211],a[28:31],v[116:119]
 TR v[224:225],v14,384
 MM v[120:123],v[208:211],a[32:35],v[120:123]
 s_waitcnt lgkmcnt(5)
 s_add_u32 m0, s79, 36864
 TR v[226:227],v14,896
 MM v[124:127],v[212:215],a[24:27],v[124:127]
 buffer_load_dwordx4 v247, s[56:59], s78 offen offset:0 lds
 MM v[128:131],v[212:215],a[28:31],v[128:131]
 TR v[228:229],v14,416
 buffer_load_dwordx4 v248, s[56:59], s78 offen offset:1024 lds
 MM v[132:135],v[212:215],a[32:35],v[132:135]
 s_waitcnt lgkmcnt(3)
 TR v[230:231],v14,928
 buffer_load_dwordx4 v249, s[56:59], s78 offen offset:2048 lds
 MM v[136:139],v[216:219],a[24:27],v[136:139]
 s_add_u32 s78, s78, 128
 s_cmp_eq_u32 s78, 896
 s_cselect_b32 s78, 0, s78
 TR v[232:233],v14,448
 MM v[140:143],v[216:219],a[28:31],v[140:143]
 s_add_u32 m0, s79, 49152
 TR v[234:235],v14,960
 MM v[144:147],v[216:219],a[32:35],v[144:147]
 buffer_load_dwordx4 v247, s[56:59], s78 offen offset:0 lds
 MM v[148:151],v[220:223],a[24:27],v[148:151]
 TR v[236:237],v14,480
 MM v[152:155],v[220:223],a[28:31],v[152:155]
 TR v[238:239],v14,992
 buffer_load_dwordx4 v248, s[56:59], s78 offen offset:1024 lds
 MM v[156:159],v[220:223],a[32:35],v[156:159]
 s_waitcnt lgkmcnt(4)
 TR v[208:209],v14,17152
 MM v[160:163],v[224:227],a[24:27],v[160:163]
 TR v[210:211],v14,17664
 MM v[164:167],v[224:227],a[28:31],v[164:167]
 buffer_load_dwordx4 v249, s[56:59], s78 offen offset:2048 lds
 MM v[168:171],v[224:227],a[32:35],v[168:171]
 s_add_u32 s78, s78, 128
 s_cmp_eq_u32 s78, 896
 s_cselect_b32 s78, 0, s78
 TR v[212:213],v14,17184
 MM v[172:175],v[228:231],a[24:27],v[172:175]
 TR v[214:215],v14,17696
 MM v[176:179],v[228:231],a[28:31],v[176:179]
 s_mov_b32 m0, s94
 TR v[216:217],v14,17216
 MM v[180:183],v[228:231],a[32:35],v[180:183]
 s_waitcnt lgkmcnt(5)
 buffer_load_dwordx4 v8, s[48:51], s76 offen offset:0 lds
 MM v[184:187],v[232:235],a[24:27],v[184:187]
 TR v[218:219],v14,17728
 buffer_load_dwordx4 v9, s[48:51], s76 offen offset:1056 lds
 MM v[188:191],v[232:235],a[28:31],v[188:191]
 TR v[220:221],v14,17248
 MM v[192:195],v[232:235],a[32:35],v[192:195]
 TR v[222:223],v14,17760
 MM v[196:199],v[236:239],a[24:27],v[196:199]
 TR v[224:225],v14,17280
 MM v[200:203],v[236:239],a[28:31],v[200:203]
 buffer_load_dwordx4 v10, s[48:51], s76 offen offset:2112 lds
 MM v[204:207],v[236:239],a[32:35],v[204:207]
 s_waitcnt lgkmcnt(5)
 TR v[226:227],v14,17792
 buffer_load_dwordx4 v11, s[48:51], s76 offen offset:3168 lds
 MM v[112:115],v[208:211],a[36:39],v[112:115]
 TR v[228:229],v14,17312
 MM v[116:119],v[208:211],a[40:43],v[116:119]
 TR v[230:231],v14,17824
 MM v[120:123],v[208:211],a[44:47],v[120:123]
 s_add_u32 m0, s94, 4224
 s_add_u32 s3, s76, 65536
 TR v[232:233],v14,17344
 MM v[124:127],v[212:215],a[36:39],v[124:127]
 buffer_load_dwordx4 v8, s[48:51], s3 offen offset:0 lds
 MM v[128:131],v[212:215],a[40:43],v[128:131]
 TR v[234:235],v14,17856
 buffer_load_dwordx4 v9, s[48:51], s3 offen offset:1056 lds
 MM v[132:135],v[212:215],a[44:47],v[132:135]
 s_waitcnt lgkmcnt(6)
 TR v[236:237],v14,17376
 MM v[136:139],v[216:219],a[36:39],v[136:139]
 TR v[238:239],v14,17888
 MM v[140:143],v[216:219],a[40:43],v[140:143]
 buffer_load_dwordx4 v10, s[48:51], s3 offen offset:2112 lds
 MM v[144:147],v[216:219],a[44:47],v[144:147]
 MM v[148:151],v[220:223],a[36:39],v[148:151]
 buffer_load_dwordx4 v11, s[48:51], s3 offen offset:3168 lds
 MM v[152:155],v[220:223],a[40:43],v[152:155]
 s_add_u32 s76, s76, 524288
 s_cmp_ge_u32 s76, 3670016
 s_cselect_b32 s7, 3670016, 0
 s_sub_u32 s76, s76, s7
 MM v[156:159],v[220:223],a[44:47],v[156:159]
 s_waitcnt lgkmcnt(6)
 MM v[160:163],v[224:227],a[36:39],v[160:163]
 MM v[164:167],v[224:227],a[40:43],v[164:167]
 MM v[168:171],v[224:227],a[44:47],v[168:171]
 s_waitcnt lgkmcnt(0) vmcnt(14)
 s_barrier
 TR v[208:209],v14,34048
 MM v[172:175],v[228:231],a[36:39],v[172:175]
 TR v[210:211],v14,34560
 ds_read_b128 a[48:51], v253 offset:24576
 ds_read_b128 a[52:55], v253 offset:26624
 MM v[176:179],v[228:231],a[40:43],v[176:179]
 ds_read_b128 a[56:59], v253 offset:28672
 ds_read_b128 a[60:63], v254 offset:24576
 ds_read_b128 a[64:67], v254 offset:26624
 MM v[180:183],v[228:231],a[44:47],v[180:183]
 TR v[212:213],v14,34080
 ds_read_b128 a[68:71], v254 offset:28672
 MM v[184:187],v[232:235],a[36:39],v[184:187]
 TR v[214:215],v14,34592
 MM v[188:191],v[232:235],a[40:43],v[188:191]
 MM v[192:195],v[232:235],a[44:47],v[192:195]
 TR v[216:217],v14,34112
 MM v[196:199],v[236:239],a[36:39],v[196:199]
 TR v[218:219],v14,34624
 MM v[200:203],v[236:239],a[40:43],v[200:203]
 MM v[204:207],v[236:239],a[44:47],v[204:207]
 s_waitcnt lgkmcnt(10)
 s_waitcnt lgkmcnt(3)
 TR v[220:221],v14,34144
 MM v[112:115],v[208:211],a[48:51],v[112:115]
 TR v[222:223],v14,34656
 MM v[116:119],v[208:211],a[52:55],v[116:119]
 TR v[224:225],v14,34176
 MM v[120:123],v[208:211],a[56:59],v[120:123]
 s_waitcnt lgkmcnt(5)
 s_add_u32 m0, s79, 0
 TR v[226:227],v14,34688
 MM v[124:127],v[212:215],a[48:51],v[124:127]
 buffer_load_dwordx4 v247, s[56:59], s78 offen offset:0 lds
 MM v[128:131],v[212:215],a[52:55],v[128:131]
 TR v[228:229],v14,34208
 buffer_load_dwordx4 v248, s[56:59], s78 offen offset:1024 lds
 MM v[132:135],v[212:215],a[56:59],v[132:135]
 s_waitcnt lgkmcnt(3)
 TR v[230:231],v14,34720
 buffer_load_dwordx4 v249, s[56:59], s78 offen offset:2048 lds
 MM v[136:139],v[216:219],a[48:51],v[136:139]
 s_add_u32 s78, s78, 128
 s_cmp_eq_u32 s78, 896
 s_cselect_b32 s78, 0, s78
 TR v[232:233],v14,34240
 MM v[140:143],v[216:219],a[52:55],v[140:143]
 s_add_u32 m0, s79, 12288
 TR v[234:235],v14,34752
 MM v[144:147],v[216:219],a[56:59],v[144:147]
 buffer_load_dwordx4 v247, s[56:59], s78 offen offset:0 lds
 MM v[148:151],v[220:223],a[48:51],v[148:151]
 TR v[236:237],v14,34272
 MM v[152:155],v[220:223],a[52:55],v[152:155]
 TR v[238:239],v14,34784
 buffer_load_dwordx4 v248, s[56:59], s78 offen offset:1024 lds
 MM v[156:159],v[220:223],a[56:59],v[156:159]
 s_waitcnt lgkmcnt(4)
 TR v[208:209],v14,50944
 MM v[160:163],v[224:227],a[48:51],v[160:163]
 TR v[210:211],v14,51456
 MM v[164:167],v[224:227],a[52:55],v[164:167]
 buffer_load_dwordx4 v249, s[56:59], s78 offen offset:2048 lds
 MM v[168:171],v[224:227],a[56:59],v[168:171]
 s_add_u32 s78, s78, 128
 s_cmp_eq_u32 s78, 896
 s_cselect_b32 s78, 0, s78
 TR v[212:213],v14,50976
 MM v[172:175],v[228:231],a[48:51],v[172:175]
 TR v[214:215],v14,51488
 MM v[176:179],v[228:231],a[52:55],v[176:179]
 s_mov_b32 m0, s90
 TR v[216:217],v14,51008
 MM v[180:183],v[228:231],a[56:59],v[180:183]
 s_waitcnt lgkmcnt(5)
 buffer_load_dwordx4 v8, s[48:51], s76 offen offset:0 lds
 MM v[184:187],v[232:235],a[48:51],v[184:187]
 TR v[218:219],v14,51520
 buffer_load_dwordx4 v9, s[48:51], s76 offen offset:1056 lds
 MM v[188:191],v[232:235],a[52:55],v[188:191]
 TR v[220:221],v14,51040
 MM v[192:195],v[232:235],a[56:59],v[192:195]
 TR v[222:223],v14,51552
 MM v[196:199],v[236:239],a[48:51],v[196:199]
 TR v[224:225],v14,51072
 MM v[200:203],v[236:239],a[52:55],v[200:203]
 buffer_load_dwordx4 v10, s[48:51], s76 offen offset:2112 lds
 MM v[204:207],v[236:239],a[56:59],v[204:207]
 s_waitcnt lgkmcnt(5)
 TR v[226:227],v14,51584
 buffer_load_dwordx4 v11, s[48:51], s76 offen offset:3168 lds
 MM v[112:115],v[208:211],a[60:63],v[112:115]
 TR v[228:229],v14,51104
 MM v[116:119],v[208:211],a[64:67],v[116:119]
 TR v[230:231],v14,51616
 MM v[120:123],v[208:211],a[68:71],v[120:123]
 s_add_u32 m0, s90, 4224
 s_add_u32 s3, s76, 65536
 TR v[232:233],v14,51136
 MM v[124:127],v[212:215],a[60:63],v[124:127]
 buffer_load_dwordx4 v8, s[48:51], s3 offen offset:0 lds
 MM v[128:131],v[212:215],a[64:67],v[128:131]
 TR v[234:235],v14,51648
 buffer_load_dwordx4 v9, s[48:51], s3 offen offset:1056 lds
 MM v[132:135],v[212:215],a[68:71],v[132:135]
 s_waitcnt lgkmcnt(6)
 TR v[236:237],v14,51168
 MM v[136:139],v[216:219],a[60:63],v[136:139]
 TR v[238:239],v14,51680
 MM v[140:143],v[216:219],a[64:67],v[140:143]
 buffer_load_dwordx4 v10, s[48:51], s3 offen offset:2112 lds
 MM v[144:147],v[216:219],a[68:71],v[144:147]
 MM v[148:151],v[220:223],a[60:63],v[148:151]
 buffer_load_dwordx4 v11, s[48:51], s3 offen offset:3168 lds
 MM v[152:155],v[220:223],a[64:67],v[152:155]
 s_add_u32 s76, s76, 524288
 s_cmp_ge_u32 s76, 3670016
 s_cselect_b32 s7, 3670016, 0
 s_sub_u32 s76, s76, s7
 MM v[156:159],v[220:223],a[68:71],v[156:159]
 s_waitcnt lgkmcnt(6)
 MM v[160:163],v[224:227],a[60:63],v[160:163]
 MM v[164:167],v[224:227],a[64:67],v[164:167]
 MM v[168:171],v[224:227],a[68:71],v[168:171]
 s_waitcnt lgkmcnt(0) vmcnt(14)
 s_barrier
 TR v[208:209],v15,256
 MM v[172:175],v[228:231],a[60:63],v[172:175]
 TR v[210:211],v15,768
 ds_read_b128 a[72:75], v253 offset:36864
 ds_read_b128 a[76:79], v253 offset:38912
 MM v[176:179],v[228:231],a[64:67],v[176:179]
 ds_read_b128 a[80:83], v253 offset:40960
 ds_read_b128 a[84:87], v254 offset:36864
 ds_read_b128 a[88:91], v254 offset:38912
 MM v[180:183],v[228:231],a[68:71],v[180:183]
 TR v[212:213],v15,288
 ds_read_b128 a[92:95], v254 offset:40960
 MM v[184:187],v[232:235],a[60:63],v[184:187]
 TR v[214:215],v15,800
 MM v[188:191],v[232:235],a[64:67],v[188:191]
 MM v[192:195],v[232:235],a[68:71],v[192:195]
 TR v[216:217],v15,320
 MM v[196:199],v[236:239],a[60:63],v[196:199]
 TR v[218:219],v15,832
 MM v[200:203],v[236:239],a[64:67],v[200:203]
 MM v[204:207],v[236:239],a[68:71],v[204:207]
 s_waitcnt lgkmcnt(10)
 s_waitcnt lgkmcnt(3)
 TR v[220:221],v15,352
 MM v[112:115],v[208:211],a[72:75],v[112:115]
 TR v[222:223],v15,864
 ds_read_b128 a[96:99], v253 offset:49152
 MM v[116:119],v[208:211],a[76:79],v[116:119]
 TR v[224:225],v15,384
 MM v[120:123],v[208:211],a[80:83],v[120:123]
 s_waitcnt lgkmcnt(6)
 s_mov_b32 m0, s92
 TR v[226:227],v15,896
 MM v[124:127],v[212:215],a[72:75],v[124:127]
 buffer_load_dwordx4 v8, s[48:51], s76 offen offset:0 lds
 MM v[128:131],v[212:215],a[76:79],v[128:131]
 TR v[228:229],v15,416
 buffer_load_dwordx4 v9, s[48:51], s76 offen offset:1056 lds
 MM v[132:135],v[212:215],a[80:83],v[132:135]
 s_waitcnt lgkmcnt(4)
 TR v[230:231],v15,928
 MM v[136:139],v[216:219],a[72:75],v[136:139]
 TR v[232:233],v15,448
 ds_read_b128 a[100:103], v253 offset:51200
 MM v[140:143],v[216:219],a[76:79],v[140:143]
 TR v[234:235],v15,960
 MM v[144:147],v[216:219],a[80:83],v[144:147]
 buffer_load_dwordx4 v10, s[48:51], s76 offen offset:2112 lds
 MM v[148:151],v[220:223],a[72:75],v[148:151]
 TR v[236:237],v15,480
 MM v[152:155],v[220:223],a[76:79],v[152:155]
 TR v[238:239],v15,992
 ds_read_b128 a[104:107], v253 offset:53248
 MM v[156:159],v[220:223],a[80:83],v[156:159]
 s_waitcnt lgkmcnt(6)
 TR v[208:209],v15,17152
 MM v[160:163],v[224:227],a[72:75],v[160:163]
 TR v[210:211],v15,17664
 MM v[164:167],v[224:227],a[76:79],v[164:167]
 buffer_load_dwordx4 v11, s[48:51], s76 offen offset:3168 lds
 MM v[168:171],v[224:227],a[80:83],v[168:171]
 TR v[212:213],v15,17184
 ds_read_b128 a[108:111], v254 offset:49152
 MM v[172:175],v[228:231],a[72:75],v[172:175]
 TR v[214:215],v15,17696
 MM v[176:179],v[228:231],a[76:79],v[176:179]
 s_add_u32 m0, s92, 4224
 s_add_u32 s3, s76, 65536
 TR v[216:217],v15,17216
 MM v[180:183],v[228:231],a[80:83],v[180:183]
 s_waitcnt lgkmcnt(7)
 buffer_load_dwordx4 v8, s[48:51], s3 offen offset:0 lds
 MM v[184:187],v[232:235],a[72:75],v[184:187]
 TR v[218:219],v15,17728
 MM v[188:191],v[232:235],a[76:79],v[188:191]
 TR v[220:221],v15,17248
 MM v[192:195],v[232:235],a[80:83],v[192:195]
 TR v[222:223],v15,17760
 ds_read_b128 a[112:115], v254 offset:51200
 MM v[196:199],v[236:239],a[72:75],v[196:199]
 TR v[224:225],v15,17280
 MM v[200:203],v[236:239],a[76:79],v[200:203]
 buffer_load_dwordx4 v9, s[48:51], s3 offen offset:1056 lds
 MM v[204:207],v[236:239],a[80:83],v[204:207]
 s_waitcnt lgkmcnt(6)
 TR v[226:227],v15,17792
 MM v[112:115],v[208:211],a[84:87],v[112:115]
 TR v[228:229],v15,17312
 ds_read_b128 a[116:119], v254 offset:53248
 MM v[116:119],v[208:211],a[88:91],v[116:119]
 TR v[230:231],v15,17824
 MM v[120:123],v[208:211],a[92:95],v[120:123]
 TR v[232:233],v15,17344
 MM v[124:127],v[212:215],a[84:87],v[124:127]
 buffer_load_dwordx4 v10, s[48:51], s3 offen offset:2112 lds
 MM v[128:131],v[212:215],a[88:91],v[128:131]
 TR v[234:235],v15,17856
 MM v[132:135],v[212:215],a[92:95],v[132:135]
 s_waitcnt lgkmcnt(8)
 TR v[236:237],v15,17376
 MM v[136:139],v[216:219],a[84:87],v[136:139]
 TR v[238:239],v15,17888
 MM v[140:143],v[216:219],a[88:91],v[140:143]
 buffer_load_dwordx4 v11, s[48:51], s3 offen offset:3168 lds
 MM v[144:147],v[216:219],a[92:95],v[144:147]
 s_add_u32 s76, s76, 524288
 s_cmp_ge_u32 s76, 3670016
 s_cselect_b32 s7, 3670016, 0
 s_sub_u32 s76, s76, s7
 MM v[148:151],v[220:223],a[84:87],v[148:151]
 MM v[152:155],v[220:223],a[88:91],v[152:155]
 MM v[156:159],v[220:223],a[92:95],v[156:159]
 s_waitcnt lgkmcnt(7)
 MM v[160:163],v[224:227],a[84:87],v[160:163]
 MM v[164:167],v[224:227],a[88:91],v[164:167]
 MM v[168:171],v[224:227],a[92:95],v[168:171]
 s_waitcnt lgkmcnt(0) vmcnt(8)
 s_barrier
 TR v[208:209],v14,256
 MM v[172:175],v[228:231],a[84:87],v[172:175]
 TR v[210:211],v14,768
 MM v[176:179],v[228:231],a[88:91],v[176:179]
 MM v[180:183],v[228:231],a[92:95],v[180:183]
 TR v[212:213],v14,288
 MM v[184:187],v[232:235],a[84:87],v[184:187]
 TR v[214:215],v14,800
 MM v[188:191],v[232:235],a[88:91],v[188:191]
 MM v[192:195],v[232:235],a[92:95],v[192:195]
 TR v[216:217],v14,320
 MM v[196:199],v[236:239],a[84:87],v[196:199]
 TR v[218:219],v14,832
 MM v[200:203],v[236:239],a[88:91],v[200:203]
 MM v[204:207],v[236:239],a[92:95],v[204:207]
 s_waitcnt lgkmcnt(4)
 TR v[220:221],v14,352
 MM v[112:115],v[208:211],a[96:99],v[112:115]
 TR v[222:223],v14,864
 v_mov_b32 v2, 0x3f803f80
 MM v[116:119],v[208:211],a[100:103],v[116:119]
 TR v[224:225],v14,384
 MM v[120:123],v[208:211],a[104:107],v[120:123]
 s_waitcnt lgkmcnt(5)
 s_mov_b32 m0, s94
 TR v[226:227],v14,896
 MM v[124:127],v[212:215],a[96:99],v[124:127]
 buffer_load_dwordx4 v8, s[48:51], s76 offen offset:0 lds
 MM v[128:131],v[212:215],a[100:103],v[128:131]
 TR v[228:229],v14,416
 buffer_load_dwordx4 v9, s[48:51], s76 offen offset:1056 lds
 MM v[132:135],v[212:215],a[104:107],v[132:135]
 s_waitcnt lgkmcnt(3)
 TR v[230:231],v14,928
 MM v[136:139],v[216:219],a[96:99],v[136:139]
 TR v[232:233],v14,448
 MM v[140:143],v[216:219],a[100:103],v[140:143]
 TR v[234:235],v14,960
 MM v[144:147],v[216:219],a[104:107],v[144:147]
 buffer_load_dwordx4 v10, s[48:51], s76 offen offset:2112 lds
 MM v[148:151],v[220:223],a[96:99],v[148:151]
 TR v[236:237],v14,480
 AW a204,v2
 MM v[152:155],v[220:223],a[100:103],v[152:155]
 TR v[238:239],v14,992
 MM v[156:159],v[220:223],a[104:107],v[156:159]
 s_waitcnt lgkmcnt(4)
 TR v[208:209],v14,17152
 MM v[160:163],v[224:227],a[96:99],v[160:163]
 TR v[210:211],v14,17664
 MM v[164:167],v[224:227],a[100:103],v[164:167]
 buffer_load_dwordx4 v11, s[48:51], s76 offen offset:3168 lds
 MM v[168:171],v[224:227],a[104:107],v[168:171]
 TR v[212:213],v14,17184
 MM v[172:175],v[228:231],a[96:99],v[172:175]
 TR v[214:215],v14,17696
 MM v[176:179],v[228:231],a[100:103],v[176:179]
 s_add_u32 m0, s94, 4224
 s_add_u32 s3, s76, 65536
 TR v[216:217],v14,17216
 MM v[180:183],v[228:231],a[104:107],v[180:183]
 s_waitcnt lgkmcnt(5)
 buffer_load_dwordx4 v8, s[48:51], s3 offen offset:0 lds
 MM v[184:187],v[232:235],a[96:99],v[184:187]
 TR v[218:219],v14,17728
 AW a205,v2
 MM v[188:191],v[232:235],a[100:103],v[188:191]
 TR v[220:221],v14,17248
 MM v[192:195],v[232:235],a[104:107],v[192:195]
 TR v[222:223],v14,17760
 MM v[196:199],v[236:239],a[96:99],v[196:199]
 TR v[224:225],v14,17280
 MM v[200:203],v[236:239],a[100:103],v[200:203]
 buffer_load_dwordx4 v9, s[48:51], s3 offen offset:1056 lds
 MM v[204:207],v[236:239],a[104:107],v[204:207]
 s_waitcnt lgkmcnt(5)
 TR v[226:227],v14,17792
 MM v[112:115],v[208:211],a[108:111],v[112:115]
 TR v[228:229],v14,17312
 MM v[116:119],v[208:211],a[112:115],v[116:119]
 TR v[230:231],v14,17824
 AW a206,v2
 MM v[120:123],v[208:211],a[116:119],v[120:123]
 TR v[232:233],v14,17344
 MM v[124:127],v[212:215],a[108:111],v[124:127]
 buffer_load_dwordx4 v10, s[48:51], s3 offen offset:2112 lds
 MM v[128:131],v[212:215],a[112:115],v[128:131]
 TR v[234:235],v14,17856
 MM v[132:135],v[212:215],a[116:119],v[132:135]
 s_waitcnt lgkmcnt(6)
 TR v[236:237],v14,17376
 MM v[136:139],v[216:219],a[108:111],v[136:139]
 TR v[238:239],v14,17888
 MM v[140:143],v[216:219],a[112:115],v[140:143]
 buffer_load_dwordx4 v11, s[48:51], s3 offen offset:3168 lds
 MM v[144:147],v[216:219],a[116:119],v[144:147]
 s_add_u32 s76, s76, 524288
 s_cmp_ge_u32 s76, 3670016
 s_cselect_b32 s7, 3670016, 0
 s_sub_u32 s76, s76, s7
 MM v[148:151],v[220:223],a[108:111],v[148:151]
 AW a207,v2
 MM v[152:155],v[220:223],a[112:115],v[152:155]
 MM v[156:159],v[220:223],a[116:119],v[156:159]
 s_waitcnt lgkmcnt(6)
 MM v[160:163],v[224:227],a[108:111],v[160:163]
 MM v[164:167],v[224:227],a[112:115],v[164:167]
 v_subrev_u32 v247, 33792, v251
 MM v[168:171],v[224:227],a[116:119],v[168:171]
 s_waitcnt lgkmcnt(0) vmcnt(8)
 s_barrier
 TR v[208:209],v14,34048
 MM v[172:175],v[228:231],a[108:111],v[172:175]
 TR v[210:211],v14,34560
 ds_read_b128 a[120:123], v253 offset:0
 ds_read_b128 a[124:127], v253 offset:2048
 MM v[176:179],v[228:231],a[112:115],v[176:179]
 ds_read_b128 a[128:131], v253 offset:4096
 ds_read_b128 a[132:135], v254 offset:0
 ds_read_b128 a[136:139], v254 offset:2048
 MM v[180:183],v[228:231],a[116:119],v[180:183]
 TR v[212:213],v14,34080
 ds_read_b128 a[140:143], v254 offset:4096
 MM v[184:187],v[232:235],a[108:111],v[184:187]
 TR v[214:215],v14,34592
 MM v[188:191],v[232:235],a[112:115],v[188:191]
 MM v[192:195],v[232:235],a[116:119],v[192:195]
 TR v[216:217],v14,34112
 MM v[196:199],v[236:239],a[108:111],v[196:199]
 TR v[218:219],v14,34624
 MM v[200:203],v[236:239],a[112:115],v[200:203]
 MM v[204:207],v[236:239],a[116:119],v[204:207]
 s_waitcnt lgkmcnt(10)
 s_waitcnt lgkmcnt(3)
 TR v[220:221],v14,34144
 MM v[112:115],v[208:211],a[120:123],v[112:115]
 TR v[222:223],v14,34656
 ds_read_b128 a[144:147], v253 offset:12288
 MM v[116:119],v[208:211],a[124:127],v[116:119]
 TR v[224:225],v14,34176
 MM v[120:123],v[208:211],a[128:131],v[120:123]
 s_waitcnt lgkmcnt(6)
 TR v[226:227],v14,34688
 MM v[124:127],v[212:215],a[120:123],v[124:127]
 MM v[128:131],v[212:215],a[124:127],v[128:131]
 TR v[228:229],v14,34208
 ds_read_b128 a[148:151], v253 offset:14336
 MM v[132:135],v[212:215],a[128:131],v[132:135]
 s_waitcnt lgkmcnt(5)
 TR v[230:231],v14,34720
 MM v[136:139],v[216:219],a[120:123],v[136:139]
 TR v[232:233],v14,34240
 MM v[140:143],v[216:219],a[124:127],v[140:143]
 TR v[234:235],v14,34752
 MM v[144:147],v[216:219],a[128:131],v[144:147]
 MM v[148:151],v[220:223],a[120:123],v[148:151]
 TR v[236:237],v14,34272
 ds_read_b128 a[152:155], v253 offset:16384
 MM v[152:155],v[220:223],a[124:127],v[152:155]
 TR v[238:239],v14,34784
 MM v[156:159],v[220:223],a[128:131],v[156:159]
 s_waitcnt lgkmcnt(5)
 TR v[208:209],v14,50944
 MM v[160:163],v[224:227],a[120:123],v[160:163]
 TR v[210:211],v14,51456
 MM v[164:167],v[224:227],a[124:127],v[164:167]
 MM v[168:171],v[224:227],a[128:131],v[168:171]
 TR v[212:213],v14,50976
 ds_read_b128 a[156:159], v254 offset:12288
 MM v[172:175],v[228:231],a[120:123],v[172:175]
 TR v[214:215],v14,51488
 MM v[176:179],v[228:231],a[124:127],v[176:179]
 TR v[216:217],v14,51008
 MM v[180:183],v[228:231],a[128:131],v[180:183]
 s_waitcnt lgkmcnt(6)
 MM v[184:187],v[232:235],a[120:123],v[184:187]
 TR v[218:219],v14,51520
 MM v[188:191],v[232:235],a[124:127],v[188:191]
 TR v[220:221],v14,51040
 ds_read_b128 a[160:163], v254 offset:14336
 MM v[192:195],v[232:235],a[128:131],v[192:195]
 TR v[222:223],v14,51552
 MM v[196:199],v[236:239],a[120:123],v[196:199]
 TR v[224:225],v14,51072
 MM v[200:203],v[236:239],a[124:127],v[200:203]
 MM v[204:207],v[236:239],a[128:131],v[204:207]
 s_waitcnt lgkmcnt(6)
 TR v[226:227],v14,51584
 MM v[112:115],v[208:211],a[132:135],v[112:115]
 TR v[228:229],v14,51104
 ds_read_b128 a[164:167], v254 offset:16384
 MM v[116:119],v[208:211],a[136:139],v[116:119]
 TR v[230:231],v14,51616
 MM v[120:123],v[208:211],a[140:143],v[120:123]
 TR v[232:233],v14,51136
 MM v[124:127],v[212:215],a[132:135],v[124:127]
 MM v[128:131],v[212:215],a[136:139],v[128:131]
 TR v[234:235],v14,51648
 MM v[132:135],v[212:215],a[140:143],v[132:135]
 s_waitcnt lgkmcnt(7)
 TR v[236:237],v14,51168
 MM v[136:139],v[216:219],a[132:135],v[136:139]
 TR v[238:239],v14,51680
 MM v[140:143],v[216:219],a[136:139],v[140:143]
 MM v[144:147],v[216:219],a[140:143],v[144:147]
 MM v[148:151],v[220:223],a[132:135],v[148:151]
 MM v[152:155],v[220:223],a[136:139],v[152:155]
 MM v[156:159],v[220:223],a[140:143],v[156:159]
 s_waitcnt lgkmcnt(7)
 MM v[160:163],v[224:227],a[132:135],v[160:163]
 MM v[164:167],v[224:227],a[136:139],v[164:167]
 MM v[168:171],v[224:227],a[140:143],v[168:171]
 s_waitcnt lgkmcnt(0) vmcnt(0)
 s_barrier
 TR v[208:209],v15,256
 MM v[172:175],v[228:231],a[132:135],v[172:175]
 TR v[210:211],v15,768
 MM v[176:179],v[228:231],a[136:139],v[176:179]
 MM v[180:183],v[228:231],a[140:143],v[180:183]
 TR v[212:213],v15,17152
 MM v[184:187],v[232:235],a[132:135],v[184:187]
 TR v[214:215],v15,17664
 MM v[188:191],v[232:235],a[136:139],v[188:191]
 MM v[192:195],v[232:235],a[140:143],v[192:195]
 TR v[216:217],v15,288
 MM v[196:199],v[236:239],a[132:135],v[196:199]
 TR v[218:219],v15,800
 MM v[200:203],v[236:239],a[136:139],v[200:203]
 MM v[204:207],v[236:239],a[140:143],v[204:207]
 s_waitcnt lgkmcnt(4)
 TR v[220:221],v15,17184
 MM v[112:115],v[208:211],a[144:147],v[112:115]
 TR v[222:223],v15,17696
 MM v[116:119],v[208:211],a[148:151],v[116:119]
 TR v[224:225],v15,320
 MM v[120:123],v[208:211],a[152:155],v[120:123]
 s_waitcnt lgkmcnt(5)
 TR v[226:227],v15,832
 MM v[112:115],v[212:215],a[156:159],v[112:115]
 MM v[116:119],v[212:215],a[160:163],v[116:119]
 TR v[228:229],v15,17216
 MM v[120:123],v[212:215],a[164:167],v[120:123]
 s_waitcnt lgkmcnt(3)
 TR v[230:231],v15,17728
 MM v[124:127],v[216:219],a[144:147],v[124:127]
 TR v[232:233],v15,352
 MM v[128:131],v[216:219],a[148:151],v[128:131]
 TR v[234:235],v15,864
 MM v[132:135],v[216:219],a[152:155],v[132:135]
 MM v[124:127],v[220:223],a[156:159],v[124:127]
 TR v[236:237],v15,17248
 MM v[128:131],v[220:223],a[160:163],v[128:131]
 TR v[238:239],v15,17760
 MM v[132:135],v[220:223],a[164:167],v[132:135]
 s_waitcnt lgkmcnt(4)
 TR v[208:209],v15,384
 MM v[136:139],v[224:227],a[144:147],v[136:139]
 TR v[210:211],v15,896
 MM v[140:143],v[224:227],a[148:151],v[140:143]
 CV v112,v112,v113
 CV v113,v114,v115
 CV v114,v124,v125
 CV v115,v126,v127
 MM v[144:147],v[224:227],a[152:155],v[144:147]
 TR v[212:213],v15,17280
 CV v116,v116,v117
 CV v117,v118,v119
 CV v118,v128,v129
 MM v[136:139],v[228:231],a[156:159],v[136:139]
 TR v[214:215],v15,17792
 CV v119,v130,v131
 CV v120,v120,v121
 CV v121,v122,v123
 MM v[140:143],v[228:231],a[160:163],v[140:143]
 TR v[216:217],v15,416
 CV v122,v132,v133
 CV v123,v134,v135
 v_permlane32_swap_b32 v112, v114
 MM v[144:147],v[228:231],a[164:167],v[144:147]
 s_waitcnt lgkmcnt(5)
 v_permlane32_swap_b32 v113, v115
 MM v[148:151],v[232:235],a[144:147],v[148:151]
 TR v[218:219],v15,928
 v_permlane32_swap_b32 v116, v118
 v_permlane32_swap_b32 v117, v119
 MM v[152:155],v[232:235],a[148:151],v[152:155]
 TR v[220:221],v15,17312
 v_permlane32_swap_b32 v120, v122
 MM v[156:159],v[232:235],a[152:155],v[156:159]
 TR v[222:223],v15,17824
 v_permlane32_swap_b32 v121, v123
 v_permlane16_swap_b32 v112, v114
 MM v[148:151],v[236:239],a[156:159],v[148:151]
 TR v[224:225],v15,448
 v_permlane16_swap_b32 v113, v115
 v_permlane16_swap_b32 v116, v118
 MM v[152:155],v[236:239],a[160:163],v[152:155]
 v_permlane16_swap_b32 v117, v119
 MM v[156:159],v[236:239],a[164:167],v[156:159]
 s_waitcnt lgkmcnt(5)
 TR v[226:227],v15,960
 v_permlane16_swap_b32 v120, v122
 v_permlane16_swap_b32 v121, v123
 MM v[160:163],v[208:211],a[144:147],v[160:163]
 TR v[228:229],v15,17344
 ds_write_b128 v251, v[112:115] offset:0
 ds_write_b128 v251, v[116:119] offset:1024
 ds_write_b128 v251, v[120:123] offset:2048
 MM v[164:167],v[208:211],a[148:151],v[164:167]
 TR v[230:231],v15,17856
 CV v124,v136,v137
 CV v125,v138,v139
 CV v126,v148,v149
 MM v[168:171],v[208:211],a[152:155],v[168:171]
 TR v[232:233],v15,480
 CV v127,v150,v151
 CV v128,v140,v141
 CV v129,v142,v143
 MM v[160:163],v[212:215],a[156:159],v[160:163]
 CV v130,v152,v153
 CV v131,v154,v155
 CV v132,v144,v145
 CV v133,v146,v147
 MM v[164:167],v[212:215],a[160:163],v[164:167]
 TR v[234:235],v15,992
 CV v134,v156,v157
 CV v135,v158,v159
 MM v[168:171],v[212:215],a[164:167],v[168:171]
 s_waitcnt lgkmcnt(9)
 TR v[236:237],v15,17376
 v_permlane32_swap_b32 v124, v126
 MM v[172:175],v[216:219],a[144:147],v[172:175]
 TR v[238:239],v15,17888
 v_permlane32_swap_b32 v125, v127
 MM v[176:179],v[216:219],a[148:151],v[176:179]
 v_permlane32_swap_b32 v128, v130
 v_permlane32_swap_b32 v129, v131
 MM v[180:183],v[216:219],a[152:155],v[180:183]
 v_permlane32_swap_b32 v132, v134
 v_permlane32_swap_b32 v133, v135
 MM v[172:175],v[220:223],a[156:159],v[172:175]
 v_permlane16_swap_b32 v124, v126
 v_permlane16_swap_b32 v125, v127
 MM v[176:179],v[220:223],a[160:163],v[176:179]
 v_permlane16_swap_b32 v128, v130
 v_permlane16_swap_b32 v129, v131
 MM v[180:183],v[220:223],a[164:167],v[180:183]
 s_waitcnt lgkmcnt(9)
 v_permlane16_swap_b32 v132, v134
 v_permlane16_swap_b32 v133, v135
 MM v[184:187],v[224:227],a[144:147],v[184:187]
 ds_write_b128 v251, v[124:127] offset:3072
 ds_write_b128 v251, v[128:131] offset:4096
 ds_write_b128 v251, v[132:135] offset:5120
 MM v[188:191],v[224:227],a[148:151],v[188:191]
 CV v136,v160,v161
 CV v137,v162,v163
 CV v138,v172,v173
 CV v139,v174,v175
 MM v[192:195],v[224:227],a[152:155],v[192:195]
 s_waitcnt lgkmcnt(0)
 s_barrier
 CV v140,v164,v165
 CV v141,v166,v167
 CV v142,v176,v177
 CV v143,v178,v179
 MM v[184:187],v[228:231],a[156:159],v[184:187]
 CV v144,v168,v169
 CV v145,v170,v171
 CV v146,v180,v181
 CV v147,v182,v183
 MM v[188:191],v[228:231],a[160:163],v[188:191]
 v_permlane32_swap_b32 v136, v138
 v_permlane32_swap_b32 v137, v139
 MM v[192:195],v[228:231],a[164:167],v[192:195]
 v_permlane32_swap_b32 v140, v142
 v_permlane32_swap_b32 v141, v143
 MM v[196:199],v[232:235],a[144:147],v[196:199]
 v_permlane32_swap_b32 v144, v146
 v_permlane32_swap_b32 v145, v147
 MM v[200:203],v[232:235],a[148:151],v[200:203]
 v_permlane16_swap_b32 v136, v138
 v_permlane16_swap_b32 v137, v139
 MM v[204:207],v[232:235],a[152:155],v[204:207]
 v_permlane16_swap_b32 v140, v142
 v_permlane16_swap_b32 v141, v143
 MM v[196:199],v[236:239],a[156:159],v[196:199]
 v_permlane16_swap_b32 v144, v146
 v_permlane16_swap_b32 v145, v147
 MM v[200:203],v[236:239],a[160:163],v[200:203]
 ds_write_b128 v251, v[136:139] offset:6144
 ds_write_b128 v251, v[140:143] offset:7168
 ds_write_b128 v251, v[144:147] offset:8192
 MM v[204:207],v[236:239],a[164:167],v[204:207]
 CV v148,v184,v185
 CV v149,v186,v187
 CV v150,v196,v197
 CV v151,v198,v199
 CV v152,v188,v189
 CV v153,v190,v191
 CV v154,v200,v201
 CV v155,v202,v203
 CV v156,v192,v193
 CV v157,v194,v195
 CV v158,v204,v205
 CV v159,v206,v207
 v_permlane32_swap_b32 v148, v150
 v_permlane32_swap_b32 v149, v151
 v_permlane32_swap_b32 v152, v154
 v_permlane32_swap_b32 v153, v155
 v_permlane32_swap_b32 v156, v158
 v_permlane32_swap_b32 v157, v159
 v_permlane16_swap_b32 v148, v150
 v_permlane16_swap_b32 v149, v151
 v_permlane16_swap_b32 v152, v154
 v_permlane16_swap_b32 v153, v155
 v_permlane16_swap_b32 v156, v158
 v_permlane16_swap_b32 v157, v159
 ds_write_b128 v251, v[148:151] offset:9216
 ds_write_b128 v251, v[152:155] offset:10240
 ds_write_b128 v251, v[156:159] offset:11264
 s_waitcnt lgkmcnt(0)
 s_barrier
 s_barrier
 s_mov_b32 m0, s96
 s_nop 0
 buffer_load_dwordx4 v8, s[52:55], s77 offen offset:0 lds
 buffer_load_dwordx4 v9, s[52:55], s77 offen offset:1056 lds
 buffer_load_dwordx4 v10, s[52:55], s77 offen offset:2112 lds
 buffer_load_dwordx4 v11, s[52:55], s77 offen offset:3168 lds
 s_add_u32 m0, s96, 4224
 s_add_u32 s3, s77, 65536
 buffer_load_dwordx4 v8, s[52:55], s3 offen offset:0 lds
 buffer_load_dwordx4 v9, s[52:55], s3 offen offset:1056 lds
 buffer_load_dwordx4 v10, s[52:55], s3 offen offset:2112 lds
 buffer_load_dwordx4 v11, s[52:55], s3 offen offset:3168 lds
 s_add_u32 s77, s77, 262144
 s_cmp_ge_u32 s77, 3670016
 s_cselect_b32 s7, 3670016, 0
 s_sub_u32 s77, s77, s7
 s_barrier
 s_mov_b32 m0, s90
 s_nop 0
 buffer_load_dwordx4 v8, s[52:55], s77 offen offset:0 lds
 buffer_load_dwordx4 v9, s[52:55], s77 offen offset:1056 lds
 buffer_load_dwordx4 v10, s[52:55], s77 offen offset:2112 lds
 buffer_load_dwordx4 v11, s[52:55], s77 offen offset:3168 lds
 s_add_u32 m0, s90, 4224
 s_add_u32 s3, s77, 65536
 buffer_load_dwordx4 v8, s[52:55], s3 offen offset:0 lds
 buffer_load_dwordx4 v9, s[52:55], s3 offen offset:1056 lds
 buffer_load_dwordx4 v10, s[52:55], s3 offen offset:2112 lds
 buffer_load_dwordx4 v11, s[52:55], s3 offen offset:3168 lds
 s_add_u32 s77, s77, 262144
 s_cmp_ge_u32 s77, 3670016
 s_cselect_b32 s7, 3670016, 0
 s_sub_u32 s77, s77, s7
 s_barrier
 s_mov_b32 m0, s92
 s_nop 0
 buffer_load_dwordx4 v8, s[52:55], s77 offen offset:0 lds
 buffer_load_dwordx4 v9, s[52:55], s77 offen offset:1056 lds
 buffer_load_dwordx4 v10, s[52:55], s77 offen offset:2112 lds
 buffer_load_dwordx4 v11, s[52:55], s77 offen offset:3168 lds
 s_add_u32 m0, s92, 4224
 s_add_u32 s3, s77, 65536
 buffer_load_dwordx4 v8, s[52:55], s3 offen offset:0 lds
 buffer_load_dwordx4 v9, s[52:55], s3 offen offset:1056 lds
 buffer_load_dwordx4 v10, s[52:55], s3 offen offset:2112 lds
 buffer_load_dwordx4 v11, s[52:55], s3 offen offset:3168 lds
 s_add_u32 s77, s77, 262144
 s_cmp_ge_u32 s77, 3670016
 s_cselect_b32 s7, 3670016, 0
 s_sub_u32 s77, s77, s7
 s_waitcnt vmcnt(16)
 s_barrier
 TR v[208:209],v15,50688
 TR v[210:211],v15,51200
 TR v[212:213],v15,50720
 TR v[214:215],v15,51232
 TR v[216:217],v15,50752
 TR v[218:219],v15,51264
 s_waitcnt lgkmcnt(4)
 TR v[220:221],v15,50784
 MM v[16:19],v[208:211],a[0:3],0
 TR v[222:223],v15,51296
 MM v[20:23],v[208:211],a[4:7],0
 TR v[224:225],v15,50816
 MM v[24:27],v[208:211],a[8:11],0
 s_waitcnt lgkmcnt(5)
 s_mov_b32 m0, s94
 TR v[226:227],v15,51328
 MM v[28:31],v[212:215],a[0:3],0
 buffer_load_dwordx4 v8, s[52:55], s77 offen offset:0 lds
 MM v[32:35],v[212:215],a[4:7],0
 TR v[228:229],v15,50848
 buffer_load_dwordx4 v9, s[52:55], s77 offen offset:1056 lds
 MM v[36:39],v[212:215],a[8:11],0
 s_waitcnt lgkmcnt(3)
 TR v[230:231],v15,51360
 MM v[40:43],v[216:219],a[0:3],0
 TR v[232:233],v15,50880
 MM v[44:47],v[216:219],a[4:7],0
 TR v[234:235],v15,51392
 MM v[48:51],v[216:219],a[8:11],0
 buffer_load_dwordx4 v10, s[52:55], s77 offen offset:2112 lds
 MM v[52:55],v[220:223],a[0:3],0
 TR v[236:237],v15,50912
 MM v[56:59],v[220:223],a[4:7],0
 TR v[238:239],v15,51424
 MM v[60:63],v[220:223],a[8:11],0
 s_waitcnt lgkmcnt(4)
 TR v[208:209],v15,50944
 MM v[64:67],v[224:227],a[0:3],0
 TR v[210:211],v15,51456
 MM v[68:71],v[224:227],a[4:7],0
 buffer_load_dwordx4 v11, s[52:55], s77 offen offset:3168 lds
 MM v[72:75],v[224:227],a[8:11],0
 TR v[212:213],v15,50976
 MM v[76:79],v[228:231],a[0:3],0
 TR v[214:215],v15,51488
 MM v[80:83],v[228:231],a[4:7],0
 s_add_u32 m0, s94, 4224
 s_add_u32 s3, s77, 65536
 TR v[216:217],v15,51008
 MM v[84:87],v[228:231],a[8:11],0
 s_waitcnt lgkmcnt(5)
 buffer_load_dwordx4 v8, s[52:55], s3 offen offset:0 lds
 MM v[88:91],v[232:235],a[0:3],0
 TR v[218:219],v15,51520
 MM v[92:95],v[232:235],a[4:7],0
 TR v[220:221],v15,51040
 MM v[96:99],v[232:235],a[8:11],0
 TR v[222:223],v15,51552
 MM v[100:103],v[236:239],a[0:3],0
 TR v[224:225],v15,51072
 MM v[104:107],v[236:239],a[4:7],0
 buffer_load_dwordx4 v9, s[52:55], s3 offen offset:1056 lds
 MM v[108:111],v[236:239],a[8:11],0
 s_waitcnt lgkmcnt(5)
 TR v[226:227],v15,51584
 MM v[112:115],v[208:211],a[0:3],0
 TR v[228:229],v15,51104
 MM v[116:119],v[208:211],a[4:7],0
 TR v[230:231],v15,51616
 MM v[120:123],v[208:211],a[8:11],0
 TR v[232:233],v15,51136
 MM v[124:127],v[212:215],a[0:3],0
 buffer_load_dwordx4 v10, s[52:55], s3 offen offset:2112 lds
 MM v[128:131],v[212:215],a[4:7],0
 TR v[234:235],v15,51648
 MM v[132:135],v[212:215],a[8:11],0
 s_waitcnt lgkmcnt(6)
 TR v[236:237],v15,51168
 MM v[136:139],v[216:219],a[0:3],0
 TR v[238:239],v15,51680
 MM v[140:143],v[216:219],a[4:7],0
 buffer_load_dwordx4 v11, s[52:55], s3 offen offset:3168 lds
 MM v[144:147],v[216:219],a[8:11],0
 s_add_u32 s77, s77, 262144
 s_cmp_ge_u32 s77, 3670016
 s_cselect_b32 s7, 3670016, 0
 s_sub_u32 s77, s77, s7
 MM v[148:151],v[220:223],a[0:3],0
 MM v[152:155],v[220:223],a[4:7],0
 MM v[156:159],v[220:223],a[8:11],0
 s_waitcnt lgkmcnt(6)
 MM v[160:163],v[224:227],a[0:3],0
 MM v[164:167],v[224:227],a[4:7],0
 MM v[168:171],v[224:227],a[8:11],0
 s_waitcnt lgkmcnt(0) vmcnt(16)
 s_barrier
 TR v[208:209],v14,16896
 MM v[172:175],v[228:231],a[0:3],0
 TR v[210:211],v14,17408
 MM v[176:179],v[228:231],a[4:7],0
 MM v[180:183],v[228:231],a[8:11],0
 TR v[212:213],v14,16928
 MM v[184:187],v[232:235],a[0:3],0
 TR v[214:215],v14,17440
 MM v[188:191],v[232:235],a[4:7],0
 MM v[192:195],v[232:235],a[8:11],0
 TR v[216:217],v14,16960
 MM v[196:199],v[236:239],a[0:3],0
 TR v[218:219],v14,17472
 MM v[200:203],v[236:239],a[4:7],0
 MM v[204:207],v[236:239],a[8:11],0
 s_waitcnt lgkmcnt(4)
 TR v[220:221],v14,16992
 MM v[16:19],v[208:211],a[12:15],v[16:19]
 TR v[222:223],v14,17504
 MM v[20:23],v[208:211],a[16:19],v[20:23]
 TR v[224:225],v14,17024
 MM v[24:27],v[208:211],a[20:23],v[24:27]
 s_waitcnt lgkmcnt(5)
 s_mov_b32 m0, s96
 TR v[226:227],v14,17536
 MM v[28:31],v[212:215],a[12:15],v[28:31]
 buffer_load_dwordx4 v8, s[52:55], s77 offen offset:0 lds
 MM v[32:35],v[212:215],a[16:19],v[32:35]
 TR v[228:229],v14,17056
 buffer_load_dwordx4 v9, s[52:55], s77 offen offset:1056 lds
 MM v[36:39],v[212:215],a[20:23],v[36:39]
 s_waitcnt lgkmcnt(3)
 TR v[230:231],v14,17568
 MM v[40:43],v[216:219],a[12:15],v[40:43]
 TR v[232:233],v14,17088
 MM v[44:47],v[216:219],a[16:19],v[44:47]
 TR v[234:235],v14,17600
 MM v[48:51],v[216:219],a[20:23],v[48:51]
 buffer_load_dwordx4 v10, s[52:55], s77 offen offset:2112 lds
 MM v[52:55],v[220:223],a[12:15],v[52:55]
 TR v[236:237],v14,17120
 MM v[56:59],v[220:223],a[16:19],v[56:59]
 TR v[238:239],v14,17632
 MM v[60:63],v[220:223],a[20:23],v[60:63]
 s_waitcnt lgkmcnt(4)
 TR v[208:209],v14,17152
 MM v[64:67],v[224:227],a[12:15],v[64:67]
 TR v[210:211],v14,17664
 MM v[68:71],v[224:227],a[16:19],v[68:71]
 buffer_load_dwordx4 v11, s[52:55], s77 offen offset:3168 lds
 MM v[72:75],v[224:227],a[20:23],v[72:75]
 TR v[212:213],v14,17184
 MM v[76:79],v[228:231],a[12:15],v[76:79]
 TR v[214:215],v14,17696
 MM v[80:83],v[228:231],a[16:19],v[80:83]
 s_add_u32 m0, s96, 4224
 s_add_u32 s3, s77, 65536
 TR v[216:217],v14,17216
 MM v[84:87],v[228:231],a[20:23],v[84:87]
 s_waitcnt lgkmcnt(5)
 buffer_load_dwordx4 v8, s[52:55], s3 offen offset:0 lds
 MM v[88:91],v[232:235],a[12:15],v[88:91]
 TR v[218:219],v14,17728
 MM v[92:95],v[232:235],a[16:19],v[92:95]
 TR v[220:221],v14,17248
 MM v[96:99],v[232:235],a[20:23],v[96:99]
 TR v[222:223],v14,17760
 MM v[100:103],v[236:239],a[12:15],v[100:103]
 TR v[224:225],v14,17280
 MM v[104:107],v[236:239],a[16:19],v[104:107]
 buffer_load_dwordx4 v9, s[52:55], s3 offen offset:1056 lds
 MM v[108:111],v[236:239],a[20:23],v[108:111]
 s_waitcnt lgkmcnt(5)
 TR v[226:227],v14,17792
 MM v[112:115],v[208:211],a[12:15],v[112:115]
 TR v[228:229],v14,17312
 MM v[116:119],v[208:211],a[16:19],v[116:119]
 TR v[230:231],v14,17824
 MM v[120:123],v[208:211],a[20:23],v[120:123]
 TR v[232:233],v14,17344
 MM v[124:127],v[212:215],a[12:15],v[124:127]
 buffer_load_dwordx4 v10, s[52:55], s3 offen offset:2112 lds
 MM v[128:131],v[212:215],a[16:19],v[128:131]
 TR v[234:235],v14,17856
 MM v[132:135],v[212:215],a[20:23],v[132:135]
 s_waitcnt lgkmcnt(6)
 TR v[236:237],v14,17376
 MM v[136:139],v[216:219],a[12:15],v[136:139]
 TR v[238:239],v14,17888
 MM v[140:143],v[216:219],a[16:19],v[140:143]
 buffer_load_dwordx4 v11, s[52:55], s3 offen offset:3168 lds
 MM v[144:147],v[216:219],a[20:23],v[144:147]
 s_add_u32 s77, s77, 262144
 s_cmp_ge_u32 s77, 3670016
 s_cselect_b32 s7, 3670016, 0
 s_sub_u32 s77, s77, s7
 MM v[148:151],v[220:223],a[12:15],v[148:151]
 MM v[152:155],v[220:223],a[16:19],v[152:155]
 MM v[156:159],v[220:223],a[20:23],v[156:159]
 s_waitcnt lgkmcnt(6)
 MM v[160:163],v[224:227],a[12:15],v[160:163]
 MM v[164:167],v[224:227],a[16:19],v[164:167]
 MM v[168:171],v[224:227],a[20:23],v[168:171]
 s_waitcnt lgkmcnt(0) vmcnt(16)
 s_barrier
 TR v[208:209],v14,50688
 MM v[172:175],v[228:231],a[12:15],v[172:175]
 TR v[210:211],v14,51200
 MM v[176:179],v[228:231],a[16:19],v[176:179]
 MM v[180:183],v[228:231],a[20:23],v[180:183]
 TR v[212:213],v14,50720
 MM v[184:187],v[232:235],a[12:15],v[184:187]
 TR v[214:215],v14,51232
 MM v[188:191],v[232:235],a[16:19],v[188:191]
 MM v[192:195],v[232:235],a[20:23],v[192:195]
 TR v[216:217],v14,50752
 MM v[196:199],v[236:239],a[12:15],v[196:199]
 TR v[218:219],v14,51264
 MM v[200:203],v[236:239],a[16:19],v[200:203]
 MM v[204:207],v[236:239],a[20:23],v[204:207]
 s_waitcnt lgkmcnt(4)
 TR v[220:221],v14,50784
 MM v[16:19],v[208:211],a[24:27],v[16:19]
 TR v[222:223],v14,51296
 MM v[20:23],v[208:211],a[28:31],v[20:23]
 TR v[224:225],v14,50816
 MM v[24:27],v[208:211],a[32:35],v[24:27]
 s_waitcnt lgkmcnt(5)
 s_mov_b32 m0, s90
 TR v[226:227],v14,51328
 MM v[28:31],v[212:215],a[24:27],v[28:31]
 buffer_load_dwordx4 v8, s[52:55], s77 offen offset:0 lds
 MM v[32:35],v[212:215],a[28:31],v[32:35]
 TR v[228:229],v14,50848
 buffer_load_dwordx4 v9, s[52:55], s77 offen offset:1056 lds
 MM v[36:39],v[212:215],a[32:35],v[36:39]
 s_waitcnt lgkmcnt(3)
 TR v[230:231],v14,51360
 MM v[40:43],v[216:219],a[24:27],v[40:43]
 TR v[232:233],v14,50880
 MM v[44:47],v[216:219],a[28:31],v[44:47]
 TR v[234:235],v14,51392
 MM v[48:51],v[216:219],a[32:35],v[48:51]
 buffer_load_dwordx4 v10, s[52:55], s77 offen offset:2112 lds
 MM v[52:55],v[220:223],a[24:27],v[52:55]
 TR v[236:237],v14,50912
 MM v[56:59],v[220:223],a[28:31],v[56:59]
 TR v[238:239],v14,51424
 MM v[60:63],v[220:223],a[32:35],v[60:63]
 s_waitcnt lgkmcnt(4)
 TR v[208:209],v14,50944
 MM v[64:67],v[224:227],a[24:27],v[64:67]
 TR v[210:211],v14,51456
 MM v[68:71],v[224:227],a[28:31],v[68:71]
 buffer_load_dwordx4 v11, s[52:55], s77 offen offset:3168 lds
 MM v[72:75],v[224:227],a[32:35],v[72:75]
 TR v[212:213],v14,50976
 MM v[76:79],v[228:231],a[24:27],v[76:79]
 TR v[214:215],v14,51488
 MM v[80:83],v[228:231],a[28:31],v[80:83]
 s_add_u32 m0, s90, 4224
 s_add_u32 s3, s77, 65536
 TR v[216:217],v14,51008
 MM v[84:87],v[228:231],a[32:35],v[84:87]
 s_waitcnt lgkmcnt(5)
 buffer_load_dwordx4 v8, s[52:55], s3 offen offset:0 lds
 MM v[88:91],v[232:235],a[24:27],v[88:91]
 TR v[218:219],v14,51520
 MM v[92:95],v[232:235],a[28:31],v[92:95]
 TR v[220:221],v14,51040
 MM v[96:99],v[232:235],a[32:35],v[96:99]
 TR v[222:223],v14,51552
 MM v[100:103],v[236:239],a[24:27],v[100:103]
 TR v[224:225],v14,51072
 MM v[104:107],v[236:239],a[28:31],v[104:107]
 buffer_load_dwordx4 v9, s[52:55], s3 offen offset:1056 lds
 MM v[108:111],v[236:239],a[32:35],v[108:111]
 s_waitcnt lgkmcnt(5)
 TR v[226:227],v14,51584
 MM v[112:115],v[208:211],a[24:27],v[112:115]
 TR v[228:229],v14,51104
 MM v[116:119],v[208:211],a[28:31],v[116:119]
 TR v[230:231],v14,51616
 MM v[120:123],v[208:211],a[32:35],v[120:123]
 TR v[232:233],v14,51136
 MM v[124:127],v[212:215],a[24:27],v[124:127]
 buffer_load_dwordx4 v10, s[52:55], s3 offen offset:2112 lds
 MM v[128:131],v[212:215],a[28:31],v[128:131]
 TR v[234:235],v14,51648
 MM v[132:135],v[212:215],a[32:35],v[132:135]
 s_waitcnt lgkmcnt(6)
 TR v[236:237],v14,51168
 MM v[136:139],v[216:219],a[24:27],v[136:139]
 TR v[238:239],v14,51680
 MM v[140:143],v[216:219],a[28:31],v[140:143]
 buffer_load_dwordx4 v11, s[52:55], s3 offen offset:3168 lds
 MM v[144:147],v[216:219],a[32:35],v[144:147]
 s_add_u32 s77, s77, 262144
 s_cmp_ge_u32 s77, 3670016
 s_cselect_b32 s7, 3670016, 0
 s_sub_u32 s77, s77, s7
 MM v[148:151],v[220:223],a[24:27],v[148:151]
 MM v[152:155],v[220:223],a[28:31],v[152:155]
 MM v[156:159],v[220:223],a[32:35],v[156:159]
 s_waitcnt lgkmcnt(6)
 MM v[160:163],v[224:227],a[24:27],v[160:163]
 MM v[164:167],v[224:227],a[28:31],v[164:167]
 MM v[168:171],v[224:227],a[32:35],v[168:171]
 s_waitcnt lgkmcnt(0) vmcnt(16)
 s_barrier
 TR v[208:209],v15,16896
 MM v[172:175],v[228:231],a[24:27],v[172:175]
 TR v[210:211],v15,17408
 MM v[176:179],v[228:231],a[28:31],v[176:179]
 MM v[180:183],v[228:231],a[32:35],v[180:183]
 TR v[212:213],v15,16928
 MM v[184:187],v[232:235],a[24:27],v[184:187]
 TR v[214:215],v15,17440
 MM v[188:191],v[232:235],a[28:31],v[188:191]
 MM v[192:195],v[232:235],a[32:35],v[192:195]
 TR v[216:217],v15,16960
 MM v[196:199],v[236:239],a[24:27],v[196:199]
 TR v[218:219],v15,17472
 MM v[200:203],v[236:239],a[28:31],v[200:203]
 MM v[204:207],v[236:239],a[32:35],v[204:207]
 s_waitcnt lgkmcnt(4)
 TR v[220:221],v15,16992
 MM v[16:19],v[208:211],a[36:39],v[16:19]
 TR v[222:223],v15,17504
 MM v[20:23],v[208:211],a[40:43],v[20:23]
 TR v[224:225],v15,17024
 MM v[24:27],v[208:211],a[44:47],v[24:27]
 s_waitcnt lgkmcnt(5)
 s_mov_b32 m0, s92
 TR v[226:227],v15,17536
 MM v[28:31],v[212:215],a[36:39],v[28:31]
 buffer_load_dwordx4 v8, s[52:55], s77 offen offset:0 lds
 MM v[32:35],v[212:215],a[40:43],v[32:35]
 TR v[228:229],v15,17056
 buffer_load_dwordx4 v9, s[52:55], s77 offen offset:1056 lds
 MM v[36:39],v[212:215],a[44:47],v[36:39]
 s_waitcnt lgkmcnt(3)
 TR v[230:231],v15,17568
 MM v[40:43],v[216:219],a[36:39],v[40:43]
 TR v[232:233],v15,17088
 MM v[44:47],v[216:219],a[40:43],v[44:47]
 TR v[234:235],v15,17600
 MM v[48:51],v[216:219],a[44:47],v[48:51]
 buffer_load_dwordx4 v10, s[52:55], s77 offen offset:2112 lds
 MM v[52:55],v[220:223],a[36:39],v[52:55]
 TR v[236:237],v15,17120
 MM v[56:59],v[220:223],a[40:43],v[56:59]
 TR v[238:239],v15,17632
 MM v[60:63],v[220:223],a[44:47],v[60:63]
 s_waitcnt lgkmcnt(4)
 TR v[208:209],v15,17152
 MM v[64:67],v[224:227],a[36:39],v[64:67]
 TR v[210:211],v15,17664
 MM v[68:71],v[224:227],a[40:43],v[68:71]
 buffer_load_dwordx4 v11, s[52:55], s77 offen offset:3168 lds
 MM v[72:75],v[224:227],a[44:47],v[72:75]
 TR v[212:213],v15,17184
 MM v[76:79],v[228:231],a[36:39],v[76:79]
 TR v[214:215],v15,17696
 MM v[80:83],v[228:231],a[40:43],v[80:83]
 s_add_u32 m0, s92, 4224
 s_add_u32 s3, s77, 65536
 TR v[216:217],v15,17216
 MM v[84:87],v[228:231],a[44:47],v[84:87]
 s_waitcnt lgkmcnt(5)
 buffer_load_dwordx4 v8, s[52:55], s3 offen offset:0 lds
 MM v[88:91],v[232:235],a[36:39],v[88:91]
 TR v[218:219],v15,17728
 MM v[92:95],v[232:235],a[40:43],v[92:95]
 TR v[220:221],v15,17248
 MM v[96:99],v[232:235],a[44:47],v[96:99]
 TR v[222:223],v15,17760
 MM v[100:103],v[236:239],a[36:39],v[100:103]
 TR v[224:225],v15,17280
 MM v[104:107],v[236:239],a[40:43],v[104:107]
 buffer_load_dwordx4 v9, s[52:55], s3 offen offset:1056 lds
 MM v[108:111],v[236:239],a[44:47],v[108:111]
 s_waitcnt lgkmcnt(5)
 TR v[226:227],v15,17792
 MM v[112:115],v[208:211],a[36:39],v[112:115]
 TR v[228:229],v15,17312
 MM v[116:119],v[208:211],a[40:43],v[116:119]
 TR v[230:231],v15,17824
 MM v[120:123],v[208:211],a[44:47],v[120:123]
 TR v[232:233],v15,17344
 MM v[124:127],v[212:215],a[36:39],v[124:127]
 buffer_load_dwordx4 v10, s[52:55], s3 offen offset:2112 lds
 MM v[128:131],v[212:215],a[40:43],v[128:131]
 TR v[234:235],v15,17856
 MM v[132:135],v[212:215],a[44:47],v[132:135]
 s_waitcnt lgkmcnt(6)
 TR v[236:237],v15,17376
 MM v[136:139],v[216:219],a[36:39],v[136:139]
 TR v[238:239],v15,17888
 MM v[140:143],v[216:219],a[40:43],v[140:143]
 buffer_load_dwordx4 v11, s[52:55], s3 offen offset:3168 lds
 MM v[144:147],v[216:219],a[44:47],v[144:147]
 s_add_u32 s77, s77, 262144
 s_cmp_ge_u32 s77, 3670016
 s_cselect_b32 s7, 3670016, 0
 s_sub_u32 s77, s77, s7
 MM v[148:151],v[220:223],a[36:39],v[148:151]
 MM v[152:155],v[220:223],a[40:43],v[152:155]
 MM v[156:159],v[220:223],a[44:47],v[156:159]
 s_waitcnt lgkmcnt(6)
 MM v[160:163],v[224:227],a[36:39],v[160:163]
 MM v[164:167],v[224:227],a[40:43],v[164:167]
 MM v[168:171],v[224:227],a[44:47],v[168:171]
 s_waitcnt lgkmcnt(0) vmcnt(16)
 s_barrier
 TR v[208:209],v15,50688
 MM v[172:175],v[228:231],a[36:39],v[172:175]
 TR v[210:211],v15,51200
 MM v[176:179],v[228:231],a[40:43],v[176:179]
 MM v[180:183],v[228:231],a[44:47],v[180:183]
 TR v[212:213],v15,50720
 MM v[184:187],v[232:235],a[36:39],v[184:187]
 TR v[214:215],v15,51232
 MM v[188:191],v[232:235],a[40:43],v[188:191]
 MM v[192:195],v[232:235],a[44:47],v[192:195]
 TR v[216:217],v15,50752
 MM v[196:199],v[236:239],a[36:39],v[196:199]
 TR v[218:219],v15,51264
 MM v[200:203],v[236:239],a[40:43],v[200:203]
 MM v[204:207],v[236:239],a[44:47],v[204:207]
 s_waitcnt lgkmcnt(4)
 TR v[220:221],v15,50784
 MM v[16:19],v[208:211],a[48:51],v[16:19]
 TR v[222:223],v15,51296
 MM v[20:23],v[208:211],a[52:55],v[20:23]
 TR v[224:225],v15,50816
 MM v[24:27],v[208:211],a[56:59],v[24:27]
 s_waitcnt lgkmcnt(5)
 s_mov_b32 m0, s94
 TR v[226:227],v15,51328
 MM v[28:31],v[212:215],a[48:51],v[28:31]
 buffer_load_dwordx4 v8, s[52:55], s77 offen offset:0 lds
 MM v[32:35],v[212:215],a[52:55],v[32:35]
 TR v[228:229],v15,50848
 buffer_load_dwordx4 v9, s[52:55], s77 offen offset:1056 lds
 MM v[36:39],v[212:215],a[56:59],v[36:39]
 s_waitcnt lgkmcnt(3)
 TR v[230:231],v15,51360
 MM v[40:43],v[216:219],a[48:51],v[40:43]
 TR v[232:233],v15,50880
 MM v[44:47],v[216:219],a[52:55],v[44:47]
 TR v[234:235],v15,51392
 MM v[48:51],v[216:219],a[56:59],v[48:51]
 buffer_load_dwordx4 v10, s[52:55], s77 offen offset:2112 lds
 MM v[52:55],v[220:223],a[48:51],v[52:55]
 TR v[236:237],v15,50912
 MM v[56:59],v[220:223],a[52:55],v[56:59]
 TR v[238:239],v15,51424
 MM v[60:63],v[220:223],a[56:59],v[60:63]
 s_waitcnt lgkmcnt(4)
 TR v[208:209],v15,50944
 MM v[64:67],v[224:227],a[48:51],v[64:67]
 TR v[210:211],v15,51456
 MM v[68:71],v[224:227],a[52:55],v[68:71]
 buffer_load_dwordx4 v11, s[52:55], s77 offen offset:3168 lds
 MM v[72:75],v[224:227],a[56:59],v[72:75]
 TR v[212:213],v15,50976
 MM v[76:79],v[228:231],a[48:51],v[76:79]
 TR v[214:215],v15,51488
 MM v[80:83],v[228:231],a[52:55],v[80:83]
 s_add_u32 m0, s94, 4224
 s_add_u32 s3, s77, 65536
 TR v[216:217],v15,51008
 MM v[84:87],v[228:231],a[56:59],v[84:87]
 s_waitcnt lgkmcnt(5)
 buffer_load_dwordx4 v8, s[52:55], s3 offen offset:0 lds
 MM v[88:91],v[232:235],a[48:51],v[88:91]
 TR v[218:219],v15,51520
 MM v[92:95],v[232:235],a[52:55],v[92:95]
 TR v[220:221],v15,51040
 MM v[96:99],v[232:235],a[56:59],v[96:99]
 TR v[222:223],v15,51552
 MM v[100:103],v[236:239],a[48:51],v[100:103]
 TR v[224:225],v15,51072
 MM v[104:107],v[236:239],a[52:55],v[104:107]
 buffer_load_dwordx4 v9, s[52:55], s3 offen offset:1056 lds
 MM v[108:111],v[236:239],a[56:59],v[108:111]
 s_waitcnt lgkmcnt(5)
 TR v[226:227],v15,51584
 MM v[112:115],v[208:211],a[48:51],v[112:115]
 TR v[228:229],v15,51104
 MM v[116:119],v[208:211],a[52:55],v[116:119]
 TR v[230:231],v15,51616
 MM v[120:123],v[208:211],a[56:59],v[120:123]
 TR v[232:233],v15,51136
 MM v[124:127],v[212:215],a[48:51],v[124:127]
 buffer_load_dwordx4 v10, s[52:55], s3 offen offset:2112 lds
 MM v[128:131],v[212:215],a[52:55],v[128:131]
 TR v[234:235],v15,51648
 MM v[132:135],v[212:215],a[56:59],v[132:135]
 s_waitcnt lgkmcnt(6)
 TR v[236:237],v15,51168
 MM v[136:139],v[216:219],a[48:51],v[136:139]
 TR v[238:239],v15,51680
 MM v[140:143],v[216:219],a[52:55],v[140:143]
 buffer_load_dwordx4 v11, s[52:55], s3 offen offset:3168 lds
 MM v[144:147],v[216:219],a[56:59],v[144:147]
 s_add_u32 s77, s77, 262144
 s_cmp_ge_u32 s77, 3670016
 s_cselect_b32 s7, 3670016, 0
 s_sub_u32 s77, s77, s7
 MM v[148:151],v[220:223],a[48:51],v[148:151]
 MM v[152:155],v[220:223],a[52:55],v[152:155]
 MM v[156:159],v[220:223],a[56:59],v[156:159]
 s_waitcnt lgkmcnt(6)
 MM v[160:163],v[224:227],a[48:51],v[160:163]
 MM v[164:167],v[224:227],a[52:55],v[164:167]
 MM v[168:171],v[224:227],a[56:59],v[168:171]
 s_waitcnt lgkmcnt(0) vmcnt(16)
 s_barrier
 TR v[208:209],v14,16896
 MM v[172:175],v[228:231],a[48:51],v[172:175]
 TR v[210:211],v14,17408
 MM v[176:179],v[228:231],a[52:55],v[176:179]
 MM v[180:183],v[228:231],a[56:59],v[180:183]
 TR v[212:213],v14,16928
 MM v[184:187],v[232:235],a[48:51],v[184:187]
 TR v[214:215],v14,17440
 MM v[188:191],v[232:235],a[52:55],v[188:191]
 MM v[192:195],v[232:235],a[56:59],v[192:195]
 TR v[216:217],v14,16960
 MM v[196:199],v[236:239],a[48:51],v[196:199]
 TR v[218:219],v14,17472
 MM v[200:203],v[236:239],a[52:55],v[200:203]
 MM v[204:207],v[236:239],a[56:59],v[204:207]
 s_waitcnt lgkmcnt(4)
 TR v[220:221],v14,16992
 MM v[16:19],v[208:211],a[60:63],v[16:19]
 TR v[222:223],v14,17504
 MM v[20:23],v[208:211],a[64:67],v[20:23]
 TR v[224:225],v14,17024
 MM v[24:27],v[208:211],a[68:71],v[24:27]
 s_waitcnt lgkmcnt(5)
 s_mov_b32 m0, s96
 TR v[226:227],v14,17536
 MM v[28:31],v[212:215],a[60:63],v[28:31]
 buffer_load_dwordx4 v8, s[52:55], s77 offen offset:0 lds
 MM v[32:35],v[212:215],a[64:67],v[32:35]
 TR v[228:229],v14,17056
 buffer_load_dwordx4 v9, s[52:55], s77 offen offset:1056 lds
 MM v[36:39],v[212:215],a[68:71],v[36:39]
 s_waitcnt lgkmcnt(3)
 TR v[230:231],v14,17568
 MM v[40:43],v[216:219],a[60:63],v[40:43]
 TR v[232:233],v14,17088
 MM v[44:47],v[216:219],a[64:67],v[44:47]
 TR v[234:235],v14,17600
 MM v[48:51],v[216:219],a[68:71],v[48:51]
 buffer_load_dwordx4 v10, s[52:55], s77 offen offset:2112 lds
 MM v[52:55],v[220:223],a[60:63],v[52:55]
 TR v[236:237],v14,17120
 MM v[56:59],v[220:223],a[64:67],v[56:59]
 TR v[238:239],v14,17632
 MM v[60:63],v[220:223],a[68:71],v[60:63]
 s_waitcnt lgkmcnt(4)
 TR v[208:209],v14,17152
 MM v[64:67],v[224:227],a[60:63],v[64:67]
 TR v[210:211],v14,17664
 MM v[68:71],v[224:227],a[64:67],v[68:71]
 buffer_load_dwordx4 v11, s[52:55], s77 offen offset:3168 lds
 MM v[72:75],v[224:227],a[68:71],v[72:75]
 TR v[212:213],v14,17184
 MM v[76:79],v[228:231],a[60:63],v[76:79]
 TR v[214:215],v14,17696
 MM v[80:83],v[228:231],a[64:67],v[80:83]
 s_add_u32 m0, s96, 4224
 s_add_u32 s3, s77, 65536
 TR v[216:217],v14,17216
 MM v[84:87],v[228:231],a[68:71],v[84:87]
 s_waitcnt lgkmcnt(5)
 buffer_load_dwordx4 v8, s[52:55], s3 offen offset:0 lds
 MM v[88:91],v[232:235],a[60:63],v[88:91]
 TR v[218:219],v14,17728
 MM v[92:95],v[232:235],a[64:67],v[92:95]
 TR v[220:221],v14,17248
 MM v[96:99],v[232:235],a[68:71],v[96:99]
 TR v[222:223],v14,17760
 MM v[100:103],v[236:239],a[60:63],v[100:103]
 TR v[224:225],v14,17280
 MM v[104:107],v[236:239],a[64:67],v[104:107]
 buffer_load_dwordx4 v9, s[52:55], s3 offen offset:1056 lds
 MM v[108:111],v[236:239],a[68:71],v[108:111]
 s_waitcnt lgkmcnt(5)
 TR v[226:227],v14,17792
 MM v[112:115],v[208:211],a[60:63],v[112:115]
 TR v[228:229],v14,17312
 MM v[116:119],v[208:211],a[64:67],v[116:119]
 TR v[230:231],v14,17824
 MM v[120:123],v[208:211],a[68:71],v[120:123]
 TR v[232:233],v14,17344
 MM v[124:127],v[212:215],a[60:63],v[124:127]
 buffer_load_dwordx4 v10, s[52:55], s3 offen offset:2112 lds
 MM v[128:131],v[212:215],a[64:67],v[128:131]
 TR v[234:235],v14,17856
 MM v[132:135],v[212:215],a[68:71],v[132:135]
 s_waitcnt lgkmcnt(6)
 TR v[236:237],v14,17376
 MM v[136:139],v[216:219],a[60:63],v[136:139]
 TR v[238:239],v14,17888
 MM v[140:143],v[216:219],a[64:67],v[140:143]
 buffer_load_dwordx4 v11, s[52:55], s3 offen offset:3168 lds
 MM v[144:147],v[216:219],a[68:71],v[144:147]
 s_add_u32 s77, s77, 262144
 s_cmp_ge_u32 s77, 3670016
 s_cselect_b32 s7, 3670016, 0
 s_sub_u32 s77, s77, s7
 MM v[148:151],v[220:223],a[60:63],v[148:151]
 MM v[152:155],v[220:223],a[64:67],v[152:155]
 MM v[156:159],v[220:223],a[68:71],v[156:159]
 s_waitcnt lgkmcnt(6)
 MM v[160:163],v[224:227],a[60:63],v[160:163]
 MM v[164:167],v[224:227],a[64:67],v[164:167]
 MM v[168:171],v[224:227],a[68:71],v[168:171]
 s_waitcnt lgkmcnt(0) vmcnt(16)
 s_barrier
 TR v[208:209],v14,50688
 MM v[172:175],v[228:231],a[60:63],v[172:175]
 TR v[210:211],v14,51200
 MM v[176:179],v[228:231],a[64:67],v[176:179]
 MM v[180:183],v[228:231],a[68:71],v[180:183]
 TR v[212:213],v14,50720
 MM v[184:187],v[232:235],a[60:63],v[184:187]
 TR v[214:215],v14,51232
 MM v[188:191],v[232:235],a[64:67],v[188:191]
 MM v[192:195],v[232:235],a[68:71],v[192:195]
 TR v[216:217],v14,50752
 MM v[196:199],v[236:239],a[60:63],v[196:199]
 TR v[218:219],v14,51264
 MM v[200:203],v[236:239],a[64:67],v[200:203]
 MM v[204:207],v[236:239],a[68:71],v[204:207]
 s_waitcnt lgkmcnt(4)
 TR v[220:221],v14,50784
 MM v[16:19],v[208:211],a[72:75],v[16:19]
 TR v[222:223],v14,51296
 MM v[20:23],v[208:211],a[76:79],v[20:23]
 TR v[224:225],v14,50816
 MM v[24:27],v[208:211],a[80:83],v[24:27]
 s_waitcnt lgkmcnt(5)
 s_mov_b32 m0, s90
 TR v[226:227],v14,51328
 MM v[28:31],v[212:215],a[72:75],v[28:31]
 buffer_load_dwordx4 v8, s[52:55], s77 offen offset:0 lds
 MM v[32:35],v[212:215],a[76:79],v[32:35]
 TR v[228:229],v14,50848
 buffer_load_dwordx4 v9, s[52:55], s77 offen offset:1056 lds
 MM v[36:39],v[212:215],a[80:83],v[36:39]
 s_waitcnt lgkmcnt(3)
 TR v[230:231],v14,51360
 MM v[40:43],v[216:219],a[72:75],v[40:43]
 TR v[232:233],v14,50880
 MM v[44:47],v[216:219],a[76:79],v[44:47]
 TR v[234:235],v14,51392
 MM v[48:51],v[216:219],a[80:83],v[48:51]
 buffer_load_dwordx4 v10, s[52:55], s77 offen offset:2112 lds
 MM v[52:55],v[220:223],a[72:75],v[52:55]
 TR v[236:237],v14,50912
 MM v[56:59],v[220:223],a[76:79],v[56:59]
 TR v[238:239],v14,51424
 MM v[60:63],v[220:223],a[80:83],v[60:63]
 s_waitcnt lgkmcnt(4)
 TR v[208:209],v14,50944
 MM v[64:67],v[224:227],a[72:75],v[64:67]
 TR v[210:211],v14,51456
 MM v[68:71],v[224:227],a[76:79],v[68:71]
 buffer_load_dwordx4 v11, s[52:55], s77 offen offset:3168 lds
 MM v[72:75],v[224:227],a[80:83],v[72:75]
 TR v[212:213],v14,50976
 MM v[76:79],v[228:231],a[72:75],v[76:79]
 TR v[214:215],v14,51488
 MM v[80:83],v[228:231],a[76:79],v[80:83]
 s_add_u32 m0, s90, 4224
 s_add_u32 s3, s77, 65536
 TR v[216:217],v14,51008
 MM v[84:87],v[228:231],a[80:83],v[84:87]
 s_waitcnt lgkmcnt(5)
 buffer_load_dwordx4 v8, s[52:55], s3 offen offset:0 lds
 MM v[88:91],v[232:235],a[72:75],v[88:91]
 TR v[218:219],v14,51520
 MM v[92:95],v[232:235],a[76:79],v[92:95]
 TR v[220:221],v14,51040
 MM v[96:99],v[232:235],a[80:83],v[96:99]
 TR v[222:223],v14,51552
 MM v[100:103],v[236:239],a[72:75],v[100:103]
 TR v[224:225],v14,51072
 MM v[104:107],v[236:239],a[76:79],v[104:107]
 buffer_load_dwordx4 v9, s[52:55], s3 offen offset:1056 lds
 MM v[108:111],v[236:239],a[80:83],v[108:111]
 s_waitcnt lgkmcnt(5)
 TR v[226:227],v14,51584
 MM v[112:115],v[208:211],a[72:75],v[112:115]
 TR v[228:229],v14,51104
 MM v[116:119],v[208:211],a[76:79],v[116:119]
 TR v[230:231],v14,51616
 MM v[120:123],v[208:211],a[80:83],v[120:123]
 TR v[232:233],v14,51136
 MM v[124:127],v[212:215],a[72:75],v[124:127]
 buffer_load_dwordx4 v10, s[52:55], s3 offen offset:2112 lds
 MM v[128:131],v[212:215],a[76:79],v[128:131]
 TR v[234:235],v14,51648
 MM v[132:135],v[212:215],a[80:83],v[132:135]
 s_waitcnt lgkmcnt(6)
 TR v[236:237],v14,51168
 MM v[136:139],v[216:219],a[72:75],v[136:139]
 TR v[238:239],v14,51680
 MM v[140:143],v[216:219],a[76:79],v[140:143]
 buffer_load_dwordx4 v11, s[52:55], s3 offen offset:3168 lds
 MM v[144:147],v[216:219],a[80:83],v[144:147]
 s_add_u32 s77, s77, 262144
 s_cmp_ge_u32 s77, 3670016
 s_cselect_b32 s7, 3670016, 0
 s_sub_u32 s77, s77, s7
 MM v[148:151],v[220:223],a[72:75],v[148:151]
 MM v[152:155],v[220:223],a[76:79],v[152:155]
 MM v[156:159],v[220:223],a[80:83],v[156:159]
 s_waitcnt lgkmcnt(6)
 MM v[160:163],v[224:227],a[72:75],v[160:163]
 MM v[164:167],v[224:227],a[76:79],v[164:167]
 MM v[168:171],v[224:227],a[80:83],v[168:171]
 s_waitcnt lgkmcnt(0) vmcnt(16)
 s_barrier
 TR v[208:209],v15,16896
 MM v[172:175],v[228:231],a[72:75],v[172:175]
 TR v[210:211],v15,17408
 MM v[176:179],v[228:231],a[76:79],v[176:179]
 MM v[180:183],v[228:231],a[80:83],v[180:183]
 TR v[212:213],v15,16928
 MM v[184:187],v[232:235],a[72:75],v[184:187]
 TR v[214:215],v15,17440
 MM v[188:191],v[232:235],a[76:79],v[188:191]
 MM v[192:195],v[232:235],a[80:83],v[192:195]
 TR v[216:217],v15,16960
 MM v[196:199],v[236:239],a[72:75],v[196:199]
 TR v[218:219],v15,17472
 MM v[200:203],v[236:239],a[76:79],v[200:203]
 MM v[204:207],v[236:239],a[80:83],v[204:207]
 s_waitcnt lgkmcnt(4)
 TR v[220:221],v15,16992
 MM v[16:19],v[208:211],a[84:87],v[16:19]
 TR v[222:223],v15,17504
 MM v[20:23],v[208:211],a[88:91],v[20:23]
 TR v[224:225],v15,17024
 MM v[24:27],v[208:211],a[92:95],v[24:27]
 s_waitcnt lgkmcnt(5)
 s_mov_b32 m0, s92
 TR v[226:227],v15,17536
 MM v[28:31],v[212:215],a[84:87],v[28:31]
 buffer_load_dwordx4 v8, s[52:55], s77 offen offset:0 lds
 MM v[32:35],v[212:215],a[88:91],v[32:35]
 TR v[228:229],v15,17056
 buffer_load_dwordx4 v9, s[52:55], s77 offen offset:1056 lds
 MM v[36:39],v[212:215],a[92:95],v[36:39]
 s_waitcnt lgkmcnt(3)
 TR v[230:231],v15,17568
 MM v[40:43],v[216:219],a[84:87],v[40:43]
 TR v[232:233],v15,17088
 MM v[44:47],v[216:219],a[88:91],v[44:47]
 TR v[234:235],v15,17600
 MM v[48:51],v[216:219],a[92:95],v[48:51]
 buffer_load_dwordx4 v10, s[52:55], s77 offen offset:2112 lds
 MM v[52:55],v[220:223],a[84:87],v[52:55]
 TR v[236:237],v15,17120
 MM v[56:59],v[220:223],a[88:91],v[56:59]
 TR v[238:239],v15,17632
 MM v[60:63],v[220:223],a[92:95],v[60:63]
 s_waitcnt lgkmcnt(4)
 TR v[208:209],v15,17152
 MM v[64:67],v[224:227],a[84:87],v[64:67]
 TR v[210:211],v15,17664
 MM v[68:71],v[224:227],a[88:91],v[68:71]
 buffer_load_dwordx4 v11, s[52:55], s77 offen offset:3168 lds
 MM v[72:75],v[224:227],a[92:95],v[72:75]
 TR v[212:213],v15,17184
 MM v[76:79],v[228:231],a[84:87],v[76:79]
 TR v[214:215],v15,17696
 MM v[80:83],v[228:231],a[88:91],v[80:83]
 s_add_u32 m0, s92, 4224
 s_add_u32 s3, s77, 65536
 TR v[216:217],v15,17216
 MM v[84:87],v[228:231],a[92:95],v[84:87]
 s_waitcnt lgkmcnt(5)
 buffer_load_dwordx4 v8, s[52:55], s3 offen offset:0 lds
 MM v[88:91],v[232:235],a[84:87],v[88:91]
 TR v[218:219],v15,17728
 MM v[92:95],v[232:235],a[88:91],v[92:95]
 TR v[220:221],v15,17248
 MM v[96:99],v[232:235],a[92:95],v[96:99]
 TR v[222:223],v15,17760
 MM v[100:103],v[236:239],a[84:87],v[100:103]
 TR v[224:225],v15,17280
 MM v[104:107],v[236:239],a[88:91],v[104:107]
 buffer_load_dwordx4 v9, s[52:55], s3 offen offset:1056 lds
 MM v[108:111],v[236:239],a[92:95],v[108:111]
 s_waitcnt lgkmcnt(5)
 TR v[226:227],v15,17792
 MM v[112:115],v[208:211],a[84:87],v[112:115]
 TR v[228:229],v15,17312
 MM v[116:119],v[208:211],a[88:91],v[116:119]
 TR v[230:231],v15,17824
 MM v[120:123],v[208:211],a[92:95],v[120:123]
 TR v[232:233],v15,17344
 MM v[124:127],v[212:215],a[84:87],v[124:127]
 buffer_load_dwordx4 v10, s[52:55], s3 offen offset:2112 lds
 MM v[128:131],v[212:215],a[88:91],v[128:131]
 TR v[234:235],v15,17856
 MM v[132:135],v[212:215],a[92:95],v[132:135]
 s_waitcnt lgkmcnt(6)
 TR v[236:237],v15,17376
 MM v[136:139],v[216:219],a[84:87],v[136:139]
 TR v[238:239],v15,17888
 MM v[140:143],v[216:219],a[88:91],v[140:143]
 buffer_load_dwordx4 v11, s[52:55], s3 offen offset:3168 lds
 MM v[144:147],v[216:219],a[92:95],v[144:147]
 s_add_u32 s77, s77, 262144
 s_cmp_ge_u32 s77, 3670016
 s_cselect_b32 s7, 3670016, 0
 s_sub_u32 s77, s77, s7
 MM v[148:151],v[220:223],a[84:87],v[148:151]
 MM v[152:155],v[220:223],a[88:91],v[152:155]
 MM v[156:159],v[220:223],a[92:95],v[156:159]
 s_waitcnt lgkmcnt(6)
 MM v[160:163],v[224:227],a[84:87],v[160:163]
 MM v[164:167],v[224:227],a[88:91],v[164:167]
 MM v[168:171],v[224:227],a[92:95],v[168:171]
 s_waitcnt lgkmcnt(0) vmcnt(16)
 s_barrier
 TR v[208:209],v15,50688
 MM v[172:175],v[228:231],a[84:87],v[172:175]
 TR v[210:211],v15,51200
 MM v[176:179],v[228:231],a[88:91],v[176:179]
 MM v[180:183],v[228:231],a[92:95],v[180:183]
 TR v[212:213],v15,50720
 MM v[184:187],v[232:235],a[84:87],v[184:187]
 TR v[214:215],v15,51232
 MM v[188:191],v[232:235],a[88:91],v[188:191]
 MM v[192:195],v[232:235],a[92:95],v[192:195]
 TR v[216:217],v15,50752
 MM v[196:199],v[236:239],a[84:87],v[196:199]
 TR v[218:219],v15,51264
 MM v[200:203],v[236:239],a[88:91],v[200:203]
 MM v[204:207],v[236:239],a[92:95],v[204:207]
 s_waitcnt lgkmcnt(4)
 TR v[220:221],v15,50784
 MM v[16:19],v[208:211],a[96:99],v[16:19]
 TR v[222:223],v15,51296
 MM v[20:23],v[208:211],a[100:103],v[20:23]
 TR v[224:225],v15,50816
 MM v[24:27],v[208:211],a[104:107],v[24:27]
 s_waitcnt lgkmcnt(5)
 s_mov_b32 m0, s94
 TR v[226:227],v15,51328
 MM v[28:31],v[212:215],a[96:99],v[28:31]
 buffer_load_dwordx4 v8, s[52:55], s77 offen offset:0 lds
 MM v[32:35],v[212:215],a[100:103],v[32:35]
 TR v[228:229],v15,50848
 buffer_load_dwordx4 v9, s[52:55], s77 offen offset:1056 lds
 MM v[36:39],v[212:215],a[104:107],v[36:39]
 s_waitcnt lgkmcnt(3)
 TR v[230:231],v15,51360
 MM v[40:43],v[216:219],a[96:99],v[40:43]
 TR v[232:233],v15,50880
 MM v[44:47],v[216:219],a[100:103],v[44:47]
 TR v[234:235],v15,51392
 MM v[48:51],v[216:219],a[104:107],v[48:51]
 buffer_load_dwordx4 v10, s[52:55], s77 offen offset:2112 lds
 MM v[52:55],v[220:223],a[96:99],v[52:55]
 TR v[236:237],v15,50912
 MM v[56:59],v[220:223],a[100:103],v[56:59]
 TR v[238:239],v15,51424
 MM v[60:63],v[220:223],a[104:107],v[60:63]
 s_waitcnt lgkmcnt(4)
 TR v[208:209],v15,50944
 MM v[64:67],v[224:227],a[96:99],v[64:67]
 TR v[210:211],v15,51456
 MM v[68:71],v[224:227],a[100:103],v[68:71]
 buffer_load_dwordx4 v11, s[52:55], s77 offen offset:3168 lds
 MM v[72:75],v[224:227],a[104:107],v[72:75]
 TR v[212:213],v15,50976
 MM v[76:79],v[228:231],a[96:99],v[76:79]
 TR v[214:215],v15,51488
 MM v[80:83],v[228:231],a[100:103],v[80:83]
 s_add_u32 m0, s94, 4224
 s_add_u32 s3, s77, 65536
 TR v[216:217],v15,51008
 MM v[84:87],v[228:231],a[104:107],v[84:87]
 s_waitcnt lgkmcnt(5)
 buffer_load_dwordx4 v8, s[52:55], s3 offen offset:0 lds
 MM v[88:91],v[232:235],a[96:99],v[88:91]
 TR v[218:219],v15,51520
 MM v[92:95],v[232:235],a[100:103],v[92:95]
 TR v[220:221],v15,51040
 MM v[96:99],v[232:235],a[104:107],v[96:99]
 TR v[222:223],v15,51552
 MM v[100:103],v[236:239],a[96:99],v[100:103]
 TR v[224:225],v15,51072
 MM v[104:107],v[236:239],a[100:103],v[104:107]
 buffer_load_dwordx4 v9, s[52:55], s3 offen offset:1056 lds
 MM v[108:111],v[236:239],a[104:107],v[108:111]
 s_waitcnt lgkmcnt(5)
 TR v[226:227],v15,51584
 MM v[112:115],v[208:211],a[96:99],v[112:115]
 TR v[228:229],v15,51104
 MM v[116:119],v[208:211],a[100:103],v[116:119]
 TR v[230:231],v15,51616
 MM v[120:123],v[208:211],a[104:107],v[120:123]
 TR v[232:233],v15,51136
 MM v[124:127],v[212:215],a[96:99],v[124:127]
 buffer_load_dwordx4 v10, s[52:55], s3 offen offset:2112 lds
 MM v[128:131],v[212:215],a[100:103],v[128:131]
 TR v[234:235],v15,51648
 MM v[132:135],v[212:215],a[104:107],v[132:135]
 s_waitcnt lgkmcnt(6)
 TR v[236:237],v15,51168
 MM v[136:139],v[216:219],a[96:99],v[136:139]
 TR v[238:239],v15,51680
 MM v[140:143],v[216:219],a[100:103],v[140:143]
 buffer_load_dwordx4 v11, s[52:55], s3 offen offset:3168 lds
 MM v[144:147],v[216:219],a[104:107],v[144:147]
 s_add_u32 s77, s77, 262144
 s_cmp_ge_u32 s77, 3670016
 s_cselect_b32 s7, 3670016, 0
 s_sub_u32 s77, s77, s7
 MM v[148:151],v[220:223],a[96:99],v[148:151]
 MM v[152:155],v[220:223],a[100:103],v[152:155]
 MM v[156:159],v[220:223],a[104:107],v[156:159]
 s_waitcnt lgkmcnt(6)
 MM v[160:163],v[224:227],a[96:99],v[160:163]
 MM v[164:167],v[224:227],a[100:103],v[164:167]
 MM v[168:171],v[224:227],a[104:107],v[168:171]
 s_waitcnt lgkmcnt(0) vmcnt(16)
 s_barrier
 TR v[208:209],v14,16896
 MM v[172:175],v[228:231],a[96:99],v[172:175]
 TR v[210:211],v14,17408
 MM v[176:179],v[228:231],a[100:103],v[176:179]
 MM v[180:183],v[228:231],a[104:107],v[180:183]
 TR v[212:213],v14,16928
 MM v[184:187],v[232:235],a[96:99],v[184:187]
 TR v[214:215],v14,17440
 MM v[188:191],v[232:235],a[100:103],v[188:191]
 MM v[192:195],v[232:235],a[104:107],v[192:195]
 TR v[216:217],v14,16960
 MM v[196:199],v[236:239],a[96:99],v[196:199]
 TR v[218:219],v14,17472
 MM v[200:203],v[236:239],a[100:103],v[200:203]
 MM v[204:207],v[236:239],a[104:107],v[204:207]
 s_waitcnt lgkmcnt(4)
 TR v[220:221],v14,16992
 MM v[16:19],v[208:211],a[108:111],v[16:19]
 TR v[222:223],v14,17504
 MM v[20:23],v[208:211],a[112:115],v[20:23]
 TR v[224:225],v14,17024
 MM v[24:27],v[208:211],a[116:119],v[24:27]
 s_waitcnt lgkmcnt(5)
 s_mov_b32 m0, s96
 TR v[226:227],v14,17536
 MM v[28:31],v[212:215],a[108:111],v[28:31]
 buffer_load_dwordx4 v8, s[52:55], s77 offen offset:0 lds
 MM v[32:35],v[212:215],a[112:115],v[32:35]
 TR v[228:229],v14,17056
 buffer_load_dwordx4 v9, s[52:55], s77 offen offset:1056 lds
 MM v[36:39],v[212:215],a[116:119],v[36:39]
 s_waitcnt lgkmcnt(3)
 TR v[230:231],v14,17568
 MM v[40:43],v[216:219],a[108:111],v[40:43]
 TR v[232:233],v14,17088
 MM v[44:47],v[216:219],a[112:115],v[44:47]
 TR v[234:235],v14,17600
 MM v[48:51],v[216:219],a[116:119],v[48:51]
 buffer_load_dwordx4 v10, s[52:55], s77 offen offset:2112 lds
 MM v[52:55],v[220:223],a[108:111],v[52:55]
 TR v[236:237],v14,17120
 MM v[56:59],v[220:223],a[112:115],v[56:59]
 TR v[238:239],v14,17632
 MM v[60:63],v[220:223],a[116:119],v[60:63]
 s_waitcnt lgkmcnt(4)
 TR v[208:209],v14,17152
 MM v[64:67],v[224:227],a[108:111],v[64:67]
 TR v[210:211],v14,17664
 MM v[68:71],v[224:227],a[112:115],v[68:71]
 buffer_load_dwordx4 v11, s[52:55], s77 offen offset:3168 lds
 MM v[72:75],v[224:227],a[116:119],v[72:75]
 TR v[212:213],v14,17184
 MM v[76:79],v[228:231],a[108:111],v[76:79]
 TR v[214:215],v14,17696
 MM v[80:83],v[228:231],a[112:115],v[80:83]
 s_add_u32 m0, s96, 4224
 s_add_u32 s3, s77, 65536
 TR v[216:217],v14,17216
 MM v[84:87],v[228:231],a[116:119],v[84:87]
 s_waitcnt lgkmcnt(5)
 buffer_load_dwordx4 v8, s[52:55], s3 offen offset:0 lds
 MM v[88:91],v[232:235],a[108:111],v[88:91]
 TR v[218:219],v14,17728
 MM v[92:95],v[232:235],a[112:115],v[92:95]
 TR v[220:221],v14,17248
 MM v[96:99],v[232:235],a[116:119],v[96:99]
 TR v[222:223],v14,17760
 MM v[100:103],v[236:239],a[108:111],v[100:103]
 TR v[224:225],v14,17280
 MM v[104:107],v[236:239],a[112:115],v[104:107]
 buffer_load_dwordx4 v9, s[52:55], s3 offen offset:1056 lds
 MM v[108:111],v[236:239],a[116:119],v[108:111]
 s_waitcnt lgkmcnt(5)
 TR v[226:227],v14,17792
 MM v[112:115],v[208:211],a[108:111],v[112:115]
 TR v[228:229],v14,17312
 MM v[116:119],v[208:211],a[112:115],v[116:119]
 TR v[230:231],v14,17824
 MM v[120:123],v[208:211],a[116:119],v[120:123]
 TR v[232:233],v14,17344
 MM v[124:127],v[212:215],a[108:111],v[124:127]
 buffer_load_dwordx4 v10, s[52:55], s3 offen offset:2112 lds
 MM v[128:131],v[212:215],a[112:115],v[128:131]
 TR v[234:235],v14,17856
 MM v[132:135],v[212:215],a[116:119],v[132:135]
 s_waitcnt lgkmcnt(6)
 TR v[236:237],v14,17376
 MM v[136:139],v[216:219],a[108:111],v[136:139]
 TR v[238:239],v14,17888
 MM v[140:143],v[216:219],a[112:115],v[140:143]
 buffer_load_dwordx4 v11, s[52:55], s3 offen offset:3168 lds
 MM v[144:147],v[216:219],a[116:119],v[144:147]
 s_add_u32 s77, s77, 262144
 s_cmp_ge_u32 s77, 3670016
 s_cselect_b32 s7, 3670016, 0
 s_sub_u32 s77, s77, s7
 MM v[148:151],v[220:223],a[108:111],v[148:151]
 MM v[152:155],v[220:223],a[112:115],v[152:155]
 MM v[156:159],v[220:223],a[116:119],v[156:159]
 s_waitcnt lgkmcnt(6)
 MM v[160:163],v[224:227],a[108:111],v[160:163]
 MM v[164:167],v[224:227],a[112:115],v[164:167]
 MM v[168:171],v[224:227],a[116:119],v[168:171]
 s_waitcnt lgkmcnt(0) vmcnt(16)
 s_barrier
 TR v[208:209],v14,50688
 MM v[172:175],v[228:231],a[108:111],v[172:175]
 TR v[210:211],v14,51200
 MM v[176:179],v[228:231],a[112:115],v[176:179]
 MM v[180:183],v[228:231],a[116:119],v[180:183]
 TR v[212:213],v14,50720
 MM v[184:187],v[232:235],a[108:111],v[184:187]
 TR v[214:215],v14,51232
 MM v[188:191],v[232:235],a[112:115],v[188:191]
 MM v[192:195],v[232:235],a[116:119],v[192:195]
 TR v[216:217],v14,50752
 MM v[196:199],v[236:239],a[108:111],v[196:199]
 TR v[218:219],v14,51264
 MM v[200:203],v[236:239],a[112:115],v[200:203]
 MM v[204:207],v[236:239],a[116:119],v[204:207]
 s_waitcnt lgkmcnt(4)
 TR v[220:221],v14,50784
 MM v[16:19],v[208:211],a[120:123],v[16:19]
 TR v[222:223],v14,51296
 MM v[20:23],v[208:211],a[124:127],v[20:23]
 TR v[224:225],v14,50816
 MM v[24:27],v[208:211],a[128:131],v[24:27]
 s_waitcnt lgkmcnt(5)
 s_mov_b32 m0, s90
 TR v[226:227],v14,51328
 MM v[28:31],v[212:215],a[120:123],v[28:31]
 buffer_load_dwordx4 v8, s[52:55], s77 offen offset:0 lds
 MM v[32:35],v[212:215],a[124:127],v[32:35]
 TR v[228:229],v14,50848
 buffer_load_dwordx4 v9, s[52:55], s77 offen offset:1056 lds
 MM v[36:39],v[212:215],a[128:131],v[36:39]
 s_waitcnt lgkmcnt(3)
 TR v[230:231],v14,51360
 MM v[40:43],v[216:219],a[120:123],v[40:43]
 TR v[232:233],v14,50880
 MM v[44:47],v[216:219],a[124:127],v[44:47]
 TR v[234:235],v14,51392
 MM v[48:51],v[216:219],a[128:131],v[48:51]
 buffer_load_dwordx4 v10, s[52:55], s77 offen offset:2112 lds
 MM v[52:55],v[220:223],a[120:123],v[52:55]
 TR v[236:237],v14,50912
 MM v[56:59],v[220:223],a[124:127],v[56:59]
 TR v[238:239],v14,51424
 MM v[60:63],v[220:223],a[128:131],v[60:63]
 s_waitcnt lgkmcnt(4)
 TR v[208:209],v14,50944
 MM v[64:67],v[224:227],a[120:123],v[64:67]
 TR v[210:211],v14,51456
 MM v[68:71],v[224:227],a[124:127],v[68:71]
 buffer_load_dwordx4 v11, s[52:55], s77 offen offset:3168 lds
 MM v[72:75],v[224:227],a[128:131],v[72:75]
 TR v[212:213],v14,50976
 MM v[76:79],v[228:231],a[120:123],v[76:79]
 TR v[214:215],v14,51488
 MM v[80:83],v[228:231],a[124:127],v[80:83]
 s_add_u32 m0, s90, 4224
 s_add_u32 s3, s77, 65536
 TR v[216:217],v14,51008
 MM v[84:87],v[228:231],a[128:131],v[84:87]
 s_waitcnt lgkmcnt(5)
 buffer_load_dwordx4 v8, s[52:55], s3 offen offset:0 lds
 MM v[88:91],v[232:235],a[120:123],v[88:91]
 TR v[218:219],v14,51520
 MM v[92:95],v[232:235],a[124:127],v[92:95]
 TR v[220:221],v14,51040
 MM v[96:99],v[232:235],a[128:131],v[96:99]
 TR v[222:223],v14,51552
 MM v[100:103],v[236:239],a[120:123],v[100:103]
 TR v[224:225],v14,51072
 MM v[104:107],v[236:239],a[124:127],v[104:107]
 buffer_load_dwordx4 v9, s[52:55], s3 offen offset:1056 lds
 MM v[108:111],v[236:239],a[128:131],v[108:111]
 s_waitcnt lgkmcnt(5)
 TR v[226:227],v14,51584
 MM v[112:115],v[208:211],a[120:123],v[112:115]
 TR v[228:229],v14,51104
 MM v[116:119],v[208:211],a[124:127],v[116:119]
 TR v[230:231],v14,51616
 MM v[120:123],v[208:211],a[128:131],v[120:123]
 TR v[232:233],v14,51136
 MM v[124:127],v[212:215],a[120:123],v[124:127]
 buffer_load_dwordx4 v10, s[52:55], s3 offen offset:2112 lds
 MM v[128:131],v[212:215],a[124:127],v[128:131]
 TR v[234:235],v14,51648
 MM v[132:135],v[212:215],a[128:131],v[132:135]
 s_waitcnt lgkmcnt(6)
 TR v[236:237],v14,51168
 MM v[136:139],v[216:219],a[120:123],v[136:139]
 TR v[238:239],v14,51680
 MM v[140:143],v[216:219],a[124:127],v[140:143]
 buffer_load_dwordx4 v11, s[52:55], s3 offen offset:3168 lds
 MM v[144:147],v[216:219],a[128:131],v[144:147]
 s_add_u32 s77, s77, 262144
 s_cmp_ge_u32 s77, 3670016
 s_cselect_b32 s7, 3670016, 0
 s_sub_u32 s77, s77, s7
 MM v[148:151],v[220:223],a[120:123],v[148:151]
 MM v[152:155],v[220:223],a[124:127],v[152:155]
 MM v[156:159],v[220:223],a[128:131],v[156:159]
 s_waitcnt lgkmcnt(6)
 MM v[160:163],v[224:227],a[120:123],v[160:163]
 MM v[164:167],v[224:227],a[124:127],v[164:167]
 MM v[168:171],v[224:227],a[128:131],v[168:171]
 s_waitcnt lgkmcnt(0) vmcnt(16)
 s_barrier
 TR v[208:209],v15,16896
 MM v[172:175],v[228:231],a[120:123],v[172:175]
 TR v[210:211],v15,17408
 MM v[176:179],v[228:231],a[124:127],v[176:179]
 MM v[180:183],v[228:231],a[128:131],v[180:183]
 TR v[212:213],v15,16928
 MM v[184:187],v[232:235],a[120:123],v[184:187]
 TR v[214:215],v15,17440
 MM v[188:191],v[232:235],a[124:127],v[188:191]
 MM v[192:195],v[232:235],a[128:131],v[192:195]
 TR v[216:217],v15,16960
 MM v[196:199],v[236:239],a[120:123],v[196:199]
 TR v[218:219],v15,17472
 MM v[200:203],v[236:239],a[124:127],v[200:203]
 MM v[204:207],v[236:239],a[128:131],v[204:207]
 s_waitcnt lgkmcnt(4)
 TR v[220:221],v15,16992
 MM v[16:19],v[208:211],a[132:135],v[16:19]
 TR v[222:223],v15,17504
 MM v[20:23],v[208:211],a[136:139],v[20:23]
 TR v[224:225],v15,17024
 MM v[24:27],v[208:211],a[140:143],v[24:27]
 s_waitcnt lgkmcnt(5)
 s_mov_b32 m0, s92
 TR v[226:227],v15,17536
 MM v[28:31],v[212:215],a[132:135],v[28:31]
 buffer_load_dwordx4 v4, s[36:39], s73 offen offset:0 nt lds
 MM v[32:35],v[212:215],a[136:139],v[32:35]
 TR v[228:229],v15,17056
 buffer_load_dwordx4 v5, s[36:39], s73 offen offset:1056 nt lds
 MM v[36:39],v[212:215],a[140:143],v[36:39]
 s_waitcnt lgkmcnt(3)
 TR v[230:231],v15,17568
 MM v[40:43],v[216:219],a[132:135],v[40:43]
 TR v[232:233],v15,17088
 MM v[44:47],v[216:219],a[136:139],v[44:47]
 TR v[234:235],v15,17600
 MM v[48:51],v[216:219],a[140:143],v[48:51]
 buffer_load_dwordx4 v6, s[36:39], s73 offen offset:2112 nt lds
 MM v[52:55],v[220:223],a[132:135],v[52:55]
 TR v[236:237],v15,17120
 MM v[56:59],v[220:223],a[136:139],v[56:59]
 TR v[238:239],v15,17632
 MM v[60:63],v[220:223],a[140:143],v[60:63]
 s_waitcnt lgkmcnt(4)
 TR v[208:209],v15,17152
 MM v[64:67],v[224:227],a[132:135],v[64:67]
 TR v[210:211],v15,17664
 MM v[68:71],v[224:227],a[136:139],v[68:71]
 buffer_load_dwordx4 v7, s[36:39], s73 offen offset:3168 nt lds
 MM v[72:75],v[224:227],a[140:143],v[72:75]
 TR v[212:213],v15,17184
 MM v[76:79],v[228:231],a[132:135],v[76:79]
 TR v[214:215],v15,17696
 MM v[80:83],v[228:231],a[136:139],v[80:83]
 s_add_u32 m0, s92, 4224
 s_add_u32 s3, s73, 4096
 TR v[216:217],v15,17216
 MM v[84:87],v[228:231],a[140:143],v[84:87]
 s_waitcnt lgkmcnt(5)
 buffer_load_dwordx4 v4, s[36:39], s3 offen offset:0 nt lds
 MM v[88:91],v[232:235],a[132:135],v[88:91]
 TR v[218:219],v15,17728
 MM v[92:95],v[232:235],a[136:139],v[92:95]
 TR v[220:221],v15,17248
 MM v[96:99],v[232:235],a[140:143],v[96:99]
 TR v[222:223],v15,17760
 MM v[100:103],v[236:239],a[132:135],v[100:103]
 TR v[224:225],v15,17280
 MM v[104:107],v[236:239],a[136:139],v[104:107]
 buffer_load_dwordx4 v5, s[36:39], s3 offen offset:1056 nt lds
 MM v[108:111],v[236:239],a[140:143],v[108:111]
 s_waitcnt lgkmcnt(5)
 TR v[226:227],v15,17792
 MM v[112:115],v[208:211],a[132:135],v[112:115]
 TR v[228:229],v15,17312
 MM v[116:119],v[208:211],a[136:139],v[116:119]
 TR v[230:231],v15,17824
 MM v[120:123],v[208:211],a[140:143],v[120:123]
 TR v[232:233],v15,17344
 MM v[124:127],v[212:215],a[132:135],v[124:127]
 buffer_load_dwordx4 v6, s[36:39], s3 offen offset:2112 nt lds
 MM v[128:131],v[212:215],a[136:139],v[128:131]
 TR v[234:235],v15,17856
 MM v[132:135],v[212:215],a[140:143],v[132:135]
 s_waitcnt lgkmcnt(6)
 TR v[236:237],v15,17376
 MM v[136:139],v[216:219],a[132:135],v[136:139]
 TR v[238:239],v15,17888
 MM v[140:143],v[216:219],a[136:139],v[140:143]
 buffer_load_dwordx4 v7, s[36:39], s3 offen offset:3168 nt lds
 MM v[144:147],v[216:219],a[140:143],v[144:147]
 s_add_u32 s73, s73, 16384
 MM v[148:151],v[220:223],a[132:135],v[148:151]
 MM v[152:155],v[220:223],a[136:139],v[152:155]
 MM v[156:159],v[220:223],a[140:143],v[156:159]
 s_waitcnt lgkmcnt(6)
 MM v[160:163],v[224:227],a[132:135],v[160:163]
 MM v[164:167],v[224:227],a[136:139],v[164:167]
 MM v[168:171],v[224:227],a[140:143],v[168:171]
 s_waitcnt lgkmcnt(0) vmcnt(16)
 s_barrier
 TR v[208:209],v15,50688
 MM v[172:175],v[228:231],a[132:135],v[172:175]
 TR v[210:211],v15,51200
 MM v[176:179],v[228:231],a[136:139],v[176:179]
 MM v[180:183],v[228:231],a[140:143],v[180:183]
 TR v[212:213],v15,50720
 MM v[184:187],v[232:235],a[132:135],v[184:187]
 TR v[214:215],v15,51232
 MM v[188:191],v[232:235],a[136:139],v[188:191]
 MM v[192:195],v[232:235],a[140:143],v[192:195]
 TR v[216:217],v15,50752
 MM v[196:199],v[236:239],a[132:135],v[196:199]
 TR v[218:219],v15,51264
 MM v[200:203],v[236:239],a[136:139],v[200:203]
 MM v[204:207],v[236:239],a[140:143],v[204:207]
 s_waitcnt lgkmcnt(4)
 TR v[220:221],v15,50784
 MM v[16:19],v[208:211],a[144:147],v[16:19]
 TR v[222:223],v15,51296
 MM v[20:23],v[208:211],a[148:151],v[20:23]
 TR v[224:225],v15,50816
 MM v[24:27],v[208:211],a[152:155],v[24:27]
 s_waitcnt lgkmcnt(5)
 s_mov_b32 m0, s94
 TR v[226:227],v15,51328
 MM v[28:31],v[212:215],a[144:147],v[28:31]
 buffer_load_dwordx4 v4, s[36:39], s73 offen offset:0 nt lds
 MM v[32:35],v[212:215],a[148:151],v[32:35]
 TR v[228:229],v15,50848
 buffer_load_dwordx4 v5, s[36:39], s73 offen offset:1056 nt lds
 MM v[36:39],v[212:215],a[152:155],v[36:39]
 s_waitcnt lgkmcnt(3)
 TR v[230:231],v15,51360
 MM v[40:43],v[216:219],a[144:147],v[40:43]
 TR v[232:233],v15,50880
 MM v[44:47],v[216:219],a[148:151],v[44:47]
 TR v[234:235],v15,51392
 MM v[48:51],v[216:219],a[152:155],v[48:51]
 buffer_load_dwordx4 v6, s[36:39], s73 offen offset:2112 nt lds
 MM v[52:55],v[220:223],a[144:147],v[52:55]
 TR v[236:237],v15,50912
 MM v[56:59],v[220:223],a[148:151],v[56:59]
 TR v[238:239],v15,51424
 MM v[60:63],v[220:223],a[152:155],v[60:63]
 s_waitcnt lgkmcnt(4)
 TR v[208:209],v15,50944
 MM v[64:67],v[224:227],a[144:147],v[64:67]
 TR v[210:211],v15,51456
 MM v[68:71],v[224:227],a[148:151],v[68:71]
 buffer_load_dwordx4 v7, s[36:39], s73 offen offset:3168 nt lds
 MM v[72:75],v[224:227],a[152:155],v[72:75]
 TR v[212:213],v15,50976
 MM v[76:79],v[228:231],a[144:147],v[76:79]
 TR v[214:215],v15,51488
 MM v[80:83],v[228:231],a[148:151],v[80:83]
 s_add_u32 m0, s94, 4224
 s_add_u32 s3, s73, 4096
 TR v[216:217],v15,51008
 MM v[84:87],v[228:231],a[152:155],v[84:87]
 s_waitcnt lgkmcnt(5)
 buffer_load_dwordx4 v4, s[36:39], s3 offen offset:0 nt lds
 MM v[88:91],v[232:235],a[144:147],v[88:91]
 TR v[218:219],v15,51520
 MM v[92:95],v[232:235],a[148:151],v[92:95]
 TR v[220:221],v15,51040
 MM v[96:99],v[232:235],a[152:155],v[96:99]
 TR v[222:223],v15,51552
 MM v[100:103],v[236:239],a[144:147],v[100:103]
 TR v[224:225],v15,51072
 MM v[104:107],v[236:239],a[148:151],v[104:107]
 buffer_load_dwordx4 v5, s[36:39], s3 offen offset:1056 nt lds
 MM v[108:111],v[236:239],a[152:155],v[108:111]
 s_waitcnt lgkmcnt(5)
 TR v[226:227],v15,51584
 MM v[112:115],v[208:211],a[144:147],v[112:115]
 TR v[228:229],v15,51104
 MM v[116:119],v[208:211],a[148:151],v[116:119]
 TR v[230:231],v15,51616
 MM v[120:123],v[208:211],a[152:155],v[120:123]
 TR v[232:233],v15,51136
 MM v[124:127],v[212:215],a[144:147],v[124:127]
 buffer_load_dwordx4 v6, s[36:39], s3 offen offset:2112 nt lds
 MM v[128:131],v[212:215],a[148:151],v[128:131]
 TR v[234:235],v15,51648
 MM v[132:135],v[212:215],a[152:155],v[132:135]
 s_waitcnt lgkmcnt(6)
 TR v[236:237],v15,51168
 MM v[136:139],v[216:219],a[144:147],v[136:139]
 TR v[238:239],v15,51680
 MM v[140:143],v[216:219],a[148:151],v[140:143]
 buffer_load_dwordx4 v7, s[36:39], s3 offen offset:3168 nt lds
 MM v[144:147],v[216:219],a[152:155],v[144:147]
 s_add_u32 s73, s73, 16384
 MM v[148:151],v[220:223],a[144:147],v[148:151]
 MM v[152:155],v[220:223],a[148:151],v[152:155]
 MM v[156:159],v[220:223],a[152:155],v[156:159]
 s_waitcnt lgkmcnt(6)
 MM v[160:163],v[224:227],a[144:147],v[160:163]
 MM v[164:167],v[224:227],a[148:151],v[164:167]
 MM v[168:171],v[224:227],a[152:155],v[168:171]
 s_waitcnt lgkmcnt(0) vmcnt(16)
 s_barrier
 TR v[208:209],v14,16896
 MM v[172:175],v[228:231],a[144:147],v[172:175]
 TR v[210:211],v14,17408
 MM v[176:179],v[228:231],a[148:151],v[176:179]
 MM v[180:183],v[228:231],a[152:155],v[180:183]
 TR v[212:213],v14,16928
 MM v[184:187],v[232:235],a[144:147],v[184:187]
 TR v[214:215],v14,17440
 MM v[188:191],v[232:235],a[148:151],v[188:191]
 MM v[192:195],v[232:235],a[152:155],v[192:195]
 TR v[216:217],v14,16960
 MM v[196:199],v[236:239],a[144:147],v[196:199]
 TR v[218:219],v14,17472
 MM v[200:203],v[236:239],a[148:151],v[200:203]
 MM v[204:207],v[236:239],a[152:155],v[204:207]
 s_waitcnt lgkmcnt(4)
 TR v[220:221],v14,16992
 MM v[16:19],v[208:211],a[156:159],v[16:19]
 TR v[222:223],v14,17504
 MM v[20:23],v[208:211],a[160:163],v[20:23]
 TR v[224:225],v14,17024
 MM v[24:27],v[208:211],a[164:167],v[24:27]
 s_waitcnt lgkmcnt(5)
 s_mov_b32 m0, s96
 TR v[226:227],v14,17536
 MM v[28:31],v[212:215],a[156:159],v[28:31]
 buffer_load_dwordx4 v4, s[44:47], s75 offen offset:0 nt lds
 MM v[32:35],v[212:215],a[160:163],v[32:35]
 TR v[228:229],v14,17056
 buffer_load_dwordx4 v5, s[44:47], s75 offen offset:1056 nt lds
 MM v[36:39],v[212:215],a[164:167],v[36:39]
 s_waitcnt lgkmcnt(3)
 TR v[230:231],v14,17568
 MM v[40:43],v[216:219],a[156:159],v[40:43]
 TR v[232:233],v14,17088
 MM v[44:47],v[216:219],a[160:163],v[44:47]
 TR v[234:235],v14,17600
 MM v[48:51],v[216:219],a[164:167],v[48:51]
 buffer_load_dwordx4 v6, s[44:47], s75 offen offset:2112 nt lds
 CV v16,v16,v17
 CV v17,v18,v19
 CV v18,v28,v29
 CV v19,v30,v31
 MM v[52:55],v[220:223],a[156:159],v[52:55]
 TR v[236:237],v14,17120
 CV v20,v20,v21
 CV v21,v22,v23
 CV v22,v32,v33
 CV v23,v34,v35
 MM v[56:59],v[220:223],a[160:163],v[56:59]
 TR v[238:239],v14,17632
 CV v24,v24,v25
 CV v25,v26,v27
 CV v26,v36,v37
 CV v27,v38,v39
 MM v[60:63],v[220:223],a[164:167],v[60:63]
 s_waitcnt lgkmcnt(4)
 TR v[208:209],v14,17152
 v_permlane32_swap_b32 v16, v18
 MM v[64:67],v[224:227],a[156:159],v[64:67]
 TR v[210:211],v14,17664
 v_permlane32_swap_b32 v17, v19
 v_permlane32_swap_b32 v20, v22
 MM v[68:71],v[224:227],a[160:163],v[68:71]
 buffer_load_dwordx4 v7, s[44:47], s75 offen offset:3168 nt lds
 v_permlane32_swap_b32 v21, v23
 v_permlane32_swap_b32 v24, v26
 MM v[72:75],v[224:227],a[164:167],v[72:75]
 TR v[212:213],v14,17184
 v_permlane32_swap_b32 v25, v27
 v_permlane16_swap_b32 v16, v18
 MM v[76:79],v[228:231],a[156:159],v[76:79]
 TR v[214:215],v14,17696
 v_permlane16_swap_b32 v17, v19
 v_permlane16_swap_b32 v20, v22
 MM v[80:83],v[228:231],a[160:163],v[80:83]
 s_add_u32 m0, s96, 4224
 s_add_u32 s3, s75, 4096
 TR v[216:217],v14,17216
 v_permlane16_swap_b32 v21, v23
 MM v[84:87],v[228:231],a[164:167],v[84:87]
 s_waitcnt lgkmcnt(5)
 buffer_load_dwordx4 v4, s[44:47], s3 offen offset:0 nt lds
 v_permlane16_swap_b32 v24, v26
 v_permlane16_swap_b32 v25, v27
 MM v[88:91],v[232:235],a[156:159],v[88:91]
 TR v[218:219],v14,17728
 CV v28,v40,v41
 CV v29,v42,v43
 CV v30,v52,v53
 CV v31,v54,v55
 MM v[92:95],v[232:235],a[160:163],v[92:95]
 TR v[220:221],v14,17248
 CV v32,v44,v45
 CV v33,v46,v47
 CV v34,v56,v57
 CV v35,v58,v59
 MM v[96:99],v[232:235],a[164:167],v[96:99]
 TR v[222:223],v14,17760
 CV v36,v48,v49
 CV v37,v50,v51
 CV v38,v60,v61
 MM v[100:103],v[236:239],a[156:159],v[100:103]
 TR v[224:225],v14,17280
 CV v39,v62,v63
 v_permlane32_swap_b32 v28, v30
 MM v[104:107],v[236:239],a[160:163],v[104:107]
 buffer_load_dwordx4 v5, s[44:47], s3 offen offset:1056 nt lds
 v_permlane32_swap_b32 v29, v31
 v_permlane32_swap_b32 v32, v34
 MM v[108:111],v[236:239],a[164:167],v[108:111]
 s_waitcnt lgkmcnt(5)
 TR v[226:227],v14,17792
 v_permlane32_swap_b32 v33, v35
 v_permlane32_swap_b32 v36, v38
 MM v[112:115],v[208:211],a[156:159],v[112:115]
 TR v[228:229],v14,17312
 v_permlane32_swap_b32 v37, v39
 v_permlane16_swap_b32 v28, v30
 MM v[116:119],v[208:211],a[160:163],v[116:119]
 TR v[230:231],v14,17824
 v_permlane16_swap_b32 v29, v31
 MM v[120:123],v[208:211],a[164:167],v[120:123]
 TR v[232:233],v14,17344
 v_permlane16_swap_b32 v32, v34
 v_permlane16_swap_b32 v33, v35
 MM v[124:127],v[212:215],a[156:159],v[124:127]
 buffer_load_dwordx4 v6, s[44:47], s3 offen offset:2112 nt lds
 v_permlane16_swap_b32 v36, v38
 v_permlane16_swap_b32 v37, v39
 MM v[128:131],v[212:215],a[160:163],v[128:131]
 TR v[234:235],v14,17856
 CV v40,v64,v65
 CV v41,v66,v67
 CV v42,v76,v77
 MM v[132:135],v[212:215],a[164:167],v[132:135]
 s_waitcnt lgkmcnt(6)
 TR v[236:237],v14,17376
 CV v43,v78,v79
 CV v44,v68,v69
 CV v45,v70,v71
 MM v[136:139],v[216:219],a[156:159],v[136:139]
 TR v[238:239],v14,17888
 CV v46,v80,v81
 CV v47,v82,v83
 CV v48,v72,v73
 MM v[140:143],v[216:219],a[160:163],v[140:143]
 buffer_load_dwordx4 v7, s[44:47], s3 offen offset:3168 nt lds
 CV v49,v74,v75
 CV v50,v84,v85
 CV v51,v86,v87
 MM v[144:147],v[216:219],a[164:167],v[144:147]
 s_add_u32 s75, s75, 16384
 v_permlane32_swap_b32 v40, v42
 v_permlane32_swap_b32 v41, v43
 MM v[148:151],v[220:223],a[156:159],v[148:151]
 v_permlane32_swap_b32 v44, v46
 v_permlane32_swap_b32 v45, v47
 MM v[152:155],v[220:223],a[160:163],v[152:155]
 v_permlane32_swap_b32 v48, v50
 v_permlane32_swap_b32 v49, v51
 MM v[156:159],v[220:223],a[164:167],v[156:159]
 s_waitcnt lgkmcnt(6)
 v_permlane16_swap_b32 v40, v42
 v_permlane16_swap_b32 v41, v43
 MM v[160:163],v[224:227],a[156:159],v[160:163]
 v_permlane16_swap_b32 v44, v46
 v_permlane16_swap_b32 v45, v47
 MM v[164:167],v[224:227],a[160:163],v[164:167]
 v_permlane16_swap_b32 v48, v50
 v_permlane16_swap_b32 v49, v51
 MM v[168:171],v[224:227],a[164:167],v[168:171]
 s_waitcnt lgkmcnt(0) vmcnt(16)
 s_barrier
 ds_read_b128 v[208:211], v12 offset:50688
 CV v64,v112,v113
 CV v65,v114,v115
 MM v[172:175],v[228:231],a[156:159],v[172:175]
 CV v66,v124,v125
 CV v67,v126,v127
 CV v68,v116,v117
 CV v69,v118,v119
 CV v70,v128,v129
 MM v[176:179],v[228:231],a[160:163],v[176:179]
 CV v71,v130,v131
 CV v72,v120,v121
 CV v73,v122,v123
 CV v74,v132,v133
 CV v75,v134,v135
 MM v[180:183],v[228:231],a[164:167],v[180:183]
 ds_read_b128 v[212:215], v12 offset:51200
 v_permlane32_swap_b32 v64, v66
 v_permlane32_swap_b32 v65, v67
 MM v[184:187],v[232:235],a[156:159],v[184:187]
 v_permlane32_swap_b32 v68, v70
 v_permlane32_swap_b32 v69, v71
 MM v[188:191],v[232:235],a[160:163],v[188:191]
 v_permlane32_swap_b32 v72, v74
 v_permlane32_swap_b32 v73, v75
 MM v[192:195],v[232:235],a[164:167],v[192:195]
 ds_read_b128 v[216:219], v12 offset:50752
 v_permlane16_swap_b32 v64, v66
 v_permlane16_swap_b32 v65, v67
 MM v[196:199],v[236:239],a[156:159],v[196:199]
 v_permlane16_swap_b32 v68, v70
 v_permlane16_swap_b32 v69, v71
 MM v[200:203],v[236:239],a[160:163],v[200:203]
 v_permlane16_swap_b32 v72, v74
 v_permlane16_swap_b32 v73, v75
 MM v[204:207],v[236:239],a[164:167],v[204:207]
 s_waitcnt lgkmcnt(2)
 ds_read_b128 v[220:223], v12 offset:51264
 CV v52,v88,v89
 CV v53,v90,v91
 CV v54,v100,v101
 CV v55,v102,v103
 MM v[112:115],v[208:211],v[16:19],0
 s_mov_b32 m0, s90
 CV v56,v92,v93
 CV v57,v94,v95
 CV v58,v104,v105
 CV v59,v106,v107
 MM v[116:119],v[208:211],v[20:23],0
 ds_read_b128 v[224:227], v12 offset:50816
 buffer_load_dwordx4 v4, s[36:39], s73 offen offset:0 nt lds
 CV v60,v96,v97
 CV v61,v98,v99
 MM v[120:123],v[208:211],v[24:27],0
 s_waitcnt lgkmcnt(3)
 CV v62,v108,v109
 CV v63,v110,v111
 v_permlane32_swap_b32 v52, v54
 MM v[124:127],v[212:215],v[16:19],0
 v_permlane32_swap_b32 v53, v55
 v_permlane32_swap_b32 v56, v58
 MM v[128:131],v[212:215],v[20:23],0
 ds_read_b128 v[228:231], v12 offset:51328
 buffer_load_dwordx4 v5, s[36:39], s73 offen offset:1056 nt lds
 v_permlane32_swap_b32 v57, v59
 MM v[132:135],v[212:215],v[24:27],0
 s_waitcnt lgkmcnt(2)
 v_permlane32_swap_b32 v60, v62
 v_permlane32_swap_b32 v61, v63
 MM v[112:115],v[216:219],v[28:31],v[112:115]
 ds_read_b128 v[232:235], v12 offset:50880
 v_permlane16_swap_b32 v52, v54
 v_permlane16_swap_b32 v53, v55
 MM v[116:119],v[216:219],v[32:35],v[116:119]
 v_permlane16_swap_b32 v56, v58
 v_permlane16_swap_b32 v57, v59
 MM v[120:123],v[216:219],v[36:39],v[120:123]
 v_permlane16_swap_b32 v60, v62
 v_permlane16_swap_b32 v61, v63
 MM v[124:127],v[220:223],v[28:31],v[124:127]
 ds_read_b128 v[236:239], v12 offset:51392
 buffer_load_dwordx4 v6, s[36:39], s73 offen offset:2112 nt lds
 CV v76,v136,v137
 CV v77,v138,v139
 CV v78,v148,v149
 MM v[128:131],v[220:223],v[32:35],v[128:131]
 CV v79,v150,v151
 CV v80,v140,v141
 CV v81,v142,v143
 CV v82,v152,v153
 MM v[132:135],v[220:223],v[36:39],v[132:135]
 s_waitcnt lgkmcnt(2)
 ds_read_b128 v[208:211], v12 offset:50944
 CV v83,v154,v155
 CV v84,v144,v145
 CV v85,v146,v147
 CV v86,v156,v157
 MM v[112:115],v[224:227],v[40:43],v[112:115]
 CV v87,v158,v159
 v_permlane32_swap_b32 v76, v78
 MM v[116:119],v[224:227],v[44:47],v[116:119]
 v_permlane32_swap_b32 v77, v79
 v_permlane32_swap_b32 v80, v82
 MM v[120:123],v[224:227],v[48:51],v[120:123]
 ds_read_b128 v[212:215], v12 offset:51456
 buffer_load_dwordx4 v7, s[36:39], s73 offen offset:3168 nt lds
 v_permlane32_swap_b32 v81, v83
 MM v[124:127],v[228:231],v[40:43],v[124:127]
 v_permlane32_swap_b32 v84, v86
 v_permlane32_swap_b32 v85, v87
 MM v[128:131],v[228:231],v[44:47],v[128:131]
 ds_read_b128 v[216:219], v12 offset:51008
 v_permlane16_swap_b32 v76, v78
 v_permlane16_swap_b32 v77, v79
 MM v[132:135],v[228:231],v[48:51],v[132:135]
 s_waitcnt lgkmcnt(3)
 v_permlane16_swap_b32 v80, v82
 v_permlane16_swap_b32 v81, v83
 MM v[112:115],v[232:235],v[52:55],v[112:115]
 s_add_u32 m0, s90, 4224
 s_add_u32 s3, s73, 4096
 v_permlane16_swap_b32 v84, v86
 v_permlane16_swap_b32 v85, v87
 MM v[116:119],v[232:235],v[56:59],v[116:119]
 ds_read_b128 v[220:223], v12 offset:51520
 buffer_load_dwordx4 v4, s[36:39], s3 offen offset:0 nt lds
 CV v88,v160,v161
 CV v89,v162,v163
 CV v90,v172,v173
 MM v[120:123],v[232:235],v[60:63],v[120:123]
 CV v91,v174,v175
 CV v92,v164,v165
 CV v93,v166,v167
 CV v94,v176,v177
 CV v95,v178,v179
 MM v[124:127],v[236:239],v[52:55],v[124:127]
 ds_read_b128 v[224:227], v12 offset:51072
 buffer_load_dwordx4 v5, s[36:39], s3 offen offset:1056 nt lds
 CV v96,v168,v169
 CV v97,v170,v171
 CV v98,v180,v181
 MM v[128:131],v[236:239],v[56:59],v[128:131]
 CV v99,v182,v183
 v_permlane32_swap_b32 v88, v90
 MM v[132:135],v[236:239],v[60:63],v[132:135]
 s_waitcnt lgkmcnt(3)
 v_permlane32_swap_b32 v89, v91
 v_permlane32_swap_b32 v92, v94
 MM v[112:115],v[208:211],v[64:67],v[112:115]
 ds_read_b128 v[228:231], v12 offset:51584
 v_permlane32_swap_b32 v93, v95
 v_permlane32_swap_b32 v96, v98
 MM v[116:119],v[208:211],v[68:71],v[116:119]
 v_permlane32_swap_b32 v97, v99
 v_permlane16_swap_b32 v88, v90
 MM v[120:123],v[208:211],v[72:75],v[120:123]
 ds_read_b128 v[232:235], v12 offset:51136
 buffer_load_dwordx4 v6, s[36:39], s3 offen offset:2112 nt lds
 v_permlane16_swap_b32 v89, v91
 MM v[124:127],v[212:215],v[64:67],v[124:127]
 v_permlane16_swap_b32 v92, v94
 v_permlane16_swap_b32 v93, v95
 MM v[128:131],v[212:215],v[68:71],v[128:131]
 v_permlane16_swap_b32 v96, v98
 v_permlane16_swap_b32 v97, v99
 MM v[132:135],v[212:215],v[72:75],v[132:135]
 s_waitcnt lgkmcnt(3)
 ds_read_b128 v[236:239], v12 offset:51648
 buffer_load_dwordx4 v7, s[36:39], s3 offen offset:3168 nt lds
 CV v100,v184,v185
 CV v101,v186,v187
 CV v102,v196,v197
 MM v[112:115],v[216:219],v[76:79],v[112:115]
 s_add_u32 s73, s73, 16384
 CV v103,v198,v199
 CV v104,v188,v189
 CV v105,v190,v191
 CV v106,v200,v201
 MM v[116:119],v[216:219],v[80:83],v[116:119]
 CV v107,v202,v203
 CV v108,v192,v193
 CV v109,v194,v195
 CV v110,v204,v205
 MM v[120:123],v[216:219],v[84:87],v[120:123]
 CV v111,v206,v207
 v_permlane32_swap_b32 v100, v102
 MM v[124:127],v[220:223],v[76:79],v[124:127]
 v_permlane32_swap_b32 v101, v103
 v_permlane32_swap_b32 v104, v106
 MM v[128:131],v[220:223],v[80:83],v[128:131]
 v_permlane32_swap_b32 v105, v107
 v_permlane32_swap_b32 v108, v110
 MM v[132:135],v[220:223],v[84:87],v[132:135]
 s_waitcnt lgkmcnt(3)
 v_permlane32_swap_b32 v109, v111
 v_permlane16_swap_b32 v100, v102
 MM v[112:115],v[224:227],v[88:91],v[112:115]
 v_permlane16_swap_b32 v101, v103
 v_permlane16_swap_b32 v104, v106
 MM v[116:119],v[224:227],v[92:95],v[116:119]
 v_permlane16_swap_b32 v105, v107
 v_permlane16_swap_b32 v108, v110
 MM v[120:123],v[224:227],v[96:99],v[120:123]
 s_waitcnt lgkmcnt(0) vmcnt(16)
 s_barrier
 ds_read_b128 v[208:211], v13 offset:16896
 v_permlane16_swap_b32 v109, v111
 MM v[124:127],v[228:231],v[88:91],v[124:127]
 MM v[128:131],v[228:231],v[92:95],v[128:131]
 MM v[132:135],v[228:231],v[96:99],v[132:135]
 ds_read_b128 v[212:215], v13 offset:16960
 MM v[112:115],v[232:235],v[100:103],v[112:115]
 MM v[116:119],v[232:235],v[104:107],v[116:119]
 MM v[120:123],v[232:235],v[108:111],v[120:123]
 ds_read_b128 v[216:219], v13 offset:17024
 MM v[124:127],v[236:239],v[100:103],v[124:127]
 MM v[128:131],v[236:239],v[104:107],v[128:131]
 MM v[132:135],v[236:239],v[108:111],v[132:135]
 s_nop 1
 v_max3_f32 v196, v112, v113, v114
 s_nop 2
 v_max3_f32 v196, v196, v115, v124
 v_max3_f32 v196, v196, v125, v126
 v_max_f32 v196, v196, v127
 v_max3_f32 v197, v116, v117, v118
 v_max3_f32 v197, v197, v119, v128
 v_max3_f32 v197, v197, v129, v130
 v_max_f32 v197, v197, v131
 v_max3_f32 v198, v120, v121, v122
 v_max3_f32 v198, v198, v123, v132
 v_max3_f32 v198, v198, v133, v134
 v_max_f32 v198, v198, v135
 v_mov_b32 v200, v196
 v_mov_b32 v201, v197
 v_mov_b32 v202, v198
 v_permlane32_swap_b32 v196, v200
 v_permlane32_swap_b32 v197, v201
 v_permlane32_swap_b32 v198, v202
 v_max_f32 v196, v196, v200
 v_max_f32 v197, v197, v201
 v_max_f32 v198, v198, v202
 v_mov_b32 v200, v196
 v_mov_b32 v201, v197
 v_mov_b32 v202, v198
 v_permlane16_swap_b32 v196, v200
 v_permlane16_swap_b32 v197, v201
 v_permlane16_swap_b32 v198, v202
 v_max_f32 v196, v196, v200
 v_max_f32 v197, v197, v201
 v_max_f32 v198, v198, v202
 v_mul_f32 v184, s82, v196
 v_mul_f32 v185, s82, v197
 v_mul_f32 v186, s82, v198
 v_sub_f32 v184, 0, v184
 v_sub_f32 v185, 0, v185
 v_sub_f32 v186, 0, v186
 v_fma_f32 v112, v112, s82, v184
 v_fma_f32 v113, v113, s82, v184
 v_fma_f32 v114, v114, s82, v184
 v_fma_f32 v115, v115, s82, v184
 v_fma_f32 v116, v116, s82, v185
 v_fma_f32 v117, v117, s82, v185
 v_fma_f32 v118, v118, s82, v185
 v_fma_f32 v119, v119, s82, v185
 v_fma_f32 v120, v120, s82, v186
 v_fma_f32 v121, v121, s82, v186
 v_fma_f32 v122, v122, s82, v186
 v_fma_f32 v123, v123, s82, v186
 v_fma_f32 v124, v124, s82, v184
 v_fma_f32 v125, v125, s82, v184
 v_fma_f32 v126, v126, s82, v184
 v_fma_f32 v127, v127, s82, v184
 v_fma_f32 v128, v128, s82, v185
 v_fma_f32 v129, v129, s82, v185
 v_fma_f32 v130, v130, s82, v185
 v_fma_f32 v131, v131, s82, v185
 v_fma_f32 v132, v132, s82, v186
 v_fma_f32 v133, v133, s82, v186
 v_fma_f32 v134, v134, s82, v186
 v_fma_f32 v135, v135, s82, v186
 s_waitcnt lgkmcnt(2)
 ds_read_b128 v[220:223], v13 offset:17088
 MM v[136:139],v[208:211],v[16:19],0
 s_mov_b32 m0, s92
 v_exp_f32 v112, v112
 MM v[140:143],v[208:211],v[20:23],0
 ds_read_b128 v[224:227], v13 offset:17152
 buffer_load_dwordx4 v4, s[44:47], s75 offen offset:0 nt lds
 MM v[144:147],v[208:211],v[24:27],0
 s_waitcnt lgkmcnt(3)
 v_exp_f32 v113, v113
 MM v[136:139],v[212:215],v[28:31],v[136:139]
 v_exp_f32 v114, v114
 MM v[140:143],v[212:215],v[32:35],v[140:143]
 ds_read_b128 v[228:231], v13 offset:17216
 buffer_load_dwordx4 v5, s[44:47], s75 offen offset:1056 nt lds
 MM v[144:147],v[212:215],v[36:39],v[144:147]
 s_waitcnt lgkmcnt(2)
 v_exp_f32 v115, v115
 MM v[136:139],v[216:219],v[40:43],v[136:139]
 ds_read_b128 v[232:235], v13 offset:17280
 CV v160,v112,v113
 MM v[140:143],v[216:219],v[44:47],v[140:143]
 v_exp_f32 v124, v124
 MM v[144:147],v[216:219],v[48:51],v[144:147]
 v_exp_f32 v125, v125
 MM v[136:139],v[220:223],v[52:55],v[136:139]
 ds_read_b128 v[236:239], v13 offset:17344
 buffer_load_dwordx4 v6, s[44:47], s75 offen offset:2112 nt lds
 MM v[140:143],v[220:223],v[56:59],v[140:143]
 CV v161,v114,v115
 CV v162,v124,v125
 MM v[144:147],v[220:223],v[60:63],v[144:147]
 s_waitcnt lgkmcnt(2)
 ds_read_b128 v[208:211], v13 offset:17408
 MM v[136:139],v[224:227],v[64:67],v[136:139]
 v_exp_f32 v126, v126
 MM v[140:143],v[224:227],v[68:71],v[140:143]
 v_exp_f32 v127, v127
 MM v[144:147],v[224:227],v[72:75],v[144:147]
 ds_read_b128 v[212:215], v13 offset:17472
 buffer_load_dwordx4 v7, s[44:47], s75 offen offset:3168 nt lds
 MM v[136:139],v[228:231],v[76:79],v[136:139]
 v_exp_f32 v116, v116
 MM v[140:143],v[228:231],v[80:83],v[140:143]
 ds_read_b128 v[216:219], v13 offset:17536
 CV v163,v126,v127
 MM v[144:147],v[228:231],v[84:87],v[144:147]
 s_waitcnt lgkmcnt(3)
 v_exp_f32 v117, v117
 MM v[136:139],v[232:235],v[88:91],v[136:139]
 s_add_u32 m0, s92, 4224
 s_add_u32 s3, s75, 4096
 CV v164,v116,v117
 MM v[140:143],v[232:235],v[92:95],v[140:143]
 ds_read_b128 v[220:223], v13 offset:17600
 buffer_load_dwordx4 v4, s[44:47], s3 offen offset:0 nt lds
 MM v[144:147],v[232:235],v[96:99],v[144:147]
 v_exp_f32 v118, v118
 MM v[136:139],v[236:239],v[100:103],v[136:139]
 ds_read_b128 v[224:227], v13 offset:17664
 buffer_load_dwordx4 v5, s[44:47], s3 offen offset:1056 nt lds
 MM v[140:143],v[236:239],v[104:107],v[140:143]
 v_exp_f32 v119, v119
 MM v[144:147],v[236:239],v[108:111],v[144:147]
 s_waitcnt lgkmcnt(3)
 v_exp_f32 v128, v128
 MM v[148:151],v[208:211],v[16:19],0
 ds_read_b128 v[228:231], v13 offset:17728
 CV v165,v118,v119
 MM v[152:155],v[208:211],v[20:23],0
 v_exp_f32 v129, v129
 MM v[156:159],v[208:211],v[24:27],0
 ds_read_b128 v[232:235], v13 offset:17792
 buffer_load_dwordx4 v6, s[44:47], s3 offen offset:2112 nt lds
 MM v[148:151],v[212:215],v[28:31],v[148:151]
 v_exp_f32 v130, v130
 MM v[152:155],v[212:215],v[32:35],v[152:155]
 v_exp_f32 v131, v131
 MM v[156:159],v[212:215],v[36:39],v[156:159]
 s_waitcnt lgkmcnt(3)
 ds_read_b128 v[236:239], v13 offset:17856
 buffer_load_dwordx4 v7, s[44:47], s3 offen offset:3168 nt lds
 MM v[148:151],v[216:219],v[40:43],v[148:151]
 s_add_u32 s75, s75, 16384
 CV v166,v128,v129
 CV v167,v130,v131
 MM v[152:155],v[216:219],v[44:47],v[152:155]
 v_exp_f32 v120, v120
 MM v[156:159],v[216:219],v[48:51],v[156:159]
 v_exp_f32 v121, v121
 MM v[148:151],v[220:223],v[52:55],v[148:151]
 v_exp_f32 v122, v122
 MM v[152:155],v[220:223],v[56:59],v[152:155]
 v_exp_f32 v123, v123
 MM v[156:159],v[220:223],v[60:63],v[156:159]
 s_waitcnt lgkmcnt(3)
 CV v168,v120,v121
 CV v169,v122,v123
 MM v[148:151],v[224:227],v[64:67],v[148:151]
 v_exp_f32 v132, v132
 MM v[152:155],v[224:227],v[68:71],v[152:155]
 v_exp_f32 v133, v133
 MM v[156:159],v[224:227],v[72:75],v[156:159]
 s_waitcnt lgkmcnt(0) vmcnt(16)
 s_barrier
 TR v[208:209],v15,50688
 MM v[148:151],v[228:231],v[76:79],v[148:151]
 TR v[210:211],v15,51200
 CV v170,v132,v133
 MM v[152:155],v[228:231],v[80:83],v[152:155]
 v_exp_f32 v134, v134
 MM v[156:159],v[228:231],v[84:87],v[156:159]
 TR v[212:213],v15,50720
 TR v[214:215],v15,51232
 MM v[148:151],v[232:235],v[88:91],v[148:151]
 v_exp_f32 v135, v135
 MM v[152:155],v[232:235],v[92:95],v[152:155]
 CV v171,v134,v135
 MM v[156:159],v[232:235],v[96:99],v[156:159]
 TR v[216:217],v15,50752
 TR v[218:219],v15,51264
 MM v[148:151],v[236:239],v[100:103],v[148:151]
 MM v[152:155],v[236:239],v[104:107],v[152:155]
 MM v[156:159],v[236:239],v[108:111],v[156:159]
 MM a[192:195],a[204:207],v[160:163],0
 MM a[196:199],a[204:207],v[164:167],0
 MM a[200:203],a[204:207],v[168:171],0
 s_waitcnt lgkmcnt(4)
 TR v[220:221],v15,50784
 MM a[0:3],v[208:211],v[160:163],0
 TR v[222:223],v15,51296
 v_fma_f32 v136, v136, s82, v184
 MM a[4:7],v[208:211],v[164:167],0
 TR v[224:225],v15,50816
 v_fma_f32 v137, v137, s82, v184
 MM a[8:11],v[208:211],v[168:171],0
 s_waitcnt lgkmcnt(5)
 s_mov_b32 m0, s94
 TR v[226:227],v15,51328
 MM a[12:15],v[212:215],v[160:163],0
 buffer_load_dwordx4 v4, s[36:39], s73 offen offset:0 nt lds
 v_fma_f32 v138, v138, s82, v184
 MM a[16:19],v[212:215],v[164:167],0
 TR v[228:229],v15,50848
 buffer_load_dwordx4 v5, s[36:39], s73 offen offset:1056 nt lds
 MM a[20:23],v[212:215],v[168:171],0
 s_waitcnt lgkmcnt(3)
 TR v[230:231],v15,51360
 v_fma_f32 v139, v139, s82, v184
 MM a[24:27],v[216:219],v[160:163],0
 TR v[232:233],v15,50880
 MM a[28:31],v[216:219],v[164:167],0
 TR v[234:235],v15,51392
 v_fma_f32 v140, v140, s82, v185
 MM a[32:35],v[216:219],v[168:171],0
 buffer_load_dwordx4 v6, s[36:39], s73 offen offset:2112 nt lds
 v_fma_f32 v141, v141, s82, v185
 MM a[36:39],v[220:223],v[160:163],0
 TR v[236:237],v15,50912
 v_fma_f32 v142, v142, s82, v185
 MM a[40:43],v[220:223],v[164:167],0
 TR v[238:239],v15,51424
 MM a[44:47],v[220:223],v[168:171],0
 s_waitcnt lgkmcnt(4)
 TR v[208:209],v15,50944
 v_fma_f32 v143, v143, s82, v185
 MM a[48:51],v[224:227],v[160:163],0
 TR v[210:211],v15,51456
 v_max3_f32 v253, v136, v137, v138
 MM a[52:55],v[224:227],v[164:167],0
 buffer_load_dwordx4 v7, s[36:39], s73 offen offset:3168 nt lds
 v_max3_f32 v254, v139, v140, v141
 MM a[56:59],v[224:227],v[168:171],0
 TR v[212:213],v15,50976
 v_fma_f32 v144, v144, s82, v186
 MM a[60:63],v[228:231],v[160:163],0
 TR v[214:215],v15,51488
 MM a[64:67],v[228:231],v[164:167],0
 s_add_u32 m0, s94, 4224
 s_add_u32 s3, s73, 4096
 TR v[216:217],v15,51008
 MM a[68:71],v[228:231],v[168:171],0
 s_waitcnt lgkmcnt(5)
 buffer_load_dwordx4 v4, s[36:39], s3 offen offset:0 nt lds
 v_fma_f32 v145, v145, s82, v186
 MM a[72:75],v[232:235],v[160:163],0
 TR v[218:219],v15,51520
 v_max3_f32 v253, v253, v142, v143
 MM a[76:79],v[232:235],v[164:167],0
 TR v[220:221],v15,51040
 v_fma_f32 v146, v146, s82, v186
 MM a[80:83],v[232:235],v[168:171],0
 TR v[222:223],v15,51552
 MM a[84:87],v[236:239],v[160:163],0
 TR v[224:225],v15,51072
 v_fma_f32 v147, v147, s82, v186
 MM a[88:91],v[236:239],v[164:167],0
 buffer_load_dwordx4 v5, s[36:39], s3 offen offset:1056 nt lds
 v_max3_f32 v254, v254, v144, v145
 MM a[92:95],v[236:239],v[168:171],0
 s_waitcnt lgkmcnt(5)
 TR v[226:227],v15,51584
 v_fma_f32 v148, v148, s82, v184
 MM a[96:99],v[208:211],v[160:163],0
 TR v[228:229],v15,51104
 MM a[100:103],v[208:211],v[164:167],0
 TR v[230:231],v15,51616
 v_fma_f32 v149, v149, s82, v184
 MM a[104:107],v[208:211],v[168:171],0
 TR v[232:233],v15,51136
 v_max3_f32 v253, v253, v146, v147
 MM a[108:111],v[212:215],v[160:163],0
 buffer_load_dwordx4 v6, s[36:39], s3 offen offset:2112 nt lds
 v_fma_f32 v150, v150, s82, v184
 MM a[112:115],v[212:215],v[164:167],0
 TR v[234:235],v15,51648
 v_fma_f32 v151, v151, s82, v184
 MM a[116:119],v[212:215],v[168:171],0
 s_waitcnt lgkmcnt(6)
 TR v[236:237],v15,51168
 MM a[120:123],v[216:219],v[160:163],0
 TR v[238:239],v15,51680
 v_max3_f32 v254, v254, v148, v149
 MM a[124:127],v[216:219],v[164:167],0
 buffer_load_dwordx4 v7, s[36:39], s3 offen offset:3168 nt lds
 v_fma_f32 v152, v152, s82, v185
 MM a[128:131],v[216:219],v[168:171],0
 s_add_u32 s73, s73, 16384
 v_fma_f32 v153, v153, s82, v185
 MM a[132:135],v[220:223],v[160:163],0
 v_max3_f32 v253, v253, v150, v151
 v_fma_f32 v154, v154, s82, v185
 MM a[136:139],v[220:223],v[164:167],0
 v_fma_f32 v155, v155, s82, v185
 MM a[140:143],v[220:223],v[168:171],0
 s_waitcnt lgkmcnt(6)
 v_max3_f32 v254, v254, v152, v153
 v_fma_f32 v156, v156, s82, v186
 MM a[144:147],v[224:227],v[160:163],0
 v_fma_f32 v157, v157, s82, v186
 v_max3_f32 v253, v253, v154, v155
 MM a[148:151],v[224:227],v[164:167],0
 v_fma_f32 v158, v158, s82, v186
 MM a[152:155],v[224:227],v[168:171],0
 s_waitcnt lgkmcnt(0) vmcnt(16)
 s_barrier
 ds_read_b128 v[208:211], v12 offset:16896
 MM a[156:159],v[228:231],v[160:163],0
 v_fma_f32 v159, v159, s82, v186
 v_max3_f32 v254, v254, v156, v157
 MM a[160:163],v[228:231],v[164:167],0
 v_max3_f32 v253, v253, v158, v159
 MM a[164:167],v[228:231],v[168:171],0
 ds_read_b128 v[212:215], v12 offset:16960
 v_max_f32 v253, v253, v254
 MM a[168:171],v[232:235],v[160:163],0
 v_cmp_lt_f32 vcc, 0x41800000, v253
 MM a[172:175],v[232:235],v[164:167],0
 MM a[176:179],v[232:235],v[168:171],0
 ds_read_b128 v[216:219], v12 offset:17024
 MM a[180:183],v[236:239],v[160:163],0
 MM a[184:187],v[236:239],v[164:167],0
 MM a[188:191],v[236:239],v[168:171],0
 s_mov_b32 s79, 0
LB1_loop28:
 s_cbranch_vccnz LB1_t0
LB1_r0:
 s_waitcnt lgkmcnt(2)
 ds_read_b128 v[220:223], v12 offset:17088
 MM v[112:115],v[208:211],v[16:19],0
 s_mov_b32 m0, s96
 v_exp_f32 v136, v136
 MM v[116:119],v[208:211],v[20:23],0
 ds_read_b128 v[224:227], v12 offset:17152
 buffer_load_dwordx4 v4, s[44:47], s75 offen offset:0 nt lds
 MM v[120:123],v[208:211],v[24:27],0
 s_waitcnt lgkmcnt(3)
 v_exp_f32 v137, v137
 MM v[112:115],v[212:215],v[28:31],v[112:115]
 v_exp_f32 v138, v138
 MM v[116:119],v[212:215],v[32:35],v[116:119]
 ds_read_b128 v[228:231], v12 offset:17216
 buffer_load_dwordx4 v5, s[44:47], s75 offen offset:1056 nt lds
 MM v[120:123],v[212:215],v[36:39],v[120:123]
 s_waitcnt lgkmcnt(2)
 v_exp_f32 v139, v139
 MM v[112:115],v[216:219],v[40:43],v[112:115]
 ds_read_b128 v[232:235], v12 offset:17280
 CV v160,v136,v137
 MM v[116:119],v[216:219],v[44:47],v[116:119]
 v_exp_f32 v148, v148
 MM v[120:123],v[216:219],v[48:51],v[120:123]
 v_exp_f32 v149, v149
 MM v[112:115],v[220:223],v[52:55],v[112:115]
 ds_read_b128 v[236:239], v12 offset:17344
 buffer_load_dwordx4 v6, s[44:47], s75 offen offset:2112 nt lds
 MM v[116:119],v[220:223],v[56:59],v[116:119]
 CV v161,v138,v139
 CV v162,v148,v149
 MM v[120:123],v[220:223],v[60:63],v[120:123]
 s_waitcnt lgkmcnt(2)
 ds_read_b128 v[208:211], v12 offset:17408
 MM v[112:115],v[224:227],v[64:67],v[112:115]
 v_exp_f32 v150, v150
 MM v[116:119],v[224:227],v[68:71],v[116:119]
 v_exp_f32 v151, v151
 MM v[120:123],v[224:227],v[72:75],v[120:123]
 ds_read_b128 v[212:215], v12 offset:17472
 buffer_load_dwordx4 v7, s[44:47], s75 offen offset:3168 nt lds
 MM v[112:115],v[228:231],v[76:79],v[112:115]
 v_exp_f32 v140, v140
 MM v[116:119],v[228:231],v[80:83],v[116:119]
 ds_read_b128 v[216:219], v12 offset:17536
 CV v163,v150,v151
 MM v[120:123],v[228:231],v[84:87],v[120:123]
 s_waitcnt lgkmcnt(3)
 v_exp_f32 v141, v141
 MM v[112:115],v[232:235],v[88:91],v[112:115]
 s_add_u32 m0, s96, 4224
 s_add_u32 s3, s75, 4096
 CV v164,v140,v141
 MM v[116:119],v[232:235],v[92:95],v[116:119]
 ds_read_b128 v[220:223], v12 offset:17600
 buffer_load_dwordx4 v4, s[44:47], s3 offen offset:0 nt lds
 MM v[120:123],v[232:235],v[96:99],v[120:123]
 v_exp_f32 v142, v142
 MM v[112:115],v[236:239],v[100:103],v[112:115]
 ds_read_b128 v[224:227], v12 offset:17664
 buffer_load_dwordx4 v5, s[44:47], s3 offen offset:1056 nt lds
 MM v[116:119],v[236:239],v[104:107],v[116:119]
 v_exp_f32 v143, v143
 MM v[120:123],v[236:239],v[108:111],v[120:123]
 s_waitcnt lgkmcnt(3)
 v_exp_f32 v152, v152
 MM v[124:127],v[208:211],v[16:19],0
 ds_read_b128 v[228:231], v12 offset:17728
 CV v165,v142,v143
 MM v[128:131],v[208:211],v[20:23],0
 v_exp_f32 v153, v153
 MM v[132:135],v[208:211],v[24:27],0
 ds_read_b128 v[232:235], v12 offset:17792
 buffer_load_dwordx4 v6, s[44:47], s3 offen offset:2112 nt lds
 MM v[124:127],v[212:215],v[28:31],v[124:127]
 v_exp_f32 v154, v154
 MM v[128:131],v[212:215],v[32:35],v[128:131]
 v_exp_f32 v155, v155
 MM v[132:135],v[212:215],v[36:39],v[132:135]
 s_waitcnt lgkmcnt(3)
 ds_read_b128 v[236:239], v12 offset:17856
 buffer_load_dwordx4 v7, s[44:47], s3 offen offset:3168 nt lds
 MM v[124:127],v[216:219],v[40:43],v[124:127]
 s_add_u32 s75, s75, 16384
 CV v166,v152,v153
 CV v167,v154,v155
 MM v[128:131],v[216:219],v[44:47],v[128:131]
 v_exp_f32 v144, v144
 MM v[132:135],v[216:219],v[48:51],v[132:135]
 v_exp_f32 v145, v145
 MM v[124:127],v[220:223],v[52:55],v[124:127]
 v_exp_f32 v146, v146
 MM v[128:131],v[220:223],v[56:59],v[128:131]
 v_exp_f32 v147, v147
 MM v[132:135],v[220:223],v[60:63],v[132:135]
 s_waitcnt lgkmcnt(3)
 CV v168,v144,v145
 CV v169,v146,v147
 MM v[124:127],v[224:227],v[64:67],v[124:127]
 v_exp_f32 v156, v156
 MM v[128:131],v[224:227],v[68:71],v[128:131]
 v_exp_f32 v157, v157
 MM v[132:135],v[224:227],v[72:75],v[132:135]
 s_waitcnt lgkmcnt(0) vmcnt(16)
 s_barrier
 TR v[208:209],v14,50688
 MM v[124:127],v[228:231],v[76:79],v[124:127]
 TR v[210:211],v14,51200
 CV v170,v156,v157
 MM v[128:131],v[228:231],v[80:83],v[128:131]
 v_exp_f32 v158, v158
 MM v[132:135],v[228:231],v[84:87],v[132:135]
 TR v[212:213],v14,50720
 TR v[214:215],v14,51232
 MM v[124:127],v[232:235],v[88:91],v[124:127]
 v_exp_f32 v159, v159
 MM v[128:131],v[232:235],v[92:95],v[128:131]
 CV v171,v158,v159
 MM v[132:135],v[232:235],v[96:99],v[132:135]
 TR v[216:217],v14,50752
 TR v[218:219],v14,51264
 MM v[124:127],v[236:239],v[100:103],v[124:127]
 MM v[128:131],v[236:239],v[104:107],v[128:131]
 MM v[132:135],v[236:239],v[108:111],v[132:135]
 MM a[192:195],a[204:207],v[160:163],a[192:195]
 MM a[196:199],a[204:207],v[164:167],a[196:199]
 MM a[200:203],a[204:207],v[168:171],a[200:203]
 s_waitcnt lgkmcnt(4)
 TR v[220:221],v14,50784
 MM a[0:3],v[208:211],v[160:163],a[0:3]
 TR v[222:223],v14,51296
 v_fma_f32 v112, v112, s82, v184
 MM a[4:7],v[208:211],v[164:167],a[4:7]
 TR v[224:225],v14,50816
 v_fma_f32 v113, v113, s82, v184
 MM a[8:11],v[208:211],v[168:171],a[8:11]
 s_waitcnt lgkmcnt(5)
 s_mov_b32 m0, s90
 TR v[226:227],v14,51328
 MM a[12:15],v[212:215],v[160:163],a[12:15]
 buffer_load_dwordx4 v4, s[36:39], s73 offen offset:0 nt lds
 v_fma_f32 v114, v114, s82, v184
 MM a[16:19],v[212:215],v[164:167],a[16:19]
 TR v[228:229],v14,50848
 buffer_load_dwordx4 v5, s[36:39], s73 offen offset:1056 nt lds
 MM a[20:23],v[212:215],v[168:171],a[20:23]
 s_waitcnt lgkmcnt(3)
 TR v[230:231],v14,51360
 v_fma_f32 v115, v115, s82, v184
 MM a[24:27],v[216:219],v[160:163],a[24:27]
 TR v[232:233],v14,50880
 MM a[28:31],v[216:219],v[164:167],a[28:31]
 TR v[234:235],v14,51392
 v_fma_f32 v116, v116, s82, v185
 MM a[32:35],v[216:219],v[168:171],a[32:35]
 buffer_load_dwordx4 v6, s[36:39], s73 offen offset:2112 nt lds
 v_fma_f32 v117, v117, s82, v185
 MM a[36:39],v[220:223],v[160:163],a[36:39]
 TR v[236:237],v14,50912
 v_fma_f32 v118, v118, s82, v185
 MM a[40:43],v[220:223],v[164:167],a[40:43]
 TR v[238:239],v14,51424
 MM a[44:47],v[220:223],v[168:171],a[44:47]
 s_waitcnt lgkmcnt(4)
 TR v[208:209],v14,50944
 v_fma_f32 v119, v119, s82, v185
 MM a[48:51],v[224:227],v[160:163],a[48:51]
 TR v[210:211],v14,51456
 v_max3_f32 v253, v112, v113, v114
 MM a[52:55],v[224:227],v[164:167],a[52:55]
 buffer_load_dwordx4 v7, s[36:39], s73 offen offset:3168 nt lds
 v_max3_f32 v254, v115, v116, v117
 MM a[56:59],v[224:227],v[168:171],a[56:59]
 TR v[212:213],v14,50976
 v_fma_f32 v120, v120, s82, v186
 MM a[60:63],v[228:231],v[160:163],a[60:63]
 TR v[214:215],v14,51488
 MM a[64:67],v[228:231],v[164:167],a[64:67]
 s_add_u32 m0, s90, 4224
 s_add_u32 s3, s73, 4096
 TR v[216:217],v14,51008
 MM a[68:71],v[228:231],v[168:171],a[68:71]
 s_waitcnt lgkmcnt(5)
 buffer_load_dwordx4 v4, s[36:39], s3 offen offset:0 nt lds
 v_fma_f32 v121, v121, s82, v186
 MM a[72:75],v[232:235],v[160:163],a[72:75]
 TR v[218:219],v14,51520
 v_max3_f32 v253, v253, v118, v119
 MM a[76:79],v[232:235],v[164:167],a[76:79]
 TR v[220:221],v14,51040
 v_fma_f32 v122, v122, s82, v186
 MM a[80:83],v[232:235],v[168:171],a[80:83]
 TR v[222:223],v14,51552
 MM a[84:87],v[236:239],v[160:163],a[84:87]
 TR v[224:225],v14,51072
 v_fma_f32 v123, v123, s82, v186
 MM a[88:91],v[236:239],v[164:167],a[88:91]
 buffer_load_dwordx4 v5, s[36:39], s3 offen offset:1056 nt lds
 v_max3_f32 v254, v254, v120, v121
 MM a[92:95],v[236:239],v[168:171],a[92:95]
 s_waitcnt lgkmcnt(5)
 TR v[226:227],v14,51584
 v_fma_f32 v124, v124, s82, v184
 MM a[96:99],v[208:211],v[160:163],a[96:99]
 TR v[228:229],v14,51104
 MM a[100:103],v[208:211],v[164:167],a[100:103]
 TR v[230:231],v14,51616
 v_fma_f32 v125, v125, s82, v184
 MM a[104:107],v[208:211],v[168:171],a[104:107]
 TR v[232:233],v14,51136
 v_max3_f32 v253, v253, v122, v123
 MM a[108:111],v[212:215],v[160:163],a[108:111]
 buffer_load_dwordx4 v6, s[36:39], s3 offen offset:2112 nt lds
 v_fma_f32 v126, v126, s82, v184
 MM a[112:115],v[212:215],v[164:167],a[112:115]
 TR v[234:235],v14,51648
 v_fma_f32 v127, v127, s82, v184
 MM a[116:119],v[212:215],v[168:171],a[116:119]
 s_waitcnt lgkmcnt(6)
 TR v[236:237],v14,51168
 MM a[120:123],v[216:219],v[160:163],a[120:123]
 TR v[238:239],v14,51680
 v_max3_f32 v254, v254, v124, v125
 MM a[124:127],v[216:219],v[164:167],a[124:127]
 buffer_load_dwordx4 v7, s[36:39], s3 offen offset:3168 nt lds
 v_fma_f32 v128, v128, s82, v185
 MM a[128:131],v[216:219],v[168:171],a[128:131]
 s_add_u32 s73, s73, 16384
 v_fma_f32 v129, v129, s82, v185
 MM a[132:135],v[220:223],v[160:163],a[132:135]
 v_max3_f32 v253, v253, v126, v127
 v_fma_f32 v130, v130, s82, v185
 MM a[136:139],v[220:223],v[164:167],a[136:139]
 v_fma_f32 v131, v131, s82, v185
 MM a[140:143],v[220:223],v[168:171],a[140:143]
 s_waitcnt lgkmcnt(6)
 v_max3_f32 v254, v254, v128, v129
 v_fma_f32 v132, v132, s82, v186
 MM a[144:147],v[224:227],v[160:163],a[144:147]
 v_fma_f32 v133, v133, s82, v186
 v_max3_f32 v253, v253, v130, v131
 MM a[148:151],v[224:227],v[164:167],a[148:151]
 v_fma_f32 v134, v134, s82, v186
 MM a[152:155],v[224:227],v[168:171],a[152:155]
 s_waitcnt lgkmcnt(0) vmcnt(16)
 s_barrier
 ds_read_b128 v[208:211], v13 offset:16896
 MM a[156:159],v[228:231],v[160:163],a[156:159]
 v_fma_f32 v135, v135, s82, v186
 v_max3_f32 v254, v254, v132, v133
 MM a[160:163],v[228:231],v[164:167],a[160:163]
 v_max3_f32 v253, v253, v134, v135
 MM a[164:167],v[228:231],v[168:171],a[164:167]
 ds_read_b128 v[212:215], v13 offset:16960
 v_max_f32 v253, v253, v254
 MM a[168:171],v[232:235],v[160:163],a[168:171]
 v_cmp_lt_f32 vcc, 0x41800000, v253
 MM a[172:175],v[232:235],v[164:167],a[172:175]
 MM a[176:179],v[232:235],v[168:171],a[176:179]
 ds_read_b128 v[216:219], v13 offset:17024
 MM a[180:183],v[236:239],v[160:163],a[180:183]
 MM a[184:187],v[236:239],v[164:167],a[184:187]
 MM a[188:191],v[236:239],v[168:171],a[188:191]
 s_cbranch_vccnz LB1_t1
LB1_r1:
 s_waitcnt lgkmcnt(2)
 ds_read_b128 v[220:223], v13 offset:17088
 MM v[136:139],v[208:211],v[16:19],0
 s_mov_b32 m0, s92
 v_exp_f32 v112, v112
 MM v[140:143],v[208:211],v[20:23],0
 ds_read_b128 v[224:227], v13 offset:17152
 buffer_load_dwordx4 v4, s[44:47], s75 offen offset:0 nt lds
 MM v[144:147],v[208:211],v[24:27],0
 s_waitcnt lgkmcnt(3)
 v_exp_f32 v113, v113
 MM v[136:139],v[212:215],v[28:31],v[136:139]
 v_exp_f32 v114, v114
 MM v[140:143],v[212:215],v[32:35],v[140:143]
 ds_read_b128 v[228:231], v13 offset:17216
 buffer_load_dwordx4 v5, s[44:47], s75 offen offset:1056 nt lds
 MM v[144:147],v[212:215],v[36:39],v[144:147]
 s_waitcnt lgkmcnt(2)
 v_exp_f32 v115, v115
 MM v[136:139],v[216:219],v[40:43],v[136:139]
 ds_read_b128 v[232:235], v13 offset:17280
 CV v160,v112,v113
 MM v[140:143],v[216:219],v[44:47],v[140:143]
 v_exp_f32 v124, v124
 MM v[144:147],v[216:219],v[48:51],v[144:147]
 v_exp_f32 v125, v125
 MM v[136:139],v[220:223],v[52:55],v[136:139]
 ds_read_b128 v[236:239], v13 offset:17344
 buffer_load_dwordx4 v6, s[44:47], s75 offen offset:2112 nt lds
 MM v[140:143],v[220:223],v[56:59],v[140:143]
 CV v161,v114,v115
 CV v162,v124,v125
 MM v[144:147],v[220:223],v[60:63],v[144:147]
 s_waitcnt lgkmcnt(2)
 ds_read_b128 v[208:211], v13 offset:17408
 MM v[136:139],v[224:227],v[64:67],v[136:139]
 v_exp_f32 v126, v126
 MM v[140:143],v[224:227],v[68:71],v[140:143]
 v_exp_f32 v127, v127
 MM v[144:147],v[224:227],v[72:75],v[144:147]
 ds_read_b128 v[212:215], v13 offset:17472
 buffer_load_dwordx4 v7, s[44:47], s75 offen offset:3168 nt lds
 MM v[136:139],v[228:231],v[76:79],v[136:139]
 v_exp_f32 v116, v116
 MM v[140:143],v[228:231],v[80:83],v[140:143]
 ds_read_b128 v[216:219], v13 offset:17536
 CV v163,v126,v127
 MM v[144:147],v[228:231],v[84:87],v[144:147]
 s_waitcnt lgkmcnt(3)
 v_exp_f32 v117, v117
 MM v[136:139],v[232:235],v[88:91],v[136:139]
 s_add_u32 m0, s92, 4224
 s_add_u32 s3, s75, 4096
 CV v164,v116,v117
 MM v[140:143],v[232:235],v[92:95],v[140:143]
 ds_read_b128 v[220:223], v13 offset:17600
 buffer_load_dwordx4 v4, s[44:47], s3 offen offset:0 nt lds
 MM v[144:147],v[232:235],v[96:99],v[144:147]
 v_exp_f32 v118, v118
 MM v[136:139],v[236:239],v[100:103],v[136:139]
 ds_read_b128 v[224:227], v13 offset:17664
 buffer_load_dwordx4 v5, s[44:47], s3 offen offset:1056 nt lds
 MM v[140:143],v[236:239],v[104:107],v[140:143]
 v_exp_f32 v119, v119
 MM v[144:147],v[236:239],v[108:111],v[144:147]
 s_waitcnt lgkmcnt(3)
 v_exp_f32 v128, v128
 MM v[148:151],v[208:211],v[16:19],0
 ds_read_b128 v[228:231], v13 offset:17728
 CV v165,v118,v119
 MM v[152:155],v[208:211],v[20:23],0
 v_exp_f32 v129, v129
 MM v[156:159],v[208:211],v[24:27],0
 ds_read_b128 v[232:235], v13 offset:17792
 buffer_load_dwordx4 v6, s[44:47], s3 offen offset:2112 nt lds
 MM v[148:151],v[212:215],v[28:31],v[148:151]
 v_exp_f32 v130, v130
 MM v[152:155],v[212:215],v[32:35],v[152:155]
 v_exp_f32 v131, v131
 MM v[156:159],v[212:215],v[36:39],v[156:159]
 s_waitcnt lgkmcnt(3)
 ds_read_b128 v[236:239], v13 offset:17856
 buffer_load_dwordx4 v7, s[44:47], s3 offen offset:3168 nt lds
 MM v[148:151],v[216:219],v[40:43],v[148:151]
 s_add_u32 s75, s75, 16384
 CV v166,v128,v129
 CV v167,v130,v131
 MM v[152:155],v[216:219],v[44:47],v[152:155]
 v_exp_f32 v120, v120
 MM v[156:159],v[216:219],v[48:51],v[156:159]
 v_exp_f32 v121, v121
 MM v[148:151],v[220:223],v[52:55],v[148:151]
 v_exp_f32 v122, v122
 MM v[152:155],v[220:223],v[56:59],v[152:155]
 v_exp_f32 v123, v123
 MM v[156:159],v[220:223],v[60:63],v[156:159]
 s_waitcnt lgkmcnt(3)
 CV v168,v120,v121
 CV v169,v122,v123
 MM v[148:151],v[224:227],v[64:67],v[148:151]
 v_exp_f32 v132, v132
 MM v[152:155],v[224:227],v[68:71],v[152:155]
 v_exp_f32 v133, v133
 MM v[156:159],v[224:227],v[72:75],v[156:159]
 s_waitcnt lgkmcnt(0) vmcnt(16)
 s_barrier
 TR v[208:209],v15,50688
 MM v[148:151],v[228:231],v[76:79],v[148:151]
 TR v[210:211],v15,51200
 CV v170,v132,v133
 MM v[152:155],v[228:231],v[80:83],v[152:155]
 v_exp_f32 v134, v134
 MM v[156:159],v[228:231],v[84:87],v[156:159]
 TR v[212:213],v15,50720
 TR v[214:215],v15,51232
 MM v[148:151],v[232:235],v[88:91],v[148:151]
 v_exp_f32 v135, v135
 MM v[152:155],v[232:235],v[92:95],v[152:155]
 CV v171,v134,v135
 MM v[156:159],v[232:235],v[96:99],v[156:159]
 TR v[216:217],v15,50752
 TR v[218:219],v15,51264
 MM v[148:151],v[236:239],v[100:103],v[148:151]
 MM v[152:155],v[236:239],v[104:107],v[152:155]
 MM v[156:159],v[236:239],v[108:111],v[156:159]
 MM a[192:195],a[204:207],v[160:163],a[192:195]
 MM a[196:199],a[204:207],v[164:167],a[196:199]
 MM a[200:203],a[204:207],v[168:171],a[200:203]
 s_waitcnt lgkmcnt(4)
 TR v[220:221],v15,50784
 MM a[0:3],v[208:211],v[160:163],a[0:3]
 TR v[222:223],v15,51296
 v_fma_f32 v136, v136, s82, v184
 MM a[4:7],v[208:211],v[164:167],a[4:7]
 TR v[224:225],v15,50816
 v_fma_f32 v137, v137, s82, v184
 MM a[8:11],v[208:211],v[168:171],a[8:11]
 s_waitcnt lgkmcnt(5)
 s_mov_b32 m0, s94
 TR v[226:227],v15,51328
 MM a[12:15],v[212:215],v[160:163],a[12:15]
 buffer_load_dwordx4 v4, s[36:39], s73 offen offset:0 nt lds
 v_fma_f32 v138, v138, s82, v184
 MM a[16:19],v[212:215],v[164:167],a[16:19]
 TR v[228:229],v15,50848
 buffer_load_dwordx4 v5, s[36:39], s73 offen offset:1056 nt lds
 MM a[20:23],v[212:215],v[168:171],a[20:23]
 s_waitcnt lgkmcnt(3)
 TR v[230:231],v15,51360
 v_fma_f32 v139, v139, s82, v184
 MM a[24:27],v[216:219],v[160:163],a[24:27]
 TR v[232:233],v15,50880
 MM a[28:31],v[216:219],v[164:167],a[28:31]
 TR v[234:235],v15,51392
 v_fma_f32 v140, v140, s82, v185
 MM a[32:35],v[216:219],v[168:171],a[32:35]
 buffer_load_dwordx4 v6, s[36:39], s73 offen offset:2112 nt lds
 v_fma_f32 v141, v141, s82, v185
 MM a[36:39],v[220:223],v[160:163],a[36:39]
 TR v[236:237],v15,50912
 v_fma_f32 v142, v142, s82, v185
 MM a[40:43],v[220:223],v[164:167],a[40:43]
 TR v[238:239],v15,51424
 MM a[44:47],v[220:223],v[168:171],a[44:47]
 s_waitcnt lgkmcnt(4)
 TR v[208:209],v15,50944
 v_fma_f32 v143, v143, s82, v185
 MM a[48:51],v[224:227],v[160:163],a[48:51]
 TR v[210:211],v15,51456
 v_max3_f32 v253, v136, v137, v138
 MM a[52:55],v[224:227],v[164:167],a[52:55]
 buffer_load_dwordx4 v7, s[36:39], s73 offen offset:3168 nt lds
 v_max3_f32 v254, v139, v140, v141
 MM a[56:59],v[224:227],v[168:171],a[56:59]
 TR v[212:213],v15,50976
 v_fma_f32 v144, v144, s82, v186
 MM a[60:63],v[228:231],v[160:163],a[60:63]
 TR v[214:215],v15,51488
 MM a[64:67],v[228:231],v[164:167],a[64:67]
 s_add_u32 m0, s94, 4224
 s_add_u32 s3, s73, 4096
 TR v[216:217],v15,51008
 MM a[68:71],v[228:231],v[168:171],a[68:71]
 s_waitcnt lgkmcnt(5)
 buffer_load_dwordx4 v4, s[36:39], s3 offen offset:0 nt lds
 v_fma_f32 v145, v145, s82, v186
 MM a[72:75],v[232:235],v[160:163],a[72:75]
 TR v[218:219],v15,51520
 v_max3_f32 v253, v253, v142, v143
 MM a[76:79],v[232:235],v[164:167],a[76:79]
 TR v[220:221],v15,51040
 v_fma_f32 v146, v146, s82, v186
 MM a[80:83],v[232:235],v[168:171],a[80:83]
 TR v[222:223],v15,51552
 MM a[84:87],v[236:239],v[160:163],a[84:87]
 TR v[224:225],v15,51072
 v_fma_f32 v147, v147, s82, v186
 MM a[88:91],v[236:239],v[164:167],a[88:91]
 buffer_load_dwordx4 v5, s[36:39], s3 offen offset:1056 nt lds
 v_max3_f32 v254, v254, v144, v145
 MM a[92:95],v[236:239],v[168:171],a[92:95]
 s_waitcnt lgkmcnt(5)
 TR v[226:227],v15,51584
 v_fma_f32 v148, v148, s82, v184
 MM a[96:99],v[208:211],v[160:163],a[96:99]
 TR v[228:229],v15,51104
 MM a[100:103],v[208:211],v[164:167],a[100:103]
 TR v[230:231],v15,51616
 v_fma_f32 v149, v149, s82, v184
 MM a[104:107],v[208:211],v[168:171],a[104:107]
 TR v[232:233],v15,51136
 v_max3_f32 v253, v253, v146, v147
 MM a[108:111],v[212:215],v[160:163],a[108:111]
 buffer_load_dwordx4 v6, s[36:39], s3 offen offset:2112 nt lds
 v_fma_f32 v150, v150, s82, v184
 MM a[112:115],v[212:215],v[164:167],a[112:115]
 TR v[234:235],v15,51648
 v_fma_f32 v151, v151, s82, v184
 MM a[116:119],v[212:215],v[168:171],a[116:119]
 s_waitcnt lgkmcnt(6)
 TR v[236:237],v15,51168
 MM a[120:123],v[216:219],v[160:163],a[120:123]
 TR v[238:239],v15,51680
 v_max3_f32 v254, v254, v148, v149
 MM a[124:127],v[216:219],v[164:167],a[124:127]
 buffer_load_dwordx4 v7, s[36:39], s3 offen offset:3168 nt lds
 v_fma_f32 v152, v152, s82, v185
 MM a[128:131],v[216:219],v[168:171],a[128:131]
 s_add_u32 s73, s73, 16384
 v_fma_f32 v153, v153, s82, v185
 MM a[132:135],v[220:223],v[160:163],a[132:135]
 v_max3_f32 v253, v253, v150, v151
 v_fma_f32 v154, v154, s82, v185
 MM a[136:139],v[220:223],v[164:167],a[136:139]
 v_fma_f32 v155, v155, s82, v185
 MM a[140:143],v[220:223],v[168:171],a[140:143]
 s_waitcnt lgkmcnt(6)
 v_max3_f32 v254, v254, v152, v153
 v_fma_f32 v156, v156, s82, v186
 MM a[144:147],v[224:227],v[160:163],a[144:147]
 v_fma_f32 v157, v157, s82, v186
 v_max3_f32 v253, v253, v154, v155
 MM a[148:151],v[224:227],v[164:167],a[148:151]
 v_fma_f32 v158, v158, s82, v186
 MM a[152:155],v[224:227],v[168:171],a[152:155]
 s_waitcnt lgkmcnt(0) vmcnt(16)
 s_barrier
 ds_read_b128 v[208:211], v12 offset:16896
 MM a[156:159],v[228:231],v[160:163],a[156:159]
 v_fma_f32 v159, v159, s82, v186
 v_max3_f32 v254, v254, v156, v157
 MM a[160:163],v[228:231],v[164:167],a[160:163]
 v_max3_f32 v253, v253, v158, v159
 MM a[164:167],v[228:231],v[168:171],a[164:167]
 ds_read_b128 v[212:215], v12 offset:16960
 v_max_f32 v253, v253, v254
 MM a[168:171],v[232:235],v[160:163],a[168:171]
 v_cmp_lt_f32 vcc, 0x41800000, v253
 MM a[172:175],v[232:235],v[164:167],a[172:175]
 MM a[176:179],v[232:235],v[168:171],a[176:179]
 ds_read_b128 v[216:219], v12 offset:17024
 MM a[180:183],v[236:239],v[160:163],a[180:183]
 MM a[184:187],v[236:239],v[164:167],a[184:187]
 MM a[188:191],v[236:239],v[168:171],a[188:191]
 s_add_u32 s79, s79, 1
 s_cmp_lt_u32 s79, 14
 s_cbranch_scc1 LB1_loop28
 s_cbranch_vccnz LB1_t28
LB1_r28:
 s_waitcnt lgkmcnt(2)
 ds_read_b128 v[220:223], v12 offset:17088
 MM v[112:115],v[208:211],v[16:19],0
 s_mov_b32 m0, s96
 v_exp_f32 v136, v136
 MM v[116:119],v[208:211],v[20:23],0
 ds_read_b128 v[224:227], v12 offset:17152
 buffer_load_dwordx4 v4, s[44:47], s75 offen offset:0 nt lds
 MM v[120:123],v[208:211],v[24:27],0
 s_waitcnt lgkmcnt(3)
 v_exp_f32 v137, v137
 MM v[112:115],v[212:215],v[28:31],v[112:115]
 v_exp_f32 v138, v138
 MM v[116:119],v[212:215],v[32:35],v[116:119]
 ds_read_b128 v[228:231], v12 offset:17216
 buffer_load_dwordx4 v5, s[44:47], s75 offen offset:1056 nt lds
 MM v[120:123],v[212:215],v[36:39],v[120:123]
 s_waitcnt lgkmcnt(2)
 v_exp_f32 v139, v139
 MM v[112:115],v[216:219],v[40:43],v[112:115]
 ds_read_b128 v[232:235], v12 offset:17280
 CV v160,v136,v137
 MM v[116:119],v[216:219],v[44:47],v[116:119]
 v_exp_f32 v148, v148
 MM v[120:123],v[216:219],v[48:51],v[120:123]
 v_exp_f32 v149, v149
 MM v[112:115],v[220:223],v[52:55],v[112:115]
 ds_read_b128 v[236:239], v12 offset:17344
 buffer_load_dwordx4 v6, s[44:47], s75 offen offset:2112 nt lds
 MM v[116:119],v[220:223],v[56:59],v[116:119]
 CV v161,v138,v139
 CV v162,v148,v149
 MM v[120:123],v[220:223],v[60:63],v[120:123]
 s_waitcnt lgkmcnt(2)
 ds_read_b128 v[208:211], v12 offset:17408
 MM v[112:115],v[224:227],v[64:67],v[112:115]
 v_exp_f32 v150, v150
 MM v[116:119],v[224:227],v[68:71],v[116:119]
 v_exp_f32 v151, v151
 MM v[120:123],v[224:227],v[72:75],v[120:123]
 ds_read_b128 v[212:215], v12 offset:17472
 buffer_load_dwordx4 v7, s[44:47], s75 offen offset:3168 nt lds
 MM v[112:115],v[228:231],v[76:79],v[112:115]
 v_exp_f32 v140, v140
 MM v[116:119],v[228:231],v[80:83],v[116:119]
 ds_read_b128 v[216:219], v12 offset:17536
 CV v163,v150,v151
 MM v[120:123],v[228:231],v[84:87],v[120:123]
 s_waitcnt lgkmcnt(3)
 v_exp_f32 v141, v141
 MM v[112:115],v[232:235],v[88:91],v[112:115]
 s_add_u32 m0, s96, 4224
 s_add_u32 s3, s75, 4096
 CV v164,v140,v141
 MM v[116:119],v[232:235],v[92:95],v[116:119]
 ds_read_b128 v[220:223], v12 offset:17600
 buffer_load_dwordx4 v4, s[44:47], s3 offen offset:0 nt lds
 MM v[120:123],v[232:235],v[96:99],v[120:123]
 v_exp_f32 v142, v142
 MM v[112:115],v[236:239],v[100:103],v[112:115]
 ds_read_b128 v[224:227], v12 offset:17664
 buffer_load_dwordx4 v5, s[44:47], s3 offen offset:1056 nt lds
 MM v[116:119],v[236:239],v[104:107],v[116:119]
 v_exp_f32 v143, v143
 MM v[120:123],v[236:239],v[108:111],v[120:123]
 s_waitcnt lgkmcnt(3)
 v_exp_f32 v152, v152
 MM v[124:127],v[208:211],v[16:19],0
 ds_read_b128 v[228:231], v12 offset:17728
 CV v165,v142,v143
 MM v[128:131],v[208:211],v[20:23],0
 v_exp_f32 v153, v153
 MM v[132:135],v[208:211],v[24:27],0
 ds_read_b128 v[232:235], v12 offset:17792
 buffer_load_dwordx4 v6, s[44:47], s3 offen offset:2112 nt lds
 MM v[124:127],v[212:215],v[28:31],v[124:127]
 v_exp_f32 v154, v154
 MM v[128:131],v[212:215],v[32:35],v[128:131]
 v_exp_f32 v155, v155
 MM v[132:135],v[212:215],v[36:39],v[132:135]
 s_waitcnt lgkmcnt(3)
 ds_read_b128 v[236:239], v12 offset:17856
 buffer_load_dwordx4 v7, s[44:47], s3 offen offset:3168 nt lds
 MM v[124:127],v[216:219],v[40:43],v[124:127]
 s_add_u32 s75, s75, 16384
 CV v166,v152,v153
 CV v167,v154,v155
 MM v[128:131],v[216:219],v[44:47],v[128:131]
 v_exp_f32 v144, v144
 MM v[132:135],v[216:219],v[48:51],v[132:135]
 v_exp_f32 v145, v145
 MM v[124:127],v[220:223],v[52:55],v[124:127]
 v_exp_f32 v146, v146
 MM v[128:131],v[220:223],v[56:59],v[128:131]
 v_exp_f32 v147, v147
 MM v[132:135],v[220:223],v[60:63],v[132:135]
 s_waitcnt lgkmcnt(3)
 CV v168,v144,v145
 CV v169,v146,v147
 MM v[124:127],v[224:227],v[64:67],v[124:127]
 v_exp_f32 v156, v156
 MM v[128:131],v[224:227],v[68:71],v[128:131]
 v_exp_f32 v157, v157
 MM v[132:135],v[224:227],v[72:75],v[132:135]
 s_waitcnt lgkmcnt(0) vmcnt(16)
 s_barrier
 TR v[208:209],v14,50688
 MM v[124:127],v[228:231],v[76:79],v[124:127]
 TR v[210:211],v14,51200
 CV v170,v156,v157
 MM v[128:131],v[228:231],v[80:83],v[128:131]
 v_exp_f32 v158, v158
 MM v[132:135],v[228:231],v[84:87],v[132:135]
 TR v[212:213],v14,50720
 TR v[214:215],v14,51232
 MM v[124:127],v[232:235],v[88:91],v[124:127]
 v_exp_f32 v159, v159
 MM v[128:131],v[232:235],v[92:95],v[128:131]
 CV v171,v158,v159
 MM v[132:135],v[232:235],v[96:99],v[132:135]
 TR v[216:217],v14,50752
 TR v[218:219],v14,51264
 MM v[124:127],v[236:239],v[100:103],v[124:127]
 MM v[128:131],v[236:239],v[104:107],v[128:131]
 MM v[132:135],v[236:239],v[108:111],v[132:135]
 MM a[192:195],a[204:207],v[160:163],a[192:195]
 MM a[196:199],a[204:207],v[164:167],a[196:199]
 MM a[200:203],a[204:207],v[168:171],a[200:203]
 s_waitcnt lgkmcnt(4)
 TR v[220:221],v14,50784
 MM a[0:3],v[208:211],v[160:163],a[0:3]
 TR v[222:223],v14,51296
 v_fma_f32 v112, v112, s82, v184
 MM a[4:7],v[208:211],v[164:167],a[4:7]
 TR v[224:225],v14,50816
 v_fma_f32 v113, v113, s82, v184
 MM a[8:11],v[208:211],v[168:171],a[8:11]
 s_waitcnt lgkmcnt(5)
 s_mov_b32 m0, s90
 TR v[226:227],v14,51328
 MM a[12:15],v[212:215],v[160:163],a[12:15]
 buffer_load_dwordx4 v4, s[44:47], s75 offen offset:0 nt lds
 v_fma_f32 v114, v114, s82, v184
 MM a[16:19],v[212:215],v[164:167],a[16:19]
 TR v[228:229],v14,50848
 buffer_load_dwordx4 v5, s[44:47], s75 offen offset:1056 nt lds
 MM a[20:23],v[212:215],v[168:171],a[20:23]
 s_waitcnt lgkmcnt(3)
 TR v[230:231],v14,51360
 v_fma_f32 v115, v115, s82, v184
 MM a[24:27],v[216:219],v[160:163],a[24:27]
 TR v[232:233],v14,50880
 MM a[28:31],v[216:219],v[164:167],a[28:31]
 TR v[234:235],v14,51392
 v_fma_f32 v116, v116, s82, v185
 MM a[32:35],v[216:219],v[168:171],a[32:35]
 buffer_load_dwordx4 v6, s[44:47], s75 offen offset:2112 nt lds
 v_fma_f32 v117, v117, s82, v185
 MM a[36:39],v[220:223],v[160:163],a[36:39]
 TR v[236:237],v14,50912
 v_fma_f32 v118, v118, s82, v185
 MM a[40:43],v[220:223],v[164:167],a[40:43]
 TR v[238:239],v14,51424
 MM a[44:47],v[220:223],v[168:171],a[44:47]
 s_waitcnt lgkmcnt(4)
 TR v[208:209],v14,50944
 v_fma_f32 v119, v119, s82, v185
 MM a[48:51],v[224:227],v[160:163],a[48:51]
 TR v[210:211],v14,51456
 v_max3_f32 v253, v112, v113, v114
 MM a[52:55],v[224:227],v[164:167],a[52:55]
 buffer_load_dwordx4 v7, s[44:47], s75 offen offset:3168 nt lds
 v_max3_f32 v254, v115, v116, v117
 MM a[56:59],v[224:227],v[168:171],a[56:59]
 TR v[212:213],v14,50976
 v_fma_f32 v120, v120, s82, v186
 MM a[60:63],v[228:231],v[160:163],a[60:63]
 TR v[214:215],v14,51488
 MM a[64:67],v[228:231],v[164:167],a[64:67]
 s_add_u32 m0, s90, 4224
 s_add_u32 s3, s75, 4096
 TR v[216:217],v14,51008
 MM a[68:71],v[228:231],v[168:171],a[68:71]
 s_waitcnt lgkmcnt(5)
 buffer_load_dwordx4 v4, s[44:47], s3 offen offset:0 nt lds
 v_fma_f32 v121, v121, s82, v186
 MM a[72:75],v[232:235],v[160:163],a[72:75]
 TR v[218:219],v14,51520
 v_max3_f32 v253, v253, v118, v119
 MM a[76:79],v[232:235],v[164:167],a[76:79]
 TR v[220:221],v14,51040
 v_fma_f32 v122, v122, s82, v186
 MM a[80:83],v[232:235],v[168:171],a[80:83]
 TR v[222:223],v14,51552
 MM a[84:87],v[236:239],v[160:163],a[84:87]
 TR v[224:225],v14,51072
 v_fma_f32 v123, v123, s82, v186
 MM a[88:91],v[236:239],v[164:167],a[88:91]
 buffer_load_dwordx4 v5, s[44:47], s3 offen offset:1056 nt lds
 v_max3_f32 v254, v254, v120, v121
 MM a[92:95],v[236:239],v[168:171],a[92:95]
 s_waitcnt lgkmcnt(5)
 TR v[226:227],v14,51584
 v_fma_f32 v124, v124, s82, v184
 MM a[96:99],v[208:211],v[160:163],a[96:99]
 TR v[228:229],v14,51104
 MM a[100:103],v[208:211],v[164:167],a[100:103]
 TR v[230:231],v14,51616
 v_fma_f32 v125, v125, s82, v184
 MM a[104:107],v[208:211],v[168:171],a[104:107]
 TR v[232:233],v14,51136
 v_max3_f32 v253, v253, v122, v123
 MM a[108:111],v[212:215],v[160:163],a[108:111]
 buffer_load_dwordx4 v6, s[44:47], s3 offen offset:2112 nt lds
 v_fma_f32 v126, v126, s82, v184
 MM a[112:115],v[212:215],v[164:167],a[112:115]
 TR v[234:235],v14,51648
 v_fma_f32 v127, v127, s82, v184
 MM a[116:119],v[212:215],v[168:171],a[116:119]
 s_waitcnt lgkmcnt(6)
 TR v[236:237],v14,51168
 MM a[120:123],v[216:219],v[160:163],a[120:123]
 TR v[238:239],v14,51680
 v_max3_f32 v254, v254, v124, v125
 MM a[124:127],v[216:219],v[164:167],a[124:127]
 buffer_load_dwordx4 v7, s[44:47], s3 offen offset:3168 nt lds
 v_fma_f32 v128, v128, s82, v185
 MM a[128:131],v[216:219],v[168:171],a[128:131]
 s_add_u32 s75, s75, 16384
 v_fma_f32 v129, v129, s82, v185
 MM a[132:135],v[220:223],v[160:163],a[132:135]
 v_max3_f32 v253, v253, v126, v127
 v_fma_f32 v130, v130, s82, v185
 MM a[136:139],v[220:223],v[164:167],a[136:139]
 v_fma_f32 v131, v131, s82, v185
 MM a[140:143],v[220:223],v[168:171],a[140:143]
 s_waitcnt lgkmcnt(6)
 v_max3_f32 v254, v254, v128, v129
 v_fma_f32 v132, v132, s82, v186
 MM a[144:147],v[224:227],v[160:163],a[144:147]
 v_fma_f32 v133, v133, s82, v186
 v_max3_f32 v253, v253, v130, v131
 MM a[148:151],v[224:227],v[164:167],a[148:151]
 v_fma_f32 v134, v134, s82, v186
 MM a[152:155],v[224:227],v[168:171],a[152:155]
 s_waitcnt lgkmcnt(0) vmcnt(16)
 s_barrier
 ds_read_b128 v[208:211], v13 offset:16896
 MM a[156:159],v[228:231],v[160:163],a[156:159]
 v_fma_f32 v135, v135, s82, v186
 v_max3_f32 v254, v254, v132, v133
 MM a[160:163],v[228:231],v[164:167],a[160:163]
 v_max3_f32 v253, v253, v134, v135
 MM a[164:167],v[228:231],v[168:171],a[164:167]
 ds_read_b128 v[212:215], v13 offset:16960
 v_max_f32 v253, v253, v254
 MM a[168:171],v[232:235],v[160:163],a[168:171]
 v_cmp_lt_f32 vcc, 0x41800000, v253
 MM a[172:175],v[232:235],v[164:167],a[172:175]
 MM a[176:179],v[232:235],v[168:171],a[176:179]
 ds_read_b128 v[216:219], v13 offset:17024
 MM a[180:183],v[236:239],v[160:163],a[180:183]
 MM a[184:187],v[236:239],v[164:167],a[184:187]
 MM a[188:191],v[236:239],v[168:171],a[188:191]
 s_cbranch_vccnz LB1_t29
LB1_r29:
 s_waitcnt lgkmcnt(2)
 ds_read_b128 v[220:223], v13 offset:17088
 MM v[136:139],v[208:211],v[16:19],0
 v_exp_f32 v112, v112
 MM v[140:143],v[208:211],v[20:23],0
 ds_read_b128 v[224:227], v13 offset:17152
 MM v[144:147],v[208:211],v[24:27],0
 s_waitcnt lgkmcnt(3)
 v_exp_f32 v113, v113
 MM v[136:139],v[212:215],v[28:31],v[136:139]
 v_exp_f32 v114, v114
 MM v[140:143],v[212:215],v[32:35],v[140:143]
 ds_read_b128 v[228:231], v13 offset:17216
 CV v160,v112,v113
 MM v[144:147],v[212:215],v[36:39],v[144:147]
 s_waitcnt lgkmcnt(2)
 v_exp_f32 v115, v115
 MM v[136:139],v[216:219],v[40:43],v[136:139]
 ds_read_b128 v[232:235], v13 offset:17280
 CV v161,v114,v115
 MM v[140:143],v[216:219],v[44:47],v[140:143]
 v_exp_f32 v124, v124
 MM v[144:147],v[216:219],v[48:51],v[144:147]
 v_exp_f32 v125, v125
 MM v[136:139],v[220:223],v[52:55],v[136:139]
 ds_read_b128 v[236:239], v13 offset:17344
 CV v162,v124,v125
 MM v[140:143],v[220:223],v[56:59],v[140:143]
 v_exp_f32 v126, v126
 MM v[144:147],v[220:223],v[60:63],v[144:147]
 s_waitcnt lgkmcnt(2)
 ds_read_b128 v[208:211], v13 offset:17408
 MM v[136:139],v[224:227],v[64:67],v[136:139]
 v_exp_f32 v127, v127
 MM v[140:143],v[224:227],v[68:71],v[140:143]
 v_exp_f32 v116, v116
 MM v[144:147],v[224:227],v[72:75],v[144:147]
 ds_read_b128 v[212:215], v13 offset:17472
 CV v163,v126,v127
 MM v[136:139],v[228:231],v[76:79],v[136:139]
 v_exp_f32 v117, v117
 MM v[140:143],v[228:231],v[80:83],v[140:143]
 ds_read_b128 v[216:219], v13 offset:17536
 CV v164,v116,v117
 MM v[144:147],v[228:231],v[84:87],v[144:147]
 s_waitcnt lgkmcnt(3)
 v_exp_f32 v118, v118
 MM v[136:139],v[232:235],v[88:91],v[136:139]
 v_exp_f32 v119, v119
 MM v[140:143],v[232:235],v[92:95],v[140:143]
 ds_read_b128 v[220:223], v13 offset:17600
 CV v165,v118,v119
 MM v[144:147],v[232:235],v[96:99],v[144:147]
 v_exp_f32 v128, v128
 MM v[136:139],v[236:239],v[100:103],v[136:139]
 ds_read_b128 v[224:227], v13 offset:17664
 MM v[140:143],v[236:239],v[104:107],v[140:143]
 v_exp_f32 v129, v129
 MM v[144:147],v[236:239],v[108:111],v[144:147]
 s_waitcnt lgkmcnt(3)
 v_exp_f32 v130, v130
 MM v[148:151],v[208:211],v[16:19],0
 ds_read_b128 v[228:231], v13 offset:17728
 CV v166,v128,v129
 MM v[152:155],v[208:211],v[20:23],0
 v_exp_f32 v131, v131
 MM v[156:159],v[208:211],v[24:27],0
 ds_read_b128 v[232:235], v13 offset:17792
 CV v167,v130,v131
 MM v[148:151],v[212:215],v[28:31],v[148:151]
 v_exp_f32 v120, v120
 MM v[152:155],v[212:215],v[32:35],v[152:155]
 v_exp_f32 v121, v121
 MM v[156:159],v[212:215],v[36:39],v[156:159]
 s_waitcnt lgkmcnt(3)
 ds_read_b128 v[236:239], v13 offset:17856
 CV v168,v120,v121
 MM v[148:151],v[216:219],v[40:43],v[148:151]
 v_exp_f32 v122, v122
 MM v[152:155],v[216:219],v[44:47],v[152:155]
 v_exp_f32 v123, v123
 MM v[156:159],v[216:219],v[48:51],v[156:159]
 v_exp_f32 v132, v132
 MM v[148:151],v[220:223],v[52:55],v[148:151]
 v_exp_f32 v133, v133
 MM v[152:155],v[220:223],v[56:59],v[152:155]
 CV v169,v122,v123
 CV v170,v132,v133
 MM v[156:159],v[220:223],v[60:63],v[156:159]
 s_waitcnt lgkmcnt(3)
 v_exp_f32 v134, v134
 MM v[148:151],v[224:227],v[64:67],v[148:151]
 v_exp_f32 v135, v135
 MM v[152:155],v[224:227],v[68:71],v[152:155]
 CV v171,v134,v135
 MM v[156:159],v[224:227],v[72:75],v[156:159]
 s_waitcnt lgkmcnt(0) vmcnt(8)
 s_barrier
 TR v[208:209],v15,50688
 MM v[148:151],v[228:231],v[76:79],v[148:151]
 TR v[210:211],v15,51200
 MM v[152:155],v[228:231],v[80:83],v[152:155]
 MM v[156:159],v[228:231],v[84:87],v[156:159]
 TR v[212:213],v15,50720
 TR v[214:215],v15,51232
 MM v[148:151],v[232:235],v[88:91],v[148:151]
 MM v[152:155],v[232:235],v[92:95],v[152:155]
 MM v[156:159],v[232:235],v[96:99],v[156:159]
 TR v[216:217],v15,50752
 TR v[218:219],v15,51264
 MM v[148:151],v[236:239],v[100:103],v[148:151]
 MM v[152:155],v[236:239],v[104:107],v[152:155]
 MM v[156:159],v[236:239],v[108:111],v[156:159]
 MM a[192:195],a[204:207],v[160:163],a[192:195]
 MM a[196:199],a[204:207],v[164:167],a[196:199]
 MM a[200:203],a[204:207],v[168:171],a[200:203]
 s_waitcnt lgkmcnt(4)
 TR v[220:221],v15,50784
 MM a[0:3],v[208:211],v[160:163],a[0:3]
 TR v[222:223],v15,51296
 v_fma_f32 v136, v136, s82, v184
 MM a[4:7],v[208:211],v[164:167],a[4:7]
 TR v[224:225],v15,50816
 v_fma_f32 v137, v137, s82, v184
 MM a[8:11],v[208:211],v[168:171],a[8:11]
 s_waitcnt lgkmcnt(5)
 TR v[226:227],v15,51328
 MM a[12:15],v[212:215],v[160:163],a[12:15]
 v_fma_f32 v138, v138, s82, v184
 v_fma_f32 v139, v139, s82, v184
 MM a[16:19],v[212:215],v[164:167],a[16:19]
 TR v[228:229],v15,50848
 MM a[20:23],v[212:215],v[168:171],a[20:23]
 s_waitcnt lgkmcnt(3)
 TR v[230:231],v15,51360
 v_fma_f32 v140, v140, s82, v185
 MM a[24:27],v[216:219],v[160:163],a[24:27]
 TR v[232:233],v15,50880
 v_fma_f32 v141, v141, s82, v185
 MM a[28:31],v[216:219],v[164:167],a[28:31]
 TR v[234:235],v15,51392
 MM a[32:35],v[216:219],v[168:171],a[32:35]
 v_fma_f32 v142, v142, s82, v185
 v_fma_f32 v143, v143, s82, v185
 MM a[36:39],v[220:223],v[160:163],a[36:39]
 TR v[236:237],v15,50912
 MM a[40:43],v[220:223],v[164:167],a[40:43]
 TR v[238:239],v15,51424
 v_max3_f32 v253, v136, v137, v138
 MM a[44:47],v[220:223],v[168:171],a[44:47]
 s_waitcnt lgkmcnt(4)
 TR v[208:209],v15,50944
 v_max3_f32 v254, v139, v140, v141
 MM a[48:51],v[224:227],v[160:163],a[48:51]
 TR v[210:211],v15,51456
 MM a[52:55],v[224:227],v[164:167],a[52:55]
 v_fma_f32 v144, v144, s82, v186
 v_fma_f32 v145, v145, s82, v186
 MM a[56:59],v[224:227],v[168:171],a[56:59]
 TR v[212:213],v15,50976
 MM a[60:63],v[228:231],v[160:163],a[60:63]
 TR v[214:215],v15,51488
 v_max3_f32 v253, v253, v142, v143
 MM a[64:67],v[228:231],v[164:167],a[64:67]
 TR v[216:217],v15,51008
 v_fma_f32 v146, v146, s82, v186
 MM a[68:71],v[228:231],v[168:171],a[68:71]
 s_waitcnt lgkmcnt(5)
 v_fma_f32 v147, v147, s82, v186
 MM a[72:75],v[232:235],v[160:163],a[72:75]
 TR v[218:219],v15,51520
 v_max3_f32 v254, v254, v144, v145
 MM a[76:79],v[232:235],v[164:167],a[76:79]
 TR v[220:221],v15,51040
 MM a[80:83],v[232:235],v[168:171],a[80:83]
 TR v[222:223],v15,51552
 v_fma_f32 v148, v148, s82, v184
 MM a[84:87],v[236:239],v[160:163],a[84:87]
 TR v[224:225],v15,51072
 v_fma_f32 v149, v149, s82, v184
 MM a[88:91],v[236:239],v[164:167],a[88:91]
 v_max3_f32 v253, v253, v146, v147
 MM a[92:95],v[236:239],v[168:171],a[92:95]
 s_waitcnt lgkmcnt(5)
 TR v[226:227],v15,51584
 v_fma_f32 v150, v150, s82, v184
 MM a[96:99],v[208:211],v[160:163],a[96:99]
 TR v[228:229],v15,51104
 MM a[100:103],v[208:211],v[164:167],a[100:103]
 TR v[230:231],v15,51616
 v_fma_f32 v151, v151, s82, v184
 MM a[104:107],v[208:211],v[168:171],a[104:107]
 TR v[232:233],v15,51136
 v_max3_f32 v254, v254, v148, v149
 MM a[108:111],v[212:215],v[160:163],a[108:111]
 v_fma_f32 v152, v152, s82, v185
 MM a[112:115],v[212:215],v[164:167],a[112:115]
 TR v[234:235],v15,51648
 v_fma_f32 v153, v153, s82, v185
 MM a[116:119],v[212:215],v[168:171],a[116:119]
 s_waitcnt lgkmcnt(6)
 TR v[236:237],v15,51168
 MM a[120:123],v[216:219],v[160:163],a[120:123]
 TR v[238:239],v15,51680
 v_max3_f32 v253, v253, v150, v151
 MM a[124:127],v[216:219],v[164:167],a[124:127]
 v_fma_f32 v154, v154, s82, v185
 MM a[128:131],v[216:219],v[168:171],a[128:131]
 v_fma_f32 v155, v155, s82, v185
 v_max3_f32 v254, v254, v152, v153
 MM a[132:135],v[220:223],v[160:163],a[132:135]
 v_fma_f32 v156, v156, s82, v186
 MM a[136:139],v[220:223],v[164:167],a[136:139]
 v_fma_f32 v157, v157, s82, v186
 MM a[140:143],v[220:223],v[168:171],a[140:143]
 s_waitcnt lgkmcnt(6)
 v_max3_f32 v253, v253, v154, v155
 v_fma_f32 v158, v158, s82, v186
 MM a[144:147],v[224:227],v[160:163],a[144:147]
 v_fma_f32 v159, v159, s82, v186
 MM a[148:151],v[224:227],v[164:167],a[148:151]
 v_max3_f32 v254, v254, v156, v157
 MM a[152:155],v[224:227],v[168:171],a[152:155]
 s_waitcnt lgkmcnt(0) vmcnt(0)
 s_barrier
 TR v[208:209],v14,16896
 MM a[156:159],v[228:231],v[160:163],a[156:159]
 TR v[210:211],v14,17408
 v_max3_f32 v253, v253, v158, v159
 MM a[160:163],v[228:231],v[164:167],a[160:163]
 v_max_f32 v253, v253, v254
 MM a[164:167],v[228:231],v[168:171],a[164:167]
 TR v[212:213],v14,16928
 v_cmp_lt_f32 vcc, 0x41800000, v253
 MM a[168:171],v[232:235],v[160:163],a[168:171]
 TR v[214:215],v14,17440
 MM a[172:175],v[232:235],v[164:167],a[172:175]
 MM a[176:179],v[232:235],v[168:171],a[176:179]
 TR v[216:217],v14,16960
 MM a[180:183],v[236:239],v[160:163],a[180:183]
 TR v[218:219],v14,17472
 MM a[184:187],v[236:239],v[164:167],a[184:187]
 MM a[188:191],v[236:239],v[168:171],a[188:191]
 s_cbranch_vccnz LB1_t30
LB1_r30:
 v_exp_f32 v136, v136
 v_exp_f32 v137, v137
 v_exp_f32 v138, v138
 v_exp_f32 v139, v139
 v_exp_f32 v148, v148
 CV v160,v136,v137
 CV v161,v138,v139
 v_exp_f32 v149, v149
 v_exp_f32 v150, v150
 v_exp_f32 v151, v151
 v_exp_f32 v140, v140
 CV v162,v148,v149
 CV v163,v150,v151
 v_exp_f32 v141, v141
 v_exp_f32 v142, v142
 v_exp_f32 v143, v143
 v_exp_f32 v152, v152
 CV v164,v140,v141
 CV v165,v142,v143
 v_exp_f32 v153, v153
 v_exp_f32 v154, v154
 v_exp_f32 v155, v155
 v_exp_f32 v144, v144
 CV v166,v152,v153
 CV v167,v154,v155
 v_exp_f32 v145, v145
 v_exp_f32 v146, v146
 v_exp_f32 v147, v147
 v_exp_f32 v156, v156
 CV v168,v144,v145
 CV v169,v146,v147
 v_exp_f32 v157, v157
 v_exp_f32 v158, v158
 v_exp_f32 v159, v159
 CV v170,v156,v157
 CV v171,v158,v159
 MM a[192:195],a[204:207],v[160:163],a[192:195]
 MM a[196:199],a[204:207],v[164:167],a[196:199]
 MM a[200:203],a[204:207],v[168:171],a[200:203]
 s_waitcnt lgkmcnt(4)
 TR v[220:221],v14,16992
 MM a[0:3],v[208:211],v[160:163],a[0:3]
 TR v[222:223],v14,17504
 MM a[4:7],v[208:211],v[164:167],a[4:7]
 TR v[224:225],v14,17024
 MM a[8:11],v[208:211],v[168:171],a[8:11]
 s_waitcnt lgkmcnt(5)
 TR v[226:227],v14,17536
 AR v244,a192
 AR v245,a196
 MM a[12:15],v[212:215],v[160:163],a[12:15]
 AR v246,a200
 MM a[16:19],v[212:215],v[164:167],a[16:19]
 TR v[228:229],v14,17056
 v_rcp_f32 v244, v244
 MM a[20:23],v[212:215],v[168:171],a[20:23]
 s_waitcnt lgkmcnt(3)
 TR v[230:231],v14,17568
 v_rcp_f32 v245, v245
 MM a[24:27],v[216:219],v[160:163],a[24:27]
 TR v[232:233],v14,17088
 MM a[28:31],v[216:219],v[164:167],a[28:31]
 TR v[234:235],v14,17600
 v_rcp_f32 v246, v246
 MM a[32:35],v[216:219],v[168:171],a[32:35]
 AR v196,a0
 AR v197,a1
 AR v198,a2
 AR v199,a3
 MM a[36:39],v[220:223],v[160:163],a[36:39]
 TR v[236:237],v14,17120
 AR v200,a12
 AR v201,a13
 AR v202,a14
 MM a[40:43],v[220:223],v[164:167],a[40:43]
 TR v[238:239],v14,17632
 AR v203,a15
 v_mul_f32 v196, v196, v244
 v_mul_f32 v197, v197, v244
 MM a[44:47],v[220:223],v[168:171],a[44:47]
 s_waitcnt lgkmcnt(4)
 TR v[208:209],v14,17152
 v_mul_f32 v198, v198, v244
 v_mul_f32 v199, v199, v244
 v_mul_f32 v200, v200, v244
 MM a[48:51],v[224:227],v[160:163],a[48:51]
 TR v[210:211],v14,17664
 v_mul_f32 v201, v201, v244
 v_mul_f32 v202, v202, v244
 MM a[52:55],v[224:227],v[164:167],a[52:55]
 v_mul_f32 v203, v203, v244
 CV v16,v196,v197
 CV v17,v198,v199
 CV v18,v200,v201
 MM a[56:59],v[224:227],v[168:171],a[56:59]
 TR v[212:213],v14,17184
 CV v19,v202,v203
 AR v196,a4
 AR v197,a5
 MM a[60:63],v[228:231],v[160:163],a[60:63]
 TR v[214:215],v14,17696
 AR v198,a6
 AR v199,a7
 AR v200,a16
 MM a[64:67],v[228:231],v[164:167],a[64:67]
 TR v[216:217],v14,17216
 AR v201,a17
 AR v202,a18
 MM a[68:71],v[228:231],v[168:171],a[68:71]
 s_waitcnt lgkmcnt(5)
 AR v203,a19
 v_mul_f32 v196, v196, v245
 v_mul_f32 v197, v197, v245
 v_mul_f32 v198, v198, v245
 MM a[72:75],v[232:235],v[160:163],a[72:75]
 TR v[218:219],v14,17728
 v_mul_f32 v199, v199, v245
 v_mul_f32 v200, v200, v245
 v_mul_f32 v201, v201, v245
 MM a[76:79],v[232:235],v[164:167],a[76:79]
 TR v[220:221],v14,17248
 v_mul_f32 v202, v202, v245
 v_mul_f32 v203, v203, v245
 CV v20,v196,v197
 MM a[80:83],v[232:235],v[168:171],a[80:83]
 TR v[222:223],v14,17760
 CV v21,v198,v199
 CV v22,v200,v201
 MM a[84:87],v[236:239],v[160:163],a[84:87]
 TR v[224:225],v14,17280
 CV v23,v202,v203
 AR v196,a8
 AR v197,a9
 MM a[88:91],v[236:239],v[164:167],a[88:91]
 AR v198,a10
 AR v199,a11
 AR v200,a20
 AR v201,a21
 MM a[92:95],v[236:239],v[168:171],a[92:95]
 s_waitcnt lgkmcnt(5)
 TR v[226:227],v14,17792
 AR v202,a22
 AR v203,a23
 MM a[96:99],v[208:211],v[160:163],a[96:99]
 TR v[228:229],v14,17312
 v_mul_f32 v196, v196, v246
 v_mul_f32 v197, v197, v246
 v_mul_f32 v198, v198, v246
 MM a[100:103],v[208:211],v[164:167],a[100:103]
 TR v[230:231],v14,17824
 v_mul_f32 v199, v199, v246
 v_mul_f32 v200, v200, v246
 v_mul_f32 v201, v201, v246
 MM a[104:107],v[208:211],v[168:171],a[104:107]
 TR v[232:233],v14,17344
 v_mul_f32 v202, v202, v246
 v_mul_f32 v203, v203, v246
 CV v24,v196,v197
 MM a[108:111],v[212:215],v[160:163],a[108:111]
 CV v25,v198,v199
 CV v26,v200,v201
 CV v27,v202,v203
 MM a[112:115],v[212:215],v[164:167],a[112:115]
 TR v[234:235],v14,17856
 AR v196,a24
 AR v197,a25
 MM a[116:119],v[212:215],v[168:171],a[116:119]
 s_waitcnt lgkmcnt(6)
 TR v[236:237],v14,17376
 AR v198,a26
 AR v199,a27
 MM a[120:123],v[216:219],v[160:163],a[120:123]
 TR v[238:239],v14,17888
 AR v200,a36
 AR v201,a37
 MM a[124:127],v[216:219],v[164:167],a[124:127]
 AR v202,a38
 AR v203,a39
 v_mul_f32 v196, v196, v244
 MM a[128:131],v[216:219],v[168:171],a[128:131]
 v_mul_f32 v197, v197, v244
 v_mul_f32 v198, v198, v244
 v_mul_f32 v199, v199, v244
 MM a[132:135],v[220:223],v[160:163],a[132:135]
 v_mul_f32 v200, v200, v244
 v_mul_f32 v201, v201, v244
 v_mul_f32 v202, v202, v244
 MM a[136:139],v[220:223],v[164:167],a[136:139]
 v_mul_f32 v203, v203, v244
 CV v28,v196,v197
 CV v29,v198,v199
 MM a[140:143],v[220:223],v[168:171],a[140:143]
 s_waitcnt lgkmcnt(6)
 CV v30,v200,v201
 CV v31,v202,v203
 AR v196,a28
 MM a[144:147],v[224:227],v[160:163],a[144:147]
 AR v197,a29
 AR v198,a30
 AR v199,a31
 MM a[148:151],v[224:227],v[164:167],a[148:151]
 AR v200,a40
 AR v201,a41
 AR v202,a42
 MM a[152:155],v[224:227],v[168:171],a[152:155]
 s_waitcnt lgkmcnt(0)
 s_barrier
 TR v[208:209],v14,33792
 AR v203,a43
 ds_read_b128 v[112:115], v251 offset:0
 ds_read_b128 v[116:119], v251 offset:1024
 MM a[156:159],v[228:231],v[160:163],a[156:159]
 TR v[210:211],v14,33920
 v_mul_f32 v196, v196, v245
 v_mul_f32 v197, v197, v245
 ds_read_b128 v[120:123], v251 offset:2048
 ds_read_b128 v[124:127], v251 offset:3072
 MM a[160:163],v[228:231],v[164:167],a[160:163]
 v_mul_f32 v198, v198, v245
 v_mul_f32 v199, v199, v245
 v_mul_f32 v200, v200, v245
 ds_read_b128 v[128:131], v251 offset:4096
 ds_read_b128 v[132:135], v251 offset:5120
 MM a[164:167],v[228:231],v[168:171],a[164:167]
 TR v[212:213],v14,33824
 v_mul_f32 v201, v201, v245
 v_mul_f32 v202, v202, v245
 ds_read_b128 v[136:139], v251 offset:6144
 ds_read_b128 v[140:143], v251 offset:7168
 MM a[168:171],v[232:235],v[160:163],a[168:171]
 TR v[214:215],v14,33952
 v_mul_f32 v203, v203, v245
 CV v32,v196,v197
 ds_read_b128 v[144:147], v251 offset:8192
 ds_read_b128 v[148:151], v251 offset:9216
 MM a[172:175],v[232:235],v[164:167],a[172:175]
 CV v33,v198,v199
 CV v34,v200,v201
 CV v35,v202,v203
 ds_read_b128 v[152:155], v251 offset:10240
 ds_read_b128 v[156:159], v251 offset:11264
 MM a[176:179],v[232:235],v[168:171],a[176:179]
 TR v[216:217],v14,33856
 AR v196,a32
 AR v197,a33
 MM a[180:183],v[236:239],v[160:163],a[180:183]
 TR v[218:219],v14,33984
 AR v198,a34
 AR v199,a35
 MM a[184:187],v[236:239],v[164:167],a[184:187]
 AR v200,a44
 AR v201,a45
 AR v202,a46
 MM a[188:191],v[236:239],v[168:171],a[188:191]
 s_waitcnt lgkmcnt(14)
 s_waitcnt lgkmcnt(13)
 TR v[220:221],v14,33888
 AR v203,a47
 v_mul_f32 v196, v196, v246
 MM v[112:115],v[208:211],v[16:19],v[112:115]
 TR v[222:223],v14,34016
 ds_write_b128 v247, v[16:19] offset:0
 v_mul_f32 v197, v197, v246
 MM v[116:119],v[208:211],v[20:23],v[116:119]
 TR v[224:225],v14,34048
 v_mul_f32 v198, v198, v246
 v_mul_f32 v199, v199, v246
 MM v[120:123],v[208:211],v[24:27],v[120:123]
 s_waitcnt lgkmcnt(10)
 TR v[226:227],v14,34176
 v_mul_f32 v200, v200, v246
 v_mul_f32 v201, v201, v246
 MM v[124:127],v[212:215],v[16:19],v[124:127]
 ds_write_b128 v247, v[20:23] offset:1024
 v_mul_f32 v202, v202, v246
 v_mul_f32 v203, v203, v246
 MM v[128:131],v[212:215],v[20:23],v[128:131]
 TR v[228:229],v14,34080
 CV v36,v196,v197
 CV v37,v198,v199
 MM v[132:135],v[212:215],v[24:27],v[132:135]
 s_waitcnt lgkmcnt(5)
 TR v[230:231],v14,34208
 CV v38,v200,v201
 CV v39,v202,v203
 MM v[136:139],v[216:219],v[16:19],v[136:139]
 TR v[232:233],v14,34112
 ds_write_b128 v247, v[24:27] offset:2048
 MM v[140:143],v[216:219],v[20:23],v[140:143]
 TR v[234:235],v14,34240
 ds_write_b128 v247, v[28:31] offset:3072
 AR v196,a48
 AR v197,a49
 AR v198,a50
 MM v[144:147],v[216:219],v[24:27],v[144:147]
 AR v199,a51
 AR v200,a60
 AR v201,a61
 AR v202,a62
 AR v203,a63
 MM v[148:151],v[220:223],v[16:19],v[148:151]
 TR v[236:237],v14,34144
 ds_write_b128 v247, v[32:35] offset:4096
 v_mul_f32 v196, v196, v244
 v_mul_f32 v197, v197, v244
 v_mul_f32 v198, v198, v244
 MM v[152:155],v[220:223],v[20:23],v[152:155]
 TR v[238:239],v14,34272
 v_mul_f32 v199, v199, v244
 v_mul_f32 v200, v200, v244
 v_mul_f32 v201, v201, v244
 MM v[156:159],v[220:223],v[24:27],v[156:159]
 s_waitcnt lgkmcnt(7)
 TR v[208:209],v14,34304
 v_mul_f32 v202, v202, v244
 v_mul_f32 v203, v203, v244
 CV v40,v196,v197
 CV v41,v198,v199
 MM v[112:115],v[224:227],v[28:31],v[112:115]
 TR v[210:211],v14,34432
 CV v42,v200,v201
 CV v43,v202,v203
 AR v196,a52
 AR v197,a53
 MM v[116:119],v[224:227],v[32:35],v[116:119]
 ds_write_b128 v247, v[36:39] offset:5120
 AR v198,a54
 AR v199,a55
 AR v200,a64
 MM v[120:123],v[224:227],v[36:39],v[120:123]
 TR v[212:213],v14,34336
 AR v201,a65
 AR v202,a66
 AR v203,a67
 v_mul_f32 v196, v196, v245
 MM v[124:127],v[228:231],v[28:31],v[124:127]
 TR v[214:215],v14,34464
 v_mul_f32 v197, v197, v245
 v_mul_f32 v198, v198, v245
 v_mul_f32 v199, v199, v245
 v_mul_f32 v200, v200, v245
 MM v[128:131],v[228:231],v[32:35],v[128:131]
 TR v[216:217],v14,34368
 v_mul_f32 v201, v201, v245
 v_mul_f32 v202, v202, v245
 v_mul_f32 v203, v203, v245
 CV v44,v196,v197
 MM v[132:135],v[228:231],v[36:39],v[132:135]
 s_waitcnt lgkmcnt(6)
 CV v45,v198,v199
 CV v46,v200,v201
 CV v47,v202,v203
 AR v196,a56
 MM v[136:139],v[232:235],v[28:31],v[136:139]
 TR v[218:219],v14,34496
 AR v197,a57
 AR v198,a58
 AR v199,a59
 AR v200,a68
 MM v[140:143],v[232:235],v[32:35],v[140:143]
 TR v[220:221],v14,34400
 AR v201,a69
 AR v202,a70
 AR v203,a71
 v_mul_f32 v196, v196, v246
 MM v[144:147],v[232:235],v[36:39],v[144:147]
 TR v[222:223],v14,34528
 v_mul_f32 v197, v197, v246
 v_mul_f32 v198, v198, v246
 v_mul_f32 v199, v199, v246
 MM v[148:151],v[236:239],v[28:31],v[148:151]
 TR v[224:225],v14,34560
 v_mul_f32 v200, v200, v246
 v_mul_f32 v201, v201, v246
 v_mul_f32 v202, v202, v246
 v_mul_f32 v203, v203, v246
 MM v[152:155],v[236:239],v[32:35],v[152:155]
 CV v48,v196,v197
 CV v49,v198,v199
 CV v50,v200,v201
 CV v51,v202,v203
 MM v[156:159],v[236:239],v[36:39],v[156:159]
 s_waitcnt lgkmcnt(5)
 TR v[226:227],v14,34688
 ds_write_b128 v247, v[40:43] offset:6144
 AR v196,a72
 AR v197,a73
 AR v198,a74
 AR v199,a75
 MM v[112:115],v[208:211],v[40:43],v[112:115]
 TR v[228:229],v14,34592
 AR v200,a84
 AR v201,a85
 AR v202,a86
 AR v203,a87
 v_mul_f32 v196, v196, v244
 MM v[116:119],v[208:211],v[44:47],v[116:119]
 TR v[230:231],v14,34720
 v_mul_f32 v197, v197, v244
 v_mul_f32 v198, v198, v244
 v_mul_f32 v199, v199, v244
 v_mul_f32 v200, v200, v244
 v_mul_f32 v201, v201, v244
 MM v[120:123],v[208:211],v[48:51],v[120:123]
 TR v[232:233],v14,34624
 ds_write_b128 v247, v[44:47] offset:7168
 v_mul_f32 v202, v202, v244
 v_mul_f32 v203, v203, v244
 CV v52,v196,v197
 CV v53,v198,v199
 MM v[124:127],v[212:215],v[40:43],v[124:127]
 CV v54,v200,v201
 CV v55,v202,v203
 AR v196,a76
 AR v197,a77
 AR v198,a78
 AR v199,a79
 MM v[128:131],v[212:215],v[44:47],v[128:131]
 TR v[234:235],v14,34752
 AR v200,a88
 AR v201,a89
 AR v202,a90
 AR v203,a91
 v_mul_f32 v196, v196, v245
 MM v[132:135],v[212:215],v[48:51],v[132:135]
 s_waitcnt lgkmcnt(8)
 TR v[236:237],v14,34656
 ds_write_b128 v247, v[48:51] offset:8192
 v_mul_f32 v197, v197, v245
 v_mul_f32 v198, v198, v245
 v_mul_f32 v199, v199, v245
 MM v[136:139],v[216:219],v[40:43],v[136:139]
 TR v[238:239],v14,34784
 v_mul_f32 v200, v200, v245
 v_mul_f32 v201, v201, v245
 v_mul_f32 v202, v202, v245
 v_mul_f32 v203, v203, v245
 CV v56,v196,v197
 MM v[140:143],v[216:219],v[44:47],v[140:143]
 CV v57,v198,v199
 CV v58,v200,v201
 CV v59,v202,v203
 AR v196,a80
 AR v197,a81
 AR v198,a82
 MM v[144:147],v[216:219],v[48:51],v[144:147]
 AR v199,a83
 AR v200,a92
 AR v201,a93
 AR v202,a94
 AR v203,a95
 v_mul_f32 v196, v196, v246
 MM v[148:151],v[220:223],v[40:43],v[148:151]
 v_mul_f32 v197, v197, v246
 v_mul_f32 v198, v198, v246
 v_mul_f32 v199, v199, v246
 v_mul_f32 v200, v200, v246
 v_mul_f32 v201, v201, v246
 v_mul_f32 v202, v202, v246
 MM v[152:155],v[220:223],v[44:47],v[152:155]
 v_mul_f32 v203, v203, v246
 CV v60,v196,v197
 CV v61,v198,v199
 CV v62,v200,v201
 CV v63,v202,v203
 MM v[156:159],v[220:223],v[48:51],v[156:159]
 s_waitcnt lgkmcnt(9)
 ds_write_b128 v247, v[52:55] offset:9216
 ds_write_b128 v247, v[56:59] offset:10240
 AR v196,a96
 AR v197,a97
 AR v198,a98
 AR v199,a99
 MM v[112:115],v[224:227],v[52:55],v[112:115]
 ds_write_b128 v247, v[60:63] offset:11264
 AR v200,a108
 AR v201,a109
 AR v202,a110
 AR v203,a111
 v_mul_f32 v196, v196, v244
 MM v[116:119],v[224:227],v[56:59],v[116:119]
 v_mul_f32 v197, v197, v244
 v_mul_f32 v198, v198, v244
 v_mul_f32 v199, v199, v244
 v_mul_f32 v200, v200, v244
 v_mul_f32 v201, v201, v244
 v_mul_f32 v202, v202, v244
 MM v[120:123],v[224:227],v[60:63],v[120:123]
 s_waitcnt lgkmcnt(0)
 s_barrier
 TR v[208:209],v15,0
 v_mul_f32 v203, v203, v244
 CV v64,v196,v197
 CV v65,v198,v199
 CV v66,v200,v201
 MM v[124:127],v[228:231],v[52:55],v[124:127]
 TR v[210:211],v15,128
 CV v67,v202,v203
 AR v196,a100
 AR v197,a101
 AR v198,a102
 AR v199,a103
 MM v[128:131],v[228:231],v[56:59],v[128:131]
 AR v200,a112
 AR v201,a113
 AR v202,a114
 AR v203,a115
 v_mul_f32 v196, v196, v245
 v_mul_f32 v197, v197, v245
 MM v[132:135],v[228:231],v[60:63],v[132:135]
 TR v[212:213],v15,32
 v_mul_f32 v198, v198, v245
 v_mul_f32 v199, v199, v245
 v_mul_f32 v200, v200, v245
 v_mul_f32 v201, v201, v245
 MM v[136:139],v[232:235],v[52:55],v[136:139]
 TR v[214:215],v15,160
 v_mul_f32 v202, v202, v245
 v_mul_f32 v203, v203, v245
 CV v68,v196,v197
 CV v69,v198,v199
 CV v70,v200,v201
 MM v[140:143],v[232:235],v[56:59],v[140:143]
 CV v71,v202,v203
 AR v196,a104
 AR v197,a105
 AR v198,a106
 AR v199,a107
 AR v200,a116
 MM v[144:147],v[232:235],v[60:63],v[144:147]
 TR v[216:217],v15,64
 AR v201,a117
 AR v202,a118
 AR v203,a119
 v_mul_f32 v196, v196, v246
 v_mul_f32 v197, v197, v246
 MM v[148:151],v[236:239],v[52:55],v[148:151]
 TR v[218:219],v15,192
 v_mul_f32 v198, v198, v246
 v_mul_f32 v199, v199, v246
 v_mul_f32 v200, v200, v246
 v_mul_f32 v201, v201, v246
 v_mul_f32 v202, v202, v246
 MM v[152:155],v[236:239],v[56:59],v[152:155]
 v_mul_f32 v203, v203, v246
 CV v72,v196,v197
 CV v73,v198,v199
 CV v74,v200,v201
 CV v75,v202,v203
 MM v[156:159],v[236:239],v[60:63],v[156:159]
 s_waitcnt lgkmcnt(4)
 TR v[220:221],v15,96
 AR v196,a120
 AR v197,a121
 AR v198,a122
 AR v199,a123
 AR v200,a132
 AR v201,a133
 MM v[112:115],v[208:211],v[64:67],v[112:115]
 TR v[222:223],v15,224
 ds_write_b128 v251, v[64:67] offset:0
 AR v202,a134
 AR v203,a135
 v_mul_f32 v196, v196, v244
 v_mul_f32 v197, v197, v244
 MM v[116:119],v[208:211],v[68:71],v[116:119]
 TR v[224:225],v15,256
 v_mul_f32 v198, v198, v244
 v_mul_f32 v199, v199, v244
 v_mul_f32 v200, v200, v244
 v_mul_f32 v201, v201, v244
 v_mul_f32 v202, v202, v244
 MM v[120:123],v[208:211],v[72:75],v[120:123]
 s_waitcnt lgkmcnt(6)
 TR v[226:227],v15,384
 v_mul_f32 v203, v203, v244
 CV v76,v196,v197
 CV v77,v198,v199
 CV v78,v200,v201
 CV v79,v202,v203
 MM v[124:127],v[212:215],v[64:67],v[124:127]
 ds_write_b128 v251, v[68:71] offset:1024
 AR v196,a124
 AR v197,a125
 AR v198,a126
 AR v199,a127
 AR v200,a136
 MM v[128:131],v[212:215],v[68:71],v[128:131]
 TR v[228:229],v15,288
 AR v201,a137
 AR v202,a138
 AR v203,a139
 v_mul_f32 v196, v196, v245
 v_mul_f32 v197, v197, v245
 MM v[132:135],v[212:215],v[72:75],v[132:135]
 s_waitcnt lgkmcnt(5)
 TR v[230:231],v15,416
 v_mul_f32 v198, v198, v245
 v_mul_f32 v199, v199, v245
 v_mul_f32 v200, v200, v245
 v_mul_f32 v201, v201, v245
 v_mul_f32 v202, v202, v245
 MM v[136:139],v[216:219],v[64:67],v[136:139]
 TR v[232:233],v15,320
 ds_write_b128 v251, v[72:75] offset:2048
 v_mul_f32 v203, v203, v245
 CV v80,v196,v197
 CV v81,v198,v199
 CV v82,v200,v201
 MM v[140:143],v[216:219],v[68:71],v[140:143]
 TR v[234:235],v15,448
 CV v83,v202,v203
 AR v196,a128
 AR v197,a129
 AR v198,a130
 AR v199,a131
 MM v[144:147],v[216:219],v[72:75],v[144:147]
 AR v200,a140
 AR v201,a141
 AR v202,a142
 AR v203,a143
 v_mul_f32 v196, v196, v246
 v_mul_f32 v197, v197, v246
 MM v[148:151],v[220:223],v[64:67],v[148:151]
 TR v[236:237],v15,352
 v_mul_f32 v198, v198, v246
 v_mul_f32 v199, v199, v246
 v_mul_f32 v200, v200, v246
 v_mul_f32 v201, v201, v246
 v_mul_f32 v202, v202, v246
 MM v[152:155],v[220:223],v[68:71],v[152:155]
 TR v[238:239],v15,480
 v_mul_f32 v203, v203, v246
 CV v84,v196,v197
 CV v85,v198,v199
 CV v86,v200,v201
 CV v87,v202,v203
 MM v[156:159],v[220:223],v[72:75],v[156:159]
 s_waitcnt lgkmcnt(5)
 TR v[208:209],v15,512
 ds_write_b128 v251, v[76:79] offset:3072
 AR v196,a144
 AR v197,a145
 AR v198,a146
 AR v199,a147
 MM v[112:115],v[224:227],v[76:79],v[112:115]
 TR v[210:211],v15,640
 AR v200,a156
 AR v201,a157
 AR v202,a158
 AR v203,a159
 v_mul_f32 v196, v196, v244
 MM v[116:119],v[224:227],v[80:83],v[116:119]
 ds_write_b128 v251, v[80:83] offset:4096
 v_mul_f32 v197, v197, v244
 v_mul_f32 v198, v198, v244
 v_mul_f32 v199, v199, v244
 v_mul_f32 v200, v200, v244
 v_mul_f32 v201, v201, v244
 MM v[120:123],v[224:227],v[84:87],v[120:123]
 TR v[212:213],v15,544
 v_mul_f32 v202, v202, v244
 v_mul_f32 v203, v203, v244
 CV v88,v196,v197
 CV v89,v198,v199
 CV v90,v200,v201
 MM v[124:127],v[228:231],v[76:79],v[124:127]
 TR v[214:215],v15,672
 CV v91,v202,v203
 AR v196,a148
 AR v197,a149
 AR v198,a150
 AR v199,a151
 MM v[128:131],v[228:231],v[80:83],v[128:131]
 TR v[216:217],v15,576
 AR v200,a160
 AR v201,a161
 AR v202,a162
 AR v203,a163
 v_mul_f32 v196, v196, v245
 MM v[132:135],v[228:231],v[84:87],v[132:135]
 s_waitcnt lgkmcnt(7)
 ds_write_b128 v251, v[84:87] offset:5120
 v_mul_f32 v197, v197, v245
 v_mul_f32 v198, v198, v245
 v_mul_f32 v199, v199, v245
 v_mul_f32 v200, v200, v245
 v_mul_f32 v201, v201, v245
 MM v[136:139],v[232:235],v[76:79],v[136:139]
 TR v[218:219],v15,704
 v_mul_f32 v202, v202, v245
 v_mul_f32 v203, v203, v245
 CV v92,v196,v197
 CV v93,v198,v199
 CV v94,v200,v201
 MM v[140:143],v[232:235],v[80:83],v[140:143]
 TR v[220:221],v15,608
 CV v95,v202,v203
 AR v196,a152
 AR v197,a153
 AR v198,a154
 AR v199,a155
 MM v[144:147],v[232:235],v[84:87],v[144:147]
 TR v[222:223],v15,736
 AR v200,a164
 AR v201,a165
 AR v202,a166
 AR v203,a167
 v_mul_f32 v196, v196, v246
 MM v[148:151],v[236:239],v[76:79],v[148:151]
 TR v[224:225],v15,768
 v_mul_f32 v197, v197, v246
 v_mul_f32 v198, v198, v246
 v_mul_f32 v199, v199, v246
 v_mul_f32 v200, v200, v246
 v_mul_f32 v201, v201, v246
 MM v[152:155],v[236:239],v[80:83],v[152:155]
 v_mul_f32 v202, v202, v246
 v_mul_f32 v203, v203, v246
 CV v96,v196,v197
 CV v97,v198,v199
 CV v98,v200,v201
 CV v99,v202,v203
 MM v[156:159],v[236:239],v[84:87],v[156:159]
 s_waitcnt lgkmcnt(6)
 TR v[226:227],v15,896
 ds_write_b128 v251, v[88:91] offset:6144
 AR v196,a168
 AR v197,a169
 AR v198,a170
 AR v199,a171
 MM v[112:115],v[208:211],v[88:91],v[112:115]
 TR v[228:229],v15,800
 AR v200,a180
 AR v201,a181
 AR v202,a182
 AR v203,a183
 v_mul_f32 v196, v196, v244
 MM v[116:119],v[208:211],v[92:95],v[116:119]
 TR v[230:231],v15,928
 v_mul_f32 v197, v197, v244
 v_mul_f32 v198, v198, v244
 v_mul_f32 v199, v199, v244
 v_mul_f32 v200, v200, v244
 v_mul_f32 v201, v201, v244
 MM v[120:123],v[208:211],v[96:99],v[120:123]
 TR v[232:233],v15,832
 ds_write_b128 v251, v[92:95] offset:7168
 v_mul_f32 v202, v202, v244
 v_mul_f32 v203, v203, v244
 CV v100,v196,v197
 CV v101,v198,v199
 MM v[124:127],v[212:215],v[88:91],v[124:127]
 CV v102,v200,v201
 CV v103,v202,v203
 AR v196,a172
 AR v197,a173
 AR v198,a174
 AR v199,a175
 MM v[128:131],v[212:215],v[92:95],v[128:131]
 TR v[234:235],v15,960
 AR v200,a184
 AR v201,a185
 AR v202,a186
 AR v203,a187
 v_mul_f32 v196, v196, v245
 MM v[132:135],v[212:215],v[96:99],v[132:135]
 s_waitcnt lgkmcnt(8)
 TR v[236:237],v15,864
 ds_write_b128 v251, v[96:99] offset:8192
 v_mul_f32 v197, v197, v245
 v_mul_f32 v198, v198, v245
 v_mul_f32 v199, v199, v245
 MM v[136:139],v[216:219],v[88:91],v[136:139]
 TR v[238:239],v15,992
 v_mul_f32 v200, v200, v245
 v_mul_f32 v201, v201, v245
 v_mul_f32 v202, v202, v245
 v_mul_f32 v203, v203, v245
 CV v104,v196,v197
 MM v[140:143],v[216:219],v[92:95],v[140:143]
 CV v105,v198,v199
 CV v106,v200,v201
 CV v107,v202,v203
 AR v196,a176
 AR v197,a177
 AR v198,a178
 MM v[144:147],v[216:219],v[96:99],v[144:147]
 AR v199,a179
 AR v200,a188
 AR v201,a189
 AR v202,a190
 AR v203,a191
 v_mul_f32 v196, v196, v246
 MM v[148:151],v[220:223],v[88:91],v[148:151]
 v_mul_f32 v197, v197, v246
 v_mul_f32 v198, v198, v246
 v_mul_f32 v199, v199, v246
 v_mul_f32 v200, v200, v246
 v_mul_f32 v201, v201, v246
 v_mul_f32 v202, v202, v246
 MM v[152:155],v[220:223],v[92:95],v[152:155]
 v_mul_f32 v203, v203, v246
 CV v108,v196,v197
 CV v109,v198,v199
 CV v110,v200,v201
 CV v111,v202,v203
 MM v[156:159],v[220:223],v[96:99],v[156:159]
 s_waitcnt lgkmcnt(9)
 ds_write_b128 v251, v[100:103] offset:9216
 ds_write_b128 v251, v[104:107] offset:10240
 MM v[112:115],v[224:227],v[100:103],v[112:115]
 ds_write_b128 v251, v[108:111] offset:11264
 MM v[116:119],v[224:227],v[104:107],v[116:119]
 MM v[120:123],v[224:227],v[108:111],v[120:123]
 s_waitcnt lgkmcnt(0)
 s_barrier
 TR v[208:209],v14,0
 ds_read_b128 v[160:163], v247 offset:0
 MM v[124:127],v[228:231],v[100:103],v[124:127]
 TR v[210:211],v14,128
 ds_read_b128 v[164:167], v247 offset:1024
 ds_read_b128 v[168:171], v247 offset:2048
 MM v[128:131],v[228:231],v[104:107],v[128:131]
 ds_read_b128 v[172:175], v247 offset:3072
 ds_read_b128 v[176:179], v247 offset:4096
 ds_read_b128 v[180:183], v247 offset:5120
 MM v[132:135],v[228:231],v[108:111],v[132:135]
 TR v[212:213],v14,32
 ds_read_b128 v[184:187], v247 offset:6144
 ds_read_b128 v[188:191], v247 offset:7168
 MM v[136:139],v[232:235],v[100:103],v[136:139]
 TR v[214:215],v14,160
 ds_read_b128 v[192:195], v247 offset:8192
 ds_read_b128 v[196:199], v247 offset:9216
 MM v[140:143],v[232:235],v[104:107],v[140:143]
 ds_read_b128 v[200:203], v247 offset:10240
 ds_read_b128 v[204:207], v247 offset:11264
 MM v[144:147],v[232:235],v[108:111],v[144:147]
 TR v[216:217],v14,64
 MM v[148:151],v[236:239],v[100:103],v[148:151]
 TR v[218:219],v14,192
 MM v[152:155],v[236:239],v[104:107],v[152:155]
 MM v[156:159],v[236:239],v[108:111],v[156:159]
 s_waitcnt lgkmcnt(15)
 s_waitcnt lgkmcnt(13)
 TR v[220:221],v14,96
 MM v[160:163],v[208:211],v[16:19],v[160:163]
 TR v[222:223],v14,224
 MM v[164:167],v[208:211],v[20:23],v[164:167]
 TR v[224:225],v14,256
 MM v[168:171],v[208:211],v[24:27],v[168:171]
 s_waitcnt lgkmcnt(9)
 TR v[226:227],v14,384
 CV v112,v112,v113
 MM v[172:175],v[212:215],v[16:19],v[172:175]
 MM v[176:179],v[212:215],v[20:23],v[176:179]
 TR v[228:229],v14,288
 CV v113,v114,v115
 MM v[180:183],v[212:215],v[24:27],v[180:183]
 s_waitcnt lgkmcnt(3)
 TR v[230:231],v14,416
 MM v[184:187],v[216:219],v[16:19],v[184:187]
 TR v[232:233],v14,320
 CV v114,v124,v125
 MM v[188:191],v[216:219],v[20:23],v[188:191]
 TR v[234:235],v14,448
 MM v[192:195],v[216:219],v[24:27],v[192:195]
 MM v[196:199],v[220:223],v[16:19],v[196:199]
 TR v[236:237],v14,352
 CV v115,v126,v127
 MM v[200:203],v[220:223],v[20:23],v[200:203]
 TR v[238:239],v14,480
 MM v[204:207],v[220:223],v[24:27],v[204:207]
 s_waitcnt lgkmcnt(4)
 TR v[208:209],v14,512
 buffer_store_dwordx4 v[112:115], v250, s[60:63], s83 offen offset:0 sc1
 MM v[160:163],v[224:227],v[28:31],v[160:163]
 TR v[210:211],v14,640
 MM v[164:167],v[224:227],v[32:35],v[164:167]
 MM v[168:171],v[224:227],v[36:39],v[168:171]
 TR v[212:213],v14,544
 CV v116,v116,v117
 MM v[172:175],v[228:231],v[28:31],v[172:175]
 TR v[214:215],v14,672
 MM v[176:179],v[228:231],v[32:35],v[176:179]
 TR v[216:217],v14,576
 CV v117,v118,v119
 MM v[180:183],v[228:231],v[36:39],v[180:183]
 s_waitcnt lgkmcnt(5)
 MM v[184:187],v[232:235],v[28:31],v[184:187]
 TR v[218:219],v14,704
 MM v[188:191],v[232:235],v[32:35],v[188:191]
 TR v[220:221],v14,608
 CV v118,v128,v129
 MM v[192:195],v[232:235],v[36:39],v[192:195]
 TR v[222:223],v14,736
 MM v[196:199],v[236:239],v[28:31],v[196:199]
 TR v[224:225],v14,768
 CV v119,v130,v131
 MM v[200:203],v[236:239],v[32:35],v[200:203]
 MM v[204:207],v[236:239],v[36:39],v[204:207]
 s_waitcnt lgkmcnt(5)
 TR v[226:227],v14,896
 buffer_store_dwordx4 v[116:119], v250, s[60:63], s83 offen offset:1024 sc1
 MM v[160:163],v[208:211],v[40:43],v[160:163]
 TR v[228:229],v14,800
 MM v[164:167],v[208:211],v[44:47],v[164:167]
 TR v[230:231],v14,928
 MM v[168:171],v[208:211],v[48:51],v[168:171]
 TR v[232:233],v14,832
 CV v120,v120,v121
 MM v[172:175],v[212:215],v[40:43],v[172:175]
 MM v[176:179],v[212:215],v[44:47],v[176:179]
 TR v[234:235],v14,960
 CV v121,v122,v123
 MM v[180:183],v[212:215],v[48:51],v[180:183]
 s_waitcnt lgkmcnt(6)
 TR v[236:237],v14,864
 MM v[184:187],v[216:219],v[40:43],v[184:187]
 TR v[238:239],v14,992
 MM v[188:191],v[216:219],v[44:47],v[188:191]
 CV v122,v132,v133
 MM v[192:195],v[216:219],v[48:51],v[192:195]
 MM v[196:199],v[220:223],v[40:43],v[196:199]
 CV v123,v134,v135
 MM v[200:203],v[220:223],v[44:47],v[200:203]
 MM v[204:207],v[220:223],v[48:51],v[204:207]
 s_waitcnt lgkmcnt(6)
 buffer_store_dwordx4 v[120:123], v250, s[60:63], s83 offen offset:2048 sc1
 MM v[160:163],v[224:227],v[52:55],v[160:163]
 MM v[164:167],v[224:227],v[56:59],v[164:167]
 CV v136,v136,v137
 MM v[168:171],v[224:227],v[60:63],v[168:171]
 s_waitcnt lgkmcnt(0)
 s_barrier
 TR v[208:209],v15,16896
 MM v[172:175],v[228:231],v[52:55],v[172:175]
 TR v[210:211],v15,17024
 MM v[176:179],v[228:231],v[56:59],v[176:179]
 CV v137,v138,v139
 MM v[180:183],v[228:231],v[60:63],v[180:183]
 TR v[212:213],v15,16928
 MM v[184:187],v[232:235],v[52:55],v[184:187]
 TR v[214:215],v15,17056
 CV v138,v148,v149
 MM v[188:191],v[232:235],v[56:59],v[188:191]
 MM v[192:195],v[232:235],v[60:63],v[192:195]
 TR v[216:217],v15,16960
 CV v139,v150,v151
 MM v[196:199],v[236:239],v[52:55],v[196:199]
 TR v[218:219],v15,17088
 MM v[200:203],v[236:239],v[56:59],v[200:203]
 buffer_store_dwordx4 v[136:139], v250, s[60:63], s84 offen offset:0 sc1
 MM v[204:207],v[236:239],v[60:63],v[204:207]
 s_waitcnt lgkmcnt(4)
 TR v[220:221],v15,16992
 MM v[160:163],v[208:211],v[64:67],v[160:163]
 TR v[222:223],v15,17120
 MM v[164:167],v[208:211],v[68:71],v[164:167]
 TR v[224:225],v15,17152
 CV v140,v140,v141
 MM v[168:171],v[208:211],v[72:75],v[168:171]
 s_waitcnt lgkmcnt(5)
 TR v[226:227],v15,17280
 MM v[172:175],v[212:215],v[64:67],v[172:175]
 CV v141,v142,v143
 MM v[176:179],v[212:215],v[68:71],v[176:179]
 TR v[228:229],v15,17184
 MM v[180:183],v[212:215],v[72:75],v[180:183]
 s_waitcnt lgkmcnt(3)
 TR v[230:231],v15,17312
 MM v[184:187],v[216:219],v[64:67],v[184:187]
 TR v[232:233],v15,17216
 CV v142,v152,v153
 MM v[188:191],v[216:219],v[68:71],v[188:191]
 TR v[234:235],v15,17344
 MM v[192:195],v[216:219],v[72:75],v[192:195]
 CV v143,v154,v155
 MM v[196:199],v[220:223],v[64:67],v[196:199]
 TR v[236:237],v15,17248
 MM v[200:203],v[220:223],v[68:71],v[200:203]
 TR v[238:239],v15,17376
 MM v[204:207],v[220:223],v[72:75],v[204:207]
 s_waitcnt lgkmcnt(4)
 TR v[208:209],v15,17408
 buffer_store_dwordx4 v[140:143], v250, s[60:63], s84 offen offset:1024 sc1
 MM v[160:163],v[224:227],v[76:79],v[160:163]
 TR v[210:211],v15,17536
 MM v[164:167],v[224:227],v[80:83],v[164:167]
 CV v144,v144,v145
 MM v[168:171],v[224:227],v[84:87],v[168:171]
 TR v[212:213],v15,17440
 MM v[172:175],v[228:231],v[76:79],v[172:175]
 TR v[214:215],v15,17568
 MM v[176:179],v[228:231],v[80:83],v[176:179]
 TR v[216:217],v15,17472
 CV v145,v146,v147
 MM v[180:183],v[228:231],v[84:87],v[180:183]
 s_waitcnt lgkmcnt(5)
 MM v[184:187],v[232:235],v[76:79],v[184:187]
 TR v[218:219],v15,17600
 CV v146,v156,v157
 MM v[188:191],v[232:235],v[80:83],v[188:191]
 TR v[220:221],v15,17504
 MM v[192:195],v[232:235],v[84:87],v[192:195]
 TR v[222:223],v15,17632
 MM v[196:199],v[236:239],v[76:79],v[196:199]
 TR v[224:225],v15,17664
 CV v147,v158,v159
 MM v[200:203],v[236:239],v[80:83],v[200:203]
 MM v[204:207],v[236:239],v[84:87],v[204:207]
 s_waitcnt lgkmcnt(5)
 TR v[226:227],v15,17792
 buffer_store_dwordx4 v[144:147], v250, s[60:63], s84 offen offset:2048 sc1
 MM v[160:163],v[208:211],v[88:91],v[160:163]
 TR v[228:229],v15,17696
 MM v[164:167],v[208:211],v[92:95],v[164:167]
 TR v[230:231],v15,17824
 MM v[168:171],v[208:211],v[96:99],v[168:171]
 TR v[232:233],v15,17728
 MM v[172:175],v[212:215],v[88:91],v[172:175]
 MM v[176:179],v[212:215],v[92:95],v[176:179]
 TR v[234:235],v15,17856
 MM v[180:183],v[212:215],v[96:99],v[180:183]
 s_waitcnt lgkmcnt(6)
 TR v[236:237],v15,17760
 MM v[184:187],v[216:219],v[88:91],v[184:187]
 TR v[238:239],v15,17888
 MM v[188:191],v[216:219],v[92:95],v[188:191]
 MM v[192:195],v[216:219],v[96:99],v[192:195]
 MM v[196:199],v[220:223],v[88:91],v[196:199]
 s_add_u32 s83, s83, 6144
 s_cmp_ge_u32 s83, 43008
 s_cselect_b32 s88, 43008, 0
 s_sub_u32 s83, s83, s88
 s_add_u32 s84, s83, 3072
 MM v[200:203],v[220:223],v[92:95],v[200:203]
 MM v[204:207],v[220:223],v[96:99],v[204:207]
 s_waitcnt lgkmcnt(6)
 MM v[160:163],v[224:227],v[100:103],v[160:163]
 MM v[164:167],v[224:227],v[104:107],v[164:167]
 MM v[168:171],v[224:227],v[108:111],v[168:171]
 s_waitcnt lgkmcnt(0)
 s_barrier
 TR v[208:209],v14,33792
 ds_read_b128 v[112:115], v251 offset:0
 MM v[172:175],v[228:231],v[100:103],v[172:175]
 TR v[210:211],v14,33920
 ds_read_b128 v[116:119], v251 offset:1024
 ds_read_b128 v[120:123], v251 offset:2048
 MM v[176:179],v[228:231],v[104:107],v[176:179]
 ds_read_b128 v[124:127], v251 offset:3072
 ds_read_b128 v[128:131], v251 offset:4096
 ds_read_b128 v[132:135], v251 offset:5120
 MM v[180:183],v[228:231],v[108:111],v[180:183]
 TR v[212:213],v14,33824
 ds_read_b128 v[136:139], v251 offset:6144
 ds_read_b128 v[140:143], v251 offset:7168
 MM v[184:187],v[232:235],v[100:103],v[184:187]
 TR v[214:215],v14,33952
 ds_read_b128 v[144:147], v251 offset:8192
 ds_read_b128 v[148:151], v251 offset:9216
 MM v[188:191],v[232:235],v[104:107],v[188:191]
 ds_read_b128 v[152:155], v251 offset:10240
 ds_read_b128 v[156:159], v251 offset:11264
 MM v[192:195],v[232:235],v[108:111],v[192:195]
 TR v[216:217],v14,33856
 MM v[196:199],v[236:239],v[100:103],v[196:199]
 TR v[218:219],v14,33984
 MM v[200:203],v[236:239],v[104:107],v[200:203]
 MM v[204:207],v[236:239],v[108:111],v[204:207]
 s_waitcnt lgkmcnt(15)
 s_waitcnt lgkmcnt(13)
 TR v[220:221],v14,33888
 MM v[112:115],v[208:211],v[16:19],v[112:115]
 TR v[222:223],v14,34016
 MM v[116:119],v[208:211],v[20:23],v[116:119]
 TR v[224:225],v14,34048
 MM v[120:123],v[208:211],v[24:27],v[120:123]
 s_waitcnt lgkmcnt(9)
 TR v[226:227],v14,34176
 CV v160,v160,v161
 MM v[124:127],v[212:215],v[16:19],v[124:127]
 MM v[128:131],v[212:215],v[20:23],v[128:131]
 TR v[228:229],v14,34080
 CV v161,v162,v163
 MM v[132:135],v[212:215],v[24:27],v[132:135]
 s_waitcnt lgkmcnt(3)
 TR v[230:231],v14,34208
 MM v[136:139],v[216:219],v[16:19],v[136:139]
 TR v[232:233],v14,34112
 CV v162,v172,v173
 MM v[140:143],v[216:219],v[20:23],v[140:143]
 TR v[234:235],v14,34240
 MM v[144:147],v[216:219],v[24:27],v[144:147]
 MM v[148:151],v[220:223],v[16:19],v[148:151]
 TR v[236:237],v14,34144
 CV v163,v174,v175
 MM v[152:155],v[220:223],v[20:23],v[152:155]
 TR v[238:239],v14,34272
 MM v[156:159],v[220:223],v[24:27],v[156:159]
 s_waitcnt lgkmcnt(4)
 TR v[208:209],v14,34304
 buffer_store_dwordx4 v[160:163], v250, s[60:63], s83 offen offset:0 sc1
 MM v[112:115],v[224:227],v[28:31],v[112:115]
 TR v[210:211],v14,34432
 MM v[116:119],v[224:227],v[32:35],v[116:119]
 MM v[120:123],v[224:227],v[36:39],v[120:123]
 TR v[212:213],v14,34336
 CV v164,v164,v165
 MM v[124:127],v[228:231],v[28:31],v[124:127]
 TR v[214:215],v14,34464
 MM v[128:131],v[228:231],v[32:35],v[128:131]
 TR v[216:217],v14,34368
 CV v165,v166,v167
 MM v[132:135],v[228:231],v[36:39],v[132:135]
 s_waitcnt lgkmcnt(5)
 MM v[136:139],v[232:235],v[28:31],v[136:139]
 TR v[218:219],v14,34496
 MM v[140:143],v[232:235],v[32:35],v[140:143]
 TR v[220:221],v14,34400
 CV v166,v176,v177
 MM v[144:147],v[232:235],v[36:39],v[144:147]
 TR v[222:223],v14,34528
 MM v[148:151],v[236:239],v[28:31],v[148:151]
 TR v[224:225],v14,34560
 CV v167,v178,v179
 MM v[152:155],v[236:239],v[32:35],v[152:155]
 MM v[156:159],v[236:239],v[36:39],v[156:159]
 s_waitcnt lgkmcnt(5)
 TR v[226:227],v14,34688
 buffer_store_dwordx4 v[164:167], v250, s[60:63], s83 offen offset:1024 sc1
 MM v[112:115],v[208:211],v[40:43],v[112:115]
 TR v[228:229],v14,34592
 MM v[116:119],v[208:211],v[44:47],v[116:119]
 TR v[230:231],v14,34720
 MM v[120:123],v[208:211],v[48:51],v[120:123]
 TR v[232:233],v14,34624
 CV v168,v168,v169
 MM v[124:127],v[212:215],v[40:43],v[124:127]
 MM v[128:131],v[212:215],v[44:47],v[128:131]
 TR v[234:235],v14,34752
 CV v169,v170,v171
 MM v[132:135],v[212:215],v[48:51],v[132:135]
 s_waitcnt lgkmcnt(6)
 TR v[236:237],v14,34656
 MM v[136:139],v[216:219],v[40:43],v[136:139]
 TR v[238:239],v14,34784
 MM v[140:143],v[216:219],v[44:47],v[140:143]
 CV v170,v180,v181
 MM v[144:147],v[216:219],v[48:51],v[144:147]
 MM v[148:151],v[220:223],v[40:43],v[148:151]
 CV v171,v182,v183
 MM v[152:155],v[220:223],v[44:47],v[152:155]
 MM v[156:159],v[220:223],v[48:51],v[156:159]
 s_waitcnt lgkmcnt(6)
 buffer_store_dwordx4 v[168:171], v250, s[60:63], s83 offen offset:2048 sc1
 MM v[112:115],v[224:227],v[52:55],v[112:115]
 MM v[116:119],v[224:227],v[56:59],v[116:119]
 CV v184,v184,v185
 MM v[120:123],v[224:227],v[60:63],v[120:123]
 s_waitcnt lgkmcnt(0)
 s_barrier
 TR v[208:209],v15,0
 MM v[124:127],v[228:231],v[52:55],v[124:127]
 TR v[210:211],v15,128
 MM v[128:131],v[228:231],v[56:59],v[128:131]
 CV v185,v186,v187
 MM v[132:135],v[228:231],v[60:63],v[132:135]
 TR v[212:213],v15,32
 MM v[136:139],v[232:235],v[52:55],v[136:139]
 TR v[214:215],v15,160
 CV v186,v196,v197
 MM v[140:143],v[232:235],v[56:59],v[140:143]
 MM v[144:147],v[232:235],v[60:63],v[144:147]
 TR v[216:217],v15,64
 CV v187,v198,v199
 MM v[148:151],v[236:239],v[52:55],v[148:151]
 TR v[218:219],v15,192
 MM v[152:155],v[236:239],v[56:59],v[152:155]
 buffer_store_dwordx4 v[184:187], v250, s[60:63], s84 offen offset:0 sc1
 MM v[156:159],v[236:239],v[60:63],v[156:159]
 s_waitcnt lgkmcnt(4)
 TR v[220:221],v15,96
 MM v[112:115],v[208:211],v[64:67],v[112:115]
 TR v[222:223],v15,224
 MM v[116:119],v[208:211],v[68:71],v[116:119]
 TR v[224:225],v15,256
 CV v188,v188,v189
 MM v[120:123],v[208:211],v[72:75],v[120:123]
 s_waitcnt lgkmcnt(5)
 TR v[226:227],v15,384
 MM v[124:127],v[212:215],v[64:67],v[124:127]
 CV v189,v190,v191
 MM v[128:131],v[212:215],v[68:71],v[128:131]
 TR v[228:229],v15,288
 MM v[132:135],v[212:215],v[72:75],v[132:135]
 s_waitcnt lgkmcnt(3)
 TR v[230:231],v15,416
 MM v[136:139],v[216:219],v[64:67],v[136:139]
 TR v[232:233],v15,320
 CV v190,v200,v201
 MM v[140:143],v[216:219],v[68:71],v[140:143]
 TR v[234:235],v15,448
 MM v[144:147],v[216:219],v[72:75],v[144:147]
 CV v191,v202,v203
 MM v[148:151],v[220:223],v[64:67],v[148:151]
 TR v[236:237],v15,352
 MM v[152:155],v[220:223],v[68:71],v[152:155]
 TR v[238:239],v15,480
 MM v[156:159],v[220:223],v[72:75],v[156:159]
 s_waitcnt lgkmcnt(4)
 TR v[208:209],v15,512
 buffer_store_dwordx4 v[188:191], v250, s[60:63], s84 offen offset:1024 sc1
 MM v[112:115],v[224:227],v[76:79],v[112:115]
 TR v[210:211],v15,640
 MM v[116:119],v[224:227],v[80:83],v[116:119]
 CV v192,v192,v193
 MM v[120:123],v[224:227],v[84:87],v[120:123]
 TR v[212:213],v15,544
 MM v[124:127],v[228:231],v[76:79],v[124:127]
 TR v[214:215],v15,672
 MM v[128:131],v[228:231],v[80:83],v[128:131]
 TR v[216:217],v15,576
 CV v193,v194,v195
 MM v[132:135],v[228:231],v[84:87],v[132:135]
 s_waitcnt lgkmcnt(5)
 MM v[136:139],v[232:235],v[76:79],v[136:139]
 TR v[218:219],v15,704
 CV v194,v204,v205
 MM v[140:143],v[232:235],v[80:83],v[140:143]
 TR v[220:221],v15,608
 MM v[144:147],v[232:235],v[84:87],v[144:147]
 TR v[222:223],v15,736
 MM v[148:151],v[236:239],v[76:79],v[148:151]
 TR v[224:225],v15,768
 CV v195,v206,v207
 MM v[152:155],v[236:239],v[80:83],v[152:155]
 MM v[156:159],v[236:239],v[84:87],v[156:159]
 s_waitcnt lgkmcnt(5)
 TR v[226:227],v15,896
 buffer_store_dwordx4 v[192:195], v250, s[60:63], s84 offen offset:2048 sc1
 MM v[112:115],v[208:211],v[88:91],v[112:115]
 TR v[228:229],v15,800
 MM v[116:119],v[208:211],v[92:95],v[116:119]
 TR v[230:231],v15,928
 MM v[120:123],v[208:211],v[96:99],v[120:123]
 TR v[232:233],v15,832
 MM v[124:127],v[212:215],v[88:91],v[124:127]
 MM v[128:131],v[212:215],v[92:95],v[128:131]
 TR v[234:235],v15,960
 MM v[132:135],v[212:215],v[96:99],v[132:135]
 s_waitcnt lgkmcnt(6)
 TR v[236:237],v15,864
 MM v[136:139],v[216:219],v[88:91],v[136:139]
 TR v[238:239],v15,992
 MM v[140:143],v[216:219],v[92:95],v[140:143]
 MM v[144:147],v[216:219],v[96:99],v[144:147]
 MM v[148:151],v[220:223],v[88:91],v[148:151]
 s_add_u32 s83, s83, 6144
 s_cmp_ge_u32 s83, 43008
 s_cselect_b32 s88, 43008, 0
 s_sub_u32 s83, s83, s88
 s_add_u32 s84, s83, 3072
 MM v[152:155],v[220:223],v[92:95],v[152:155]
 MM v[156:159],v[220:223],v[96:99],v[156:159]
 s_waitcnt lgkmcnt(6)
 MM v[112:115],v[224:227],v[100:103],v[112:115]
 MM v[116:119],v[224:227],v[104:107],v[116:119]
 MM v[120:123],v[224:227],v[108:111],v[120:123]
 s_waitcnt lgkmcnt(0)
 s_barrier
 TR v[208:209],v15,33792
 ds_read_b128 v[160:163], v251 offset:0
 MM v[124:127],v[228:231],v[100:103],v[124:127]
 TR v[210:211],v15,33920
 ds_read_b128 v[164:167], v251 offset:1024
 ds_read_b128 v[168:171], v251 offset:2048
 MM v[128:131],v[228:231],v[104:107],v[128:131]
 ds_read_b128 v[172:175], v251 offset:3072
 ds_read_b128 v[176:179], v251 offset:4096
 ds_read_b128 v[180:183], v251 offset:5120
 MM v[132:135],v[228:231],v[108:111],v[132:135]
 TR v[212:213],v15,33824
 ds_read_b128 v[184:187], v251 offset:6144
 ds_read_b128 v[188:191], v251 offset:7168
 MM v[136:139],v[232:235],v[100:103],v[136:139]
 TR v[214:215],v15,33952
 ds_read_b128 v[192:195], v251 offset:8192
 ds_read_b128 v[196:199], v251 offset:9216
 MM v[140:143],v[232:235],v[104:107],v[140:143]
 ds_read_b128 v[200:203], v251 offset:10240
 ds_read_b128 v[204:207], v251 offset:11264
 MM v[144:147],v[232:235],v[108:111],v[144:147]
 TR v[216:217],v15,33856
 MM v[148:151],v[236:239],v[100:103],v[148:151]
 TR v[218:219],v15,33984
 MM v[152:155],v[236:239],v[104:107],v[152:155]
 MM v[156:159],v[236:239],v[108:111],v[156:159]
 s_waitcnt lgkmcnt(15)
 s_waitcnt lgkmcnt(13)
 TR v[220:221],v15,33888
 MM v[160:163],v[208:211],v[16:19],v[160:163]
 TR v[222:223],v15,34016
 MM v[164:167],v[208:211],v[20:23],v[164:167]
 TR v[224:225],v15,34048
 MM v[168:171],v[208:211],v[24:27],v[168:171]
 s_waitcnt lgkmcnt(9)
 TR v[226:227],v15,34176
 CV v112,v112,v113
 MM v[172:175],v[212:215],v[16:19],v[172:175]
 MM v[176:179],v[212:215],v[20:23],v[176:179]
 TR v[228:229],v15,34080
 CV v113,v114,v115
 MM v[180:183],v[212:215],v[24:27],v[180:183]
 s_waitcnt lgkmcnt(3)
 TR v[230:231],v15,34208
 MM v[184:187],v[216:219],v[16:19],v[184:187]
 TR v[232:233],v15,34112
 CV v114,v124,v125
 MM v[188:191],v[216:219],v[20:23],v[188:191]
 TR v[234:235],v15,34240
 MM v[192:195],v[216:219],v[24:27],v[192:195]
 MM v[196:199],v[220:223],v[16:19],v[196:199]
 TR v[236:237],v15,34144
 CV v115,v126,v127
 MM v[200:203],v[220:223],v[20:23],v[200:203]
 TR v[238:239],v15,34272
 MM v[204:207],v[220:223],v[24:27],v[204:207]
 s_waitcnt lgkmcnt(4)
 TR v[208:209],v15,34304
 buffer_store_dwordx4 v[112:115], v250, s[60:63], s83 offen offset:0 sc1
 MM v[160:163],v[224:227],v[28:31],v[160:163]
 TR v[210:211],v15,34432
 MM v[164:167],v[224:227],v[32:35],v[164:167]
 MM v[168:171],v[224:227],v[36:39],v[168:171]
 TR v[212:213],v15,34336
 CV v116,v116,v117
 MM v[172:175],v[228:231],v[28:31],v[172:175]
 TR v[214:215],v15,34464
 MM v[176:179],v[228:231],v[32:35],v[176:179]
 TR v[216:217],v15,34368
 CV v117,v118,v119
 MM v[180:183],v[228:231],v[36:39],v[180:183]
 s_waitcnt lgkmcnt(5)
 MM v[184:187],v[232:235],v[28:31],v[184:187]
 TR v[218:219],v15,34496
 MM v[188:191],v[232:235],v[32:35],v[188:191]
 TR v[220:221],v15,34400
 CV v118,v128,v129
 MM v[192:195],v[232:235],v[36:39],v[192:195]
 TR v[222:223],v15,34528
 MM v[196:199],v[236:239],v[28:31],v[196:199]
 TR v[224:225],v15,34560
 CV v119,v130,v131
 MM v[200:203],v[236:239],v[32:35],v[200:203]
 MM v[204:207],v[236:239],v[36:39],v[204:207]
 s_waitcnt lgkmcnt(5)
 TR v[226:227],v15,34688
 buffer_store_dwordx4 v[116:119], v250, s[60:63], s83 offen offset:1024 sc1
 MM v[160:163],v[208:211],v[40:43],v[160:163]
 TR v[228:229],v15,34592
 MM v[164:167],v[208:211],v[44:47],v[164:167]
 TR v[230:231],v15,34720
 MM v[168:171],v[208:211],v[48:51],v[168:171]
 TR v[232:233],v15,34624
 CV v120,v120,v121
 MM v[172:175],v[212:215],v[40:43],v[172:175]
 MM v[176:179],v[212:215],v[44:47],v[176:179]
 TR v[234:235],v15,34752
 CV v121,v122,v123
 MM v[180:183],v[212:215],v[48:51],v[180:183]
 s_waitcnt lgkmcnt(6)
 TR v[236:237],v15,34656
 MM v[184:187],v[216:219],v[40:43],v[184:187]
 TR v[238:239],v15,34784
 MM v[188:191],v[216:219],v[44:47],v[188:191]
 CV v122,v132,v133
 MM v[192:195],v[216:219],v[48:51],v[192:195]
 MM v[196:199],v[220:223],v[40:43],v[196:199]
 CV v123,v134,v135
 MM v[200:203],v[220:223],v[44:47],v[200:203]
 MM v[204:207],v[220:223],v[48:51],v[204:207]
 s_waitcnt lgkmcnt(6)
 buffer_store_dwordx4 v[120:123], v250, s[60:63], s83 offen offset:2048 sc1
 MM v[160:163],v[224:227],v[52:55],v[160:163]
 MM v[164:167],v[224:227],v[56:59],v[164:167]
 CV v136,v136,v137
 MM v[168:171],v[224:227],v[60:63],v[168:171]
 s_waitcnt lgkmcnt(0)
 s_barrier
 TR v[208:209],v15,16896
 MM v[172:175],v[228:231],v[52:55],v[172:175]
 TR v[210:211],v15,17024
 MM v[176:179],v[228:231],v[56:59],v[176:179]
 CV v137,v138,v139
 MM v[180:183],v[228:231],v[60:63],v[180:183]
 TR v[212:213],v15,16928
 MM v[184:187],v[232:235],v[52:55],v[184:187]
 TR v[214:215],v15,17056
 CV v138,v148,v149
 MM v[188:191],v[232:235],v[56:59],v[188:191]
 MM v[192:195],v[232:235],v[60:63],v[192:195]
 TR v[216:217],v15,16960
 CV v139,v150,v151
 MM v[196:199],v[236:239],v[52:55],v[196:199]
 TR v[218:219],v15,17088
 MM v[200:203],v[236:239],v[56:59],v[200:203]
 buffer_store_dwordx4 v[136:139], v250, s[60:63], s84 offen offset:0 sc1
 MM v[204:207],v[236:239],v[60:63],v[204:207]
 s_waitcnt lgkmcnt(4)
 TR v[220:221],v15,16992
 MM v[160:163],v[208:211],v[64:67],v[160:163]
 TR v[222:223],v15,17120
 MM v[164:167],v[208:211],v[68:71],v[164:167]
 TR v[224:225],v15,17152
 CV v140,v140,v141
 MM v[168:171],v[208:211],v[72:75],v[168:171]
 s_waitcnt lgkmcnt(5)
 TR v[226:227],v15,17280
 MM v[172:175],v[212:215],v[64:67],v[172:175]
 CV v141,v142,v143
 MM v[176:179],v[212:215],v[68:71],v[176:179]
 TR v[228:229],v15,17184
 MM v[180:183],v[212:215],v[72:75],v[180:183]
 s_waitcnt lgkmcnt(3)
 TR v[230:231],v15,17312
 MM v[184:187],v[216:219],v[64:67],v[184:187]
 TR v[232:233],v15,17216
 CV v142,v152,v153
 MM v[188:191],v[216:219],v[68:71],v[188:191]
 TR v[234:235],v15,17344
 MM v[192:195],v[216:219],v[72:75],v[192:195]
 CV v143,v154,v155
 MM v[196:199],v[220:223],v[64:67],v[196:199]
 TR v[236:237],v15,17248
 MM v[200:203],v[220:223],v[68:71],v[200:203]
 TR v[238:239],v15,17376
 MM v[204:207],v[220:223],v[72:75],v[204:207]
 s_waitcnt lgkmcnt(4)
 TR v[208:209],v15,17408
 buffer_store_dwordx4 v[140:143], v250, s[60:63], s84 offen offset:1024 sc1
 MM v[160:163],v[224:227],v[76:79],v[160:163]
 TR v[210:211],v15,17536
 MM v[164:167],v[224:227],v[80:83],v[164:167]
 CV v144,v144,v145
 MM v[168:171],v[224:227],v[84:87],v[168:171]
 TR v[212:213],v15,17440
 MM v[172:175],v[228:231],v[76:79],v[172:175]
 TR v[214:215],v15,17568
 MM v[176:179],v[228:231],v[80:83],v[176:179]
 TR v[216:217],v15,17472
 CV v145,v146,v147
 MM v[180:183],v[228:231],v[84:87],v[180:183]
 s_waitcnt lgkmcnt(5)
 MM v[184:187],v[232:235],v[76:79],v[184:187]
 TR v[218:219],v15,17600
 CV v146,v156,v157
 MM v[188:191],v[232:235],v[80:83],v[188:191]
 TR v[220:221],v15,17504
 MM v[192:195],v[232:235],v[84:87],v[192:195]
 TR v[222:223],v15,17632
 MM v[196:199],v[236:239],v[76:79],v[196:199]
 TR v[224:225],v15,17664
 CV v147,v158,v159
 MM v[200:203],v[236:239],v[80:83],v[200:203]
 MM v[204:207],v[236:239],v[84:87],v[204:207]
 s_waitcnt lgkmcnt(5)
 TR v[226:227],v15,17792
 buffer_store_dwordx4 v[144:147], v250, s[60:63], s84 offen offset:2048 sc1
 MM v[160:163],v[208:211],v[88:91],v[160:163]
 TR v[228:229],v15,17696
 MM v[164:167],v[208:211],v[92:95],v[164:167]
 TR v[230:231],v15,17824
 MM v[168:171],v[208:211],v[96:99],v[168:171]
 TR v[232:233],v15,17728
 MM v[172:175],v[212:215],v[88:91],v[172:175]
 MM v[176:179],v[212:215],v[92:95],v[176:179]
 TR v[234:235],v15,17856
 MM v[180:183],v[212:215],v[96:99],v[180:183]
 s_waitcnt lgkmcnt(6)
 TR v[236:237],v15,17760
 MM v[184:187],v[216:219],v[88:91],v[184:187]
 TR v[238:239],v15,17888
 MM v[188:191],v[216:219],v[92:95],v[188:191]
 MM v[192:195],v[216:219],v[96:99],v[192:195]
 MM v[196:199],v[220:223],v[88:91],v[196:199]
 s_add_u32 s83, s83, 6144
 s_cmp_ge_u32 s83, 43008
 s_cselect_b32 s88, 43008, 0
 s_sub_u32 s83, s83, s88
 s_add_u32 s84, s83, 3072
 MM v[200:203],v[220:223],v[92:95],v[200:203]
 MM v[204:207],v[220:223],v[96:99],v[204:207]
 s_waitcnt lgkmcnt(6)
 MM v[160:163],v[224:227],v[100:103],v[160:163]
 MM v[164:167],v[224:227],v[104:107],v[164:167]
 MM v[168:171],v[224:227],v[108:111],v[168:171]
 MM v[172:175],v[228:231],v[100:103],v[172:175]
 MM v[176:179],v[228:231],v[104:107],v[176:179]
 MM v[180:183],v[228:231],v[108:111],v[180:183]
 MM v[184:187],v[232:235],v[100:103],v[184:187]
 MM v[188:191],v[232:235],v[104:107],v[188:191]
 MM v[192:195],v[232:235],v[108:111],v[192:195]
 MM v[196:199],v[236:239],v[100:103],v[196:199]
 MM v[200:203],v[236:239],v[104:107],v[200:203]
 MM v[204:207],v[236:239],v[108:111],v[204:207]
 CV v160,v160,v161
 CV v161,v162,v163
 CV v162,v172,v173
 CV v163,v174,v175
 buffer_store_dwordx4 v[160:163], v250, s[60:63], s83 offen offset:0 sc1
 CV v164,v164,v165
 CV v165,v166,v167
 CV v166,v176,v177
 CV v167,v178,v179
 buffer_store_dwordx4 v[164:167], v250, s[60:63], s83 offen offset:1024 sc1
 CV v168,v168,v169
 CV v169,v170,v171
 CV v170,v180,v181
 CV v171,v182,v183
 buffer_store_dwordx4 v[168:171], v250, s[60:63], s83 offen offset:2048 sc1
 CV v184,v184,v185
 CV v185,v186,v187
 CV v186,v196,v197
 CV v187,v198,v199
 buffer_store_dwordx4 v[184:187], v250, s[60:63], s84 offen offset:0 sc1
 CV v188,v188,v189
 CV v189,v190,v191
 CV v190,v200,v201
 CV v191,v202,v203
 buffer_store_dwordx4 v[188:191], v250, s[60:63], s84 offen offset:1024 sc1
 CV v192,v192,v193
 CV v193,v194,v195
 CV v194,v204,v205
 CV v195,v206,v207
 buffer_store_dwordx4 v[192:195], v250, s[60:63], s84 offen offset:2048 sc1
 s_add_u32 s83, s83, 6144
 s_cmp_ge_u32 s83, 43008
 s_cselect_b32 s88, 43008, 0
 s_sub_u32 s83, s83, s88
 s_add_u32 s84, s83, 3072
 s_branch L_tailB
LB1_t0:
 s_call_b64 s[86:87], L_rare1
 s_branch LB1_r0
LB1_t1:
 s_call_b64 s[86:87], L_rare0
 s_branch LB1_r1
LB1_t28:
 s_call_b64 s[86:87], L_rare1
 s_branch LB1_r28
LB1_t29:
 s_call_b64 s[86:87], L_rare0
 s_branch LB1_r29
LB1_t30:
 s_call_b64 s[86:87], L_rare1
 s_branch LB1_r30
L_codeend:
.section .rodata,"a"
.p2align 6
.amdhsa_kernel concat_heads__gqa_block_cached__mha_block_cached__near_ridge_kernel
  .amdhsa_next_free_vgpr 512
  .amdhsa_next_free_sgpr 102
  .amdhsa_accum_offset 256
  .amdhsa_group_segment_fixed_size 0
  .amdhsa_kernarg_size 104
  .amdhsa_user_sgpr_count 2
  .amdhsa_user_sgpr_kernarg_segment_ptr 1
  .amdhsa_system_sgpr_workgroup_id_x 1
.end_amdhsa_kernel
```
